```python
import torch

def _softmax(x, axis=-1):
    return torch.softmax(x, dim=axis)
def _gelu(x):
    return torch.nn.functional.gelu(x, approximate="tanh")
def _silu(x):
    return torch.nn.functional.silu(x)
def _sigmoid(x):
    return torch.sigmoid(x)
def _layernorm(x, axis=-1, eps=1e-5):
    m = x.mean(dim=axis, keepdim=True)
    v = x.var(dim=axis, keepdim=True, unbiased=False)
    return (x - m) / torch.sqrt(v + eps)
def _scatter_add(tgt, idx, src, axis=0):
    return tgt.clone().index_add_(axis, idx, src)
def _segment_sum(src, seg, n):
    out = torch.zeros((n,) + src.shape[1:], dtype=src.dtype)
    return out.index_add_(0, seg, src)
def _pad(x, pw):
    flat = tuple(v for pair in reversed(pw) for v in pair)
    return torch.nn.functional.pad(x, flat)

kernel_name = 'recurrent_scan__linear_kernel_hedgehog__glu_gated_geglu__prompt'

def setup_inputs():

    _w = (lambda a: (lambda t: t.to(torch.bfloat16) if t.is_floating_point() else t)(torch.as_tensor(a)))
    def _A_setup():
        B, S, D, H = 1, 2048, 640, 32
        Dh = D // H
        return {
            "x": _w((lambda *s: torch.randn(*s, dtype=torch.bfloat16) * 0.05)(B, S, D)),
            "wqkv": _w((lambda *s: torch.randn(*s, dtype=torch.bfloat16) * 0.8)(D, 3 * D)),
            "w_phi": _w((lambda *s: torch.randn(*s, dtype=torch.bfloat16) * 0.8)(H, Dh, Dh) * (Dh ** -0.5)),
            "wo": _w((lambda *s: torch.randn(*s, dtype=torch.bfloat16) * 0.8)(D, D)),
        }
    _A_in = _A_setup()

    def _B_setup():
        B, S, Dm, Df = 1, 2048, 640, 1728
        return {
            "x": _w((lambda *s: torch.randn(*s, dtype=torch.bfloat16) * 0.05)(B, S, Dm)),
            "w_gate": _w((lambda *s: torch.randn(*s, dtype=torch.bfloat16) * 0.2)(Dm, Df) * (Dm ** -0.5)),
            "w_up": _w((lambda *s: torch.randn(*s, dtype=torch.bfloat16) * 0.2)(Dm, Df) * (Dm ** -0.5)),
            "w_down": _w((lambda *s: torch.randn(*s, dtype=torch.bfloat16) * 0.2)(Df, Dm) * (Df ** -0.5)),
        }
    _B_in = _B_setup()

    return {
        "A_x": _A_in["x"],
        "A_wqkv": _A_in["wqkv"],
        "A_w_phi": _A_in["w_phi"],
        "A_wo": _A_in["wo"],
        "B_x": _B_in["x"],
        "B_w_gate": _B_in["w_gate"],
        "B_w_up": _B_in["w_up"],
        "B_w_down": _B_in["w_down"],
    }

def reference(A_x, A_wqkv, A_w_phi, A_wo, B_x, B_w_gate, B_w_up, B_w_down):
    def _A_ref(x, wqkv, w_phi, wo):
        B, S, D = x.shape
        H = 32; Dh = D // H
        qkv = (lambda x, *d: x.permute(*d))((x @ wqkv).reshape(B, S, 3, H, Dh), 2, 0, 3, 1, 4)
        q, k, v = qkv[0], qkv[1], qkv[2]
        pq = torch.einsum("bhsd,hdf->bhsf", q, w_phi)
        pk = torch.einsum("bhsd,hdf->bhsf", k, w_phi)
        phi_q = torch.concatenate([_softmax(pq, axis=-1), _softmax(-pq, axis=-1)], axis=-1)
        phi_k = torch.concatenate([_softmax(pk, axis=-1), _softmax(-pk, axis=-1)], axis=-1)
        kv = torch.einsum("bhsf,bhsd->bhfd", phi_k, v)
        z  = torch.einsum("bhsf->bhf", phi_k)
        num = torch.einsum("bhqf,bhfd->bhqd", phi_q, kv)
        den = torch.einsum("bhqf,bhf->bhq", phi_q, z)[..., None] + 1e-6
        o = num / den
        return (lambda x, *d: x.permute(*d))(o, 0, 2, 1, 3).reshape(B, S, D) @ wo

    def _B_ref(x, w_gate, w_up, w_down):
        g = torch.einsum("bsd,df->bsf", x, w_gate)
        u = torch.einsum("bsd,df->bsf", x, w_up)
        h = _gelu(g) * u
        return torch.einsum("bsf,fd->bsd", h, w_down)

    x = A_x
    xn = _layernorm(x, axis=-1)
    s = _A_ref(xn, A_wqkv, A_w_phi, A_wo)
    g = _silu(_B_ref(xn, B_w_gate, B_w_up, B_w_down))
    return x + s * g
```

```asm
; @launch grid=(256,1,1) block=(256,1,1) lds=163840
.amdgcn_target "amdgcn-amd-amdhsa--gfx950"
.text
.globl recurrent_scan__linear_kernel_hedgehog__glu_gated_geglu__prompt_kernel
.p2align 8
.type recurrent_scan__linear_kernel_hedgehog__glu_gated_geglu__prompt_kernel,@function
recurrent_scan__linear_kernel_hedgehog__glu_gated_geglu__prompt_kernel:
    s_cmp_ge_u32 s2, 256
    s_cbranch_scc1 KP_end
    s_load_dwordx4 s[28:31], s[0:1], 0
    s_load_dwordx4 s[32:35], s[0:1], 40
    s_load_dwordx2 s[36:37], s[0:1], 80
    s_getpc_b64 s[4:5]
K1_pf:
    s_mov_b32 s6, CODE_END-K1_pf
    s_mov_b32 s7, 0x20000
    s_lshr_b32 s8, s2, 3
    s_lshl_b32 s8, s8, 12
    v_lshlrev_b32 v1, 4, v0
    buffer_load_dwordx4 a[252:255], v1, s[4:7], s8 offen
    v_lshrrev_b32 v1, 6, v0
    v_and_b32 v0, 63, v0
    v_readfirstlane_b32 s40, v1
    s_bfe_u32 s73, s2, 0x30003
    s_and_b32 s72, s2, 1
    s_lshl_b32 s41, s72, 3
    s_add_u32 s41, s41, s73
    s_lshr_b32 s74, s2, 6
    s_lshl_b32 s42, s41, 2
    s_add_u32 s42, s42, s40
    s_lshl_b32 s66, s40, 12
    s_mul_i32 s49, s42, 40960
    s_add_u32 s45, s49, 18432
    v_lshrrev_b32 v1, 3, v0
    v_and_b32 v2, 7, v0
    v_lshrrev_b32 v4, 4, v0
    v_xor_b32 v4, v2, v4
    v_mul_u32_u24 v5, 1280, v1
    v_lshl_add_u32 v204, v4, 4, v5
    v_xor_b32 v4, 64, v204
    v_add_u32 v205, 9216, v4
    s_cmp_lt_u32 s2, 128
    s_mov_b32 s59, 98304
    s_cselect_b32 s59, 61440, s59
    s_add_u32 s59, s59, s66
    s_mov_b32 m0, s59
    s_mov_b32 s26, 2621440
    s_mov_b32 s27, 0x20000
    s_and_b32 s75, s2, 6
    s_and_b32 s76, s74, 1
    s_add_u32 s44, s75, s76
    v_bfe_u32 v3, v0, 4, 1
    v_lshlrev_b32 v3, 1, v3
    v_xor_b32 v2, v2, v3
    v_lshlrev_b32 v2, 4, v2
    s_waitcnt lgkmcnt(0)
    s_mov_b32 s24, s28
    s_mov_b32 s25, s29
    buffer_load_dwordx4 v204, s[24:27], s49 offen offset:0 lds
    buffer_load_dwordx4 v205, s[24:27], s49 offen offset:1024 lds
    buffer_load_dwordx4 v204, s[24:27], s45 offen offset:2048 lds
    buffer_load_dwordx4 v205, s[24:27], s45 offen offset:3072 lds
    s_cmp_lt_u32 s2, 128
    s_cbranch_scc1 K1_kv
    s_cmp_lt_u32 s44, 5
    s_cbranch_scc1 K1_q
    v_mul_u32_u24 v3, 3456, v1
    v_add_u32 v200, v3, v2
    v_xor_b32 v3, 64, v200
    v_add_u32 v201, 26624, v3
    s_mov_b32 s4, s32
    s_mov_b32 s5, s33
    s_mov_b32 s6, 2211840
    s_mov_b32 s7, 0x20000
    s_sub_u32 s8, s34, 2048
    s_subb_u32 s9, s35, 0
    s_mov_b32 s10, 2213888
    s_mov_b32 s11, 0x20000
    s_lshl_b32 s77, s44, 1
    s_sub_u32 s77, s77, 5
    s_lshl_b32 s71, s77, 7
    s_mul_i32 s46, s40, 55296
    s_add_u32 s46, s46, s71
    s_and_b32 s50, s71, 0xffffff80
    s_add_u32 m0, s66, 65536
    s_nop 0
    buffer_load_dwordx4 v200, s[4:7], s46 offen offset:0 lds
    buffer_load_dwordx4 v201, s[4:7], s46 offen offset:1024 lds
    buffer_load_dwordx4 v200, s[8:11], s46 offen offset:2048 lds
    buffer_load_dwordx4 v201, s[8:11], s46 offen offset:3072 lds
    s_add_u32 s46, s46, 221184
    s_mul_i32 s70, s42, 10
    v_mov_b32 v3, 1073741824
    v_add_u32 v4, s70, v0
    v_cmp_gt_u32 vcc, 10, v0
    v_mul_u32_u24 v4, 3456, v4
    s_nop 0
    v_cndmask_b32 v206, v3, v4, vcc
    buffer_load_dword a211, v206, s[4:7], s50 offen
    buffer_load_dword a246, v206, s[8:11], s50 offen offset:2048
    v_lshrrev_b32 v6, 4, v0
    v_mul_u32_u24 v6, 1280, v6
    v_and_b32 v7, 15, v0
    v_lshl_add_u32 v247, v7, 4, v6
    s_lshl_b32 s64, s41, 3
    s_add_u32 s64, s64, s44
    s_lshl_b32 s64, s64, 2
    s_add_u32 s64, s64, s40
    s_lshl_b32 s69, s64, 5
    s_add_u32 s69, s69, 19671040
    s_mul_i32 s64, s64, 5120
    buffer_load_dwordx4 v[224:227], v247, s[24:27], s64 offen offset:0
    buffer_load_dwordx4 v[228:231], v247, s[24:27], s64 offen offset:256
    buffer_load_dwordx4 v[232:235], v247, s[24:27], s64 offen offset:512
    buffer_load_dwordx4 v[236:239], v247, s[24:27], s64 offen offset:768
    buffer_load_dwordx4 v[240:243], v247, s[24:27], s64 offen offset:1024
    s_and_b32 s3, s74, 2
    s_lshl_b32 s3, s3, 2
    s_add_u32 s3, s3, s44
    s_add_u32 s49, s49, 128
    s_add_u32 s45, s49, 18432
    s_mov_b32 s20, s36
    s_mov_b32 s21, s37
    s_mov_b32 s22, 19972096
    s_mov_b32 s23, 0x20000
    s_add_u32 s36, s36, 19447808
    s_addc_u32 s37, s37, 0
    s_load_dword s38, s[36:37], 0
    s_load_dwordx2 s[28:29], s[0:1], 16
    s_load_dwordx2 s[30:31], s[0:1], 64
    s_load_dwordx2 s[96:97], s[0:1], 24
    s_load_dwordx2 s[98:99], s[0:1], 56
    v_lshlrev_b32 v209, 4, v0
    v_bfe_u32 v1, v0, 4, 1
    v_bfe_u32 v2, v0, 2, 2
    v_lshl_add_u32 v3, v1, 3, v2
    v_lshrrev_b32 v4, 5, v0
    v_and_b32 v5, 3, v0
    v_lshlrev_b32 v5, 3, v5
    v_bfe_u32 v2, v0, 3, 2
    v_xor_b32 v2, s40, v2
    v_lshl_add_u32 v2, v2, 5, v5
    v_lshl_add_u32 v2, v3, 7, v2
    v_lshl_add_u32 v64, v4, 12, v2
    v_xor_b32 v65, 32, v64
    v_xor_b32 v66, 64, v64
    v_xor_b32 v67, 96, v64
    v_xor_b32 v68, 65536, v64
    v_xor_b32 v69, 65536, v65
    v_xor_b32 v70, 65536, v66
    v_xor_b32 v71, 65536, v67
    v_xor_b32 v2, s40, v1
    v_lshl_add_u32 v2, v2, 1, v4
    v_and_b32 v5, 15, v0
    v_lshlrev_b32 v6, 4, v5
    v_lshl_add_u32 v152, v2, 9, v6
    v_xor_b32 v153, 2048, v152
    v_lshrrev_b32 v2, 4, v0
    v_bfe_u32 v3, v0, 1, 3
    v_xor_b32 v2, v2, v3
    v_lshlrev_b32 v2, 4, v2
    v_lshl_add_u32 v2, v5, 7, v2
    v_add_u32 v144, s59, v2
    v_xor_b32 v145, 64, v144
    v_mov_b32 v146, 0x3f803f80
    v_lshrrev_b32 v2, 4, v0
    v_lshlrev_b32 v2, 2, v2
    v_cmp_eq_u32 vcc, v5, v2
    v_lshlrev_b32 v1, 5, v0
    v_add_u32 v1, 143360, v1
    v_lshl_add_u32 v156, s40, 3, v1
    v_lshl_add_u32 v157, s40, 11, v1
    v_cndmask_b32 v148, 0, v146, vcc
    v_cndmask_b32 v149, 0, v146, vcc
    v_cndmask_b32 v150, 0, v146, vcc
    v_cndmask_b32 v151, 0, v146, vcc
    v_mov_b32 v90, v0
    s_waitcnt vmcnt(7) lgkmcnt(0)
    s_barrier
    ds_read_b128 a[0:3], v144 offset:0
    ds_read_b128 a[4:7], v144 offset:2048
    ds_read_b128 a[8:11], v145 offset:0
    ds_read_b128 a[12:15], v145 offset:2048
    ds_read_b64_tr_b16 v[160:161], v68 offset:0
    ds_read_b64_tr_b16 v[162:163], v68 offset:512
    ds_read_b64_tr_b16 v[164:165], v69 offset:0
    ds_read_b64_tr_b16 v[166:167], v69 offset:512
    ds_read_b64_tr_b16 v[168:169], v70 offset:0
    ds_read_b64_tr_b16 v[170:171], v70 offset:512
    ds_read_b64_tr_b16 v[172:173], v71 offset:0
    ds_read_b64_tr_b16 v[174:175], v71 offset:512
    ds_read_b64_tr_b16 v[176:177], v68 offset:2048
    ds_read_b64_tr_b16 v[178:179], v68 offset:2560
    ds_read_b64_tr_b16 v[180:181], v69 offset:2048
    ds_read_b64_tr_b16 v[182:183], v69 offset:2560
    ds_read_b64_tr_b16 v[184:185], v70 offset:2048
    ds_read_b64_tr_b16 v[186:187], v70 offset:2560
    s_add_u32 m0, s66, 81920
    s_waitcnt lgkmcnt(6)
    v_mfma_f32_16x16x32_bf16 v[0:3], v[160:163], a[0:3], 0
    buffer_load_dwordx4 v200, s[4:7], s46 offen offset:0 lds
    v_mfma_f32_16x16x32_bf16 v[4:7], v[160:163], a[4:7], 0
    ds_read_b64_tr_b16 v[188:189], v71 offset:2048
    v_mfma_f32_16x16x32_bf16 a[248:251], v[148:151], v[160:163], 0
    ds_read_b64_tr_b16 v[190:191], v71 offset:2560
    v_mfma_f32_16x16x32_bf16 v[8:11], v[164:167], a[0:3], 0
    buffer_load_dwordx4 v201, s[4:7], s46 offen offset:1024 lds
    ds_read_b64_tr_b16 v[192:193], v68 offset:8192
    v_mfma_f32_16x16x32_bf16 v[12:15], v[164:167], a[4:7], 0
    ds_read_b64_tr_b16 v[194:195], v68 offset:8704
    ds_read_b64_tr_b16 v[196:197], v69 offset:8192
    v_mfma_f32_16x16x32_bf16 v[16:19], v[168:171], a[0:3], 0
    buffer_load_dwordx4 v200, s[8:11], s46 offen offset:2048 lds
    v_mfma_f32_16x16x32_bf16 v[20:23], v[168:171], a[4:7], 0
    ds_read_b64_tr_b16 v[198:199], v69 offset:8704
    ds_read_b64_tr_b16 v[160:161], v70 offset:8192
    v_mfma_f32_16x16x32_bf16 v[24:27], v[172:175], a[0:3], 0
    buffer_load_dwordx4 v201, s[8:11], s46 offen offset:3072 lds
    ds_read_b64_tr_b16 v[162:163], v70 offset:8704
    v_mfma_f32_16x16x32_bf16 v[28:31], v[172:175], a[4:7], 0
    ds_read_b64_tr_b16 v[164:165], v71 offset:8192
    s_add_u32 s46, s46, 221184
    s_add_u32 m0, s59, 16384
    s_waitcnt lgkmcnt(7)
    v_mfma_f32_16x16x32_bf16 v[32:35], v[176:179], a[0:3], 0
    buffer_load_dwordx4 v204, s[24:27], s49 offen offset:0 lds
    v_mfma_f32_16x16x32_bf16 v[36:39], v[176:179], a[4:7], 0
    ds_read_b64_tr_b16 v[166:167], v71 offset:8704
    v_mfma_f32_16x16x32_bf16 a[252:255], v[148:151], v[176:179], 0
    ds_read_b64_tr_b16 v[168:169], v68 offset:10240
    ds_read_b64_tr_b16 v[170:171], v68 offset:10752
    v_mfma_f32_16x16x32_bf16 v[40:43], v[180:183], a[0:3], 0
    buffer_load_dwordx4 v205, s[24:27], s49 offen offset:1024 lds
    v_mfma_f32_16x16x32_bf16 v[44:47], v[180:183], a[4:7], 0
    ds_read_b64_tr_b16 v[172:173], v69 offset:10240
    ds_read_b64_tr_b16 v[174:175], v69 offset:10752
    v_mfma_f32_16x16x32_bf16 v[48:51], v[184:187], a[0:3], 0
    buffer_load_dwordx4 v204, s[24:27], s45 offen offset:2048 lds
    v_mfma_f32_16x16x32_bf16 v[52:55], v[184:187], a[4:7], 0
    ds_read_b64_tr_b16 v[176:177], v70 offset:10240
    ds_read_b64_tr_b16 v[178:179], v70 offset:10752
    v_mfma_f32_16x16x32_bf16 v[56:59], v[188:191], a[0:3], 0
    buffer_load_dwordx4 v205, s[24:27], s45 offen offset:3072 lds
    ds_read_b64_tr_b16 v[180:181], v71 offset:10240
    ds_read_b64_tr_b16 v[182:183], v71 offset:10752
    v_mfma_f32_16x16x32_bf16 v[60:63], v[188:191], a[4:7], 0
    s_add_u32 s49, s49, 128
    s_add_u32 s45, s49, 18432
    s_add_u32 m0, s66, 0
    s_waitcnt lgkmcnt(8)
    v_mfma_f32_16x16x32_bf16 v[0:3], v[192:195], a[8:11], v[0:3]
    v_mfma_f32_16x16x32_bf16 v[4:7], v[192:195], a[12:15], v[4:7]
    v_mfma_f32_16x16x32_bf16 a[248:251], v[148:151], v[192:195], a[248:251]
    buffer_load_dwordx4 v200, s[4:7], s46 offen offset:0 lds
    s_mul_i32 s60, s42, 110592
    s_lshl_b32 s79, s77, 12
    s_add_u32 s60, s60, s79
    s_add_u32 s60, s60, 2621440
    s_add_u32 s77, s77, 1
    s_lshl_b32 s71, s77, 7
    s_mul_i32 s47, s40, 55296
    s_add_u32 s47, s47, s71
    s_and_b32 s51, s71, 0xffffff80
    s_mul_i32 s61, s42, 110592
    s_lshl_b32 s79, s77, 12
    s_add_u32 s61, s61, s79
    s_add_u32 s61, s61, 2621440
    s_add_u32 s77, s44, 19
    s_lshl_b32 s65, s77, 7
    s_sub_u32 s65, s65, s71
    s_mul_i32 s62, s42, 110592
    s_lshl_b32 s79, s77, 12
    s_add_u32 s62, s62, s79
    s_add_u32 s62, s62, 2621440
    s_mul_i32 s58, s40, 5120
    s_mov_b32 s53, s28
    s_mov_b32 s57, s29
    s_mul_i32 s38, s38, 0x9E3779B1
    s_add_u32 s38, s38, 0x7F4A7C15
    v_mov_b32 v80, s38
    v_mov_b32 v81, 1073741824
    v_cmp_eq_u32 vcc, 0, v90
    v_bfe_u32 v82, v209, 1, 8
    v_and_b32 v91, 15, v90
    v_cndmask_b32 v81, v81, v90, vcc
    v_cmp_eq_u32 vcc, 0, v91
    v_lshrrev_b32 v91, 1, v90
    v_mov_b32 v246, 1073741824
    v_mov_b32 v244, 0
    v_mov_b32 v245, 0
    v_cndmask_b32 v246, v246, v91, vcc
    s_lshl_b32 s70, s40, 10
    s_and_b32 s75, s2, 7
    s_lshl_b32 s75, s75, 1
    s_bfe_u32 s71, s2, 0x10003
    s_add_u32 s75, s75, s71
    s_and_b32 s70, s70, 1024
    s_mul_i32 s100, s75, 1600
    s_add_u32 s100, s100, s70
    v_lshrrev_b32 v92, 5, v209
    v_min_u32 v92, 18, v92
    s_mul_i32 s70, s40, 6
    v_add_u32 v91, s70, v92
    v_min_u32 v91, 21, v91
    v_add_u32 v91, 20, v91
    s_lshl_b32 s70, s40, 3
    s_add_u32 s70, s70, 36
    v_add_u32 v93, s70, v92
    v_cmp_lt_u32 vcc, 5, v92
    s_nop 1
    v_cndmask_b32 v91, v91, v93, vcc
    s_mul_i32 s70, s40, 5
    s_sub_u32 s70, s70, 14
    v_add_u32 v93, s70, v92
    v_cmp_lt_u32 vcc, 13, v92
    s_nop 1
    v_cndmask_b32 v91, v91, v93, vcc
    v_cndmask_b32 v92, 1, 0, vcc
    v_mad_u32_u24 v91, v91, 10, v92
    v_bfe_u32 v92, v209, 4, 1
    s_mul_i32 s70, s2, 257
    s_bfe_u32 s70, s70, 0x30006
    s_mul_i32 s70, s70, 5
    s_lshr_b32 s70, s70, 2
    v_add3_u32 v91, v91, v92, s70
    v_mul_u32_u24 v91, 21846, v91
    v_lshrrev_b32 v91, 16, v91
    v_lshlrev_b32 v91, 4, v91
    v_accvgpr_write_b32 a212, v91
    s_lshl_b32 s1, s2, 2
    s_add_u32 s1, s1, 19448832
    s_cmp_eq_u32 s40, 0
    s_cselect_b32 s1, s1, 1073741824
    s_lshr_b32 s70, s2, 4
    s_lshl_b32 s70, s70, 2
    s_add_u32 s70, s70, s40
    s_lshl_b32 s36, s70, 7
    s_add_u32 s36, s36, 19646464
    s_mul_i32 s76, s70, 40960
    s_mul_i32 s71, s75, 2560
    s_add_u32 s76, s76, s71
    s_add_u32 s76, s76, 9699328
    s_lshr_b32 s28, s70, 1
    s_lshl_b32 s28, s28, 4
    s_add_u32 s28, s28, s75
    s_lshl_b32 s28, s28, 7
    s_and_b32 s70, s40, 1
    s_lshl_b32 s70, s70, 2
    s_add_u32 s70, s70, 19447808
    s_add_u32 s28, s28, s70
    s_add_u32 s28, s28, 133120
    s_lshl_b32 s77, s75, 2
    s_add_u32 s77, s77, s40
    s_lshl_b32 s33, s77, 7
    s_add_u32 s33, s33, 19687424
    s_lshl_b32 s77, s77, 10
    s_add_u32 s77, s77, 18857984
    s_cmp_lt_u32 s40, 3
    s_cselect_b32 s35, 12, 4
    s_lshr_b32 s43, s42, 1
    s_lshl_b32 s43, s43, 4
    s_add_u32 s43, s43, s3
    s_lshl_b32 s43, s43, 7
    s_add_u32 s43, s43, s70
    s_add_u32 s43, s43, 2048
    s_lshl_b32 s67, s42, 8
    s_add_u32 s67, s67, 19671040
    s_add_u32 s48, s47, 221184
    s_add_u32 s51, s47, 442368
    s_add_u32 s52, s47, 663552
    s_add_u32 s55, s47, 884736
    s_add_u32 s56, s47, 1105920
    s_add_u32 s41, s47, 1327104
    s_add_u32 s42, s47, 1548288
    s_add_u32 s44, s47, 1769472
    s_add_u32 s3, s47, 1990656
    s_mul_i32 s68, s2, 257
    s_bfe_u32 s68, s68, 0x30006
    s_mul_i32 s0, s68, 378880
    s_add_u32 s0, s0, 14942208
    s_mul_i32 s75, s58, 6
    s_add_u32 s75, s75, s0
    s_add_u32 s75, s75, 102400
    s_lshl_b32 s101, s58, 3
    s_add_u32 s101, s101, s0
    s_add_u32 s101, s101, 215040
    s_mul_i32 s68, s58, 5
    s_add_u32 s0, s0, s68
    v_lshrrev_b32 v91, 4, v90
    v_mul_u32_u24 v91, 3072, v91
    v_bfe_u32 v92, v90, 2, 2
    v_lshl_add_u32 v91, v92, 7, v91
    v_bfe_u32 v92, v90, 3, 1
    v_bfe_u32 v93, v90, 1, 1
    v_xor_b32 v92, v92, v93
    v_lshl_add_u32 v91, v92, 4, v91
    v_and_b32 v92, 1, v90
    v_lshl_add_u32 v91, v92, 3, v91
    v_lshl_add_u32 v91, s40, 5, v91
    v_add_u32 v104, 49152, v91
    v_xor_b32 v105, 32, v104
    s_cmp_lt_u32 s2, 67
    s_cselect_b32 s96, s96, s98
    s_cselect_b32 s97, s97, s99
    s_mov_b32 s98, 2211840
    s_cselect_b32 s98, 819200, s98
    s_mov_b32 s99, 0x20000
    s_cselect_b32 s29, 0, 67
    s_cselect_b32 s79, 0, 100
    s_cselect_b32 s63, 20, 54
    s_sub_u32 s29, s2, s29
    s_mul_i32 s29, s29, 3
    s_add_u32 s79, s79, s40
    v_add_u32 v91, s29, v90
    v_mul_u32_u24 v92, 6554, v91
    v_lshrrev_b32 v92, 16, v92
    v_mul_u32_u24 v93, 10, v92
    v_sub_u32 v91, v91, v93
    v_cmp_gt_u32 vcc, s63, v92
    v_lshl_add_u32 v93, v91, 2, s40
    v_mul_u32_u24 v93, 52, v93
    v_lshrrev_b32 v93, 8, v93
    v_mul_u32_u24 v93, 365, v93
    v_lshl_add_u32 v93, v91, 2, v93
    v_mad_u32_u24 v93, v92, 5, v93
    v_add_u32 v93, s79, v93
    v_lshlrev_b32 v93, 10, v93
    v_add_u32 v93, 14942208, v93
    v_mov_b32 v94, 1073741824
    v_cndmask_b32 v93, v94, v93, vcc
    v_lshl_add_u32 v92, v92, 2, s40
    v_mul_u32_u24 v92, 10240, v92
    v_lshl_add_u32 v92, v91, 7, v92
    v_readlane_b32 s68, v93, 0
    v_readlane_b32 s63, v92, 0
    v_readlane_b32 s37, v93, 1
    v_readlane_b32 s78, v92, 1
    v_readlane_b32 s54, v93, 2
    v_readlane_b32 s32, v92, 2
    s_lshl_b32 s29, s2, 4
    s_add_u32 s29, s29, 19695616
    s_cmp_eq_u32 s40, 0
    s_cselect_b32 s29, s29, 1073741824
    s_mul_i32 s79, s40, 3072
    s_bfe_u32 s70, s2, 0x10006
    s_and_b32 s71, s2, 6
    s_add_u32 s71, s71, s70
    s_lshl_b32 s34, s71, 8
    s_sub_u32 s34, s34, 640
    s_add_u32 s70, s34, 128
    s_lshl_b32 s71, s71, 7
    s_add_u32 s71, s71, 2432
    s_mov_b32 s39, 20000
    v_mfma_f32_16x16x32_bf16 v[8:11], v[196:199], a[8:11], v[8:11]
    v_mfma_f32_16x16x32_bf16 v[12:15], v[196:199], a[12:15], v[12:15]
    s_waitcnt vmcnt(1) lgkmcnt(0)
    s_barrier
    v_mfma_f32_16x16x32_bf16 v[16:19], v[160:163], a[8:11], v[16:19]
    buffer_load_dwordx4 v201, s[4:7], s46 offen offset:1024 lds
    ds_read_b128 a[16:19], v144 offset:16384
    v_mfma_f32_16x16x32_bf16 v[20:23], v[160:163], a[12:15], v[20:23]
    ds_read_b64_tr_b16 v[184:185], v68 offset:16384
    ds_read_b64_tr_b16 v[186:187], v68 offset:16896
    ds_read_b64_tr_b16 v[188:189], v69 offset:16384
    v_mfma_f32_16x16x32_bf16 v[24:27], v[164:167], a[8:11], v[24:27]
    buffer_load_dwordx4 v200, s[8:11], s46 offen offset:2048 lds
    ds_read_b128 a[20:23], v144 offset:18432
    v_mfma_f32_16x16x32_bf16 v[28:31], v[164:167], a[12:15], v[28:31]
    ds_read_b64_tr_b16 v[190:191], v69 offset:16896
    ds_read_b64_tr_b16 v[192:193], v70 offset:16384
    v_mfma_f32_16x16x32_bf16 v[32:35], v[168:171], a[8:11], v[32:35]
    buffer_load_dwordx4 v201, s[8:11], s46 offen offset:3072 lds
    ds_read_b128 a[24:27], v145 offset:16384
    v_mfma_f32_16x16x32_bf16 v[36:39], v[168:171], a[12:15], v[36:39]
    ds_read_b64_tr_b16 v[194:195], v70 offset:16896
    ds_read_b64_tr_b16 v[196:197], v71 offset:16384
    v_mfma_f32_16x16x32_bf16 a[252:255], v[148:151], v[168:171], a[252:255]
    s_add_u32 s46, s46, 221184
    s_add_u32 m0, s59, 32768
    v_mfma_f32_16x16x32_bf16 v[40:43], v[172:175], a[8:11], v[40:43]
    buffer_load_dwordx4 v204, s[24:27], s49 offen offset:0 lds
    ds_read_b128 a[28:31], v145 offset:18432
    v_mfma_f32_16x16x32_bf16 v[44:47], v[172:175], a[12:15], v[44:47]
    ds_read_b64_tr_b16 v[198:199], v71 offset:16896
    ds_read_b64_tr_b16 v[160:161], v68 offset:18432
    ds_read_b64_tr_b16 v[162:163], v68 offset:18944
    v_mfma_f32_16x16x32_bf16 v[48:51], v[176:179], a[8:11], v[48:51]
    buffer_load_dwordx4 v205, s[24:27], s49 offen offset:1024 lds
    v_mfma_f32_16x16x32_bf16 v[52:55], v[176:179], a[12:15], v[52:55]
    ds_read_b64_tr_b16 v[164:165], v69 offset:18432
    ds_read_b64_tr_b16 v[166:167], v69 offset:18944
    v_mfma_f32_16x16x32_bf16 v[56:59], v[180:183], a[8:11], v[56:59]
    buffer_load_dwordx4 v204, s[24:27], s45 offen offset:2048 lds
    v_mfma_f32_16x16x32_bf16 v[60:63], v[180:183], a[12:15], v[60:63]
    ds_read_b64_tr_b16 v[168:169], v70 offset:18432
    ds_read_b64_tr_b16 v[170:171], v70 offset:18944
    s_waitcnt lgkmcnt(6)
    v_mfma_f32_16x16x32_bf16 v[0:3], v[184:187], a[16:19], v[0:3]
    buffer_load_dwordx4 v205, s[24:27], s45 offen offset:3072 lds
    ds_read_b64_tr_b16 v[172:173], v71 offset:18432
    v_mfma_f32_16x16x32_bf16 v[4:7], v[184:187], a[20:23], v[4:7]
    ds_read_b64_tr_b16 v[174:175], v71 offset:18944
    s_add_u32 s49, s49, 128
    v_mfma_f32_16x16x32_bf16 a[248:251], v[148:151], v[184:187], a[248:251]
    s_add_u32 s45, s49, 18432
    s_add_u32 m0, s66, 16384
    v_mfma_f32_16x16x32_bf16 v[8:11], v[188:191], a[16:19], v[8:11]
    buffer_load_dwordx4 v200, s[4:7], s46 offen offset:0 lds
    ds_read_b64_tr_b16 v[176:177], v68 offset:24576
    v_mfma_f32_16x16x32_bf16 v[12:15], v[188:191], a[20:23], v[12:15]
    ds_read_b64_tr_b16 v[178:179], v68 offset:25088
    ds_read_b64_tr_b16 v[180:181], v69 offset:24576
    v_mfma_f32_16x16x32_bf16 v[16:19], v[192:195], a[16:19], v[16:19]
    buffer_load_dwordx4 v201, s[4:7], s46 offen offset:1024 lds
    v_mfma_f32_16x16x32_bf16 v[20:23], v[192:195], a[20:23], v[20:23]
    ds_read_b64_tr_b16 v[182:183], v69 offset:25088
    ds_read_b64_tr_b16 v[184:185], v70 offset:24576
    v_mfma_f32_16x16x32_bf16 v[24:27], v[196:199], a[16:19], v[24:27]
    buffer_load_dwordx4 v200, s[8:11], s46 offen offset:2048 lds
    v_mfma_f32_16x16x32_bf16 v[28:31], v[196:199], a[20:23], v[28:31]
    ds_read_b64_tr_b16 v[186:187], v70 offset:25088
    ds_read_b64_tr_b16 v[188:189], v71 offset:24576
    s_waitcnt lgkmcnt(7)
    v_mfma_f32_16x16x32_bf16 v[32:35], v[160:163], a[16:19], v[32:35]
    buffer_load_dwordx4 v201, s[8:11], s46 offen offset:3072 lds
    ds_read_b64_tr_b16 v[190:191], v71 offset:25088
    v_mfma_f32_16x16x32_bf16 v[36:39], v[160:163], a[20:23], v[36:39]
    ds_read_b64_tr_b16 v[192:193], v68 offset:26624
    ds_read_b64_tr_b16 v[194:195], v68 offset:27136
    v_mfma_f32_16x16x32_bf16 a[252:255], v[148:151], v[160:163], a[252:255]
    s_add_u32 s46, s46, 221184
    s_add_u32 m0, s59, 0
    v_mfma_f32_16x16x32_bf16 v[40:43], v[164:167], a[16:19], v[40:43]
    buffer_load_dwordx4 v204, s[24:27], s49 offen offset:0 lds
    v_mfma_f32_16x16x32_bf16 v[44:47], v[164:167], a[20:23], v[44:47]
    ds_read_b64_tr_b16 v[196:197], v69 offset:26624
    ds_read_b64_tr_b16 v[198:199], v69 offset:27136
    v_mfma_f32_16x16x32_bf16 v[48:51], v[168:171], a[16:19], v[48:51]
    buffer_load_dwordx4 v205, s[24:27], s49 offen offset:1024 lds
    v_mfma_f32_16x16x32_bf16 v[52:55], v[168:171], a[20:23], v[52:55]
    ds_read_b64_tr_b16 v[160:161], v70 offset:26624
    ds_read_b64_tr_b16 v[162:163], v70 offset:27136
    v_mfma_f32_16x16x32_bf16 v[56:59], v[172:175], a[16:19], v[56:59]
    buffer_load_dwordx4 v204, s[24:27], s45 offen offset:2048 lds
    v_mfma_f32_16x16x32_bf16 v[60:63], v[172:175], a[20:23], v[60:63]
    ds_read_b64_tr_b16 v[164:165], v71 offset:26624
    ds_read_b64_tr_b16 v[166:167], v71 offset:27136
    s_waitcnt lgkmcnt(8)
    v_mfma_f32_16x16x32_bf16 v[0:3], v[176:179], a[24:27], v[0:3]
    v_mfma_f32_16x16x32_bf16 v[4:7], v[176:179], a[28:31], v[4:7]
    v_mfma_f32_16x16x32_bf16 a[248:251], v[148:151], v[176:179], a[248:251]
    buffer_load_dwordx4 v205, s[24:27], s45 offen offset:3072 lds
    s_add_u32 s49, s49, 128
    s_add_u32 s45, s49, 18432
    v_dot2c_f32_bf16 v244, v224, v146
    v_dot2c_f32_bf16 v245, v224, v224
    v_dot2c_f32_bf16 v244, v225, v146
    v_dot2c_f32_bf16 v245, v225, v225
    v_dot2c_f32_bf16 v244, v226, v146
    v_dot2c_f32_bf16 v245, v226, v226
    v_dot2c_f32_bf16 v244, v227, v146
    v_dot2c_f32_bf16 v245, v227, v227
    v_dot2c_f32_bf16 v244, v228, v146
    v_dot2c_f32_bf16 v245, v228, v228
    v_dot2c_f32_bf16 v244, v229, v146
    v_dot2c_f32_bf16 v245, v229, v229
    v_dot2c_f32_bf16 v244, v230, v146
    v_dot2c_f32_bf16 v245, v230, v230
    v_dot2c_f32_bf16 v244, v231, v146
    v_dot2c_f32_bf16 v245, v231, v231
    v_dot2c_f32_bf16 v244, v232, v146
    v_dot2c_f32_bf16 v245, v232, v232
    v_dot2c_f32_bf16 v244, v233, v146
    v_dot2c_f32_bf16 v245, v233, v233
    v_dot2c_f32_bf16 v244, v234, v146
    v_dot2c_f32_bf16 v245, v234, v234
    v_dot2c_f32_bf16 v244, v235, v146
    v_dot2c_f32_bf16 v245, v235, v235
    v_dot2c_f32_bf16 v244, v236, v146
    v_dot2c_f32_bf16 v245, v236, v236
    v_dot2c_f32_bf16 v244, v237, v146
    v_dot2c_f32_bf16 v245, v237, v237
    v_dot2c_f32_bf16 v244, v238, v146
    v_dot2c_f32_bf16 v245, v238, v238
    v_dot2c_f32_bf16 v244, v239, v146
    v_dot2c_f32_bf16 v245, v239, v239
    v_dot2c_f32_bf16 v244, v240, v146
    v_dot2c_f32_bf16 v245, v240, v240
    v_dot2c_f32_bf16 v244, v241, v146
    v_dot2c_f32_bf16 v245, v241, v241
    v_dot2c_f32_bf16 v244, v242, v146
    v_dot2c_f32_bf16 v245, v242, v242
    v_dot2c_f32_bf16 v244, v243, v146
    v_dot2c_f32_bf16 v245, v243, v243
    s_nop 1
    v_add_f32_dpp v244, v244, v244 row_ror:8 row_mask:0xf bank_mask:0xf
    v_add_f32_dpp v245, v245, v245 row_ror:8 row_mask:0xf bank_mask:0xf
    s_nop 0
    v_add_f32_dpp v244, v244, v244 row_ror:4 row_mask:0xf bank_mask:0xf
    v_add_f32_dpp v245, v245, v245 row_ror:4 row_mask:0xf bank_mask:0xf
    s_nop 0
    v_add_f32_dpp v244, v244, v244 row_ror:2 row_mask:0xf bank_mask:0xf
    v_add_f32_dpp v245, v245, v245 row_ror:2 row_mask:0xf bank_mask:0xf
    s_nop 0
    v_add_f32_dpp v244, v244, v244 row_ror:1 row_mask:0xf bank_mask:0xf
    v_add_f32_dpp v245, v245, v245 row_ror:1 row_mask:0xf bank_mask:0xf
    v_mul_f32 v244, 0xbacccccd, v244
    v_mul_f32 v245, 0x3acccccd, v245
    v_fma_f32 v245, -v244, v244, v245
    v_max_f32 v245, 0, v245
    v_cvt_pk_bf16_f32 v245, v245, v245
    v_lshlrev_b32 v245, 16, v245
    v_add_f32 v245, 0x3727c5ac, v245
    v_cvt_pk_bf16_f32 v245, v245, v245
    v_lshlrev_b32 v245, 16, v245
    v_sqrt_f32 v245, v245
    s_nop 0
    v_cvt_pk_bf16_f32 v244, v244, v245
    v_mov_b32 v245, s38
    buffer_store_dwordx2 v[244:245], v246, s[20:23], s69 offen sc1
    v_mfma_f32_16x16x32_bf16 v[8:11], v[180:183], a[24:27], v[8:11]
    v_mfma_f32_16x16x32_bf16 v[12:15], v[180:183], a[28:31], v[12:15]
    s_waitcnt vmcnt(9) lgkmcnt(0)
    s_barrier
    v_mfma_f32_16x16x32_bf16 v[16:19], v[184:187], a[24:27], v[16:19]
    buffer_load_dword a247, v206, s[4:7], s70 offen
    ds_read_b128 a[32:35], v144 offset:32768
    v_mfma_f32_16x16x32_bf16 v[20:23], v[184:187], a[28:31], v[20:23]
    ds_read_b64_tr_b16 v[168:169], v64 offset:0
    ds_read_b64_tr_b16 v[170:171], v64 offset:512
    ds_read_b64_tr_b16 v[172:173], v65 offset:0
    v_mfma_f32_16x16x32_bf16 v[24:27], v[188:191], a[24:27], v[24:27]
    buffer_load_dword a246, v206, s[8:11], s70 offen offset:2048
    ds_read_b128 a[36:39], v144 offset:34816
    v_mfma_f32_16x16x32_bf16 v[28:31], v[188:191], a[28:31], v[28:31]
    ds_read_b64_tr_b16 v[174:175], v65 offset:512
    ds_read_b64_tr_b16 v[176:177], v66 offset:0
    s_add_u32 m0, s66, 65536
    v_mfma_f32_16x16x32_bf16 v[32:35], v[192:195], a[24:27], v[32:35]
    buffer_load_dwordx4 v200, s[4:7], s46 offen offset:0 lds
    v_mfma_f32_16x16x32_bf16 v[36:39], v[192:195], a[28:31], v[36:39]
    ds_read_b128 a[40:43], v145 offset:32768
    v_mfma_f32_16x16x32_bf16 a[252:255], v[148:151], v[192:195], a[252:255]
    ds_read_b64_tr_b16 v[178:179], v66 offset:512
    ds_read_b64_tr_b16 v[180:181], v67 offset:0
    v_mfma_f32_16x16x32_bf16 v[40:43], v[196:199], a[24:27], v[40:43]
    buffer_load_dwordx4 v201, s[4:7], s46 offen offset:1024 lds
    ds_read_b128 a[44:47], v145 offset:34816
    v_mfma_f32_16x16x32_bf16 v[44:47], v[196:199], a[28:31], v[44:47]
    ds_read_b64_tr_b16 v[182:183], v67 offset:512
    ds_read_b64_tr_b16 v[184:185], v64 offset:2048
    ds_read_b64_tr_b16 v[186:187], v64 offset:2560
    v_mfma_f32_16x16x32_bf16 v[48:51], v[160:163], a[24:27], v[48:51]
    buffer_load_dwordx4 v200, s[8:11], s46 offen offset:2048 lds
    v_mfma_f32_16x16x32_bf16 v[52:55], v[160:163], a[28:31], v[52:55]
    ds_read_b64_tr_b16 v[188:189], v65 offset:2048
    ds_read_b64_tr_b16 v[190:191], v65 offset:2560
    v_mfma_f32_16x16x32_bf16 v[56:59], v[164:167], a[24:27], v[56:59]
    buffer_load_dwordx4 v201, s[8:11], s46 offen offset:3072 lds
    ds_read_b64_tr_b16 v[192:193], v66 offset:2048
    v_mfma_f32_16x16x32_bf16 v[60:63], v[164:167], a[28:31], v[60:63]
    ds_read_b64_tr_b16 v[194:195], v66 offset:2560
    s_add_u32 s46, s46, 221184
    s_add_u32 m0, s59, 16384
    s_waitcnt lgkmcnt(6)
    v_mfma_f32_16x16x32_bf16 v[0:3], v[168:171], a[32:35], v[0:3]
    buffer_load_dwordx4 v204, s[24:27], s49 offen offset:0 lds
    v_mfma_f32_16x16x32_bf16 v[4:7], v[168:171], a[36:39], v[4:7]
    ds_read_b64_tr_b16 v[196:197], v67 offset:2048
    v_mfma_f32_16x16x32_bf16 a[248:251], v[148:151], v[168:171], a[248:251]
    ds_read_b64_tr_b16 v[198:199], v67 offset:2560
    v_mfma_f32_16x16x32_bf16 v[8:11], v[172:175], a[32:35], v[8:11]
    ds_read_b64_tr_b16 v[160:161], v64 offset:8192
    ds_read_b64_tr_b16 v[162:163], v64 offset:8704
    v_mfma_f32_16x16x32_bf16 v[12:15], v[172:175], a[36:39], v[12:15]
    ds_read_b64_tr_b16 v[164:165], v65 offset:8192
    v_mfma_f32_16x16x32_bf16 v[16:19], v[176:179], a[32:35], v[16:19]
    buffer_load_dwordx4 v205, s[24:27], s49 offen offset:1024 lds
    v_mfma_f32_16x16x32_bf16 v[20:23], v[176:179], a[36:39], v[20:23]
    ds_read_b64_tr_b16 v[166:167], v65 offset:8704
    ds_read_b64_tr_b16 v[168:169], v66 offset:8192
    v_mfma_f32_16x16x32_bf16 v[24:27], v[180:183], a[32:35], v[24:27]
    ds_read_b64_tr_b16 v[170:171], v66 offset:8704
    v_mfma_f32_16x16x32_bf16 v[28:31], v[180:183], a[36:39], v[28:31]
    ds_read_b64_tr_b16 v[172:173], v67 offset:8192
    s_waitcnt lgkmcnt(7)
    v_mfma_f32_16x16x32_bf16 v[32:35], v[184:187], a[32:35], v[32:35]
    buffer_load_dwordx4 v204, s[24:27], s45 offen offset:2048 lds
    v_mfma_f32_16x16x32_bf16 v[36:39], v[184:187], a[36:39], v[36:39]
    ds_read_b64_tr_b16 v[174:175], v67 offset:8704
    v_mfma_f32_16x16x32_bf16 a[252:255], v[148:151], v[184:187], a[252:255]
    ds_read_b64_tr_b16 v[176:177], v64 offset:10240
    ds_read_b64_tr_b16 v[178:179], v64 offset:10752
    v_mfma_f32_16x16x32_bf16 v[40:43], v[188:191], a[32:35], v[40:43]
    ds_read_b64_tr_b16 v[180:181], v65 offset:10240
    v_mfma_f32_16x16x32_bf16 v[44:47], v[188:191], a[36:39], v[44:47]
    ds_read_b64_tr_b16 v[182:183], v65 offset:10752
    v_mfma_f32_16x16x32_bf16 v[48:51], v[192:195], a[32:35], v[48:51]
    buffer_load_dwordx4 v205, s[24:27], s45 offen offset:3072 lds
    v_mfma_f32_16x16x32_bf16 v[52:55], v[192:195], a[36:39], v[52:55]
    ds_read_b64_tr_b16 v[184:185], v66 offset:10240
    ds_read_b64_tr_b16 v[186:187], v66 offset:10752
    v_mfma_f32_16x16x32_bf16 v[56:59], v[196:199], a[32:35], v[56:59]
    ds_read_b64_tr_b16 v[188:189], v67 offset:10240
    ds_read_b64_tr_b16 v[190:191], v67 offset:10752
    v_mfma_f32_16x16x32_bf16 v[60:63], v[196:199], a[36:39], v[60:63]
    s_add_u32 s49, s49, 128
    s_add_u32 s45, s49, 18432
    s_waitcnt lgkmcnt(8)
    v_mfma_f32_16x16x32_bf16 v[0:3], v[160:163], a[40:43], v[0:3]
    v_mfma_f32_16x16x32_bf16 v[4:7], v[160:163], a[44:47], v[4:7]
    v_mfma_f32_16x16x32_bf16 a[248:251], v[148:151], v[160:163], a[248:251]
    v_mfma_f32_16x16x32_bf16 v[8:11], v[164:167], a[40:43], v[8:11]
    v_mfma_f32_16x16x32_bf16 v[12:15], v[164:167], a[44:47], v[12:15]
    s_waitcnt vmcnt(11) lgkmcnt(0)
    s_barrier
    s_add_u32 m0, s66, 81920
    v_mfma_f32_16x16x32_bf16 v[16:19], v[168:171], a[40:43], v[16:19]
    buffer_load_dwordx4 v200, s[4:7], s46 offen offset:0 lds
    ds_read_b128 a[48:51], v144 offset:0
    v_mfma_f32_16x16x32_bf16 v[20:23], v[168:171], a[44:47], v[20:23]
    ds_read_b64_tr_b16 v[192:193], v64 offset:16384
    ds_read_b64_tr_b16 v[194:195], v64 offset:16896
    ds_read_b64_tr_b16 v[196:197], v65 offset:16384
    v_mfma_f32_16x16x32_bf16 v[24:27], v[172:175], a[40:43], v[24:27]
    ds_read_b128 a[52:55], v144 offset:2048
    ds_read_b64_tr_b16 v[198:199], v65 offset:16896
    v_mfma_f32_16x16x32_bf16 v[28:31], v[172:175], a[44:47], v[28:31]
    ds_read_b64_tr_b16 v[160:161], v66 offset:16384
    v_mfma_f32_16x16x32_bf16 v[32:35], v[176:179], a[40:43], v[32:35]
    buffer_load_dwordx4 v201, s[4:7], s46 offen offset:1024 lds
    v_mfma_f32_16x16x32_bf16 v[36:39], v[176:179], a[44:47], v[36:39]
    ds_read_b128 a[56:59], v145 offset:0
    v_mfma_f32_16x16x32_bf16 a[252:255], v[148:151], v[176:179], a[252:255]
    ds_read_b64_tr_b16 v[162:163], v66 offset:16896
    ds_read_b64_tr_b16 v[164:165], v67 offset:16384
    v_mfma_f32_16x16x32_bf16 v[40:43], v[180:183], a[40:43], v[40:43]
    ds_read_b128 a[60:63], v145 offset:2048
    ds_read_b64_tr_b16 v[166:167], v67 offset:16896
    v_mfma_f32_16x16x32_bf16 v[44:47], v[180:183], a[44:47], v[44:47]
    ds_read_b64_tr_b16 v[168:169], v64 offset:18432
    ds_read_b64_tr_b16 v[170:171], v64 offset:18944
    v_mfma_f32_16x16x32_bf16 v[48:51], v[184:187], a[40:43], v[48:51]
    buffer_load_dwordx4 v200, s[8:11], s46 offen offset:2048 lds
    v_mfma_f32_16x16x32_bf16 v[52:55], v[184:187], a[44:47], v[52:55]
    ds_read_b64_tr_b16 v[172:173], v65 offset:18432
    ds_read_b64_tr_b16 v[174:175], v65 offset:18944
    v_mfma_f32_16x16x32_bf16 v[56:59], v[188:191], a[40:43], v[56:59]
    ds_read_b64_tr_b16 v[176:177], v66 offset:18432
    v_mfma_f32_16x16x32_bf16 v[60:63], v[188:191], a[44:47], v[60:63]
    ds_read_b64_tr_b16 v[178:179], v66 offset:18944
    s_waitcnt lgkmcnt(6)
    v_mfma_f32_16x16x32_bf16 v[0:3], v[192:195], a[48:51], v[0:3]
    buffer_load_dwordx4 v201, s[8:11], s46 offen offset:3072 lds
    v_mfma_f32_16x16x32_bf16 v[4:7], v[192:195], a[52:55], v[4:7]
    ds_read_b64_tr_b16 v[180:181], v67 offset:18432
    v_mfma_f32_16x16x32_bf16 a[248:251], v[148:151], v[192:195], a[248:251]
    ds_read_b64_tr_b16 v[182:183], v67 offset:18944
    v_mfma_f32_16x16x32_bf16 v[8:11], v[196:199], a[48:51], v[8:11]
    ds_read_b64_tr_b16 v[184:185], v64 offset:24576
    ds_read_b64_tr_b16 v[186:187], v64 offset:25088
    ds_read_b64_tr_b16 v[188:189], v65 offset:24576
    v_mfma_f32_16x16x32_bf16 v[12:15], v[196:199], a[52:55], v[12:15]
    s_add_u32 s46, s46, 221184
    s_add_u32 m0, s59, 32768
    v_mfma_f32_16x16x32_bf16 v[16:19], v[160:163], a[48:51], v[16:19]
    buffer_load_dwordx4 v204, s[24:27], s49 offen offset:0 lds
    v_mfma_f32_16x16x32_bf16 v[20:23], v[160:163], a[52:55], v[20:23]
    ds_read_b64_tr_b16 v[190:191], v65 offset:25088
    ds_read_b64_tr_b16 v[192:193], v66 offset:24576
    v_mfma_f32_16x16x32_bf16 v[24:27], v[164:167], a[48:51], v[24:27]
    ds_read_b64_tr_b16 v[194:195], v66 offset:25088
    v_mfma_f32_16x16x32_bf16 v[28:31], v[164:167], a[52:55], v[28:31]
    ds_read_b64_tr_b16 v[196:197], v67 offset:24576
    s_waitcnt lgkmcnt(7)
    v_mfma_f32_16x16x32_bf16 v[32:35], v[168:171], a[48:51], v[32:35]
    buffer_load_dwordx4 v205, s[24:27], s49 offen offset:1024 lds
    v_mfma_f32_16x16x32_bf16 v[36:39], v[168:171], a[52:55], v[36:39]
    ds_read_b64_tr_b16 v[198:199], v67 offset:25088
    v_mfma_f32_16x16x32_bf16 a[252:255], v[148:151], v[168:171], a[252:255]
    ds_read_b64_tr_b16 v[160:161], v64 offset:26624
    ds_read_b64_tr_b16 v[162:163], v64 offset:27136
    v_mfma_f32_16x16x32_bf16 v[40:43], v[172:175], a[48:51], v[40:43]
    ds_read_b64_tr_b16 v[164:165], v65 offset:26624
    v_mfma_f32_16x16x32_bf16 v[44:47], v[172:175], a[52:55], v[44:47]
    ds_read_b64_tr_b16 v[166:167], v65 offset:27136
    v_mfma_f32_16x16x32_bf16 v[48:51], v[176:179], a[48:51], v[48:51]
    buffer_load_dwordx4 v204, s[24:27], s45 offen offset:2048 lds
    v_mfma_f32_16x16x32_bf16 v[52:55], v[176:179], a[52:55], v[52:55]
    ds_read_b64_tr_b16 v[168:169], v66 offset:26624
    ds_read_b64_tr_b16 v[170:171], v66 offset:27136
    v_mfma_f32_16x16x32_bf16 v[56:59], v[180:183], a[48:51], v[56:59]
    ds_read_b64_tr_b16 v[172:173], v67 offset:26624
    v_mfma_f32_16x16x32_bf16 v[60:63], v[180:183], a[52:55], v[60:63]
    ds_read_b64_tr_b16 v[174:175], v67 offset:27136
    s_waitcnt lgkmcnt(8)
    v_mfma_f32_16x16x32_bf16 v[0:3], v[184:187], a[56:59], v[0:3]
    buffer_load_dwordx4 v205, s[24:27], s45 offen offset:3072 lds
    v_mfma_f32_16x16x32_bf16 v[4:7], v[184:187], a[60:63], v[4:7]
    s_add_u32 s49, s49, 128
    v_mfma_f32_16x16x32_bf16 a[248:251], v[148:151], v[184:187], a[248:251]
    s_add_u32 s45, s49, 18432
    v_mfma_f32_16x16x32_bf16 v[8:11], v[188:191], a[56:59], v[8:11]
    v_mfma_f32_16x16x32_bf16 v[12:15], v[188:191], a[60:63], v[12:15]
    s_waitcnt vmcnt(8) lgkmcnt(0)
    s_barrier
    s_add_u32 m0, s66, 0
    v_mfma_f32_16x16x32_bf16 v[16:19], v[192:195], a[56:59], v[16:19]
    buffer_load_dwordx4 v200, s[4:7], s46 offen offset:0 lds
    ds_read_b128 a[64:67], v144 offset:16384
    v_mfma_f32_16x16x32_bf16 v[20:23], v[192:195], a[60:63], v[20:23]
    ds_read_b64_tr_b16 v[176:177], v68 offset:0
    ds_read_b64_tr_b16 v[178:179], v68 offset:512
    ds_read_b64_tr_b16 v[180:181], v69 offset:0
    v_mfma_f32_16x16x32_bf16 v[24:27], v[196:199], a[56:59], v[24:27]
    ds_read_b128 a[68:71], v144 offset:18432
    ds_read_b64_tr_b16 v[182:183], v69 offset:512
    v_mfma_f32_16x16x32_bf16 v[28:31], v[196:199], a[60:63], v[28:31]
    ds_read_b64_tr_b16 v[184:185], v70 offset:0
    v_mfma_f32_16x16x32_bf16 v[32:35], v[160:163], a[56:59], v[32:35]
    buffer_load_dwordx4 v201, s[4:7], s46 offen offset:1024 lds
    v_mfma_f32_16x16x32_bf16 v[36:39], v[160:163], a[60:63], v[36:39]
    ds_read_b128 a[72:75], v145 offset:16384
    v_mfma_f32_16x16x32_bf16 a[252:255], v[148:151], v[160:163], a[252:255]
    ds_read_b64_tr_b16 v[186:187], v70 offset:512
    ds_read_b64_tr_b16 v[188:189], v71 offset:0
    v_mfma_f32_16x16x32_bf16 v[40:43], v[164:167], a[56:59], v[40:43]
    ds_read_b128 a[76:79], v145 offset:18432
    ds_read_b64_tr_b16 v[190:191], v71 offset:512
    v_mfma_f32_16x16x32_bf16 v[44:47], v[164:167], a[60:63], v[44:47]
    ds_read_b64_tr_b16 v[192:193], v68 offset:2048
    ds_read_b64_tr_b16 v[194:195], v68 offset:2560
    v_mfma_f32_16x16x32_bf16 v[48:51], v[168:171], a[56:59], v[48:51]
    buffer_load_dwordx4 v200, s[8:11], s46 offen offset:2048 lds
    v_mfma_f32_16x16x32_bf16 v[52:55], v[168:171], a[60:63], v[52:55]
    ds_read_b64_tr_b16 v[196:197], v69 offset:2048
    ds_read_b64_tr_b16 v[198:199], v69 offset:2560
    v_mfma_f32_16x16x32_bf16 v[56:59], v[172:175], a[56:59], v[56:59]
    ds_read_b64_tr_b16 v[160:161], v70 offset:2048
    v_mfma_f32_16x16x32_bf16 v[60:63], v[172:175], a[60:63], v[60:63]
    ds_read_b64_tr_b16 v[162:163], v70 offset:2560
    s_waitcnt lgkmcnt(6)
    v_mfma_f32_16x16x32_bf16 v[0:3], v[176:179], a[64:67], v[0:3]
    buffer_load_dwordx4 v201, s[8:11], s46 offen offset:3072 lds
    v_mfma_f32_16x16x32_bf16 v[4:7], v[176:179], a[68:71], v[4:7]
    ds_read_b64_tr_b16 v[164:165], v71 offset:2048
    v_mfma_f32_16x16x32_bf16 a[248:251], v[148:151], v[176:179], a[248:251]
    ds_read_b64_tr_b16 v[166:167], v71 offset:2560
    v_mfma_f32_16x16x32_bf16 v[8:11], v[180:183], a[64:67], v[8:11]
    ds_read_b64_tr_b16 v[168:169], v68 offset:8192
    ds_read_b64_tr_b16 v[170:171], v68 offset:8704
    v_mfma_f32_16x16x32_bf16 v[12:15], v[180:183], a[68:71], v[12:15]
    ds_read_b64_tr_b16 v[172:173], v69 offset:8192
    s_add_u32 s46, s46, 221184
    s_add_u32 m0, s59, 0
    v_mfma_f32_16x16x32_bf16 v[16:19], v[184:187], a[64:67], v[16:19]
    buffer_load_dwordx4 v204, s[24:27], s49 offen offset:0 lds
    v_mfma_f32_16x16x32_bf16 v[20:23], v[184:187], a[68:71], v[20:23]
    ds_read_b64_tr_b16 v[174:175], v69 offset:8704
    ds_read_b64_tr_b16 v[176:177], v70 offset:8192
    v_mfma_f32_16x16x32_bf16 v[24:27], v[188:191], a[64:67], v[24:27]
    ds_read_b64_tr_b16 v[178:179], v70 offset:8704
    v_mfma_f32_16x16x32_bf16 v[28:31], v[188:191], a[68:71], v[28:31]
    ds_read_b64_tr_b16 v[180:181], v71 offset:8192
    s_waitcnt lgkmcnt(7)
    v_mfma_f32_16x16x32_bf16 v[32:35], v[192:195], a[64:67], v[32:35]
    buffer_load_dwordx4 v205, s[24:27], s49 offen offset:1024 lds
    v_mfma_f32_16x16x32_bf16 v[36:39], v[192:195], a[68:71], v[36:39]
    ds_read_b64_tr_b16 v[182:183], v71 offset:8704
    v_mfma_f32_16x16x32_bf16 a[252:255], v[148:151], v[192:195], a[252:255]
    ds_read_b64_tr_b16 v[184:185], v68 offset:10240
    ds_read_b64_tr_b16 v[186:187], v68 offset:10752
    v_mfma_f32_16x16x32_bf16 v[40:43], v[196:199], a[64:67], v[40:43]
    ds_read_b64_tr_b16 v[188:189], v69 offset:10240
    v_mfma_f32_16x16x32_bf16 v[44:47], v[196:199], a[68:71], v[44:47]
    ds_read_b64_tr_b16 v[190:191], v69 offset:10752
    v_mfma_f32_16x16x32_bf16 v[48:51], v[160:163], a[64:67], v[48:51]
    buffer_load_dwordx4 v204, s[24:27], s45 offen offset:2048 lds
    v_mfma_f32_16x16x32_bf16 v[52:55], v[160:163], a[68:71], v[52:55]
    ds_read_b64_tr_b16 v[192:193], v70 offset:10240
    ds_read_b64_tr_b16 v[194:195], v70 offset:10752
    v_mfma_f32_16x16x32_bf16 v[56:59], v[164:167], a[64:67], v[56:59]
    ds_read_b64_tr_b16 v[196:197], v71 offset:10240
    v_mfma_f32_16x16x32_bf16 v[60:63], v[164:167], a[68:71], v[60:63]
    ds_read_b64_tr_b16 v[198:199], v71 offset:10752
    s_waitcnt lgkmcnt(8)
    v_mfma_f32_16x16x32_bf16 v[0:3], v[168:171], a[72:75], v[0:3]
    buffer_load_dwordx4 v205, s[24:27], s45 offen offset:3072 lds
    v_mfma_f32_16x16x32_bf16 v[4:7], v[168:171], a[76:79], v[4:7]
    s_add_u32 s49, s49, 128
    v_mfma_f32_16x16x32_bf16 a[248:251], v[148:151], v[168:171], a[248:251]
    s_add_u32 s45, s49, 18432
    v_mfma_f32_16x16x32_bf16 v[8:11], v[172:175], a[72:75], v[8:11]
    v_mfma_f32_16x16x32_bf16 v[12:15], v[172:175], a[76:79], v[12:15]
    s_waitcnt vmcnt(8) lgkmcnt(0)
    s_barrier
    s_add_u32 m0, s79, 49152
    v_mfma_f32_16x16x32_bf16 v[16:19], v[176:179], a[72:75], v[16:19]
    buffer_load_dwordx4 v204, s[96:99], s63 offen lds
    ds_read_b128 a[80:83], v144 offset:32768
    v_mfma_f32_16x16x32_bf16 v[20:23], v[176:179], a[76:79], v[20:23]
    ds_read_b64_tr_b16 v[160:161], v68 offset:16384
    ds_read_b64_tr_b16 v[162:163], v68 offset:16896
    ds_read_b64_tr_b16 v[164:165], v69 offset:16384
    v_mfma_f32_16x16x32_bf16 v[24:27], v[180:183], a[72:75], v[24:27]
    ds_read_b128 a[84:87], v144 offset:34816
    ds_read_b64_tr_b16 v[166:167], v69 offset:16896
    v_mfma_f32_16x16x32_bf16 v[28:31], v[180:183], a[76:79], v[28:31]
    ds_read_b64_tr_b16 v[168:169], v70 offset:16384
    s_add_u32 m0, s79, 50176
    v_mfma_f32_16x16x32_bf16 v[32:35], v[184:187], a[72:75], v[32:35]
    buffer_load_dwordx4 v204, s[96:99], s78 offen lds
    v_mfma_f32_16x16x32_bf16 v[36:39], v[184:187], a[76:79], v[36:39]
    ds_read_b128 a[88:91], v145 offset:32768
    v_mfma_f32_16x16x32_bf16 a[252:255], v[148:151], v[184:187], a[252:255]
    ds_read_b64_tr_b16 v[170:171], v70 offset:16896
    ds_read_b64_tr_b16 v[172:173], v71 offset:16384
    v_mfma_f32_16x16x32_bf16 v[40:43], v[188:191], a[72:75], v[40:43]
    ds_read_b128 a[92:95], v145 offset:34816
    ds_read_b64_tr_b16 v[174:175], v71 offset:16896
    ds_read_b64_tr_b16 v[176:177], v68 offset:18432
    v_mfma_f32_16x16x32_bf16 v[44:47], v[188:191], a[76:79], v[44:47]
    ds_read_b64_tr_b16 v[178:179], v68 offset:18944
    s_add_u32 m0, s79, 51200
    v_mfma_f32_16x16x32_bf16 v[48:51], v[192:195], a[72:75], v[48:51]
    buffer_load_dwordx4 v204, s[96:99], s32 offen lds
    v_mfma_f32_16x16x32_bf16 v[52:55], v[192:195], a[76:79], v[52:55]
    ds_read_b64_tr_b16 v[180:181], v69 offset:18432
    ds_read_b64_tr_b16 v[182:183], v69 offset:18944
    v_mfma_f32_16x16x32_bf16 v[56:59], v[196:199], a[72:75], v[56:59]
    ds_read_b64_tr_b16 v[184:185], v70 offset:18432
    ds_read_b64_tr_b16 v[186:187], v70 offset:18944
    v_mfma_f32_16x16x32_bf16 v[60:63], v[196:199], a[76:79], v[60:63]
    s_add_u32 m0, s66, 16384
    s_waitcnt lgkmcnt(6)
    v_mfma_f32_16x16x32_bf16 v[0:3], v[160:163], a[80:83], v[0:3]
    buffer_load_dwordx4 v200, s[4:7], s46 offen offset:0 lds
    v_mfma_f32_16x16x32_bf16 v[4:7], v[160:163], a[84:87], v[4:7]
    ds_read_b64_tr_b16 v[188:189], v71 offset:18432
    v_mfma_f32_16x16x32_bf16 a[248:251], v[148:151], v[160:163], a[248:251]
    ds_read_b64_tr_b16 v[190:191], v71 offset:18944
    v_mfma_f32_16x16x32_bf16 v[8:11], v[164:167], a[80:83], v[8:11]
    ds_read_b64_tr_b16 v[192:193], v68 offset:24576
    ds_read_b64_tr_b16 v[194:195], v68 offset:25088
    v_mfma_f32_16x16x32_bf16 v[12:15], v[164:167], a[84:87], v[12:15]
    ds_read_b64_tr_b16 v[196:197], v69 offset:24576
    v_mfma_f32_16x16x32_bf16 v[16:19], v[168:171], a[80:83], v[16:19]
    buffer_load_dwordx4 v201, s[4:7], s46 offen offset:1024 lds
    v_mfma_f32_16x16x32_bf16 v[20:23], v[168:171], a[84:87], v[20:23]
    ds_read_b64_tr_b16 v[198:199], v69 offset:25088
    ds_read_b64_tr_b16 v[160:161], v70 offset:24576
    v_mfma_f32_16x16x32_bf16 v[24:27], v[172:175], a[80:83], v[24:27]
    ds_read_b64_tr_b16 v[162:163], v70 offset:25088
    v_mfma_f32_16x16x32_bf16 v[28:31], v[172:175], a[84:87], v[28:31]
    ds_read_b64_tr_b16 v[164:165], v71 offset:24576
    s_waitcnt lgkmcnt(7)
    v_mfma_f32_16x16x32_bf16 v[32:35], v[176:179], a[80:83], v[32:35]
    buffer_load_dwordx4 v200, s[8:11], s46 offen offset:2048 lds
    v_mfma_f32_16x16x32_bf16 v[36:39], v[176:179], a[84:87], v[36:39]
    ds_read_b64_tr_b16 v[166:167], v71 offset:25088
    v_mfma_f32_16x16x32_bf16 a[252:255], v[148:151], v[176:179], a[252:255]
    ds_read_b64_tr_b16 v[168:169], v68 offset:26624
    ds_read_b64_tr_b16 v[170:171], v68 offset:27136
    v_mfma_f32_16x16x32_bf16 v[40:43], v[180:183], a[80:83], v[40:43]
    ds_read_b64_tr_b16 v[172:173], v69 offset:26624
    v_mfma_f32_16x16x32_bf16 v[44:47], v[180:183], a[84:87], v[44:47]
    ds_read_b64_tr_b16 v[174:175], v69 offset:27136
    v_mfma_f32_16x16x32_bf16 v[48:51], v[184:187], a[80:83], v[48:51]
    buffer_load_dwordx4 v201, s[8:11], s46 offen offset:3072 lds
    v_mfma_f32_16x16x32_bf16 v[52:55], v[184:187], a[84:87], v[52:55]
    ds_read_b64_tr_b16 v[176:177], v70 offset:26624
    ds_read_b64_tr_b16 v[178:179], v70 offset:27136
    v_mfma_f32_16x16x32_bf16 v[56:59], v[188:191], a[80:83], v[56:59]
    ds_read_b64_tr_b16 v[180:181], v71 offset:26624
    ds_read_b64_tr_b16 v[182:183], v71 offset:27136
    v_mfma_f32_16x16x32_bf16 v[60:63], v[188:191], a[84:87], v[60:63]
    s_add_u32 s46, s46, 221184
    s_add_u32 m0, s59, 16384
    s_waitcnt lgkmcnt(8)
    v_mfma_f32_16x16x32_bf16 v[0:3], v[192:195], a[88:91], v[0:3]
    buffer_load_dwordx4 v204, s[24:27], s49 offen offset:0 lds
    v_mfma_f32_16x16x32_bf16 v[4:7], v[192:195], a[92:95], v[4:7]
    v_mfma_f32_16x16x32_bf16 a[248:251], v[148:151], v[192:195], a[248:251]
    buffer_load_dwordx2 v[158:159], v82, s[20:23], s67 offen sc1
    v_mfma_f32_16x16x32_bf16 v[8:11], v[196:199], a[88:91], v[8:11]
    v_mfma_f32_16x16x32_bf16 v[12:15], v[196:199], a[92:95], v[12:15]
    s_waitcnt vmcnt(9) lgkmcnt(0)
    s_barrier
    v_mfma_f32_16x16x32_bf16 v[16:19], v[160:163], a[88:91], v[16:19]
    buffer_load_dwordx4 v205, s[24:27], s49 offen offset:1024 lds
    ds_read_b128 a[96:99], v144 offset:0
    v_mfma_f32_16x16x32_bf16 v[20:23], v[160:163], a[92:95], v[20:23]
    ds_read_b64_tr_b16 v[184:185], v64 offset:0
    ds_read_b64_tr_b16 v[186:187], v64 offset:512
    ds_read_b64_tr_b16 v[188:189], v65 offset:0
    v_mfma_f32_16x16x32_bf16 v[24:27], v[164:167], a[88:91], v[24:27]
    ds_read_b128 a[100:103], v144 offset:2048
    ds_read_b64_tr_b16 v[190:191], v65 offset:512
    v_mfma_f32_16x16x32_bf16 v[28:31], v[164:167], a[92:95], v[28:31]
    ds_read_b64_tr_b16 v[192:193], v66 offset:0
    v_mfma_f32_16x16x32_bf16 v[32:35], v[168:171], a[88:91], v[32:35]
    buffer_load_dwordx4 v204, s[24:27], s45 offen offset:2048 lds
    v_mfma_f32_16x16x32_bf16 v[36:39], v[168:171], a[92:95], v[36:39]
    ds_read_b128 a[104:107], v145 offset:0
    v_mfma_f32_16x16x32_bf16 a[252:255], v[148:151], v[168:171], a[252:255]
    ds_read_b64_tr_b16 v[194:195], v66 offset:512
    ds_read_b64_tr_b16 v[196:197], v67 offset:0
    v_mfma_f32_16x16x32_bf16 v[40:43], v[172:175], a[88:91], v[40:43]
    ds_read_b128 a[108:111], v145 offset:2048
    ds_read_b64_tr_b16 v[198:199], v67 offset:512
    v_mfma_f32_16x16x32_bf16 v[44:47], v[172:175], a[92:95], v[44:47]
    ds_read_b64_tr_b16 v[160:161], v64 offset:2048
    ds_read_b64_tr_b16 v[162:163], v64 offset:2560
    v_mfma_f32_16x16x32_bf16 v[48:51], v[176:179], a[88:91], v[48:51]
    buffer_load_dwordx4 v205, s[24:27], s45 offen offset:3072 lds
    v_mfma_f32_16x16x32_bf16 v[52:55], v[176:179], a[92:95], v[52:55]
    ds_read_b64_tr_b16 v[164:165], v65 offset:2048
    ds_read_b64_tr_b16 v[166:167], v65 offset:2560
    v_mfma_f32_16x16x32_bf16 v[56:59], v[180:183], a[88:91], v[56:59]
    ds_read_b64_tr_b16 v[168:169], v66 offset:2048
    ds_read_b64_tr_b16 v[170:171], v66 offset:2560
    s_add_u32 s49, s49, 128
    v_mfma_f32_16x16x32_bf16 v[60:63], v[180:183], a[92:95], v[60:63]
    s_add_u32 s45, s49, 18432
    s_add_u32 m0, s66, 65536
    s_waitcnt lgkmcnt(6)
    v_mfma_f32_16x16x32_bf16 v[0:3], v[184:187], a[96:99], v[0:3]
    buffer_load_dwordx4 v200, s[4:7], s46 offen offset:0 lds
    v_mfma_f32_16x16x32_bf16 v[4:7], v[184:187], a[100:103], v[4:7]
    ds_read_b64_tr_b16 v[172:173], v67 offset:2048
    v_mfma_f32_16x16x32_bf16 a[248:251], v[148:151], v[184:187], a[248:251]
    ds_read_b64_tr_b16 v[174:175], v67 offset:2560
    v_mfma_f32_16x16x32_bf16 v[8:11], v[188:191], a[96:99], v[8:11]
    ds_read_b64_tr_b16 v[176:177], v64 offset:8192
    ds_read_b64_tr_b16 v[178:179], v64 offset:8704
    v_mfma_f32_16x16x32_bf16 v[12:15], v[188:191], a[100:103], v[12:15]
    ds_read_b64_tr_b16 v[180:181], v65 offset:8192
    v_mfma_f32_16x16x32_bf16 v[16:19], v[192:195], a[96:99], v[16:19]
    buffer_load_dwordx4 v201, s[4:7], s46 offen offset:1024 lds
    v_mfma_f32_16x16x32_bf16 v[20:23], v[192:195], a[100:103], v[20:23]
    ds_read_b64_tr_b16 v[182:183], v65 offset:8704
    ds_read_b64_tr_b16 v[184:185], v66 offset:8192
    v_mfma_f32_16x16x32_bf16 v[24:27], v[196:199], a[96:99], v[24:27]
    ds_read_b64_tr_b16 v[186:187], v66 offset:8704
    v_mfma_f32_16x16x32_bf16 v[28:31], v[196:199], a[100:103], v[28:31]
    ds_read_b64_tr_b16 v[188:189], v67 offset:8192
    s_waitcnt lgkmcnt(7)
    v_mfma_f32_16x16x32_bf16 v[32:35], v[160:163], a[96:99], v[32:35]
    buffer_load_dwordx4 v200, s[8:11], s46 offen offset:2048 lds
    v_mfma_f32_16x16x32_bf16 v[36:39], v[160:163], a[100:103], v[36:39]
    ds_read_b64_tr_b16 v[190:191], v67 offset:8704
    v_mfma_f32_16x16x32_bf16 a[252:255], v[148:151], v[160:163], a[252:255]
    ds_read_b64_tr_b16 v[192:193], v64 offset:10240
    ds_read_b64_tr_b16 v[194:195], v64 offset:10752
    v_mfma_f32_16x16x32_bf16 v[40:43], v[164:167], a[96:99], v[40:43]
    ds_read_b64_tr_b16 v[196:197], v65 offset:10240
    v_mfma_f32_16x16x32_bf16 v[44:47], v[164:167], a[100:103], v[44:47]
    ds_read_b64_tr_b16 v[198:199], v65 offset:10752
    v_mfma_f32_16x16x32_bf16 v[48:51], v[168:171], a[96:99], v[48:51]
    buffer_load_dwordx4 v201, s[8:11], s46 offen offset:3072 lds
    v_mfma_f32_16x16x32_bf16 v[52:55], v[168:171], a[100:103], v[52:55]
    ds_read_b64_tr_b16 v[160:161], v66 offset:10240
    ds_read_b64_tr_b16 v[162:163], v66 offset:10752
    v_mfma_f32_16x16x32_bf16 v[56:59], v[172:175], a[96:99], v[56:59]
    ds_read_b64_tr_b16 v[164:165], v67 offset:10240
    ds_read_b64_tr_b16 v[166:167], v67 offset:10752
    v_mfma_f32_16x16x32_bf16 v[60:63], v[172:175], a[100:103], v[60:63]
    s_add_u32 s46, s46, 221184
    s_waitcnt vmcnt(13)
    s_add_u32 m0, s59, 32768
    s_waitcnt lgkmcnt(8)
    v_mfma_f32_16x16x32_bf16 v[0:3], v[176:179], a[104:107], v[0:3]
    v_mfma_f32_16x16x32_bf16 v[4:7], v[176:179], a[108:111], v[4:7]
    buffer_load_dwordx4 v204, s[24:27], s49 offen offset:0 lds
    v_mfma_f32_16x16x32_bf16 a[248:251], v[148:151], v[176:179], a[248:251]
    v_mfma_f32_16x16x32_bf16 v[8:11], v[180:183], a[104:107], v[8:11]
    v_mfma_f32_16x16x32_bf16 v[12:15], v[180:183], a[108:111], v[12:15]
    s_waitcnt vmcnt(5) lgkmcnt(0)
    s_barrier
    v_mfma_f32_16x16x32_bf16 v[16:19], v[184:187], a[104:107], v[16:19]
    buffer_load_dwordx4 v205, s[24:27], s49 offen offset:1024 lds
    ds_read_b128 a[112:115], v144 offset:16384
    v_mfma_f32_16x16x32_bf16 v[20:23], v[184:187], a[108:111], v[20:23]
    ds_read_b64_tr_b16 v[168:169], v64 offset:16384
    ds_read_b64_tr_b16 v[170:171], v64 offset:16896
    ds_read_b64_tr_b16 v[172:173], v65 offset:16384
    v_mfma_f32_16x16x32_bf16 v[24:27], v[188:191], a[104:107], v[24:27]
    ds_read_b128 a[116:119], v144 offset:18432
    ds_read_b64_tr_b16 v[174:175], v65 offset:16896
    v_mfma_f32_16x16x32_bf16 v[28:31], v[188:191], a[108:111], v[28:31]
    ds_read_b64_tr_b16 v[176:177], v66 offset:16384
    ds_read_b64_tr_b16 v[108:109], v104 offset:0
    v_mfma_f32_16x16x32_bf16 v[32:35], v[192:195], a[104:107], v[32:35]
    buffer_load_dwordx4 v204, s[24:27], s45 offen offset:2048 lds
    ds_read_b128 a[120:123], v145 offset:16384
    v_mfma_f32_16x16x32_bf16 v[36:39], v[192:195], a[108:111], v[36:39]
    ds_read_b64_tr_b16 v[178:179], v66 offset:16896
    ds_read_b64_tr_b16 v[180:181], v67 offset:16384
    v_mfma_f32_16x16x32_bf16 a[252:255], v[148:151], v[192:195], a[252:255]
    ds_read_b64_tr_b16 v[110:111], v105 offset:512
    ds_read_b64_tr_b16 v[112:113], v104 offset:1024
    v_mfma_f32_16x16x32_bf16 v[40:43], v[196:199], a[104:107], v[40:43]
    ds_read_b128 a[124:127], v145 offset:18432
    ds_read_b64_tr_b16 v[182:183], v67 offset:16896
    ds_read_b64_tr_b16 v[184:185], v64 offset:18432
    v_mfma_f32_16x16x32_bf16 v[44:47], v[196:199], a[108:111], v[44:47]
    ds_read_b64_tr_b16 v[186:187], v64 offset:18944
    ds_read_b64_tr_b16 v[114:115], v105 offset:1536
    v_mfma_f32_16x16x32_bf16 v[48:51], v[160:163], a[104:107], v[48:51]
    buffer_load_dwordx4 v205, s[24:27], s45 offen offset:3072 lds
    ds_read_b64_tr_b16 v[188:189], v65 offset:18432
    v_mfma_f32_16x16x32_bf16 v[52:55], v[160:163], a[108:111], v[52:55]
    ds_read_b64_tr_b16 v[190:191], v65 offset:18944
    ds_read_b64_tr_b16 v[116:117], v104 offset:2048
    v_mfma_f32_16x16x32_bf16 v[56:59], v[164:167], a[104:107], v[56:59]
    ds_read_b64_tr_b16 v[192:193], v66 offset:18432
    ds_read_b64_tr_b16 v[194:195], v66 offset:18944
    s_add_u32 s49, s49, 128
    v_mfma_f32_16x16x32_bf16 v[60:63], v[164:167], a[108:111], v[60:63]
    s_add_u32 s45, s49, 18432
    s_add_u32 m0, s66, 81920
    s_waitcnt lgkmcnt(8)
    v_mfma_f32_16x16x32_bf16 v[0:3], v[168:171], a[112:115], v[0:3]
    buffer_load_dwordx4 v200, s[4:7], s46 offen offset:0 lds
    ds_read_b64_tr_b16 v[196:197], v67 offset:18432
    v_mfma_f32_16x16x32_bf16 v[4:7], v[168:171], a[116:119], v[4:7]
    ds_read_b64_tr_b16 v[198:199], v67 offset:18944
    ds_read_b64_tr_b16 v[118:119], v105 offset:2560
    v_mfma_f32_16x16x32_bf16 a[248:251], v[148:151], v[168:171], a[248:251]
    buffer_store_dwordx4 v[108:111], v209, s[20:23], s68 offen sc1
    s_waitcnt lgkmcnt(8)
    v_mfma_f32_16x16x32_bf16 v[8:11], v[172:175], a[112:115], v[8:11]
    ds_read_b64_tr_b16 v[160:161], v64 offset:24576
    ds_read_b64_tr_b16 v[162:163], v64 offset:25088
    v_mfma_f32_16x16x32_bf16 v[12:15], v[172:175], a[116:119], v[12:15]
    ds_read_b64_tr_b16 v[164:165], v65 offset:24576
    buffer_store_dwordx4 v[112:115], v209, s[20:23], s37 offen sc1
    s_waitcnt lgkmcnt(3)
    v_mfma_f32_16x16x32_bf16 v[16:19], v[176:179], a[112:115], v[16:19]
    buffer_load_dwordx4 v201, s[4:7], s46 offen offset:1024 lds
    ds_read_b64_tr_b16 v[166:167], v65 offset:25088
    v_mfma_f32_16x16x32_bf16 v[20:23], v[176:179], a[116:119], v[20:23]
    ds_read_b64_tr_b16 v[168:169], v66 offset:24576
    buffer_store_dwordx4 v[116:119], v209, s[20:23], s54 offen sc1
    v_mfma_f32_16x16x32_bf16 v[24:27], v[180:183], a[112:115], v[24:27]
    ds_read_b64_tr_b16 v[170:171], v66 offset:25088
    v_mfma_f32_16x16x32_bf16 v[28:31], v[180:183], a[116:119], v[28:31]
    ds_read_b64_tr_b16 v[172:173], v67 offset:24576
    v_mfma_f32_16x16x32_bf16 v[32:35], v[184:187], a[112:115], v[32:35]
    buffer_load_dwordx4 v200, s[8:11], s46 offen offset:2048 lds
    v_mfma_f32_16x16x32_bf16 v[36:39], v[184:187], a[116:119], v[36:39]
    ds_read_b64_tr_b16 v[174:175], v67 offset:25088
    v_mfma_f32_16x16x32_bf16 a[252:255], v[148:151], v[184:187], a[252:255]
    ds_read_b64_tr_b16 v[176:177], v64 offset:26624
    ds_read_b64_tr_b16 v[178:179], v64 offset:27136
    v_mfma_f32_16x16x32_bf16 v[40:43], v[188:191], a[112:115], v[40:43]
    ds_read_b64_tr_b16 v[180:181], v65 offset:26624
    v_mfma_f32_16x16x32_bf16 v[44:47], v[188:191], a[116:119], v[44:47]
    ds_read_b64_tr_b16 v[182:183], v65 offset:27136
    v_mfma_f32_16x16x32_bf16 v[48:51], v[192:195], a[112:115], v[48:51]
    buffer_load_dwordx4 v201, s[8:11], s46 offen offset:3072 lds
    v_mfma_f32_16x16x32_bf16 v[52:55], v[192:195], a[116:119], v[52:55]
    ds_read_b64_tr_b16 v[184:185], v66 offset:26624
    ds_read_b64_tr_b16 v[186:187], v66 offset:27136
    v_mfma_f32_16x16x32_bf16 v[56:59], v[196:199], a[112:115], v[56:59]
    ds_read_b64_tr_b16 v[188:189], v67 offset:26624
    ds_read_b64_tr_b16 v[190:191], v67 offset:27136
    v_mfma_f32_16x16x32_bf16 v[60:63], v[196:199], a[116:119], v[60:63]
    s_add_u32 m0, s59, 0
    s_waitcnt lgkmcnt(8)
    v_mfma_f32_16x16x32_bf16 v[0:3], v[160:163], a[120:123], v[0:3]
    v_mfma_f32_16x16x32_bf16 v[4:7], v[160:163], a[124:127], v[4:7]
    buffer_load_dwordx4 v204, s[24:27], s49 offen offset:0 lds
    v_mfma_f32_16x16x32_bf16 a[248:251], v[148:151], v[160:163], a[248:251]
    v_mfma_f32_16x16x32_bf16 v[8:11], v[164:167], a[120:123], v[8:11]
    v_mfma_f32_16x16x32_bf16 v[12:15], v[164:167], a[124:127], v[12:15]
    s_waitcnt vmcnt(8) lgkmcnt(0)
    s_barrier
    v_mfma_f32_16x16x32_bf16 v[16:19], v[168:171], a[120:123], v[16:19]
    buffer_load_dwordx4 v205, s[24:27], s49 offen offset:1024 lds
    ds_read_b128 a[128:131], v144 offset:32768
    v_mfma_f32_16x16x32_bf16 v[20:23], v[168:171], a[124:127], v[20:23]
    ds_read_b64_tr_b16 v[192:193], v68 offset:0
    ds_read_b64_tr_b16 v[194:195], v68 offset:512
    ds_read_b64_tr_b16 v[196:197], v69 offset:0
    v_mfma_f32_16x16x32_bf16 v[24:27], v[172:175], a[120:123], v[24:27]
    ds_read_b128 a[132:135], v144 offset:34816
    ds_read_b64_tr_b16 v[198:199], v69 offset:512
    v_mfma_f32_16x16x32_bf16 v[28:31], v[172:175], a[124:127], v[28:31]
    ds_read_b64_tr_b16 v[160:161], v70 offset:0
    v_mfma_f32_16x16x32_bf16 v[32:35], v[176:179], a[120:123], v[32:35]
    buffer_load_dwordx4 v204, s[24:27], s45 offen offset:2048 lds
    v_mfma_f32_16x16x32_bf16 v[36:39], v[176:179], a[124:127], v[36:39]
    ds_read_b128 a[136:139], v145 offset:32768
    v_mfma_f32_16x16x32_bf16 a[252:255], v[148:151], v[176:179], a[252:255]
    ds_read_b64_tr_b16 v[162:163], v70 offset:512
    ds_read_b64_tr_b16 v[164:165], v71 offset:0
    v_mfma_f32_16x16x32_bf16 v[40:43], v[180:183], a[120:123], v[40:43]
    ds_read_b128 a[140:143], v145 offset:34816
    ds_read_b64_tr_b16 v[166:167], v71 offset:512
    v_mfma_f32_16x16x32_bf16 v[44:47], v[180:183], a[124:127], v[44:47]
    ds_read_b64_tr_b16 v[168:169], v68 offset:2048
    ds_read_b64_tr_b16 v[170:171], v68 offset:2560
    v_mfma_f32_16x16x32_bf16 v[48:51], v[184:187], a[120:123], v[48:51]
    buffer_load_dwordx4 v205, s[24:27], s45 offen offset:3072 lds
    v_mfma_f32_16x16x32_bf16 v[52:55], v[184:187], a[124:127], v[52:55]
    ds_read_b64_tr_b16 v[172:173], v69 offset:2048
    ds_read_b64_tr_b16 v[174:175], v69 offset:2560
    v_mfma_f32_16x16x32_bf16 v[56:59], v[188:191], a[120:123], v[56:59]
    ds_read_b64_tr_b16 v[176:177], v70 offset:2048
    ds_read_b64_tr_b16 v[178:179], v70 offset:2560
    v_mfma_f32_16x16x32_bf16 v[60:63], v[188:191], a[124:127], v[60:63]
    s_add_u32 m0, s66, 32768
    s_waitcnt lgkmcnt(6)
    v_mfma_f32_16x16x32_bf16 v[0:3], v[192:195], a[128:131], v[0:3]
    buffer_load_dwordx4 v200, s[4:7], s47 offen offset:0 lds
    v_mfma_f32_16x16x32_bf16 v[4:7], v[192:195], a[132:135], v[4:7]
    ds_read_b64_tr_b16 v[180:181], v71 offset:2048
    v_mfma_f32_16x16x32_bf16 a[248:251], v[148:151], v[192:195], a[248:251]
    ds_read_b64_tr_b16 v[182:183], v71 offset:2560
    v_mfma_f32_16x16x32_bf16 v[8:11], v[196:199], a[128:131], v[8:11]
    ds_read_b64_tr_b16 v[184:185], v68 offset:8192
    ds_read_b64_tr_b16 v[186:187], v68 offset:8704
    v_mfma_f32_16x16x32_bf16 v[12:15], v[196:199], a[132:135], v[12:15]
    ds_read_b64_tr_b16 v[188:189], v69 offset:8192
    v_mfma_f32_16x16x32_bf16 v[16:19], v[160:163], a[128:131], v[16:19]
    buffer_load_dwordx4 v201, s[4:7], s47 offen offset:1024 lds
    v_mfma_f32_16x16x32_bf16 v[20:23], v[160:163], a[132:135], v[20:23]
    ds_read_b64_tr_b16 v[190:191], v69 offset:8704
    ds_read_b64_tr_b16 v[192:193], v70 offset:8192
    v_mfma_f32_16x16x32_bf16 v[24:27], v[164:167], a[128:131], v[24:27]
    ds_read_b64_tr_b16 v[194:195], v70 offset:8704
    v_mfma_f32_16x16x32_bf16 v[28:31], v[164:167], a[132:135], v[28:31]
    ds_read_b64_tr_b16 v[196:197], v71 offset:8192
    s_waitcnt lgkmcnt(7)
    v_mfma_f32_16x16x32_bf16 v[32:35], v[168:171], a[128:131], v[32:35]
    buffer_load_dwordx4 v200, s[8:11], s47 offen offset:2048 lds
    ds_read_b64_tr_b16 v[198:199], v71 offset:8704
    v_mfma_f32_16x16x32_bf16 v[36:39], v[168:171], a[132:135], v[36:39]
    ds_read_b64_tr_b16 v[160:161], v68 offset:10240
    ds_read_b64_tr_b16 v[162:163], v68 offset:10752
    v_mfma_f32_16x16x32_bf16 a[252:255], v[148:151], v[168:171], a[252:255]
    s_nop 0
P_stg_chk:
    v_cmp_ne_u32 vcc, v159, v80
    s_nop 4
    s_cbranch_vccnz P_stg_slow
P_stg_done:
    v_mov_b32 v159, v158
    v_mov_b32 v249, 0
    v_mfma_f32_16x16x32_bf16 v[40:43], v[172:175], a[128:131], v[40:43]
    ds_read_b64_tr_b16 v[164:165], v69 offset:10240
    ds_read_b64_tr_b16 v[166:167], v69 offset:10752
    v_mov_b32 v250, 0
    v_mfma_f32_16x16x32_bf16 v[44:47], v[172:175], a[132:135], v[44:47]
    v_permlane16_swap_b32 v158, v159
    v_mov_b32 v253, 0
    v_mov_b32 v254, 0
    v_mfma_f32_16x16x32_bf16 v[48:51], v[176:179], a[128:131], v[48:51]
    buffer_load_dwordx4 v201, s[8:11], s47 offen offset:3072 lds
    ds_read_b64_tr_b16 v[168:169], v70 offset:10240
    v_mfma_f32_16x16x32_bf16 v[52:55], v[176:179], a[132:135], v[52:55]
    ds_read_b64_tr_b16 v[170:171], v70 offset:10752
    v_and_b32 v218, 0xffff0000, v158
    v_and_b32 v248, 0xffff, v158
    v_mfma_f32_16x16x32_bf16 v[56:59], v[180:183], a[128:131], v[56:59]
    ds_read_b64_tr_b16 v[172:173], v71 offset:10240
    ds_read_b64_tr_b16 v[174:175], v71 offset:10752
    v_rcp_f32 v219, v218
    v_mfma_f32_16x16x32_bf16 v[60:63], v[180:183], a[132:135], v[60:63]
    v_lshl_or_b32 v248, v158, 16, v248
    s_waitcnt vmcnt(10)
    s_add_u32 m0, s66, 49152
    s_waitcnt lgkmcnt(8)
    v_mfma_f32_16x16x32_bf16 v[0:3], v[184:187], a[136:139], v[0:3]
    buffer_load_dwordx4 v200, s[4:7], s48 offen offset:0 lds
    v_mul_f32 v218, v218, v218
    v_mfma_f32_16x16x32_bf16 v[4:7], v[184:187], a[140:143], v[4:7]
    v_mov_b32 v251, v248
    v_mul_f32 v216, 0xc0135761, v219
    v_mfma_f32_16x16x32_bf16 a[248:251], v[148:151], v[184:187], a[248:251]
    v_mul_f32 v217, v219, v219
    v_mul_f32 v217, 0x3d372713, v217
    v_mul_f32 v217, v217, v216
    v_mfma_f32_16x16x32_bf16 v[8:11], v[188:191], a[136:139], v[8:11]
    v_mfma_f32_16x16x32_bf16 v[12:15], v[188:191], a[140:143], v[12:15]
    s_waitcnt vmcnt(5) lgkmcnt(0)
    s_barrier
    v_mfma_f32_16x16x32_bf16 v[16:19], v[192:195], a[136:139], v[16:19]
    buffer_load_dwordx4 v201, s[4:7], s48 offen offset:1024 lds
    ds_read_b128 a[144:147], v144 offset:0
    ds_read_b64_tr_b16 v[176:177], v68 offset:16384
    v_mfma_f32_16x16x32_bf16 v[20:23], v[192:195], a[140:143], v[20:23]
    ds_read_b64_tr_b16 v[178:179], v68 offset:16896
    ds_read_b64_tr_b16 v[180:181], v68 offset:18432
    buffer_store_dword v80, v81, s[20:23], s29 offen sc1
    v_mfma_f32_16x16x32_bf16 v[24:27], v[196:199], a[136:139], v[24:27]
    ds_read_b128 a[148:151], v144 offset:2048
    ds_read_b64_tr_b16 v[182:183], v68 offset:18944
    ds_read_b64_tr_b16 v[184:185], v68 offset:24576
    v_mfma_f32_16x16x32_bf16 v[28:31], v[196:199], a[140:143], v[28:31]
    v_and_b32 v222, 0xffff0000, v159
    v_and_b32 v252, 0xffff, v159
    v_mfma_f32_16x16x32_bf16 v[32:35], v[160:163], a[136:139], v[32:35]
    buffer_load_dwordx4 v200, s[8:11], s48 offen offset:2048 lds
    ds_read_b128 a[152:155], v145 offset:0
    v_mfma_f32_16x16x32_bf16 v[36:39], v[160:163], a[140:143], v[36:39]
    ds_read_b64_tr_b16 v[186:187], v68 offset:25088
    ds_read_b64_tr_b16 v[188:189], v68 offset:26624
    v_mfma_f32_16x16x32_bf16 a[252:255], v[148:151], v[160:163], a[252:255]
    v_rcp_f32 v223, v222
    v_lshl_or_b32 v252, v159, 16, v252
    v_mfma_f32_16x16x32_bf16 v[40:43], v[164:167], a[136:139], v[40:43]
    ds_read_b128 a[156:159], v145 offset:2048
    ds_read_b64_tr_b16 v[190:191], v68 offset:27136
    ds_read_b64_tr_b16 v[192:193], v69 offset:16384
    v_mfma_f32_16x16x32_bf16 v[44:47], v[164:167], a[140:143], v[44:47]
    ds_read_b64_tr_b16 v[194:195], v69 offset:16896
    v_mul_f32 v222, v222, v222
    v_mov_b32 v255, v252
    v_mfma_f32_16x16x32_bf16 v[48:51], v[168:171], a[136:139], v[48:51]
    buffer_load_dwordx4 v201, s[8:11], s48 offen offset:3072 lds
    ds_read_b64_tr_b16 v[196:197], v70 offset:16384
    v_mfma_f32_16x16x32_bf16 v[52:55], v[168:171], a[140:143], v[52:55]
    ds_read_b64_tr_b16 v[198:199], v70 offset:16896
    v_mul_f32 v220, 0xc0135761, v223
    v_mul_f32 v221, v223, v223
    v_mfma_f32_16x16x32_bf16 v[56:59], v[172:175], a[136:139], v[56:59]
    ds_read_b64_tr_b16 v[160:161], v71 offset:16384
    ds_read_b64_tr_b16 v[162:163], v71 offset:16896
    v_mfma_f32_16x16x32_bf16 v[60:63], v[172:175], a[140:143], v[60:63]
    v_mul_f32 v221, 0x3d372713, v221
    v_mul_f32 v221, v221, v220
    s_add_u32 m0, s66, 0
    s_waitcnt lgkmcnt(6)
    v_mfma_f32_16x16x32_bf16 v[0:3], v[176:179], a[144:147], v[0:3]
    buffer_load_dwordx4 v200, s[4:7], s51 offen offset:0 lds
    v_mfma_f32_16x16x32_bf16 v[4:7], v[176:179], a[148:151], v[4:7]
    ds_read_b64_tr_b16 v[164:165], v69 offset:18432
    v_mfma_f32_16x16x32_bf16 a[248:251], v[148:151], v[176:179], a[248:251]
    ds_read_b64_tr_b16 v[166:167], v69 offset:18944
    v_mfma_f32_16x16x32_bf16 v[32:35], v[180:183], a[144:147], v[32:35]
    ds_read_b64_tr_b16 v[168:169], v70 offset:18432
    v_mfma_f32_16x16x32_bf16 v[36:39], v[180:183], a[148:151], v[36:39]
    ds_read_b64_tr_b16 v[170:171], v70 offset:18944
    v_mfma_f32_16x16x32_bf16 a[252:255], v[148:151], v[180:183], a[252:255]
    ds_read_b64_tr_b16 v[172:173], v71 offset:18432
    v_mfma_f32_16x16x32_bf16 v[0:3], v[184:187], a[152:155], v[0:3]
    buffer_load_dwordx4 v201, s[4:7], s51 offen offset:1024 lds
    v_mfma_f32_16x16x32_bf16 v[4:7], v[184:187], a[156:159], v[4:7]
    ds_read_b64_tr_b16 v[174:175], v71 offset:18944
    v_mfma_f32_16x16x32_bf16 a[248:251], v[148:151], v[184:187], a[248:251]
    ds_read_b64_tr_b16 v[176:177], v69 offset:24576
    v_mfma_f32_16x16x32_bf16 v[32:35], v[188:191], a[152:155], v[32:35]
    ds_read_b64_tr_b16 v[178:179], v69 offset:25088
    v_mfma_f32_16x16x32_bf16 v[36:39], v[188:191], a[156:159], v[36:39]
    ds_read_b64_tr_b16 v[180:181], v70 offset:24576
    v_mfma_f32_16x16x32_bf16 a[252:255], v[148:151], v[188:191], a[252:255]
    s_waitcnt lgkmcnt(7)
    v_mfma_f32_16x16x32_bf16 v[8:11], v[192:195], a[144:147], v[8:11]
    buffer_load_dwordx4 v200, s[8:11], s51 offen offset:2048 lds
    ds_read_b64_tr_b16 v[182:183], v70 offset:25088
    v_mfma_f32_16x16x32_bf16 v[12:15], v[192:195], a[148:151], v[12:15]
    ds_read_b64_tr_b16 v[184:185], v71 offset:24576
    ds_read_b64_tr_b16 v[186:187], v71 offset:25088
    v_mfma_f32_16x16x32_bf16 v[16:19], v[196:199], a[144:147], v[16:19]
    ds_read_b64_tr_b16 v[188:189], v69 offset:26624
    ds_read_b64_tr_b16 v[190:191], v69 offset:27136
    v_accvgpr_read_b32 v240, a248
    v_mfma_f32_16x16x32_bf16 v[20:23], v[196:199], a[148:151], v[20:23]
    v_accvgpr_read_b32 v241, a252
    v_xor_b32 v244, 8, v156
    v_xor_b32 v245, 16, v156
    v_xor_b32 v246, 24, v156
    v_mfma_f32_16x16x32_bf16 v[24:27], v[160:163], a[144:147], v[24:27]
    buffer_load_dwordx4 v201, s[8:11], s51 offen offset:3072 lds
    ds_read_b64_tr_b16 v[192:193], v70 offset:26624
    ds_read_b64_tr_b16 v[194:195], v70 offset:27136
    v_mfma_f32_16x16x32_bf16 v[28:31], v[160:163], a[148:151], v[28:31]
    v_and_b32 v242, 0xffff0000, v240
    v_sub_f32 v240, v240, v242
    v_cvt_pk_bf16_f32 v240, v242, v240
    v_mfma_f32_16x16x32_bf16 v[40:43], v[164:167], a[144:147], v[40:43]
    ds_read_b64_tr_b16 v[196:197], v71 offset:26624
    ds_read_b64_tr_b16 v[198:199], v71 offset:27136
    v_and_b32 v243, 0xffff0000, v241
    v_mfma_f32_16x16x32_bf16 v[44:47], v[164:167], a[148:151], v[44:47]
    v_sub_f32 v241, v241, v243
    v_cvt_pk_bf16_f32 v241, v243, v241
    ds_write_b64 v156, v[240:241] offset:0
    s_waitcnt lgkmcnt(9)
    v_mfma_f32_16x16x32_bf16 v[48:51], v[168:171], a[144:147], v[48:51]
    buffer_load_dword a247, v206, s[4:7], s71 offen
    ds_write_b64 v244, v[240:241] offset:2048
    v_mfma_f32_16x16x32_bf16 v[52:55], v[168:171], a[148:151], v[52:55]
    ds_write_b64 v245, v[240:241] offset:4096
    ds_write_b64 v246, v[240:241] offset:6144
    v_mfma_f32_16x16x32_bf16 v[56:59], v[172:175], a[144:147], v[56:59]
    v_mfma_f32_16x16x32_bf16 v[60:63], v[172:175], a[148:151], v[60:63]
    s_waitcnt vmcnt(10) lgkmcnt(0)
    s_barrier
    v_mfma_f32_16x16x32_bf16 v[8:11], v[176:179], a[152:155], v[8:11]
    buffer_load_dword a246, v206, s[8:11], s71 offen offset:2048
    ds_read_b64_tr_b16 v[160:161], v64 offset:32768
    ds_read_b64_tr_b16 v[162:163], v64 offset:33280
    v_mfma_f32_16x16x32_bf16 v[12:15], v[176:179], a[156:159], v[12:15]
    ds_read_b64_tr_b16 v[164:165], v65 offset:32768
    ds_read_b128 v[240:243], v157 offset:0
    ds_read_b128 v[244:247], v157 offset:16
    v_mfma_f32_16x16x32_bf16 v[16:19], v[180:183], a[152:155], v[16:19]
    ds_read_b64_tr_b16 v[166:167], v65 offset:33280
    ds_read_b64_tr_b16 v[168:169], v66 offset:32768
    v_mfma_f32_16x16x32_bf16 v[20:23], v[180:183], a[156:159], v[20:23]
    s_add_u32 m0, s66, 16384
    v_mfma_f32_16x16x32_bf16 v[24:27], v[184:187], a[152:155], v[24:27]
    buffer_load_dwordx4 v200, s[4:7], s52 offen offset:0 lds
    v_mfma_f32_16x16x32_bf16 v[28:31], v[184:187], a[156:159], v[28:31]
    ds_read_b64_tr_b16 v[170:171], v66 offset:33280
    ds_read_b64_tr_b16 v[172:173], v67 offset:32768
    v_mfma_f32_16x16x32_bf16 v[40:43], v[188:191], a[152:155], v[40:43]
    ds_read_b64_tr_b16 v[174:175], v67 offset:33280
    ds_read_b64_tr_b16 v[176:177], v64 offset:34816
    v_mfma_f32_16x16x32_bf16 v[44:47], v[188:191], a[156:159], v[44:47]
    ds_read_b64_tr_b16 v[178:179], v64 offset:35328
    s_waitcnt lgkmcnt(7)
    v_mfma_f32_16x16x16_bf16 v[0:3], v[240:241], v[248:249], v[0:3]
    v_mfma_f32_16x16x16_bf16 v[32:35], v[240:241], v[250:251], v[32:35]
    v_mfma_f32_16x16x32_bf16 v[48:51], v[192:195], a[152:155], v[48:51]
    buffer_load_dwordx4 v201, s[4:7], s52 offen offset:1024 lds
    v_mfma_f32_16x16x32_bf16 v[52:55], v[192:195], a[156:159], v[52:55]
    ds_read_b64_tr_b16 v[180:181], v65 offset:34816
    ds_read_b64_tr_b16 v[182:183], v65 offset:35328
    v_mfma_f32_16x16x16_bf16 v[8:11], v[242:243], v[248:249], v[8:11]
    v_mfma_f32_16x16x16_bf16 v[40:43], v[242:243], v[250:251], v[40:43]
    v_mfma_f32_16x16x32_bf16 v[56:59], v[196:199], a[152:155], v[56:59]
    ds_read_b64_tr_b16 v[184:185], v66 offset:34816
    v_mfma_f32_16x16x32_bf16 v[60:63], v[196:199], a[156:159], v[60:63]
    ds_read_b64_tr_b16 v[186:187], v66 offset:35328
    v_mfma_f32_16x16x16_bf16 v[4:7], v[240:241], v[252:253], v[4:7]
    v_mfma_f32_16x16x16_bf16 v[36:39], v[240:241], v[254:255], v[36:39]
    s_waitcnt lgkmcnt(6)
    v_mfma_f32_16x16x32_bf16 v[80:83], v[160:163], a[0:3], 0
    buffer_load_dwordx4 v200, s[8:11], s52 offen offset:2048 lds
    v_mfma_f32_16x16x32_bf16 v[84:87], v[160:163], a[4:7], 0
    ds_read_b64_tr_b16 v[188:189], v67 offset:34816
    ds_read_b64_tr_b16 v[190:191], v67 offset:35328
    v_mfma_f32_16x16x32_bf16 a[248:251], v[148:151], v[160:163], 0
    s_mov_b32 s37, 19695616
    v_mov_b32 v145, s38
    v_mfma_f32_16x16x32_bf16 v[88:91], v[164:167], a[0:3], 0
    ds_read_b64_tr_b16 v[192:193], v64 offset:40960
    ds_read_b64_tr_b16 v[194:195], v64 offset:41472
    ds_read_b64_tr_b16 v[196:197], v65 offset:40960
    v_mul_f32 v224, v0, v0
    v_mfma_f32_16x16x16_bf16 v[12:15], v[242:243], v[252:253], v[12:15]
    v_mfma_f32_16x16x32_bf16 v[92:95], v[164:167], a[4:7], 0
    v_mul_f32 v225, v1, v1
    v_mul_f32 v226, v2, v2
    v_mul_f32 v227, v3, v3
    v_mfma_f32_16x16x16_bf16 v[44:47], v[242:243], v[254:255], v[44:47]
    v_fma_f32 v224, v224, v217, v216
    v_fma_f32 v225, v225, v217, v216
    v_mfma_f32_16x16x32_bf16 v[96:99], v[168:171], a[0:3], 0
    buffer_load_dwordx4 v201, s[8:11], s52 offen offset:3072 lds
    ds_read_b64_tr_b16 v[198:199], v65 offset:41472
    ds_read_b64_tr_b16 v[160:161], v66 offset:40960
    v_mfma_f32_16x16x32_bf16 v[100:103], v[168:171], a[4:7], 0
    v_fma_f32 v226, v226, v217, v216
    v_mfma_f32_16x16x16_bf16 v[16:19], v[244:245], v[248:249], v[16:19]
    v_fma_f32 v227, v227, v217, v216
    v_mul_f32 v224, v224, v0
    v_mfma_f32_16x16x32_bf16 v[104:107], v[172:175], a[0:3], 0
    ds_read_b64_tr_b16 v[162:163], v66 offset:41472
    ds_read_b64_tr_b16 v[164:165], v67 offset:40960
    v_mul_f32 v225, v225, v1
    v_mfma_f32_16x16x16_bf16 v[48:51], v[244:245], v[250:251], v[48:51]
    v_mfma_f32_16x16x32_bf16 v[108:111], v[172:175], a[4:7], 0
    v_mul_f32 v226, v226, v2
    v_mul_f32 v227, v227, v3
    s_add_u32 m0, s66, 98304
    s_waitcnt lgkmcnt(7)
    v_mfma_f32_16x16x32_bf16 v[112:115], v[176:179], a[0:3], 0
    buffer_load_dwordx4 v200, s[4:7], s55 offen offset:0 lds
    ds_read_b64_tr_b16 v[166:167], v67 offset:41472
    v_mfma_f32_16x16x32_bf16 v[116:119], v[176:179], a[4:7], 0
    ds_read_b64_tr_b16 v[168:169], v64 offset:43008
    ds_read_b64_tr_b16 v[170:171], v64 offset:43520
    v_mfma_f32_16x16x32_bf16 a[252:255], v[148:151], v[176:179], 0
    v_exp_f32 v224, v224
    v_mfma_f32_16x16x16_bf16 v[24:27], v[246:247], v[248:249], v[24:27]
    v_mul_f32 v32, v0, v32
    v_mfma_f32_16x16x32_bf16 v[120:123], v[180:183], a[0:3], 0
    ds_read_b64_tr_b16 v[172:173], v65 offset:43008
    ds_read_b64_tr_b16 v[174:175], v65 offset:43520
    v_mfma_f32_16x16x32_bf16 v[124:127], v[180:183], a[4:7], 0
    v_mov_b32 v144, 1073741824
    v_cmp_eq_u32 vcc, 0, v209
    v_mfma_f32_16x16x32_bf16 v[128:131], v[184:187], a[0:3], 0
    buffer_load_dwordx4 v201, s[4:7], s55 offen offset:1024 lds
    ds_read_b64_tr_b16 v[176:177], v66 offset:43008
    v_mfma_f32_16x16x32_bf16 v[132:135], v[184:187], a[4:7], 0
    ds_read_b64_tr_b16 v[178:179], v66 offset:43520
    v_exp_f32 v225, v225
    v_mfma_f32_16x16x32_bf16 v[136:139], v[188:191], a[0:3], 0
    ds_read_b64_tr_b16 v[180:181], v67 offset:43008
    ds_read_b64_tr_b16 v[182:183], v67 offset:43520
    v_add_u32 v159, 4096, v209
    v_mfma_f32_16x16x32_bf16 v[140:143], v[188:191], a[4:7], 0
    v_mul_f32 v33, v1, v33
    v_mfma_f32_16x16x16_bf16 v[56:59], v[246:247], v[250:251], v[56:59]
    v_exp_f32 v226, v226
    v_mul_f32 v34, v2, v34
    s_waitcnt lgkmcnt(8)
    v_mfma_f32_16x16x32_bf16 v[80:83], v[192:195], a[8:11], v[80:83]
    buffer_load_dwordx4 v200, s[8:11], s55 offen offset:2048 lds
    v_accvgpr_read_b32 v158, a212
    v_mfma_f32_16x16x32_bf16 v[84:87], v[192:195], a[12:15], v[84:87]
    v_cndmask_b32 v144, v144, v209, vcc
    buffer_store_dword v145, v144, s[20:23], s1 offen sc1
    v_mfma_f32_16x16x32_bf16 a[248:251], v[148:151], v[192:195], a[248:251]
    v_exp_f32 v227, v227
    v_mfma_f32_16x16x16_bf16 v[20:23], v[244:245], v[252:253], v[20:23]
    v_mul_f32 v35, v3, v35
    v_fma_f32 v224, v224, v218, v218
    v_mfma_f32_16x16x32_bf16 v[88:91], v[196:199], a[8:11], v[88:91]
    v_mfma_f32_16x16x32_bf16 v[92:95], v[196:199], a[12:15], v[92:95]
    s_waitcnt vmcnt(14) lgkmcnt(0)
    s_barrier
    v_mfma_f32_16x16x32_bf16 v[96:99], v[160:163], a[8:11], v[96:99]
    buffer_load_dwordx4 v201, s[8:11], s55 offen offset:3072 lds
    ds_read_b64_tr_b16 v[184:185], v64 offset:49152
    v_mfma_f32_16x16x32_bf16 v[100:103], v[160:163], a[12:15], v[100:103]
    ds_read_b64_tr_b16 v[186:187], v64 offset:49664
    ds_read_b64_tr_b16 v[188:189], v65 offset:49152
    v_mfma_f32_16x16x32_bf16 v[104:107], v[164:167], a[8:11], v[104:107]
    ds_read_b64_tr_b16 v[190:191], v65 offset:49664
    ds_read_b64_tr_b16 v[192:193], v66 offset:49152
    v_fma_f32 v225, v225, v218, v218
    v_mfma_f32_16x16x16_bf16 v[52:55], v[244:245], v[254:255], v[52:55]
    v_mfma_f32_16x16x32_bf16 v[108:111], v[164:167], a[12:15], v[108:111]
    v_fma_f32 v226, v226, v218, v218
    v_fma_f32 v227, v227, v218, v218
    s_add_u32 m0, s66, 114688
    v_mfma_f32_16x16x32_bf16 v[112:115], v[168:171], a[8:11], v[112:115]
    buffer_load_dwordx4 v200, s[4:7], s56 offen offset:0 lds
    ds_read_b64_tr_b16 v[194:195], v66 offset:49664
    v_mfma_f32_16x16x32_bf16 v[116:119], v[168:171], a[12:15], v[116:119]
    ds_read_b64_tr_b16 v[196:197], v67 offset:49152
    v_rcp_f32 v224, v224
    v_mfma_f32_16x16x16_bf16 v[28:31], v[246:247], v[252:253], v[28:31]
    v_mfma_f32_16x16x32_bf16 a[252:255], v[148:151], v[168:171], a[252:255]
    v_rcp_f32 v225, v225
    v_rcp_f32 v226, v226
    v_mfma_f32_16x16x32_bf16 v[120:123], v[172:175], a[8:11], v[120:123]
    ds_read_b64_tr_b16 v[198:199], v67 offset:49664
    ds_read_b64_tr_b16 v[160:161], v64 offset:51200
    ds_read_b64_tr_b16 v[162:163], v64 offset:51712
    v_mfma_f32_16x16x32_bf16 v[124:127], v[172:175], a[12:15], v[124:127]
    v_rcp_f32 v227, v227
    v_mfma_f32_16x16x16_bf16 v[60:63], v[246:247], v[254:255], v[60:63]
    v_mul_f32 v32, v32, v224
    v_mul_f32 v33, v33, v225
    v_mfma_f32_16x16x32_bf16 v[128:131], v[176:179], a[8:11], v[128:131]
    buffer_load_dwordx4 v201, s[4:7], s56 offen offset:1024 lds
    ds_read_b64_tr_b16 v[164:165], v65 offset:51200
    v_mfma_f32_16x16x32_bf16 v[132:135], v[176:179], a[12:15], v[132:135]
    ds_read_b64_tr_b16 v[166:167], v65 offset:51712
    v_mul_f32 v34, v34, v226
    v_mul_f32 v35, v35, v227
    v_mfma_f32_16x16x32_bf16 v[136:139], v[180:183], a[8:11], v[136:139]
    ds_read_b64_tr_b16 v[168:169], v66 offset:51200
    ds_read_b64_tr_b16 v[170:171], v66 offset:51712
    v_cvt_pk_bf16_f32 v232, v32, v33
    v_mfma_f32_16x16x32_bf16 v[140:143], v[180:183], a[12:15], v[140:143]
    v_cvt_pk_bf16_f32 v233, v34, v35
    v_mul_f32 v228, v8, v8
    s_waitcnt lgkmcnt(6)
    v_mfma_f32_16x16x32_bf16 v[80:83], v[184:187], a[16:19], v[80:83]
    buffer_load_dwordx4 v200, s[8:11], s56 offen offset:2048 lds
    ds_read_b64_tr_b16 v[172:173], v67 offset:51200
    v_mfma_f32_16x16x32_bf16 v[84:87], v[184:187], a[20:23], v[84:87]
    ds_read_b64_tr_b16 v[174:175], v67 offset:51712
    s_getpc_b64 s[12:13]
KR_pcg:
    s_sub_u32 s12, s12, KR_pcg-K1_pf
    s_subb_u32 s13, s13, 0
    v_mfma_f32_16x16x32_bf16 a[248:251], v[148:151], v[184:187], a[248:251]
    s_mov_b32 s14, CODE_END-K1_pf
    v_mul_f32 v229, v9, v9
    v_mul_f32 v230, v10, v10
    v_mfma_f32_16x16x32_bf16 v[88:91], v[188:191], a[16:19], v[88:91]
    ds_read_b64_tr_b16 v[176:177], v64 offset:57344
    ds_read_b64_tr_b16 v[178:179], v64 offset:57856
    v_mfma_f32_16x16x32_bf16 v[92:95], v[188:191], a[20:23], v[92:95]
    ds_read_b64_tr_b16 v[180:181], v65 offset:57344
    v_mul_f32 v231, v11, v11
    v_fma_f32 v228, v228, v217, v216
    v_mfma_f32_16x16x32_bf16 v[96:99], v[192:195], a[16:19], v[96:99]
    buffer_load_dwordx4 v201, s[8:11], s56 offen offset:3072 lds
    ds_read_b64_tr_b16 v[182:183], v65 offset:57856
    v_mfma_f32_16x16x32_bf16 v[100:103], v[192:195], a[20:23], v[100:103]
    ds_read_b64_tr_b16 v[184:185], v66 offset:57344
    v_fma_f32 v229, v229, v217, v216
    v_mfma_f32_16x16x32_bf16 v[104:107], v[196:199], a[16:19], v[104:107]
    ds_read_b64_tr_b16 v[186:187], v66 offset:57856
    ds_read_b64_tr_b16 v[188:189], v67 offset:57344
    v_mfma_f32_16x16x32_bf16 v[108:111], v[196:199], a[20:23], v[108:111]
    v_fma_f32 v230, v230, v217, v216
    s_add_u32 m0, s66, 65536
    s_waitcnt lgkmcnt(7)
    v_mfma_f32_16x16x32_bf16 v[112:115], v[160:163], a[16:19], v[112:115]
    buffer_load_dwordx4 v200, s[4:7], s41 offen offset:0 lds
    ds_read_b64_tr_b16 v[190:191], v67 offset:57856
    v_mfma_f32_16x16x32_bf16 v[116:119], v[160:163], a[20:23], v[116:119]
    ds_read_b64_tr_b16 v[192:193], v64 offset:59392
    ds_read_b64_tr_b16 v[194:195], v64 offset:59904
    v_mfma_f32_16x16x32_bf16 a[252:255], v[148:151], v[160:163], a[252:255]
    v_fma_f32 v231, v231, v217, v216
    v_mul_f32 v228, v228, v8
    v_mfma_f32_16x16x32_bf16 v[120:123], v[164:167], a[16:19], v[120:123]
    ds_read_b64_tr_b16 v[196:197], v65 offset:59392
    ds_read_b64_tr_b16 v[198:199], v65 offset:59904
    v_mfma_f32_16x16x32_bf16 v[124:127], v[164:167], a[20:23], v[124:127]
    s_mov_b32 s15, 0x20000
    s_lshr_b32 s16, s2, 3
    v_mul_f32 v229, v229, v9
    v_mfma_f32_16x16x32_bf16 v[128:131], v[168:171], a[16:19], v[128:131]
    buffer_load_dwordx4 v201, s[4:7], s41 offen offset:1024 lds
    ds_read_b64_tr_b16 v[160:161], v66 offset:59392
    v_mfma_f32_16x16x32_bf16 v[132:135], v[168:171], a[20:23], v[132:135]
    ds_read_b64_tr_b16 v[162:163], v66 offset:59904
    v_mul_f32 v230, v230, v10
    v_mul_f32 v231, v231, v11
    v_mfma_f32_16x16x32_bf16 v[136:139], v[172:175], a[16:19], v[136:139]
    ds_read_b64_tr_b16 v[164:165], v67 offset:59392
    ds_read_b64_tr_b16 v[166:167], v67 offset:59904
    v_mfma_f32_16x16x32_bf16 v[140:143], v[172:175], a[20:23], v[140:143]
    s_lshl_b32 s16, s16, 2
    v_exp_f32 v228, v228
    s_waitcnt lgkmcnt(8)
    v_mfma_f32_16x16x32_bf16 v[80:83], v[176:179], a[24:27], v[80:83]
    buffer_load_dwordx4 v200, s[8:11], s41 offen offset:2048 lds
    v_mfma_f32_16x16x32_bf16 v[84:87], v[176:179], a[28:31], v[84:87]
    s_add_u32 s16, s16, s40
    s_lshl_b32 s16, s16, 10
    v_mfma_f32_16x16x32_bf16 a[248:251], v[148:151], v[176:179], a[248:251]
    buffer_load_dwordx4 a[244:247], v209, s[12:15], s16 offen
    v_mul_f32 v40, v8, v40
    v_mfma_f32_16x16x32_bf16 v[88:91], v[180:183], a[24:27], v[88:91]
    v_mfma_f32_16x16x32_bf16 v[92:95], v[180:183], a[28:31], v[92:95]
    s_waitcnt vmcnt(13) lgkmcnt(0)
    s_barrier
    v_mfma_f32_16x16x32_bf16 v[96:99], v[184:187], a[24:27], v[96:99]
    buffer_load_dwordx4 v201, s[8:11], s41 offen offset:3072 lds
    ds_read_b64_tr_b16 v[168:169], v64 offset:0
    v_mfma_f32_16x16x32_bf16 v[100:103], v[184:187], a[28:31], v[100:103]
    ds_read_b64_tr_b16 v[170:171], v64 offset:512
    ds_read_b64_tr_b16 v[172:173], v65 offset:0
    v_mfma_f32_16x16x32_bf16 v[104:107], v[188:191], a[24:27], v[104:107]
    ds_read_b64_tr_b16 v[174:175], v65 offset:512
    ds_read_b64_tr_b16 v[176:177], v66 offset:0
    v_mfma_f32_16x16x32_bf16 v[108:111], v[188:191], a[28:31], v[108:111]
    v_exp_f32 v229, v229
    s_add_u32 m0, s66, 81920
    v_mfma_f32_16x16x32_bf16 v[112:115], v[192:195], a[24:27], v[112:115]
    buffer_load_dwordx4 v200, s[4:7], s42 offen offset:0 lds
    ds_read_b64_tr_b16 v[178:179], v66 offset:512
    v_mfma_f32_16x16x32_bf16 v[116:119], v[192:195], a[28:31], v[116:119]
    ds_read_b64_tr_b16 v[180:181], v67 offset:0
    v_mul_f32 v41, v9, v41
    v_mfma_f32_16x16x32_bf16 a[252:255], v[148:151], v[192:195], a[252:255]
    v_exp_f32 v230, v230
    v_mul_f32 v42, v10, v42
    v_mfma_f32_16x16x32_bf16 v[120:123], v[196:199], a[24:27], v[120:123]
    ds_read_b64_tr_b16 v[182:183], v67 offset:512
    ds_read_b64_tr_b16 v[184:185], v64 offset:2048
    v_mfma_f32_16x16x32_bf16 v[124:127], v[196:199], a[28:31], v[124:127]
    v_exp_f32 v231, v231
    v_mul_f32 v43, v11, v43
    v_mfma_f32_16x16x32_bf16 v[128:131], v[160:163], a[24:27], v[128:131]
    buffer_load_dwordx4 v201, s[4:7], s42 offen offset:1024 lds
    ds_read_b64_tr_b16 v[186:187], v64 offset:2560
    v_mfma_f32_16x16x32_bf16 v[132:135], v[160:163], a[28:31], v[132:135]
    ds_read_b64_tr_b16 v[188:189], v65 offset:2048
    v_fma_f32 v228, v228, v218, v218
    v_mfma_f32_16x16x32_bf16 v[136:139], v[164:167], a[24:27], v[136:139]
    ds_read_b64_tr_b16 v[190:191], v65 offset:2560
    ds_read_b64_tr_b16 v[192:193], v66 offset:2048
    v_mfma_f32_16x16x32_bf16 v[140:143], v[164:167], a[28:31], v[140:143]
    v_fma_f32 v229, v229, v218, v218
    v_fma_f32 v230, v230, v218, v218
    s_waitcnt lgkmcnt(5)
    v_mfma_f32_16x16x32_bf16 v[80:83], v[168:171], a[32:35], v[80:83]
    buffer_load_dwordx4 v200, s[8:11], s42 offen offset:2048 lds
    v_mfma_f32_16x16x32_bf16 v[84:87], v[168:171], a[36:39], v[84:87]
    ds_read_b64_tr_b16 v[194:195], v66 offset:2560
    ds_read_b64_tr_b16 v[196:197], v67 offset:2048
    v_fma_f32 v231, v231, v218, v218
    v_mfma_f32_16x16x32_bf16 a[248:251], v[148:151], v[168:171], a[248:251]
    v_rcp_f32 v228, v228
    v_mfma_f32_16x16x32_bf16 v[88:91], v[172:175], a[32:35], v[88:91]
    ds_read_b64_tr_b16 v[198:199], v67 offset:2560
    ds_read_b64_tr_b16 v[160:161], v64 offset:8192
    v_mfma_f32_16x16x32_bf16 v[92:95], v[172:175], a[36:39], v[92:95]
    ds_read_b64_tr_b16 v[162:163], v64 offset:8704
    v_rcp_f32 v229, v229
    v_mfma_f32_16x16x32_bf16 v[96:99], v[176:179], a[32:35], v[96:99]
    buffer_load_dwordx4 v201, s[8:11], s42 offen offset:3072 lds
    ds_read_b64_tr_b16 v[164:165], v65 offset:8192
    v_mfma_f32_16x16x32_bf16 v[100:103], v[176:179], a[36:39], v[100:103]
    ds_read_b64_tr_b16 v[166:167], v65 offset:8704
    v_rcp_f32 v230, v230
    v_mfma_f32_16x16x32_bf16 v[104:107], v[180:183], a[32:35], v[104:107]
    ds_read_b64_tr_b16 v[168:169], v66 offset:8192
    ds_read_b64_tr_b16 v[170:171], v66 offset:8704
    v_mfma_f32_16x16x32_bf16 v[108:111], v[180:183], a[36:39], v[108:111]
    s_mov_b32 s96, s53
    s_mov_b32 s97, s57
    s_mov_b32 s98, 25600
    s_mov_b32 s99, 0x20000
    s_lshl_b32 s64, s40, 10
    s_and_b32 s64, s64, 1024
    s_add_u32 m0, s64, 160768
    s_waitcnt lgkmcnt(6)
    v_mfma_f32_16x16x32_bf16 v[112:115], v[184:187], a[32:35], v[112:115]
    buffer_load_dwordx4 v209, s[96:99], s100 offen lds
    ds_read_b64_tr_b16 v[172:173], v67 offset:8192
    v_mfma_f32_16x16x32_bf16 v[116:119], v[184:187], a[36:39], v[116:119]
    ds_read_b64_tr_b16 v[174:175], v67 offset:8704
    v_rcp_f32 v231, v231
    v_mfma_f32_16x16x32_bf16 a[252:255], v[148:151], v[184:187], a[252:255]
    v_mul_f32 v40, v40, v228
    v_mul_f32 v41, v41, v229
    v_mfma_f32_16x16x32_bf16 v[120:123], v[188:191], a[32:35], v[120:123]
    ds_read_b64_tr_b16 v[176:177], v64 offset:10240
    ds_read_b64_tr_b16 v[178:179], v64 offset:10752
    v_mfma_f32_16x16x32_bf16 v[124:127], v[188:191], a[36:39], v[124:127]
    s_getpc_b64 s[96:97]
KC_pcg:
    s_add_u32 s96, s96, KC_tab-KC_pcg
    s_addc_u32 s97, s97, 0
    s_movk_i32 s98, 6144
    s_lshl_b32 s64, s40, 10
    s_add_u32 m0, s64, 152576
    v_mfma_f32_16x16x32_bf16 v[128:131], v[192:195], a[32:35], v[128:131]
    buffer_load_dwordx4 v209, s[96:99], s64 offen lds
    ds_read_b64_tr_b16 v[180:181], v65 offset:10240
    v_mfma_f32_16x16x32_bf16 v[132:135], v[192:195], a[36:39], v[132:135]
    ds_read_b64_tr_b16 v[182:183], v65 offset:10752
    v_mul_f32 v42, v42, v230
    v_mul_f32 v43, v43, v231
    v_mfma_f32_16x16x32_bf16 v[136:139], v[196:199], a[32:35], v[136:139]
    ds_read_b64_tr_b16 v[184:185], v66 offset:10240
    ds_read_b64_tr_b16 v[186:187], v66 offset:10752
    v_mfma_f32_16x16x32_bf16 v[140:143], v[196:199], a[36:39], v[140:143]
    s_add_u32 s64, s64, 4096
    s_add_u32 m0, s64, 152576
    s_waitcnt lgkmcnt(6)
    v_mfma_f32_16x16x32_bf16 v[80:83], v[160:163], a[40:43], v[80:83]
    buffer_load_dwordx4 v209, s[96:99], s64 offen lds
    ds_read_b64_tr_b16 v[188:189], v67 offset:10240
    v_mfma_f32_16x16x32_bf16 v[84:87], v[160:163], a[44:47], v[84:87]
    ds_read_b64_tr_b16 v[190:191], v67 offset:10752
    v_cvt_pk_bf16_f32 v234, v40, v41
    v_mfma_f32_16x16x32_bf16 a[248:251], v[148:151], v[160:163], a[248:251]
    v_cvt_pk_bf16_f32 v235, v42, v43
    v_mul_f32 v224, v4, v4
    v_mfma_f32_16x16x32_bf16 v[88:91], v[164:167], a[40:43], v[88:91]
    ds_read_b64_tr_b16 v[192:193], v64 offset:16384
    ds_read_b64_tr_b16 v[194:195], v64 offset:16896
    v_mfma_f32_16x16x32_bf16 v[92:95], v[164:167], a[44:47], v[92:95]
    ds_read_b64_tr_b16 v[196:197], v65 offset:16384
    v_mul_f32 v225, v5, v5
    s_add_u32 m0, s66, 32768
    v_mfma_f32_16x16x32_bf16 v[96:99], v[168:171], a[40:43], v[96:99]
    buffer_load_dwordx4 v200, s[4:7], s44 offen offset:0 lds
    ds_read_b64_tr_b16 v[198:199], v65 offset:16896
    v_mfma_f32_16x16x32_bf16 v[100:103], v[168:171], a[44:47], v[100:103]
    ds_read_b64_tr_b16 v[160:161], v66 offset:16384
    v_mul_f32 v226, v6, v6
    v_mul_f32 v227, v7, v7
    v_mfma_f32_16x16x32_bf16 v[104:107], v[172:175], a[40:43], v[104:107]
    ds_read_b64_tr_b16 v[162:163], v66 offset:16896
    ds_read_b64_tr_b16 v[164:165], v67 offset:16384
    v_mfma_f32_16x16x32_bf16 v[108:111], v[172:175], a[44:47], v[108:111]
    v_permlane16_swap_b32 v232, v234
    v_permlane16_swap_b32 v233, v235
    s_waitcnt lgkmcnt(7)
    v_mfma_f32_16x16x32_bf16 v[112:115], v[176:179], a[40:43], v[112:115]
    buffer_load_dwordx4 v201, s[4:7], s44 offen offset:1024 lds
    v_mfma_f32_16x16x32_bf16 v[116:119], v[176:179], a[44:47], v[116:119]
    ds_read_b64_tr_b16 v[166:167], v67 offset:16896
    ds_read_b64_tr_b16 v[168:169], v64 offset:18432
    v_mfma_f32_16x16x32_bf16 a[252:255], v[148:151], v[176:179], a[252:255]
    buffer_store_dwordx4 v[232:235], v152, s[20:23], s60 offen offset:0 sc1
    v_fma_f32 v224, v224, v221, v220
    v_mfma_f32_16x16x32_bf16 v[120:123], v[180:183], a[40:43], v[120:123]
    ds_read_b64_tr_b16 v[170:171], v64 offset:18944
    ds_read_b64_tr_b16 v[172:173], v65 offset:18432
    v_fma_f32 v225, v225, v221, v220
    v_mfma_f32_16x16x32_bf16 v[124:127], v[180:183], a[44:47], v[124:127]
    v_fma_f32 v226, v226, v221, v220
    v_fma_f32 v227, v227, v221, v220
    v_mfma_f32_16x16x32_bf16 v[128:131], v[184:187], a[40:43], v[128:131]
    buffer_load_dwordx4 v200, s[8:11], s44 offen offset:2048 lds
    ds_read_b64_tr_b16 v[174:175], v65 offset:18944
    v_mfma_f32_16x16x32_bf16 v[132:135], v[184:187], a[44:47], v[132:135]
    ds_read_b64_tr_b16 v[176:177], v66 offset:18432
    v_mul_f32 v224, v224, v4
    v_mul_f32 v225, v225, v5
    v_mfma_f32_16x16x32_bf16 v[136:139], v[188:191], a[40:43], v[136:139]
    ds_read_b64_tr_b16 v[178:179], v66 offset:18944
    ds_read_b64_tr_b16 v[180:181], v67 offset:18432
    v_mfma_f32_16x16x32_bf16 v[140:143], v[188:191], a[44:47], v[140:143]
    v_mul_f32 v226, v226, v6
    v_mul_f32 v227, v227, v7
    s_waitcnt lgkmcnt(7)
    v_mfma_f32_16x16x32_bf16 v[80:83], v[192:195], a[48:51], v[80:83]
    buffer_load_dwordx4 v201, s[8:11], s44 offen offset:3072 lds
    v_mfma_f32_16x16x32_bf16 v[84:87], v[192:195], a[52:55], v[84:87]
    ds_read_b64_tr_b16 v[182:183], v67 offset:18944
    ds_read_b64_tr_b16 v[184:185], v64 offset:24576
    ds_read_b64_tr_b16 v[186:187], v64 offset:25088
    v_mfma_f32_16x16x32_bf16 a[248:251], v[148:151], v[192:195], a[248:251]
    v_exp_f32 v224, v224
    v_mfma_f32_16x16x32_bf16 v[88:91], v[196:199], a[48:51], v[88:91]
    ds_read_b64_tr_b16 v[188:189], v65 offset:24576
    ds_read_b64_tr_b16 v[190:191], v65 offset:25088
    v_mfma_f32_16x16x32_bf16 v[92:95], v[196:199], a[52:55], v[92:95]
    v_mul_f32 v36, v4, v36
    s_add_u32 m0, s66, 49152
    v_mfma_f32_16x16x32_bf16 v[96:99], v[160:163], a[48:51], v[96:99]
    buffer_load_dwordx4 v200, s[4:7], s3 offen offset:0 lds
    ds_read_b64_tr_b16 v[192:193], v66 offset:24576
    v_mfma_f32_16x16x32_bf16 v[100:103], v[160:163], a[52:55], v[100:103]
    ds_read_b64_tr_b16 v[194:195], v66 offset:25088
    v_exp_f32 v225, v225
    v_mfma_f32_16x16x32_bf16 v[104:107], v[164:167], a[48:51], v[104:107]
    ds_read_b64_tr_b16 v[196:197], v67 offset:24576
    ds_read_b64_tr_b16 v[198:199], v67 offset:25088
    v_mfma_f32_16x16x32_bf16 v[108:111], v[164:167], a[52:55], v[108:111]
    v_mul_f32 v37, v5, v37
    v_exp_f32 v226, v226
    s_waitcnt lgkmcnt(8)
    v_mfma_f32_16x16x32_bf16 v[112:115], v[168:171], a[48:51], v[112:115]
    buffer_load_dwordx4 v201, s[4:7], s3 offen offset:1024 lds
    ds_read_b64_tr_b16 v[160:161], v64 offset:26624
    v_mfma_f32_16x16x32_bf16 v[116:119], v[168:171], a[52:55], v[116:119]
    ds_read_b64_tr_b16 v[162:163], v64 offset:27136
    v_mul_f32 v38, v6, v38
    v_mfma_f32_16x16x32_bf16 a[252:255], v[148:151], v[168:171], a[252:255]
    v_exp_f32 v227, v227
    v_mul_f32 v39, v7, v39
    v_mfma_f32_16x16x32_bf16 v[120:123], v[172:175], a[48:51], v[120:123]
    ds_read_b64_tr_b16 v[164:165], v65 offset:26624
    ds_read_b64_tr_b16 v[166:167], v65 offset:27136
    v_fma_f32 v224, v224, v222, v222
    v_mfma_f32_16x16x32_bf16 v[124:127], v[172:175], a[52:55], v[124:127]
    v_fma_f32 v225, v225, v222, v222
    v_fma_f32 v226, v226, v222, v222
    v_mfma_f32_16x16x32_bf16 v[128:131], v[176:179], a[48:51], v[128:131]
    buffer_load_dwordx4 v200, s[8:11], s3 offen offset:2048 lds
    ds_read_b64_tr_b16 v[168:169], v66 offset:26624
    v_mfma_f32_16x16x32_bf16 v[132:135], v[176:179], a[52:55], v[132:135]
    ds_read_b64_tr_b16 v[170:171], v66 offset:27136
    v_fma_f32 v227, v227, v222, v222
    v_mfma_f32_16x16x32_bf16 v[136:139], v[180:183], a[48:51], v[136:139]
    ds_read_b64_tr_b16 v[172:173], v67 offset:26624
    ds_read_b64_tr_b16 v[174:175], v67 offset:27136
    v_mfma_f32_16x16x32_bf16 v[140:143], v[180:183], a[52:55], v[140:143]
    v_rcp_f32 v224, v224
    s_waitcnt lgkmcnt(8)
    v_mfma_f32_16x16x32_bf16 v[80:83], v[184:187], a[56:59], v[80:83]
    buffer_load_dwordx4 v201, s[8:11], s3 offen offset:3072 lds
    v_mfma_f32_16x16x32_bf16 v[84:87], v[184:187], a[60:63], v[84:87]
    v_rcp_f32 v225, v225
    v_rcp_f32 v226, v226
    v_mfma_f32_16x16x32_bf16 a[248:251], v[148:151], v[184:187], a[248:251]
    v_rcp_f32 v227, v227
    v_mfma_f32_16x16x32_bf16 v[88:91], v[188:191], a[56:59], v[88:91]
    v_mfma_f32_16x16x32_bf16 v[92:95], v[188:191], a[60:63], v[92:95]
    s_waitcnt vmcnt(21) lgkmcnt(0)
    s_barrier
    s_add_u32 s4, s4, s65
    s_addc_u32 s5, s5, 0
    s_sub_u32 s6, s6, s65
    s_add_u32 s8, s8, s65
    s_addc_u32 s9, s9, 0
    s_sub_u32 s10, s10, s65
    s_add_u32 m0, s66, 0
    v_mfma_f32_16x16x32_bf16 v[96:99], v[192:195], a[56:59], v[96:99]
    buffer_load_dwordx4 v200, s[4:7], s47 offen offset:0 lds
    ds_read_b64_tr_b16 v[176:177], v68 offset:32768
    v_mfma_f32_16x16x32_bf16 v[100:103], v[192:195], a[60:63], v[100:103]
    ds_read_b64_tr_b16 v[178:179], v68 offset:33280
    ds_read_b64_tr_b16 v[180:181], v69 offset:32768
    v_mfma_f32_16x16x32_bf16 v[104:107], v[196:199], a[56:59], v[104:107]
    ds_read_b64_tr_b16 v[182:183], v69 offset:33280
    ds_read_b64_tr_b16 v[184:185], v70 offset:32768
    v_mfma_f32_16x16x32_bf16 v[108:111], v[196:199], a[60:63], v[108:111]
    v_mul_f32 v36, v36, v224
    v_mul_f32 v37, v37, v225
    v_mul_f32 v38, v38, v226
    v_mfma_f32_16x16x32_bf16 v[112:115], v[160:163], a[56:59], v[112:115]
    buffer_load_dwordx4 v201, s[4:7], s47 offen offset:1024 lds
    ds_read_b64_tr_b16 v[186:187], v70 offset:33280
    v_mfma_f32_16x16x32_bf16 v[116:119], v[160:163], a[60:63], v[116:119]
    ds_read_b64_tr_b16 v[188:189], v71 offset:32768
    v_mul_f32 v39, v39, v227
    v_mfma_f32_16x16x32_bf16 a[252:255], v[148:151], v[160:163], a[252:255]
    v_cvt_pk_bf16_f32 v236, v36, v37
    v_cvt_pk_bf16_f32 v237, v38, v39
    v_mfma_f32_16x16x32_bf16 v[120:123], v[164:167], a[56:59], v[120:123]
    ds_read_b64_tr_b16 v[190:191], v71 offset:33280
    ds_read_b64_tr_b16 v[192:193], v68 offset:34816
    v_mul_f32 v228, v12, v12
    v_mfma_f32_16x16x32_bf16 v[124:127], v[164:167], a[60:63], v[124:127]
    v_mul_f32 v229, v13, v13
    v_mul_f32 v230, v14, v14
    v_mul_f32 v231, v15, v15
    v_mfma_f32_16x16x32_bf16 v[128:131], v[168:171], a[56:59], v[128:131]
    buffer_load_dwordx4 v200, s[8:11], s47 offen offset:2048 lds
    ds_read_b64_tr_b16 v[194:195], v68 offset:35328
    v_mfma_f32_16x16x32_bf16 v[132:135], v[168:171], a[60:63], v[132:135]
    ds_read_b64_tr_b16 v[196:197], v69 offset:34816
    v_fma_f32 v228, v228, v221, v220
    v_mfma_f32_16x16x32_bf16 v[136:139], v[172:175], a[56:59], v[136:139]
    ds_read_b64_tr_b16 v[198:199], v69 offset:35328
    ds_read_b64_tr_b16 v[160:161], v70 offset:34816
    v_mfma_f32_16x16x32_bf16 v[140:143], v[172:175], a[60:63], v[140:143]
    v_fma_f32 v229, v229, v221, v220
    v_fma_f32 v230, v230, v221, v220
    s_waitcnt lgkmcnt(5)
    v_mfma_f32_16x16x32_bf16 v[80:83], v[176:179], a[64:67], v[80:83]
    buffer_load_dwordx4 v201, s[8:11], s47 offen offset:3072 lds
    v_mfma_f32_16x16x32_bf16 v[84:87], v[176:179], a[68:71], v[84:87]
    ds_read_b64_tr_b16 v[162:163], v70 offset:35328
    ds_read_b64_tr_b16 v[164:165], v71 offset:34816
    v_fma_f32 v231, v231, v221, v220
    v_mfma_f32_16x16x32_bf16 a[248:251], v[148:151], v[176:179], a[248:251]
    v_mul_f32 v228, v228, v12
    v_mul_f32 v229, v229, v13
    v_mfma_f32_16x16x32_bf16 v[88:91], v[180:183], a[64:67], v[88:91]
    ds_read_b64_tr_b16 v[166:167], v71 offset:35328
    ds_read_b64_tr_b16 v[168:169], v68 offset:40960
    v_mfma_f32_16x16x32_bf16 v[92:95], v[180:183], a[68:71], v[92:95]
    ds_read_b64_tr_b16 v[170:171], v68 offset:41472
    v_mul_f32 v230, v230, v14
    s_add_u32 m0, s66, 16384
    v_mfma_f32_16x16x32_bf16 v[96:99], v[184:187], a[64:67], v[96:99]
    buffer_load_dwordx4 v200, s[4:7], s48 offen offset:0 lds
    ds_read_b64_tr_b16 v[172:173], v69 offset:40960
    v_mfma_f32_16x16x32_bf16 v[100:103], v[184:187], a[68:71], v[100:103]
    ds_read_b64_tr_b16 v[174:175], v69 offset:41472
    v_mul_f32 v231, v231, v15
    v_mfma_f32_16x16x32_bf16 v[104:107], v[188:191], a[64:67], v[104:107]
    ds_read_b64_tr_b16 v[176:177], v70 offset:40960
    ds_read_b64_tr_b16 v[178:179], v70 offset:41472
    v_mfma_f32_16x16x32_bf16 v[108:111], v[188:191], a[68:71], v[108:111]
    v_exp_f32 v228, v228
    v_mul_f32 v44, v12, v44
    s_waitcnt lgkmcnt(6)
    v_mfma_f32_16x16x32_bf16 v[112:115], v[192:195], a[64:67], v[112:115]
    buffer_load_dwordx4 v201, s[4:7], s48 offen offset:1024 lds
    v_mfma_f32_16x16x32_bf16 v[116:119], v[192:195], a[68:71], v[116:119]
    ds_read_b64_tr_b16 v[180:181], v71 offset:40960
    ds_read_b64_tr_b16 v[182:183], v71 offset:41472
    v_mfma_f32_16x16x32_bf16 a[252:255], v[148:151], v[192:195], a[252:255]
    v_exp_f32 v229, v229
    v_mul_f32 v45, v13, v45
    v_mfma_f32_16x16x32_bf16 v[120:123], v[196:199], a[64:67], v[120:123]
    ds_read_b64_tr_b16 v[184:185], v68 offset:43008
    ds_read_b64_tr_b16 v[186:187], v68 offset:43520
    v_mfma_f32_16x16x32_bf16 v[124:127], v[196:199], a[68:71], v[124:127]
    v_exp_f32 v230, v230
    v_mul_f32 v46, v14, v46
    v_mfma_f32_16x16x32_bf16 v[128:131], v[160:163], a[64:67], v[128:131]
    buffer_load_dwordx4 v200, s[8:11], s48 offen offset:2048 lds
    ds_read_b64_tr_b16 v[188:189], v69 offset:43008
    v_mfma_f32_16x16x32_bf16 v[132:135], v[160:163], a[68:71], v[132:135]
    ds_read_b64_tr_b16 v[190:191], v69 offset:43520
    v_exp_f32 v231, v231
    v_mfma_f32_16x16x32_bf16 v[136:139], v[164:167], a[64:67], v[136:139]
    ds_read_b64_tr_b16 v[192:193], v70 offset:43008
    ds_read_b64_tr_b16 v[194:195], v70 offset:43520
    v_mul_f32 v47, v15, v47
    v_mfma_f32_16x16x32_bf16 v[140:143], v[164:167], a[68:71], v[140:143]
    v_fma_f32 v228, v228, v222, v222
    v_fma_f32 v229, v229, v222, v222
    s_waitcnt lgkmcnt(6)
    v_mfma_f32_16x16x32_bf16 v[80:83], v[168:171], a[72:75], v[80:83]
    buffer_load_dwordx4 v201, s[8:11], s48 offen offset:3072 lds
    v_mfma_f32_16x16x32_bf16 v[84:87], v[168:171], a[76:79], v[84:87]
    ds_read_b64_tr_b16 v[196:197], v71 offset:43008
    ds_read_b64_tr_b16 v[198:199], v71 offset:43520
    v_mfma_f32_16x16x32_bf16 a[248:251], v[148:151], v[168:171], a[248:251]
    buffer_load_dword v146, v158, s[20:23], s37 offen sc1
    v_fma_f32 v230, v230, v222, v222
    v_mfma_f32_16x16x32_bf16 v[88:91], v[172:175], a[72:75], v[88:91]
    ds_read_b64_tr_b16 v[160:161], v68 offset:49152
    ds_read_b64_tr_b16 v[162:163], v68 offset:49664
    v_mfma_f32_16x16x32_bf16 v[92:95], v[172:175], a[76:79], v[92:95]
    ds_read_b64_tr_b16 v[164:165], v69 offset:49152
    v_fma_f32 v231, v231, v222, v222
    v_mfma_f32_16x16x32_bf16 v[96:99], v[176:179], a[72:75], v[96:99]
    ds_read_b64_tr_b16 v[166:167], v69 offset:49664
    ds_read_b64_tr_b16 v[168:169], v70 offset:49152
    v_mfma_f32_16x16x32_bf16 v[100:103], v[176:179], a[76:79], v[100:103]
    v_rcp_f32 v228, v228
    v_rcp_f32 v229, v229
    v_mfma_f32_16x16x32_bf16 v[104:107], v[180:183], a[72:75], v[104:107]
    ds_read_b64_tr_b16 v[170:171], v70 offset:49664
    ds_read_b64_tr_b16 v[172:173], v71 offset:49152
    v_mfma_f32_16x16x32_bf16 v[108:111], v[180:183], a[76:79], v[108:111]
    v_rcp_f32 v230, v230
    s_waitcnt lgkmcnt(7)
    v_mfma_f32_16x16x32_bf16 v[112:115], v[184:187], a[72:75], v[112:115]
    ds_read_b64_tr_b16 v[174:175], v71 offset:49664
    ds_read_b64_tr_b16 v[176:177], v68 offset:51200
    v_mfma_f32_16x16x32_bf16 v[116:119], v[184:187], a[76:79], v[116:119]
    v_rcp_f32 v231, v231
    v_mul_f32 v44, v44, v228
    v_mfma_f32_16x16x32_bf16 a[252:255], v[148:151], v[184:187], a[252:255]
    v_mul_f32 v45, v45, v229
    v_mul_f32 v46, v46, v230
    v_mul_f32 v47, v47, v231
    v_mfma_f32_16x16x32_bf16 v[120:123], v[188:191], a[72:75], v[120:123]
    ds_read_b64_tr_b16 v[178:179], v68 offset:51712
    ds_read_b64_tr_b16 v[180:181], v69 offset:51200
    v_mfma_f32_16x16x32_bf16 v[124:127], v[188:191], a[76:79], v[124:127]
    v_cvt_pk_bf16_f32 v238, v44, v45
    v_cvt_pk_bf16_f32 v239, v46, v47
    v_mul_f32 v224, v16, v16
    v_mfma_f32_16x16x32_bf16 v[128:131], v[192:195], a[72:75], v[128:131]
    ds_read_b64_tr_b16 v[182:183], v69 offset:51712
    ds_read_b64_tr_b16 v[184:185], v70 offset:51200
    v_mul_f32 v225, v17, v17
    v_mfma_f32_16x16x32_bf16 v[132:135], v[192:195], a[76:79], v[132:135]
    v_mul_f32 v226, v18, v18
    v_mul_f32 v227, v19, v19
    v_permlane16_swap_b32 v236, v238
    v_mfma_f32_16x16x32_bf16 v[136:139], v[196:199], a[72:75], v[136:139]
    ds_read_b64_tr_b16 v[186:187], v70 offset:51712
    ds_read_b64_tr_b16 v[188:189], v71 offset:51200
    v_mfma_f32_16x16x32_bf16 v[140:143], v[196:199], a[76:79], v[140:143]
    v_permlane16_swap_b32 v237, v239
    buffer_store_dwordx4 v[236:239], v152, s[20:23], s60 offen offset:256 sc1
    s_waitcnt lgkmcnt(7)
    v_mfma_f32_16x16x32_bf16 v[80:83], v[160:163], a[80:83], v[80:83]
    ds_read_b64_tr_b16 v[190:191], v71 offset:51712
    ds_read_b64_tr_b16 v[192:193], v68 offset:57344
    v_mfma_f32_16x16x32_bf16 v[84:87], v[160:163], a[84:87], v[84:87]
    ds_read_b64_tr_b16 v[194:195], v68 offset:57856
    v_fma_f32 v224, v224, v217, v216
    v_mfma_f32_16x16x32_bf16 a[248:251], v[148:151], v[160:163], a[248:251]
    v_fma_f32 v225, v225, v217, v216
    v_fma_f32 v226, v226, v217, v216
    v_mfma_f32_16x16x32_bf16 v[88:91], v[164:167], a[80:83], v[88:91]
    ds_read_b64_tr_b16 v[196:197], v69 offset:57344
    ds_read_b64_tr_b16 v[198:199], v69 offset:57856
    v_mfma_f32_16x16x32_bf16 v[92:95], v[164:167], a[84:87], v[92:95]
    v_fma_f32 v227, v227, v217, v216
    v_mul_f32 v224, v224, v16
    v_mul_f32 v225, v225, v17
    v_mfma_f32_16x16x32_bf16 v[96:99], v[168:171], a[80:83], v[96:99]
    ds_read_b64_tr_b16 v[160:161], v70 offset:57344
    ds_read_b64_tr_b16 v[162:163], v70 offset:57856
    v_mul_f32 v226, v226, v18
    v_mfma_f32_16x16x32_bf16 v[100:103], v[168:171], a[84:87], v[100:103]
    v_mul_f32 v227, v227, v19
    v_exp_f32 v224, v224
    v_mfma_f32_16x16x32_bf16 v[104:107], v[172:175], a[80:83], v[104:107]
    ds_read_b64_tr_b16 v[164:165], v71 offset:57344
    ds_read_b64_tr_b16 v[166:167], v71 offset:57856
    v_mfma_f32_16x16x32_bf16 v[108:111], v[172:175], a[84:87], v[108:111]
    v_mul_f32 v48, v16, v48
    v_exp_f32 v225, v225
    s_waitcnt lgkmcnt(8)
    v_mfma_f32_16x16x32_bf16 v[112:115], v[176:179], a[80:83], v[112:115]
    ds_read_b64_tr_b16 v[168:169], v68 offset:59392
    ds_read_b64_tr_b16 v[170:171], v68 offset:59904
    v_mfma_f32_16x16x32_bf16 v[116:119], v[176:179], a[84:87], v[116:119]
    v_mul_f32 v49, v17, v49
    v_exp_f32 v226, v226
    v_mfma_f32_16x16x32_bf16 a[252:255], v[148:151], v[176:179], a[252:255]
    v_mul_f32 v50, v18, v50
    v_exp_f32 v227, v227
    v_mfma_f32_16x16x32_bf16 v[120:123], v[180:183], a[80:83], v[120:123]
    ds_read_b64_tr_b16 v[172:173], v69 offset:59392
    ds_read_b64_tr_b16 v[174:175], v69 offset:59904
    v_mul_f32 v51, v19, v51
    v_mfma_f32_16x16x32_bf16 v[124:127], v[180:183], a[84:87], v[124:127]
    v_fma_f32 v224, v224, v218, v218
    v_fma_f32 v225, v225, v218, v218
    v_mfma_f32_16x16x32_bf16 v[128:131], v[184:187], a[80:83], v[128:131]
    ds_read_b64_tr_b16 v[176:177], v70 offset:59392
    ds_read_b64_tr_b16 v[178:179], v70 offset:59904
    v_mfma_f32_16x16x32_bf16 v[132:135], v[184:187], a[84:87], v[132:135]
    v_fma_f32 v226, v226, v218, v218
    v_fma_f32 v227, v227, v218, v218
    v_mfma_f32_16x16x32_bf16 v[136:139], v[188:191], a[80:83], v[136:139]
    ds_read_b64_tr_b16 v[180:181], v71 offset:59392
    ds_read_b64_tr_b16 v[182:183], v71 offset:59904
    v_mfma_f32_16x16x32_bf16 v[140:143], v[188:191], a[84:87], v[140:143]
    v_rcp_f32 v224, v224
    s_waitcnt lgkmcnt(8)
    v_mfma_f32_16x16x32_bf16 v[80:83], v[192:195], a[88:91], v[80:83]
    v_rcp_f32 v225, v225
    v_mfma_f32_16x16x32_bf16 v[84:87], v[192:195], a[92:95], v[84:87]
    v_rcp_f32 v226, v226
    v_rcp_f32 v227, v227
    v_mfma_f32_16x16x32_bf16 a[248:251], v[148:151], v[192:195], a[248:251]
    v_mul_f32 v48, v48, v224
    v_mul_f32 v49, v49, v225
    v_mfma_f32_16x16x32_bf16 v[88:91], v[196:199], a[88:91], v[88:91]
    v_mfma_f32_16x16x32_bf16 v[92:95], v[196:199], a[92:95], v[92:95]
    s_waitcnt vmcnt(22) lgkmcnt(0)
    s_barrier
    s_add_u32 m0, s66, 98304
    v_mfma_f32_16x16x32_bf16 v[96:99], v[160:163], a[88:91], v[96:99]
    buffer_load_dwordx4 v200, s[4:7], s51 offen offset:0 lds
    ds_read_b64_tr_b16 v[184:185], v68 offset:0
    v_mfma_f32_16x16x32_bf16 v[100:103], v[160:163], a[92:95], v[100:103]
    ds_read_b64_tr_b16 v[186:187], v68 offset:512
    ds_read_b64_tr_b16 v[188:189], v69 offset:0
    v_mfma_f32_16x16x32_bf16 v[104:107], v[164:167], a[88:91], v[104:107]
    ds_read_b64_tr_b16 v[190:191], v69 offset:512
    ds_read_b64_tr_b16 v[192:193], v70 offset:0
    v_mul_f32 v50, v50, v226
    v_mfma_f32_16x16x32_bf16 v[108:111], v[164:167], a[92:95], v[108:111]
    v_mul_f32 v51, v51, v227
    v_cvt_pk_bf16_f32 v232, v48, v49
    v_mfma_f32_16x16x32_bf16 v[112:115], v[168:171], a[88:91], v[112:115]
    buffer_load_dwordx4 v201, s[4:7], s51 offen offset:1024 lds
    v_mfma_f32_16x16x32_bf16 v[116:119], v[168:171], a[92:95], v[116:119]
    ds_read_b64_tr_b16 v[194:195], v70 offset:512
    ds_read_b64_tr_b16 v[196:197], v71 offset:0
    v_cvt_pk_bf16_f32 v233, v50, v51
    v_mfma_f32_16x16x32_bf16 a[252:255], v[148:151], v[168:171], a[252:255]
    v_mul_f32 v228, v24, v24
    v_mul_f32 v229, v25, v25
    v_mfma_f32_16x16x32_bf16 v[120:123], v[172:175], a[88:91], v[120:123]
    ds_read_b64_tr_b16 v[198:199], v71 offset:512
    ds_read_b64_tr_b16 v[160:161], v68 offset:2048
    v_mfma_f32_16x16x32_bf16 v[124:127], v[172:175], a[92:95], v[124:127]
    v_mul_f32 v230, v26, v26
    v_mul_f32 v231, v27, v27
    v_fma_f32 v228, v228, v217, v216
    v_mfma_f32_16x16x32_bf16 v[128:131], v[176:179], a[88:91], v[128:131]
    buffer_load_dwordx4 v200, s[8:11], s51 offen offset:2048 lds
    ds_read_b64_tr_b16 v[162:163], v68 offset:2560
    v_mfma_f32_16x16x32_bf16 v[132:135], v[176:179], a[92:95], v[132:135]
    ds_read_b64_tr_b16 v[164:165], v69 offset:2048
    v_fma_f32 v229, v229, v217, v216
    v_mfma_f32_16x16x32_bf16 v[136:139], v[180:183], a[88:91], v[136:139]
    ds_read_b64_tr_b16 v[166:167], v69 offset:2560
    ds_read_b64_tr_b16 v[168:169], v70 offset:2048
    v_fma_f32 v230, v230, v217, v216
    v_mfma_f32_16x16x32_bf16 v[140:143], v[180:183], a[92:95], v[140:143]
    v_fma_f32 v231, v231, v217, v216
    v_mul_f32 v228, v228, v24
    s_waitcnt lgkmcnt(5)
    v_mfma_f32_16x16x32_bf16 v[80:83], v[184:187], a[96:99], v[80:83]
    buffer_load_dwordx4 v201, s[8:11], s51 offen offset:3072 lds
    v_mfma_f32_16x16x32_bf16 v[84:87], v[184:187], a[100:103], v[84:87]
    ds_read_b64_tr_b16 v[170:171], v70 offset:2560
    ds_read_b64_tr_b16 v[172:173], v71 offset:2048
    v_mul_f32 v229, v229, v25
    v_mfma_f32_16x16x32_bf16 a[248:251], v[148:151], v[184:187], a[248:251]
    v_mul_f32 v230, v230, v26
    v_mul_f32 v231, v231, v27
    v_mfma_f32_16x16x32_bf16 v[88:91], v[188:191], a[96:99], v[88:91]
    ds_read_b64_tr_b16 v[174:175], v71 offset:2560
    ds_read_b64_tr_b16 v[176:177], v68 offset:8192
    v_mfma_f32_16x16x32_bf16 v[92:95], v[188:191], a[100:103], v[92:95]
    ds_read_b64_tr_b16 v[178:179], v68 offset:8704
    s_add_u32 m0, s66, 114688
    v_mfma_f32_16x16x32_bf16 v[96:99], v[192:195], a[96:99], v[96:99]
    buffer_load_dwordx4 v200, s[4:7], s52 offen offset:0 lds
    ds_read_b64_tr_b16 v[180:181], v69 offset:8192
    v_mfma_f32_16x16x32_bf16 v[100:103], v[192:195], a[100:103], v[100:103]
    ds_read_b64_tr_b16 v[182:183], v69 offset:8704
    v_exp_f32 v228, v228
    v_mfma_f32_16x16x32_bf16 v[104:107], v[196:199], a[96:99], v[104:107]
    ds_read_b64_tr_b16 v[184:185], v70 offset:8192
    ds_read_b64_tr_b16 v[186:187], v70 offset:8704
    v_mfma_f32_16x16x32_bf16 v[108:111], v[196:199], a[100:103], v[108:111]
    v_mul_f32 v56, v24, v56
    v_exp_f32 v229, v229
    s_waitcnt lgkmcnt(6)
    v_mfma_f32_16x16x32_bf16 v[112:115], v[160:163], a[96:99], v[112:115]
    buffer_load_dwordx4 v201, s[4:7], s52 offen offset:1024 lds
    v_mfma_f32_16x16x32_bf16 v[116:119], v[160:163], a[100:103], v[116:119]
    ds_read_b64_tr_b16 v[188:189], v71 offset:8192
    ds_read_b64_tr_b16 v[190:191], v71 offset:8704
    s_waitcnt vmcnt(7)
    v_mfma_f32_16x16x32_bf16 a[252:255], v[148:151], v[160:163], a[252:255]
    v_cmp_ne_u32 vcc, v146, v145
    s_nop 3
    s_cmp_eq_u64 vcc, 0
    s_cselect_b32 s101, s101, 1073741824
    s_cselect_b32 s75, s75, 1073741824
    s_cselect_b32 s0, s0, 1073741824
    v_mul_f32 v57, v25, v57
    v_mfma_f32_16x16x32_bf16 v[120:123], v[164:167], a[96:99], v[120:123]
    ds_read_b64_tr_b16 v[192:193], v68 offset:10240
    ds_read_b64_tr_b16 v[194:195], v68 offset:10752
    v_mfma_f32_16x16x32_bf16 v[124:127], v[164:167], a[100:103], v[124:127]
    v_exp_f32 v230, v230
    v_mul_f32 v58, v26, v58
    v_mfma_f32_16x16x32_bf16 v[128:131], v[168:171], a[96:99], v[128:131]
    buffer_load_dwordx4 v200, s[8:11], s52 offen offset:2048 lds
    ds_read_b64_tr_b16 v[196:197], v69 offset:10240
    v_mfma_f32_16x16x32_bf16 v[132:135], v[168:171], a[100:103], v[132:135]
    ds_read_b64_tr_b16 v[198:199], v69 offset:10752
    v_exp_f32 v231, v231
    v_mfma_f32_16x16x32_bf16 v[136:139], v[172:175], a[96:99], v[136:139]
    ds_read_b64_tr_b16 v[160:161], v70 offset:10240
    ds_read_b64_tr_b16 v[162:163], v70 offset:10752
    v_mul_f32 v59, v27, v59
    v_mfma_f32_16x16x32_bf16 v[140:143], v[172:175], a[100:103], v[140:143]
    v_fma_f32 v228, v228, v218, v218
    v_fma_f32 v229, v229, v218, v218
    s_waitcnt lgkmcnt(6)
    v_mfma_f32_16x16x32_bf16 v[80:83], v[176:179], a[104:107], v[80:83]
    buffer_load_dwordx4 v201, s[8:11], s52 offen offset:3072 lds
    ds_read_b64_tr_b16 v[164:165], v71 offset:10240
    v_mfma_f32_16x16x32_bf16 v[84:87], v[176:179], a[108:111], v[84:87]
    ds_read_b64_tr_b16 v[166:167], v71 offset:10752
    v_fma_f32 v230, v230, v218, v218
    v_mfma_f32_16x16x32_bf16 a[248:251], v[148:151], v[176:179], a[248:251]
    v_fma_f32 v231, v231, v218, v218
    s_add_u32 s100, s75, 0
    v_mfma_f32_16x16x32_bf16 v[88:91], v[180:183], a[104:107], v[88:91]
    buffer_load_dwordx4 a[160:163], v209, s[20:23], s100 offen offset:0 sc1
    ds_read_b64_tr_b16 v[168:169], v68 offset:16384
    v_mfma_f32_16x16x32_bf16 v[92:95], v[180:183], a[108:111], v[92:95]
    ds_read_b64_tr_b16 v[170:171], v68 offset:16896
    ds_read_b64_tr_b16 v[172:173], v69 offset:16384
    v_mfma_f32_16x16x32_bf16 v[96:99], v[184:187], a[104:107], v[96:99]
    ds_read_b64_tr_b16 v[174:175], v69 offset:16896
    ds_read_b64_tr_b16 v[176:177], v70 offset:16384
    v_mfma_f32_16x16x32_bf16 v[100:103], v[184:187], a[108:111], v[100:103]
    v_rcp_f32 v228, v228
    v_rcp_f32 v229, v229
    v_mfma_f32_16x16x32_bf16 v[104:107], v[188:191], a[104:107], v[104:107]
    ds_read_b64_tr_b16 v[178:179], v70 offset:16896
    ds_read_b64_tr_b16 v[180:181], v71 offset:16384
    v_mfma_f32_16x16x32_bf16 v[108:111], v[188:191], a[108:111], v[108:111]
    v_rcp_f32 v230, v230
    s_waitcnt lgkmcnt(7)
    v_mfma_f32_16x16x32_bf16 v[112:115], v[192:195], a[104:107], v[112:115]
    buffer_load_dwordx4 a[164:167], v209, s[20:23], s100 offen offset:1024 sc1
    ds_read_b64_tr_b16 v[182:183], v71 offset:16896
    v_mfma_f32_16x16x32_bf16 v[116:119], v[192:195], a[108:111], v[116:119]
    ds_read_b64_tr_b16 v[184:185], v68 offset:18432
    v_rcp_f32 v231, v231
    v_mfma_f32_16x16x32_bf16 a[252:255], v[148:151], v[192:195], a[252:255]
    v_mul_f32 v56, v56, v228
    v_mul_f32 v57, v57, v229
    v_mfma_f32_16x16x32_bf16 v[120:123], v[196:199], a[104:107], v[120:123]
    ds_read_b64_tr_b16 v[186:187], v68 offset:18944
    ds_read_b64_tr_b16 v[188:189], v69 offset:18432
    v_mfma_f32_16x16x32_bf16 v[124:127], v[196:199], a[108:111], v[124:127]
    v_mul_f32 v58, v58, v230
    v_mul_f32 v59, v59, v231
    v_cvt_pk_bf16_f32 v234, v56, v57
    v_mfma_f32_16x16x32_bf16 v[128:131], v[160:163], a[104:107], v[128:131]
    ds_read_b64_tr_b16 v[190:191], v69 offset:18944
    ds_read_b64_tr_b16 v[192:193], v70 offset:18432
    v_mfma_f32_16x16x32_bf16 v[132:135], v[160:163], a[108:111], v[132:135]
    v_cvt_pk_bf16_f32 v235, v58, v59
    v_mul_f32 v224, v20, v20
    v_mul_f32 v225, v21, v21
    v_mfma_f32_16x16x32_bf16 v[136:139], v[164:167], a[104:107], v[136:139]
    buffer_load_dwordx4 a[168:171], v209, s[20:23], s100 offen offset:2048 sc1
    ds_read_b64_tr_b16 v[194:195], v70 offset:18944
    v_mfma_f32_16x16x32_bf16 v[140:143], v[164:167], a[108:111], v[140:143]
    ds_read_b64_tr_b16 v[196:197], v71 offset:18432
    v_mul_f32 v226, v22, v22
    s_waitcnt lgkmcnt(7)
    v_mfma_f32_16x16x32_bf16 v[80:83], v[168:171], a[112:115], v[80:83]
    ds_read_b64_tr_b16 v[198:199], v71 offset:18944
    ds_read_b64_tr_b16 v[160:161], v68 offset:24576
    v_mfma_f32_16x16x32_bf16 v[84:87], v[168:171], a[116:119], v[84:87]
    ds_read_b64_tr_b16 v[162:163], v68 offset:25088
    v_mul_f32 v227, v23, v23
    v_mfma_f32_16x16x32_bf16 a[248:251], v[148:151], v[168:171], a[248:251]
    v_permlane16_swap_b32 v232, v234
    v_permlane16_swap_b32 v233, v235
    v_mfma_f32_16x16x32_bf16 v[88:91], v[172:175], a[112:115], v[88:91]
    ds_read_b64_tr_b16 v[164:165], v69 offset:24576
    ds_read_b64_tr_b16 v[166:167], v69 offset:25088
    v_mfma_f32_16x16x32_bf16 v[92:95], v[172:175], a[116:119], v[92:95]
    buffer_store_dwordx4 v[232:235], v153, s[20:23], s60 offen offset:0 sc1
    v_fma_f32 v224, v224, v221, v220
    v_mfma_f32_16x16x32_bf16 v[96:99], v[176:179], a[112:115], v[96:99]
    buffer_load_dwordx4 a[172:175], v209, s[20:23], s100 offen offset:3072 sc1
    ds_read_b64_tr_b16 v[168:169], v70 offset:24576
    v_mfma_f32_16x16x32_bf16 v[100:103], v[176:179], a[116:119], v[100:103]
    ds_read_b64_tr_b16 v[170:171], v70 offset:25088
    v_fma_f32 v225, v225, v221, v220
    v_mfma_f32_16x16x32_bf16 v[104:107], v[180:183], a[112:115], v[104:107]
    ds_read_b64_tr_b16 v[172:173], v71 offset:24576
    ds_read_b64_tr_b16 v[174:175], v71 offset:25088
    v_fma_f32 v226, v226, v221, v220
    v_mfma_f32_16x16x32_bf16 v[108:111], v[180:183], a[116:119], v[108:111]
    v_fma_f32 v227, v227, v221, v220
    v_mul_f32 v224, v224, v20
    s_waitcnt lgkmcnt(8)
    v_mfma_f32_16x16x32_bf16 v[112:115], v[184:187], a[112:115], v[112:115]
    ds_read_b64_tr_b16 v[176:177], v68 offset:26624
    ds_read_b64_tr_b16 v[178:179], v68 offset:27136
    v_mfma_f32_16x16x32_bf16 v[116:119], v[184:187], a[116:119], v[116:119]
    v_mul_f32 v225, v225, v21
    v_mul_f32 v226, v226, v22
    v_mul_f32 v227, v227, v23
    v_mfma_f32_16x16x32_bf16 a[252:255], v[148:151], v[184:187], a[252:255]
    v_exp_f32 v224, v224
    v_mul_f32 v52, v20, v52
    v_mfma_f32_16x16x32_bf16 v[120:123], v[188:191], a[112:115], v[120:123]
    buffer_load_dwordx4 a[176:179], v159, s[20:23], s100 offen offset:0 sc1
    ds_read_b64_tr_b16 v[180:181], v69 offset:26624
    v_mfma_f32_16x16x32_bf16 v[124:127], v[188:191], a[116:119], v[124:127]
    ds_read_b64_tr_b16 v[182:183], v69 offset:27136
    v_exp_f32 v225, v225
    v_mfma_f32_16x16x32_bf16 v[128:131], v[192:195], a[112:115], v[128:131]
    ds_read_b64_tr_b16 v[184:185], v70 offset:26624
    ds_read_b64_tr_b16 v[186:187], v70 offset:27136
    v_mul_f32 v53, v21, v53
    v_mfma_f32_16x16x32_bf16 v[132:135], v[192:195], a[116:119], v[132:135]
    v_exp_f32 v226, v226
    v_mul_f32 v54, v22, v54
    v_mfma_f32_16x16x32_bf16 v[136:139], v[196:199], a[112:115], v[136:139]
    ds_read_b64_tr_b16 v[188:189], v71 offset:26624
    ds_read_b64_tr_b16 v[190:191], v71 offset:27136
    v_mfma_f32_16x16x32_bf16 v[140:143], v[196:199], a[116:119], v[140:143]
    v_exp_f32 v227, v227
    s_add_u32 s100, s75, 5120
    s_waitcnt lgkmcnt(8)
    v_mfma_f32_16x16x32_bf16 v[80:83], v[160:163], a[120:123], v[80:83]
    buffer_load_dwordx4 a[180:183], v209, s[20:23], s100 offen offset:0 sc1
    v_mul_f32 v55, v23, v55
    v_mfma_f32_16x16x32_bf16 v[84:87], v[160:163], a[124:127], v[84:87]
    v_fma_f32 v224, v224, v222, v222
    v_fma_f32 v225, v225, v222, v222
    v_mfma_f32_16x16x32_bf16 a[248:251], v[148:151], v[160:163], a[248:251]
    v_fma_f32 v226, v226, v222, v222
    v_fma_f32 v227, v227, v222, v222
    v_mfma_f32_16x16x32_bf16 v[88:91], v[164:167], a[120:123], v[88:91]
    v_mfma_f32_16x16x32_bf16 v[92:95], v[164:167], a[124:127], v[92:95]
    s_waitcnt lgkmcnt(0)
    s_barrier
    s_add_u32 m0, s66, 65536
    v_mfma_f32_16x16x32_bf16 v[96:99], v[168:171], a[120:123], v[96:99]
    buffer_load_dwordx4 v200, s[4:7], s55 offen offset:0 lds
    ds_read_b64_tr_b16 v[192:193], v64 offset:32768
    v_mfma_f32_16x16x32_bf16 v[100:103], v[168:171], a[124:127], v[100:103]
    ds_read_b64_tr_b16 v[194:195], v64 offset:33280
    ds_read_b64_tr_b16 v[196:197], v64 offset:34816
    v_mfma_f32_16x16x32_bf16 v[104:107], v[172:175], a[120:123], v[104:107]
    buffer_load_dwordx4 a[184:187], v209, s[20:23], s100 offen offset:1024 sc1
    v_mfma_f32_16x16x32_bf16 v[108:111], v[172:175], a[124:127], v[108:111]
    ds_read_b64_tr_b16 v[198:199], v64 offset:35328
    ds_read_b64_tr_b16 v[160:161], v64 offset:40960
    v_mfma_f32_16x16x32_bf16 v[112:115], v[176:179], a[120:123], v[112:115]
    buffer_load_dwordx4 v201, s[4:7], s55 offen offset:1024 lds
    ds_read_b64_tr_b16 v[162:163], v64 offset:41472
    v_mfma_f32_16x16x32_bf16 v[116:119], v[176:179], a[124:127], v[116:119]
    ds_read_b64_tr_b16 v[164:165], v64 offset:43008
    v_rcp_f32 v224, v224
    v_mfma_f32_16x16x32_bf16 a[252:255], v[148:151], v[176:179], a[252:255]
    v_rcp_f32 v225, v225
    v_mfma_f32_16x16x32_bf16 v[120:123], v[180:183], a[120:123], v[120:123]
    ds_read_b64_tr_b16 v[166:167], v64 offset:43520
    ds_read_b64_tr_b16 v[168:169], v64 offset:49152
    v_mfma_f32_16x16x32_bf16 v[124:127], v[180:183], a[124:127], v[124:127]
    v_rcp_f32 v226, v226
    v_rcp_f32 v227, v227
    v_mfma_f32_16x16x32_bf16 v[128:131], v[184:187], a[120:123], v[128:131]
    buffer_load_dwordx4 v200, s[8:11], s55 offen offset:2048 lds
    ds_read_b64_tr_b16 v[170:171], v64 offset:49664
    v_mfma_f32_16x16x32_bf16 v[132:135], v[184:187], a[124:127], v[132:135]
    ds_read_b64_tr_b16 v[172:173], v64 offset:51200
    v_mul_f32 v52, v52, v224
    v_mul_f32 v53, v53, v225
    v_mfma_f32_16x16x32_bf16 v[136:139], v[188:191], a[120:123], v[136:139]
    buffer_load_dwordx4 a[188:191], v209, s[20:23], s100 offen offset:2048 sc1
    ds_read_b64_tr_b16 v[174:175], v64 offset:51712
    v_mfma_f32_16x16x32_bf16 v[140:143], v[188:191], a[124:127], v[140:143]
    ds_read_b64_tr_b16 v[176:177], v64 offset:57344
    v_mul_f32 v54, v54, v226
    s_waitcnt lgkmcnt(5)
    v_mfma_f32_16x16x32_bf16 v[80:83], v[192:195], a[128:131], v[80:83]
    buffer_load_dwordx4 v201, s[8:11], s55 offen offset:3072 lds
    ds_read_b64_tr_b16 v[178:179], v64 offset:57856
    v_mfma_f32_16x16x32_bf16 v[84:87], v[192:195], a[132:135], v[84:87]
    ds_read_b64_tr_b16 v[180:181], v64 offset:59392
    v_mul_f32 v55, v55, v227
    v_mfma_f32_16x16x32_bf16 a[248:251], v[148:151], v[192:195], a[248:251]
    v_cvt_pk_bf16_f32 v236, v52, v53
    v_cvt_pk_bf16_f32 v237, v54, v55
    v_mfma_f32_16x16x32_bf16 v[112:115], v[196:199], a[128:131], v[112:115]
    ds_read_b64_tr_b16 v[182:183], v64 offset:59904
    ds_read_b64_tr_b16 v[184:185], v65 offset:32768
    v_mfma_f32_16x16x32_bf16 v[116:119], v[196:199], a[132:135], v[116:119]
    ds_read_b64_tr_b16 v[186:187], v65 offset:33280
    v_mul_f32 v228, v28, v28
    v_mul_f32 v229, v29, v29
    v_mfma_f32_16x16x32_bf16 a[252:255], v[148:151], v[196:199], a[252:255]
    v_mul_f32 v230, v30, v30
    s_add_u32 m0, s66, 81920
    v_mfma_f32_16x16x32_bf16 v[80:83], v[160:163], a[136:139], v[80:83]
    buffer_load_dwordx4 v200, s[4:7], s56 offen offset:0 lds
    ds_read_b64_tr_b16 v[188:189], v66 offset:32768
    v_mfma_f32_16x16x32_bf16 v[84:87], v[160:163], a[140:143], v[84:87]
    ds_read_b64_tr_b16 v[190:191], v66 offset:33280
    v_mul_f32 v231, v31, v31
    v_mfma_f32_16x16x32_bf16 a[248:251], v[148:151], v[160:163], a[248:251]
    v_fma_f32 v228, v228, v221, v220
    v_fma_f32 v229, v229, v221, v220
    v_mfma_f32_16x16x32_bf16 v[112:115], v[164:167], a[136:139], v[112:115]
    buffer_load_dwordx4 a[192:195], v209, s[20:23], s100 offen offset:3072 sc1
    ds_read_b64_tr_b16 v[192:193], v67 offset:32768
    v_mfma_f32_16x16x32_bf16 v[116:119], v[164:167], a[140:143], v[116:119]
    ds_read_b64_tr_b16 v[194:195], v67 offset:33280
    v_fma_f32 v230, v230, v221, v220
    v_mfma_f32_16x16x32_bf16 a[252:255], v[148:151], v[164:167], a[252:255]
    v_fma_f32 v231, v231, v221, v220
    v_mul_f32 v228, v228, v28
    s_waitcnt lgkmcnt(6)
    v_mfma_f32_16x16x32_bf16 v[80:83], v[168:171], a[144:147], v[80:83]
    buffer_load_dwordx4 v201, s[4:7], s56 offen offset:1024 lds
    v_mfma_f32_16x16x32_bf16 v[84:87], v[168:171], a[148:151], v[84:87]
    ds_read_b64_tr_b16 v[196:197], v65 offset:34816
    ds_read_b64_tr_b16 v[198:199], v65 offset:35328
    v_mul_f32 v229, v229, v29
    v_mfma_f32_16x16x32_bf16 a[248:251], v[148:151], v[168:171], a[248:251]
    v_mul_f32 v230, v230, v30
    v_mul_f32 v231, v231, v31
    v_mfma_f32_16x16x32_bf16 v[112:115], v[172:175], a[144:147], v[112:115]
    ds_read_b64_tr_b16 v[160:161], v66 offset:34816
    ds_read_b64_tr_b16 v[162:163], v66 offset:35328
    v_mfma_f32_16x16x32_bf16 v[116:119], v[172:175], a[148:151], v[116:119]
    v_exp_f32 v228, v228
    v_mul_f32 v60, v28, v60
    v_mfma_f32_16x16x32_bf16 a[252:255], v[148:151], v[172:175], a[252:255]
    v_exp_f32 v229, v229
    v_mul_f32 v61, v29, v61
    v_mfma_f32_16x16x32_bf16 v[80:83], v[176:179], a[152:155], v[80:83]
    buffer_load_dwordx4 v200, s[8:11], s56 offen offset:2048 lds
    v_mfma_f32_16x16x32_bf16 v[84:87], v[176:179], a[156:159], v[84:87]
    ds_read_b64_tr_b16 v[164:165], v67 offset:34816
    ds_read_b64_tr_b16 v[166:167], v67 offset:35328
    v_mfma_f32_16x16x32_bf16 a[248:251], v[148:151], v[176:179], a[248:251]
    v_exp_f32 v230, v230
    v_mul_f32 v62, v30, v62
    v_mfma_f32_16x16x32_bf16 v[112:115], v[180:183], a[152:155], v[112:115]
    buffer_load_dwordx4 a[196:199], v159, s[20:23], s100 offen offset:0 sc1
    ds_read_b64_tr_b16 v[168:169], v65 offset:40960
    v_mfma_f32_16x16x32_bf16 v[116:119], v[180:183], a[156:159], v[116:119]
    ds_read_b64_tr_b16 v[170:171], v65 offset:41472
    v_mfma_f32_16x16x32_bf16 a[252:255], v[148:151], v[180:183], a[252:255]
    v_exp_f32 v231, v231
    v_mul_f32 v63, v31, v63
    s_waitcnt lgkmcnt(6)
    v_mfma_f32_16x16x32_bf16 v[88:91], v[184:187], a[128:131], v[88:91]
    buffer_load_dwordx4 v201, s[8:11], s56 offen offset:3072 lds
    ds_read_b64_tr_b16 v[172:173], v66 offset:40960
    v_mfma_f32_16x16x32_bf16 v[92:95], v[184:187], a[132:135], v[92:95]
    ds_read_b64_tr_b16 v[174:175], v66 offset:41472
    v_fma_f32 v228, v228, v222, v222
    v_mfma_f32_16x16x32_bf16 v[96:99], v[188:191], a[128:131], v[96:99]
    ds_read_b64_tr_b16 v[176:177], v67 offset:40960
    ds_read_b64_tr_b16 v[178:179], v67 offset:41472
    ds_read_b64_tr_b16 v[180:181], v65 offset:43008
    v_mfma_f32_16x16x32_bf16 v[100:103], v[188:191], a[132:135], v[100:103]
    v_fma_f32 v229, v229, v222, v222
    s_add_u32 s100, s75, 10240
    v_mfma_f32_16x16x32_bf16 v[104:107], v[192:195], a[128:131], v[104:107]
    buffer_load_dwordx4 a[200:203], v209, s[20:23], s100 offen offset:0 sc1
    ds_read_b64_tr_b16 v[182:183], v65 offset:43520
    v_mfma_f32_16x16x32_bf16 v[108:111], v[192:195], a[132:135], v[108:111]
    ds_read_b64_tr_b16 v[184:185], v66 offset:43008
    v_accvgpr_read_b32 v240, a248
    v_mfma_f32_16x16x32_bf16 v[120:123], v[196:199], a[128:131], v[120:123]
    ds_read_b64_tr_b16 v[186:187], v66 offset:43520
    ds_read_b64_tr_b16 v[188:189], v67 offset:43008
    v_accvgpr_read_b32 v241, a252
    v_mfma_f32_16x16x32_bf16 v[124:127], v[196:199], a[132:135], v[124:127]
    v_xor_b32 v244, 8, v156
    v_fma_f32 v230, v230, v222, v222
    s_waitcnt lgkmcnt(7)
    v_mfma_f32_16x16x32_bf16 v[128:131], v[160:163], a[128:131], v[128:131]
    ds_read_b64_tr_b16 v[190:191], v67 offset:43520
    ds_read_b64_tr_b16 v[192:193], v65 offset:49152
    v_mfma_f32_16x16x32_bf16 v[132:135], v[160:163], a[132:135], v[132:135]
    v_xor_b32 v245, 16, v156
    v_xor_b32 v246, 24, v156
    v_and_b32 v242, 0xffff0000, v240
    v_mfma_f32_16x16x32_bf16 v[136:139], v[164:167], a[128:131], v[136:139]
    buffer_load_dwordx4 a[204:207], v209, s[20:23], s100 offen offset:1024 sc1
    ds_read_b64_tr_b16 v[194:195], v65 offset:49664
    v_mfma_f32_16x16x32_bf16 v[140:143], v[164:167], a[132:135], v[140:143]
    ds_read_b64_tr_b16 v[196:197], v66 offset:49152
    v_sub_f32 v240, v240, v242
    v_mfma_f32_16x16x32_bf16 v[88:91], v[168:171], a[136:139], v[88:91]
    ds_read_b64_tr_b16 v[198:199], v66 offset:49664
    ds_read_b64_tr_b16 v[160:161], v67 offset:49152
    v_cvt_pk_bf16_f32 v240, v242, v240
    v_mfma_f32_16x16x32_bf16 v[92:95], v[168:171], a[140:143], v[92:95]
    v_and_b32 v243, 0xffff0000, v241
    v_fma_f32 v231, v231, v222, v222
    v_mfma_f32_16x16x32_bf16 v[96:99], v[172:175], a[136:139], v[96:99]
    ds_read_b64_tr_b16 v[162:163], v67 offset:49664
    ds_read_b64_tr_b16 v[164:165], v65 offset:51200
    v_mfma_f32_16x16x32_bf16 v[100:103], v[172:175], a[140:143], v[100:103]
    v_sub_f32 v241, v241, v243
    v_cvt_pk_bf16_f32 v241, v243, v241
    s_waitcnt lgkmcnt(7)
    v_mfma_f32_16x16x32_bf16 v[104:107], v[176:179], a[136:139], v[104:107]
    buffer_load_dwordx4 a[208:211], v209, s[20:23], s100 offen offset:2048 sc1
    ds_read_b64_tr_b16 v[166:167], v65 offset:51712
    v_mfma_f32_16x16x32_bf16 v[108:111], v[176:179], a[140:143], v[108:111]
    ds_read_b64_tr_b16 v[168:169], v66 offset:51200
    ds_read_b64_tr_b16 v[170:171], v66 offset:51712
    v_mfma_f32_16x16x32_bf16 v[120:123], v[180:183], a[136:139], v[120:123]
    ds_read_b64_tr_b16 v[172:173], v67 offset:51200
    ds_read_b64_tr_b16 v[174:175], v67 offset:51712
    v_mfma_f32_16x16x32_bf16 v[124:127], v[180:183], a[140:143], v[124:127]
    ds_write_b64 v156, v[240:241] offset:0
    v_rcp_f32 v228, v228
    v_mfma_f32_16x16x32_bf16 v[128:131], v[184:187], a[136:139], v[128:131]
    ds_read_b64_tr_b16 v[176:177], v65 offset:57344
    ds_read_b64_tr_b16 v[178:179], v65 offset:57856
    v_mfma_f32_16x16x32_bf16 v[132:135], v[184:187], a[140:143], v[132:135]
    ds_write_b64 v244, v[240:241] offset:2048
    v_rcp_f32 v229, v229
    v_mfma_f32_16x16x32_bf16 v[136:139], v[188:191], a[136:139], v[136:139]
    buffer_load_dwordx4 a[212:215], v209, s[20:23], s100 offen offset:3072 sc1
    v_mfma_f32_16x16x32_bf16 v[140:143], v[188:191], a[140:143], v[140:143]
    ds_read_b64_tr_b16 v[180:181], v66 offset:57344
    ds_read_b64_tr_b16 v[182:183], v66 offset:57856
    s_waitcnt lgkmcnt(10)
    v_mfma_f32_16x16x32_bf16 v[88:91], v[192:195], a[144:147], v[88:91]
    ds_read_b64_tr_b16 v[184:185], v67 offset:57344
    ds_read_b64_tr_b16 v[186:187], v67 offset:57856
    v_mfma_f32_16x16x32_bf16 v[92:95], v[192:195], a[148:151], v[92:95]
    ds_write_b64 v245, v[240:241] offset:4096
    v_rcp_f32 v230, v230
    v_mfma_f32_16x16x32_bf16 v[96:99], v[196:199], a[144:147], v[96:99]
    ds_read_b64_tr_b16 v[188:189], v65 offset:59392
    ds_read_b64_tr_b16 v[190:191], v65 offset:59904
    v_mfma_f32_16x16x32_bf16 v[100:103], v[196:199], a[148:151], v[100:103]
    ds_write_b64 v246, v[240:241] offset:6144
    v_rcp_f32 v231, v231
    v_mfma_f32_16x16x32_bf16 v[104:107], v[160:163], a[144:147], v[104:107]
    buffer_load_dwordx4 a[216:219], v159, s[20:23], s100 offen offset:0 sc1
    ds_read_b64_tr_b16 v[192:193], v66 offset:59392
    v_mfma_f32_16x16x32_bf16 v[108:111], v[160:163], a[148:151], v[108:111]
    ds_read_b64_tr_b16 v[194:195], v66 offset:59904
    v_mul_f32 v60, v60, v228
    v_mul_f32 v61, v61, v229
    v_mfma_f32_16x16x32_bf16 v[120:123], v[164:167], a[144:147], v[120:123]
    ds_read_b64_tr_b16 v[196:197], v67 offset:59392
    ds_read_b64_tr_b16 v[198:199], v67 offset:59904
    v_mul_f32 v62, v62, v230
    v_mfma_f32_16x16x32_bf16 v[124:127], v[164:167], a[148:151], v[124:127]
    v_mul_f32 v63, v63, v231
    v_cvt_pk_bf16_f32 v238, v60, v61
    s_waitcnt lgkmcnt(10)
    v_mfma_f32_16x16x32_bf16 v[128:131], v[168:171], a[144:147], v[128:131]
    v_cvt_pk_bf16_f32 v239, v62, v63
    v_permlane16_swap_b32 v236, v238
    v_mfma_f32_16x16x32_bf16 v[132:135], v[168:171], a[148:151], v[132:135]
    v_permlane16_swap_b32 v237, v239
    buffer_store_dwordx4 v[236:239], v153, s[20:23], s60 offen offset:256 sc1
    v_mfma_f32_16x16x32_bf16 v[136:139], v[172:175], a[144:147], v[136:139]
    v_mfma_f32_16x16x32_bf16 v[140:143], v[172:175], a[148:151], v[140:143]
    s_waitcnt lgkmcnt(0)
    s_barrier
    s_add_u32 m0, s66, 32768
    v_mfma_f32_16x16x32_bf16 v[88:91], v[176:179], a[152:155], v[88:91]
    buffer_load_dwordx4 v200, s[4:7], s41 offen offset:0 lds
    ds_read_b64_tr_b16 v[160:161], v64 offset:0
    ds_read_b64_tr_b16 v[162:163], v64 offset:512
    v_mfma_f32_16x16x32_bf16 v[92:95], v[176:179], a[156:159], v[92:95]
    ds_read_b64_tr_b16 v[164:165], v65 offset:0
    ds_read_b128 v[240:243], v157 offset:0
    ds_read_b128 v[244:247], v157 offset:16
    s_add_u32 s100, s101, 25600
    v_mfma_f32_16x16x32_bf16 v[96:99], v[180:183], a[152:155], v[96:99]
    buffer_load_dwordx4 a[220:223], v209, s[20:23], s100 offen offset:0 sc1
    v_mfma_f32_16x16x32_bf16 v[100:103], v[180:183], a[156:159], v[100:103]
    ds_read_b64_tr_b16 v[166:167], v65 offset:512
    ds_read_b64_tr_b16 v[168:169], v66 offset:0
    v_mfma_f32_16x16x32_bf16 v[104:107], v[184:187], a[152:155], v[104:107]
    buffer_load_dwordx4 v201, s[4:7], s41 offen offset:1024 lds
    v_mfma_f32_16x16x32_bf16 v[108:111], v[184:187], a[156:159], v[108:111]
    ds_read_b64_tr_b16 v[170:171], v66 offset:512
    ds_read_b64_tr_b16 v[172:173], v67 offset:0
    v_mfma_f32_16x16x32_bf16 v[120:123], v[188:191], a[152:155], v[120:123]
    ds_read_b64_tr_b16 v[174:175], v67 offset:512
    v_mfma_f32_16x16x32_bf16 v[124:127], v[188:191], a[156:159], v[124:127]
    ds_read_b64_tr_b16 v[176:177], v64 offset:2048
    s_waitcnt lgkmcnt(6)
    v_mfma_f32_16x16x16_bf16 v[80:83], v[240:241], v[248:249], v[80:83]
    v_mfma_f32_16x16x16_bf16 v[112:115], v[240:241], v[250:251], v[112:115]
    v_mfma_f32_16x16x32_bf16 v[128:131], v[192:195], a[152:155], v[128:131]
    buffer_load_dwordx4 v200, s[8:11], s41 offen offset:2048 lds
    v_mfma_f32_16x16x32_bf16 v[132:135], v[192:195], a[156:159], v[132:135]
    ds_read_b64_tr_b16 v[178:179], v64 offset:2560
    ds_read_b64_tr_b16 v[180:181], v65 offset:2048
    v_mfma_f32_16x16x16_bf16 v[88:91], v[242:243], v[248:249], v[88:91]
    v_mfma_f32_16x16x16_bf16 v[120:123], v[242:243], v[250:251], v[120:123]
    v_mfma_f32_16x16x32_bf16 v[136:139], v[196:199], a[152:155], v[136:139]
    buffer_load_dwordx4 a[224:227], v209, s[20:23], s100 offen offset:1024 sc1
    v_mfma_f32_16x16x32_bf16 v[140:143], v[196:199], a[156:159], v[140:143]
    ds_read_b64_tr_b16 v[182:183], v65 offset:2560
    ds_read_b64_tr_b16 v[184:185], v66 offset:2048
    v_mfma_f32_16x16x16_bf16 v[84:87], v[240:241], v[252:253], v[84:87]
    v_mfma_f32_16x16x16_bf16 v[116:119], v[240:241], v[254:255], v[116:119]
    s_waitcnt lgkmcnt(5)
    v_mfma_f32_16x16x32_bf16 v[0:3], v[160:163], a[0:3], 0
    buffer_load_dwordx4 v201, s[8:11], s41 offen offset:3072 lds
    v_mfma_f32_16x16x32_bf16 v[4:7], v[160:163], a[4:7], 0
    ds_read_b64_tr_b16 v[186:187], v66 offset:2560
    v_mfma_f32_16x16x32_bf16 a[248:251], v[148:151], v[160:163], 0
    ds_read_b64_tr_b16 v[188:189], v67 offset:2048
    v_mfma_f32_16x16x32_bf16 v[8:11], v[164:167], a[0:3], 0
    ds_read_b64_tr_b16 v[190:191], v67 offset:2560
    ds_read_b64_tr_b16 v[192:193], v64 offset:8192
    ds_read_b64_tr_b16 v[194:195], v64 offset:8704
    v_mul_f32 v224, v80, v80
    v_mfma_f32_16x16x16_bf16 v[92:95], v[242:243], v[252:253], v[92:95]
    v_mul_f32 v225, v81, v81
    v_mfma_f32_16x16x32_bf16 v[12:15], v[164:167], a[4:7], 0
    v_mul_f32 v226, v82, v82
    v_mul_f32 v227, v83, v83
    v_mfma_f32_16x16x16_bf16 v[124:127], v[242:243], v[254:255], v[124:127]
    v_fma_f32 v224, v224, v217, v216
    v_fma_f32 v225, v225, v217, v216
    s_add_u32 m0, s66, 49152
    v_mfma_f32_16x16x32_bf16 v[16:19], v[168:171], a[0:3], 0
    buffer_load_dwordx4 v200, s[4:7], s42 offen offset:0 lds
    ds_read_b64_tr_b16 v[196:197], v65 offset:8192
    ds_read_b64_tr_b16 v[198:199], v65 offset:8704
    v_fma_f32 v226, v226, v217, v216
    v_mfma_f32_16x16x32_bf16 v[20:23], v[168:171], a[4:7], 0
    v_mfma_f32_16x16x16_bf16 v[96:99], v[244:245], v[248:249], v[96:99]
    v_fma_f32 v227, v227, v217, v216
    v_mul_f32 v224, v224, v80
    v_mul_f32 v225, v225, v81
    v_mfma_f32_16x16x16_bf16 v[128:131], v[244:245], v[250:251], v[128:131]
    v_mul_f32 v226, v226, v82
    v_mul_f32 v227, v227, v83
    v_mfma_f32_16x16x32_bf16 v[24:27], v[172:175], a[0:3], 0
    buffer_load_dwordx4 a[228:231], v209, s[20:23], s100 offen offset:2048 sc1
    ds_read_b64_tr_b16 v[160:161], v66 offset:8192
    ds_read_b64_tr_b16 v[162:163], v66 offset:8704
    v_mfma_f32_16x16x32_bf16 v[28:31], v[172:175], a[4:7], 0
    v_exp_f32 v224, v224
    v_mfma_f32_16x16x16_bf16 v[104:107], v[246:247], v[248:249], v[104:107]
    v_mul_f32 v112, v80, v112
    s_waitcnt lgkmcnt(6)
    v_mfma_f32_16x16x32_bf16 v[32:35], v[176:179], a[0:3], 0
    buffer_load_dwordx4 v201, s[4:7], s42 offen offset:1024 lds
    ds_read_b64_tr_b16 v[164:165], v67 offset:8192
    v_mfma_f32_16x16x32_bf16 v[36:39], v[176:179], a[4:7], 0
    ds_read_b64_tr_b16 v[166:167], v67 offset:8704
    v_exp_f32 v225, v225
    v_mul_f32 v113, v81, v113
    v_mfma_f32_16x16x32_bf16 a[252:255], v[148:151], v[176:179], 0
    v_mfma_f32_16x16x16_bf16 v[136:139], v[246:247], v[250:251], v[136:139]
    v_exp_f32 v226, v226
    v_mul_f32 v114, v82, v114
    v_mfma_f32_16x16x32_bf16 v[40:43], v[180:183], a[0:3], 0
    ds_read_b64_tr_b16 v[168:169], v64 offset:10240
    ds_read_b64_tr_b16 v[170:171], v64 offset:10752
    v_exp_f32 v227, v227
    v_mfma_f32_16x16x16_bf16 v[100:103], v[244:245], v[252:253], v[100:103]
    v_mul_f32 v115, v83, v115
    v_mfma_f32_16x16x32_bf16 v[44:47], v[180:183], a[4:7], 0
    v_fma_f32 v224, v224, v218, v218
    v_fma_f32 v225, v225, v218, v218
    v_mfma_f32_16x16x16_bf16 v[132:135], v[244:245], v[254:255], v[132:135]
    v_fma_f32 v226, v226, v218, v218
    v_fma_f32 v227, v227, v218, v218
    v_mfma_f32_16x16x32_bf16 v[48:51], v[184:187], a[0:3], 0
    buffer_load_dwordx4 v200, s[8:11], s42 offen offset:2048 lds
    ds_read_b64_tr_b16 v[172:173], v65 offset:10240
    ds_read_b64_tr_b16 v[174:175], v65 offset:10752
    v_mfma_f32_16x16x32_bf16 v[52:55], v[184:187], a[4:7], 0
    v_rcp_f32 v224, v224
    v_mfma_f32_16x16x16_bf16 v[108:111], v[246:247], v[252:253], v[108:111]
    v_rcp_f32 v225, v225
    v_mfma_f32_16x16x32_bf16 v[56:59], v[188:191], a[0:3], 0
    buffer_load_dwordx4 a[232:235], v209, s[20:23], s100 offen offset:3072 sc1
    ds_read_b64_tr_b16 v[176:177], v66 offset:10240
    v_mfma_f32_16x16x32_bf16 v[60:63], v[188:191], a[4:7], 0
    ds_read_b64_tr_b16 v[178:179], v66 offset:10752
    v_rcp_f32 v226, v226
    s_waitcnt lgkmcnt(6)
    v_mfma_f32_16x16x32_bf16 v[0:3], v[192:195], a[8:11], v[0:3]
    buffer_load_dwordx4 v201, s[8:11], s42 offen offset:3072 lds
    ds_read_b64_tr_b16 v[180:181], v67 offset:10240
    v_mfma_f32_16x16x32_bf16 v[4:7], v[192:195], a[12:15], v[4:7]
    ds_read_b64_tr_b16 v[182:183], v67 offset:10752
    v_rcp_f32 v227, v227
    v_mfma_f32_16x16x16_bf16 v[140:143], v[246:247], v[254:255], v[140:143]
    v_mul_f32 v112, v112, v224
    v_mfma_f32_16x16x32_bf16 a[248:251], v[148:151], v[192:195], a[248:251]
    v_mul_f32 v113, v113, v225
    v_mul_f32 v114, v114, v226
    v_mul_f32 v115, v115, v227
    v_mfma_f32_16x16x32_bf16 v[8:11], v[196:199], a[8:11], v[8:11]
    ds_read_b64_tr_b16 v[184:185], v64 offset:16384
    ds_read_b64_tr_b16 v[186:187], v64 offset:16896
    ds_read_b64_tr_b16 v[188:189], v65 offset:16384
    v_mfma_f32_16x16x32_bf16 v[12:15], v[196:199], a[12:15], v[12:15]
    v_cvt_pk_bf16_f32 v232, v112, v113
    v_cvt_pk_bf16_f32 v233, v114, v115
    v_mul_f32 v228, v88, v88
    v_mfma_f32_16x16x32_bf16 v[16:19], v[160:163], a[8:11], v[16:19]
    buffer_load_dwordx4 a[236:239], v159, s[20:23], s100 offen offset:0 sc1
    ds_read_b64_tr_b16 v[190:191], v65 offset:16896
    v_mfma_f32_16x16x32_bf16 v[20:23], v[160:163], a[12:15], v[20:23]
    ds_read_b64_tr_b16 v[192:193], v66 offset:16384
    v_mul_f32 v229, v89, v89
    v_mul_f32 v230, v90, v90
    v_mul_f32 v231, v91, v91
    v_mfma_f32_16x16x32_bf16 v[24:27], v[164:167], a[8:11], v[24:27]
    ds_read_b64_tr_b16 v[194:195], v66 offset:16896
    ds_read_b64_tr_b16 v[196:197], v67 offset:16384
    v_fma_f32 v228, v228, v217, v216
    v_mfma_f32_16x16x32_bf16 v[28:31], v[164:167], a[12:15], v[28:31]
    v_fma_f32 v229, v229, v217, v216
    v_fma_f32 v230, v230, v217, v216
    s_waitcnt lgkmcnt(7)
    v_mfma_f32_16x16x32_bf16 v[32:35], v[168:171], a[8:11], v[32:35]
    ds_read_b64_tr_b16 v[198:199], v67 offset:16896
    ds_read_b64_tr_b16 v[160:161], v64 offset:18432
    v_mfma_f32_16x16x32_bf16 v[36:39], v[168:171], a[12:15], v[36:39]
    v_fma_f32 v231, v231, v217, v216
    v_mul_f32 v228, v228, v88
    v_mul_f32 v229, v229, v89
    v_mfma_f32_16x16x32_bf16 a[252:255], v[148:151], v[168:171], a[252:255]
    v_mul_f32 v230, v230, v90
    v_mul_f32 v231, v231, v91
    s_add_u32 s100, s75, 15360
    v_mfma_f32_16x16x32_bf16 v[40:43], v[172:175], a[8:11], v[40:43]
    buffer_load_dwordx4 a[0:3], v209, s[20:23], s100 offen offset:0 sc1
    ds_read_b64_tr_b16 v[162:163], v64 offset:18944
    v_mfma_f32_16x16x32_bf16 v[44:47], v[172:175], a[12:15], v[44:47]
    ds_read_b64_tr_b16 v[164:165], v65 offset:18432
    v_exp_f32 v228, v228
    v_mul_f32 v120, v88, v120
    v_mfma_f32_16x16x32_bf16 v[48:51], v[176:179], a[8:11], v[48:51]
    ds_read_b64_tr_b16 v[166:167], v65 offset:18944
    ds_read_b64_tr_b16 v[168:169], v66 offset:18432
    v_exp_f32 v229, v229
    v_mfma_f32_16x16x32_bf16 v[52:55], v[176:179], a[12:15], v[52:55]
    v_mul_f32 v121, v89, v121
    v_exp_f32 v230, v230
    v_mfma_f32_16x16x32_bf16 v[56:59], v[180:183], a[8:11], v[56:59]
    ds_read_b64_tr_b16 v[170:171], v66 offset:18944
    ds_read_b64_tr_b16 v[172:173], v67 offset:18432
    v_mul_f32 v122, v90, v122
    v_mfma_f32_16x16x32_bf16 v[60:63], v[180:183], a[12:15], v[60:63]
    v_exp_f32 v231, v231
    v_mul_f32 v123, v91, v123
    s_waitcnt lgkmcnt(7)
    v_mfma_f32_16x16x32_bf16 v[0:3], v[184:187], a[16:19], v[0:3]
    buffer_load_dwordx4 a[4:7], v209, s[20:23], s100 offen offset:1024 sc1
    ds_read_b64_tr_b16 v[174:175], v67 offset:18944
    v_mfma_f32_16x16x32_bf16 v[4:7], v[184:187], a[20:23], v[4:7]
    ds_read_b64_tr_b16 v[176:177], v64 offset:24576
    ds_read_b64_tr_b16 v[178:179], v64 offset:25088
    v_mfma_f32_16x16x32_bf16 a[248:251], v[148:151], v[184:187], a[248:251]
    v_fma_f32 v228, v228, v218, v218
    v_fma_f32 v229, v229, v218, v218
    v_fma_f32 v230, v230, v218, v218
    v_mfma_f32_16x16x32_bf16 v[8:11], v[188:191], a[16:19], v[8:11]
    ds_read_b64_tr_b16 v[180:181], v65 offset:24576
    ds_read_b64_tr_b16 v[182:183], v65 offset:25088
    v_mfma_f32_16x16x32_bf16 v[12:15], v[188:191], a[20:23], v[12:15]
    v_fma_f32 v231, v231, v218, v218
    v_rcp_f32 v228, v228
    v_mfma_f32_16x16x32_bf16 v[16:19], v[192:195], a[16:19], v[16:19]
    ds_read_b64_tr_b16 v[184:185], v66 offset:24576
    ds_read_b64_tr_b16 v[186:187], v66 offset:25088
    v_mfma_f32_16x16x32_bf16 v[20:23], v[192:195], a[20:23], v[20:23]
    v_rcp_f32 v229, v229
    v_rcp_f32 v230, v230
    v_mfma_f32_16x16x32_bf16 v[24:27], v[196:199], a[16:19], v[24:27]
    buffer_load_dwordx4 a[8:11], v209, s[20:23], s100 offen offset:2048 sc1
    ds_read_b64_tr_b16 v[188:189], v67 offset:24576
    v_mfma_f32_16x16x32_bf16 v[28:31], v[196:199], a[20:23], v[28:31]
    ds_read_b64_tr_b16 v[190:191], v67 offset:25088
    v_rcp_f32 v231, v231
    s_waitcnt lgkmcnt(8)
    v_mfma_f32_16x16x32_bf16 v[32:35], v[160:163], a[16:19], v[32:35]
    ds_read_b64_tr_b16 v[192:193], v64 offset:26624
    ds_read_b64_tr_b16 v[194:195], v64 offset:27136
    v_mul_f32 v120, v120, v228
    v_mfma_f32_16x16x32_bf16 v[36:39], v[160:163], a[20:23], v[36:39]
    v_mul_f32 v121, v121, v229
    v_mul_f32 v122, v122, v230
    v_mul_f32 v123, v123, v231
    v_mfma_f32_16x16x32_bf16 a[252:255], v[148:151], v[160:163], a[252:255]
    v_cvt_pk_bf16_f32 v234, v120, v121
    v_cvt_pk_bf16_f32 v235, v122, v123
    v_mfma_f32_16x16x32_bf16 v[40:43], v[164:167], a[16:19], v[40:43]
    ds_read_b64_tr_b16 v[196:197], v65 offset:26624
    ds_read_b64_tr_b16 v[198:199], v65 offset:27136
    v_mul_f32 v224, v84, v84
    v_mfma_f32_16x16x32_bf16 v[44:47], v[164:167], a[20:23], v[44:47]
    v_mul_f32 v225, v85, v85
    v_mul_f32 v226, v86, v86
    v_mul_f32 v227, v87, v87
    v_permlane16_swap_b32 v232, v234
    v_mfma_f32_16x16x32_bf16 v[48:51], v[168:171], a[16:19], v[48:51]
    buffer_load_dwordx4 a[12:15], v209, s[20:23], s100 offen offset:3072 sc1
    ds_read_b64_tr_b16 v[160:161], v66 offset:26624
    v_mfma_f32_16x16x32_bf16 v[52:55], v[168:171], a[20:23], v[52:55]
    ds_read_b64_tr_b16 v[162:163], v66 offset:27136
    v_permlane16_swap_b32 v233, v235
    buffer_store_dwordx4 v[232:235], v152, s[20:23], s61 offen offset:0 sc1
    v_mfma_f32_16x16x32_bf16 v[56:59], v[172:175], a[16:19], v[56:59]
    ds_read_b64_tr_b16 v[164:165], v67 offset:26624
    ds_read_b64_tr_b16 v[166:167], v67 offset:27136
    v_fma_f32 v224, v224, v221, v220
    v_mfma_f32_16x16x32_bf16 v[60:63], v[172:175], a[20:23], v[60:63]
    v_fma_f32 v225, v225, v221, v220
    v_fma_f32 v226, v226, v221, v220
    s_waitcnt lgkmcnt(8)
    v_mfma_f32_16x16x32_bf16 v[0:3], v[176:179], a[24:27], v[0:3]
    v_fma_f32 v227, v227, v221, v220
    v_mul_f32 v224, v224, v84
    v_mul_f32 v225, v225, v85
    v_mfma_f32_16x16x32_bf16 v[4:7], v[176:179], a[28:31], v[4:7]
    v_mul_f32 v226, v226, v86
    v_mul_f32 v227, v227, v87
    v_mfma_f32_16x16x32_bf16 a[248:251], v[148:151], v[176:179], a[248:251]
    v_exp_f32 v224, v224
    v_mul_f32 v116, v84, v116
    v_mfma_f32_16x16x32_bf16 v[8:11], v[180:183], a[24:27], v[8:11]
    v_mfma_f32_16x16x32_bf16 v[12:15], v[180:183], a[28:31], v[12:15]
    s_waitcnt vmcnt(43) lgkmcnt(0)
    s_barrier
    s_add_u32 m0, s66, 0
    v_mfma_f32_16x16x32_bf16 v[16:19], v[184:187], a[24:27], v[16:19]
    buffer_load_dwordx4 v200, s[4:7], s44 offen offset:0 lds
    ds_read_b64_tr_b16 v[168:169], v68 offset:32768
    v_mfma_f32_16x16x32_bf16 v[20:23], v[184:187], a[28:31], v[20:23]
    ds_read_b64_tr_b16 v[170:171], v68 offset:33280
    ds_read_b64_tr_b16 v[172:173], v69 offset:32768
    v_mfma_f32_16x16x32_bf16 v[24:27], v[188:191], a[24:27], v[24:27]
    buffer_load_dwordx4 a[16:19], v159, s[20:23], s100 offen offset:0 sc1
    ds_read_b64_tr_b16 v[174:175], v69 offset:33280
    v_mfma_f32_16x16x32_bf16 v[28:31], v[188:191], a[28:31], v[28:31]
    ds_read_b64_tr_b16 v[176:177], v70 offset:32768
    v_exp_f32 v225, v225
    v_mfma_f32_16x16x32_bf16 v[32:35], v[192:195], a[24:27], v[32:35]
    buffer_load_dwordx4 v201, s[4:7], s44 offen offset:1024 lds
    ds_read_b64_tr_b16 v[178:179], v70 offset:33280
    v_mfma_f32_16x16x32_bf16 v[36:39], v[192:195], a[28:31], v[36:39]
    ds_read_b64_tr_b16 v[180:181], v71 offset:32768
    v_mul_f32 v117, v85, v117
    v_mfma_f32_16x16x32_bf16 a[252:255], v[148:151], v[192:195], a[252:255]
    v_exp_f32 v226, v226
    v_mul_f32 v118, v86, v118
    v_mfma_f32_16x16x32_bf16 v[40:43], v[196:199], a[24:27], v[40:43]
    ds_read_b64_tr_b16 v[182:183], v71 offset:33280
    ds_read_b64_tr_b16 v[184:185], v68 offset:34816
    v_mfma_f32_16x16x32_bf16 v[44:47], v[196:199], a[28:31], v[44:47]
    v_exp_f32 v227, v227
    v_mul_f32 v119, v87, v119
    v_fma_f32 v224, v224, v222, v222
    v_mfma_f32_16x16x32_bf16 v[48:51], v[160:163], a[24:27], v[48:51]
    buffer_load_dwordx4 v200, s[8:11], s44 offen offset:2048 lds
    ds_read_b64_tr_b16 v[186:187], v68 offset:35328
    ds_read_b64_tr_b16 v[188:189], v69 offset:34816
    v_mfma_f32_16x16x32_bf16 v[52:55], v[160:163], a[28:31], v[52:55]
    s_add_u32 s100, s75, 20480
    s_cmp_lt_u32 s40, 3
    s_cselect_b32 s100, s100, 1073741824
    v_mfma_f32_16x16x32_bf16 v[56:59], v[164:167], a[24:27], v[56:59]
    buffer_load_dwordx4 a[20:23], v209, s[20:23], s100 offen offset:0 sc1
    ds_read_b64_tr_b16 v[190:191], v69 offset:35328
    v_mfma_f32_16x16x32_bf16 v[60:63], v[164:167], a[28:31], v[60:63]
    ds_read_b64_tr_b16 v[192:193], v70 offset:34816
    v_fma_f32 v225, v225, v222, v222
    v_fma_f32 v226, v226, v222, v222
    s_waitcnt lgkmcnt(5)
    v_mfma_f32_16x16x32_bf16 v[0:3], v[168:171], a[32:35], v[0:3]
    buffer_load_dwordx4 v201, s[8:11], s44 offen offset:3072 lds
    v_mfma_f32_16x16x32_bf16 v[4:7], v[168:171], a[36:39], v[4:7]
    ds_read_b64_tr_b16 v[194:195], v70 offset:35328
    ds_read_b64_tr_b16 v[196:197], v71 offset:34816
    v_fma_f32 v227, v227, v222, v222
    v_mfma_f32_16x16x32_bf16 a[248:251], v[148:151], v[168:171], a[248:251]
    v_rcp_f32 v224, v224
    v_mfma_f32_16x16x32_bf16 v[8:11], v[172:175], a[32:35], v[8:11]
    ds_read_b64_tr_b16 v[198:199], v71 offset:35328
    ds_read_b64_tr_b16 v[160:161], v68 offset:40960
    ds_read_b64_tr_b16 v[162:163], v68 offset:41472
    v_mfma_f32_16x16x32_bf16 v[12:15], v[172:175], a[36:39], v[12:15]
    v_rcp_f32 v225, v225
    s_add_u32 m0, s66, 16384
    v_mfma_f32_16x16x32_bf16 v[16:19], v[176:179], a[32:35], v[16:19]
    buffer_load_dwordx4 v200, s[4:7], s3 offen offset:0 lds
    ds_read_b64_tr_b16 v[164:165], v69 offset:40960
    v_mfma_f32_16x16x32_bf16 v[20:23], v[176:179], a[36:39], v[20:23]
    ds_read_b64_tr_b16 v[166:167], v69 offset:41472
    v_rcp_f32 v226, v226
    v_mfma_f32_16x16x32_bf16 v[24:27], v[180:183], a[32:35], v[24:27]
    buffer_load_dwordx4 a[24:27], v209, s[20:23], s100 offen offset:1024 sc1
    ds_read_b64_tr_b16 v[168:169], v70 offset:40960
    v_mfma_f32_16x16x32_bf16 v[28:31], v[180:183], a[36:39], v[28:31]
    ds_read_b64_tr_b16 v[170:171], v70 offset:41472
    v_rcp_f32 v227, v227
    s_waitcnt lgkmcnt(6)
    v_mfma_f32_16x16x32_bf16 v[32:35], v[184:187], a[32:35], v[32:35]
    buffer_load_dwordx4 v201, s[4:7], s3 offen offset:1024 lds
    ds_read_b64_tr_b16 v[172:173], v71 offset:40960
    v_mfma_f32_16x16x32_bf16 v[36:39], v[184:187], a[36:39], v[36:39]
    ds_read_b64_tr_b16 v[174:175], v71 offset:41472
    v_mul_f32 v116, v116, v224
    v_mfma_f32_16x16x32_bf16 a[252:255], v[148:151], v[184:187], a[252:255]
    v_mul_f32 v117, v117, v225
    v_mul_f32 v118, v118, v226
    v_mul_f32 v119, v119, v227
    v_mfma_f32_16x16x32_bf16 v[40:43], v[188:191], a[32:35], v[40:43]
    ds_read_b64_tr_b16 v[176:177], v68 offset:43008
    ds_read_b64_tr_b16 v[178:179], v68 offset:43520
    v_cvt_pk_bf16_f32 v236, v116, v117
    v_mfma_f32_16x16x32_bf16 v[44:47], v[188:191], a[36:39], v[44:47]
    v_cvt_pk_bf16_f32 v237, v118, v119
    v_mul_f32 v228, v92, v92
    v_mul_f32 v229, v93, v93
    v_mfma_f32_16x16x32_bf16 v[48:51], v[192:195], a[32:35], v[48:51]
    buffer_load_dwordx4 v200, s[8:11], s3 offen offset:2048 lds
    ds_read_b64_tr_b16 v[180:181], v69 offset:43008
    v_mfma_f32_16x16x32_bf16 v[52:55], v[192:195], a[36:39], v[52:55]
    ds_read_b64_tr_b16 v[182:183], v69 offset:43520
    v_mul_f32 v230, v94, v94
    v_mul_f32 v231, v95, v95
    v_mfma_f32_16x16x32_bf16 v[56:59], v[196:199], a[32:35], v[56:59]
    buffer_load_dwordx4 a[28:31], v209, s[20:23], s100 offen offset:2048 sc1
    ds_read_b64_tr_b16 v[184:185], v70 offset:43008
    v_mfma_f32_16x16x32_bf16 v[60:63], v[196:199], a[36:39], v[60:63]
    ds_read_b64_tr_b16 v[186:187], v70 offset:43520
    v_fma_f32 v228, v228, v221, v220
    v_fma_f32 v229, v229, v221, v220
    s_waitcnt lgkmcnt(6)
    v_mfma_f32_16x16x32_bf16 v[0:3], v[160:163], a[40:43], v[0:3]
    buffer_load_dwordx4 v201, s[8:11], s3 offen offset:3072 lds
    ds_read_b64_tr_b16 v[188:189], v71 offset:43008
    v_mfma_f32_16x16x32_bf16 v[4:7], v[160:163], a[44:47], v[4:7]
    ds_read_b64_tr_b16 v[190:191], v71 offset:43520
    v_fma_f32 v230, v230, v221, v220
    v_mfma_f32_16x16x32_bf16 a[248:251], v[148:151], v[160:163], a[248:251]
    v_fma_f32 v231, v231, v221, v220
    v_mul_f32 v228, v228, v92
    v_mul_f32 v229, v229, v93
    v_mfma_f32_16x16x32_bf16 v[8:11], v[164:167], a[40:43], v[8:11]
    ds_read_b64_tr_b16 v[192:193], v68 offset:49152
    ds_read_b64_tr_b16 v[194:195], v68 offset:49664
    v_mfma_f32_16x16x32_bf16 v[12:15], v[164:167], a[44:47], v[12:15]
    ds_read_b64_tr_b16 v[196:197], v69 offset:49152
    v_mul_f32 v230, v230, v94
    v_mul_f32 v231, v231, v95
    v_mfma_f32_16x16x32_bf16 v[16:19], v[168:171], a[40:43], v[16:19]
    buffer_load_dwordx4 a[32:35], v209, s[20:23], s100 offen offset:3072 sc1
    ds_read_b64_tr_b16 v[198:199], v69 offset:49664
    v_mfma_f32_16x16x32_bf16 v[20:23], v[168:171], a[44:47], v[20:23]
    ds_read_b64_tr_b16 v[160:161], v70 offset:49152
    v_exp_f32 v228, v228
    v_mul_f32 v124, v92, v124
    v_mfma_f32_16x16x32_bf16 v[24:27], v[172:175], a[40:43], v[24:27]
    ds_read_b64_tr_b16 v[162:163], v70 offset:49664
    ds_read_b64_tr_b16 v[164:165], v71 offset:49152
    v_mfma_f32_16x16x32_bf16 v[28:31], v[172:175], a[44:47], v[28:31]
    v_exp_f32 v229, v229
    v_mul_f32 v125, v93, v125
    s_waitcnt lgkmcnt(7)
    v_mfma_f32_16x16x32_bf16 v[32:35], v[176:179], a[40:43], v[32:35]
    ds_read_b64_tr_b16 v[166:167], v71 offset:49664
    ds_read_b64_tr_b16 v[168:169], v68 offset:51200
    v_mfma_f32_16x16x32_bf16 v[36:39], v[176:179], a[44:47], v[36:39]
    buffer_load_dwordx4 a[244:247], v209, s[12:15], s16 offen
    v_exp_f32 v230, v230
    v_mfma_f32_16x16x32_bf16 a[252:255], v[148:151], v[176:179], a[252:255]
    v_mul_f32 v126, v94, v126
    v_exp_f32 v231, v231
    v_mfma_f32_16x16x32_bf16 v[40:43], v[180:183], a[40:43], v[40:43]
    buffer_load_dwordx4 a[36:39], v159, s[20:23], s100 offen offset:0 sc1
    ds_read_b64_tr_b16 v[170:171], v68 offset:51712
    v_mfma_f32_16x16x32_bf16 v[44:47], v[180:183], a[44:47], v[44:47]
    ds_read_b64_tr_b16 v[172:173], v69 offset:51200
    v_mul_f32 v127, v95, v127
    v_fma_f32 v228, v228, v222, v222
    v_mfma_f32_16x16x32_bf16 v[48:51], v[184:187], a[40:43], v[48:51]
    ds_read_b64_tr_b16 v[174:175], v69 offset:51712
    ds_read_b64_tr_b16 v[176:177], v70 offset:51200
    v_fma_f32 v229, v229, v222, v222
    v_mfma_f32_16x16x32_bf16 v[52:55], v[184:187], a[44:47], v[52:55]
    v_fma_f32 v230, v230, v222, v222
    v_fma_f32 v231, v231, v222, v222
    v_mfma_f32_16x16x32_bf16 v[56:59], v[188:191], a[40:43], v[56:59]
    ds_read_b64_tr_b16 v[178:179], v70 offset:51712
    ds_read_b64_tr_b16 v[180:181], v71 offset:51200
    v_mfma_f32_16x16x32_bf16 v[60:63], v[188:191], a[44:47], v[60:63]
    s_add_u32 s100, s75, 25600
    s_cmp_lt_u32 s40, 3
    s_cselect_b32 s100, s100, 1073741824
    s_waitcnt lgkmcnt(7)
    v_mfma_f32_16x16x32_bf16 v[0:3], v[192:195], a[48:51], v[0:3]
    buffer_load_dwordx4 a[40:43], v209, s[20:23], s100 offen offset:0 sc1
    v_mfma_f32_16x16x32_bf16 v[4:7], v[192:195], a[52:55], v[4:7]
    ds_read_b64_tr_b16 v[182:183], v71 offset:51712
    ds_read_b64_tr_b16 v[184:185], v68 offset:57344
    ds_read_b64_tr_b16 v[186:187], v68 offset:57856
    v_mfma_f32_16x16x32_bf16 a[248:251], v[148:151], v[192:195], a[248:251]
    v_rcp_f32 v228, v228
    v_mfma_f32_16x16x32_bf16 v[8:11], v[196:199], a[48:51], v[8:11]
    ds_read_b64_tr_b16 v[188:189], v69 offset:57344
    ds_read_b64_tr_b16 v[190:191], v69 offset:57856
    v_mfma_f32_16x16x32_bf16 v[12:15], v[196:199], a[52:55], v[12:15]
    v_rcp_f32 v229, v229
    v_rcp_f32 v230, v230
    v_mfma_f32_16x16x32_bf16 v[16:19], v[160:163], a[48:51], v[16:19]
    ds_read_b64_tr_b16 v[192:193], v70 offset:57344
    ds_read_b64_tr_b16 v[194:195], v70 offset:57856
    v_rcp_f32 v231, v231
    v_mfma_f32_16x16x32_bf16 v[20:23], v[160:163], a[52:55], v[20:23]
    v_mul_f32 v124, v124, v228
    v_mul_f32 v125, v125, v229
    v_mul_f32 v126, v126, v230
    v_mfma_f32_16x16x32_bf16 v[24:27], v[164:167], a[48:51], v[24:27]
    buffer_load_dwordx4 a[44:47], v209, s[20:23], s100 offen offset:1024 sc1
    ds_read_b64_tr_b16 v[196:197], v71 offset:57344
    v_mfma_f32_16x16x32_bf16 v[28:31], v[164:167], a[52:55], v[28:31]
    ds_read_b64_tr_b16 v[198:199], v71 offset:57856
    v_mul_f32 v127, v127, v231
    v_cvt_pk_bf16_f32 v238, v124, v125
    s_waitcnt lgkmcnt(8)
    v_mfma_f32_16x16x32_bf16 v[32:35], v[168:171], a[48:51], v[32:35]
    ds_read_b64_tr_b16 v[160:161], v68 offset:59392
    ds_read_b64_tr_b16 v[162:163], v68 offset:59904
    v_mfma_f32_16x16x32_bf16 v[36:39], v[168:171], a[52:55], v[36:39]
    v_cvt_pk_bf16_f32 v239, v126, v127
    v_mul_f32 v224, v96, v96
    v_mul_f32 v225, v97, v97
    v_mfma_f32_16x16x32_bf16 a[252:255], v[148:151], v[168:171], a[252:255]
    v_mul_f32 v226, v98, v98
    v_mul_f32 v227, v99, v99
    v_permlane16_swap_b32 v236, v238
    v_mfma_f32_16x16x32_bf16 v[40:43], v[172:175], a[48:51], v[40:43]
    ds_read_b64_tr_b16 v[164:165], v69 offset:59392
    ds_read_b64_tr_b16 v[166:167], v69 offset:59904
    v_permlane16_swap_b32 v237, v239
    v_mfma_f32_16x16x32_bf16 v[44:47], v[172:175], a[52:55], v[44:47]
    buffer_store_dwordx4 v[236:239], v152, s[20:23], s61 offen offset:256 sc1
    v_fma_f32 v224, v224, v217, v216
    v_mfma_f32_16x16x32_bf16 v[48:51], v[176:179], a[48:51], v[48:51]
    ds_read_b64_tr_b16 v[168:169], v70 offset:59392
    ds_read_b64_tr_b16 v[170:171], v70 offset:59904
    v_fma_f32 v225, v225, v217, v216
    v_mfma_f32_16x16x32_bf16 v[52:55], v[176:179], a[52:55], v[52:55]
    v_fma_f32 v226, v226, v217, v216
    v_fma_f32 v227, v227, v217, v216
    v_mul_f32 v224, v224, v96
    v_mfma_f32_16x16x32_bf16 v[56:59], v[180:183], a[48:51], v[56:59]
    ds_read_b64_tr_b16 v[172:173], v71 offset:59392
    ds_read_b64_tr_b16 v[174:175], v71 offset:59904
    v_mfma_f32_16x16x32_bf16 v[60:63], v[180:183], a[52:55], v[60:63]
    v_mul_f32 v225, v225, v97
    v_mul_f32 v226, v226, v98
    v_mul_f32 v227, v227, v99
    s_waitcnt lgkmcnt(8)
    v_mfma_f32_16x16x32_bf16 v[0:3], v[184:187], a[56:59], v[0:3]
    buffer_load_dwordx4 a[48:51], v209, s[20:23], s100 offen offset:2048 sc1
    v_mfma_f32_16x16x32_bf16 v[4:7], v[184:187], a[60:63], v[4:7]
    v_exp_f32 v224, v224
    v_mul_f32 v128, v96, v128
    v_mfma_f32_16x16x32_bf16 a[248:251], v[148:151], v[184:187], a[248:251]
    v_exp_f32 v225, v225
    v_mul_f32 v129, v97, v129
    v_mfma_f32_16x16x32_bf16 v[8:11], v[188:191], a[56:59], v[8:11]
    v_mfma_f32_16x16x32_bf16 v[12:15], v[188:191], a[60:63], v[12:15]
    s_waitcnt vmcnt(43) lgkmcnt(0)
    s_barrier
    s_add_u32 s45, s101, 30720
    s_add_u32 m0, s58, 102400
    v_mfma_f32_16x16x32_bf16 v[16:19], v[192:195], a[56:59], v[16:19]
    buffer_load_dwordx4 v209, s[20:23], s45 offen offset:0 sc1 lds
    ds_read_b64_tr_b16 v[176:177], v68 offset:0
    v_mfma_f32_16x16x32_bf16 v[20:23], v[192:195], a[60:63], v[20:23]
    ds_read_b64_tr_b16 v[178:179], v68 offset:512
    ds_read_b64_tr_b16 v[180:181], v69 offset:0
    v_mfma_f32_16x16x32_bf16 v[24:27], v[196:199], a[56:59], v[24:27]
    buffer_load_dwordx4 a[52:55], v209, s[20:23], s100 offen offset:3072 sc1
    ds_read_b64_tr_b16 v[182:183], v69 offset:512
    v_mfma_f32_16x16x32_bf16 v[28:31], v[196:199], a[60:63], v[28:31]
    ds_read_b64_tr_b16 v[184:185], v70 offset:0
    v_exp_f32 v226, v226
    v_mfma_f32_16x16x32_bf16 v[32:35], v[160:163], a[56:59], v[32:35]
    buffer_load_dwordx4 v209, s[20:23], s45 offen offset:1024 sc1 lds
    ds_read_b64_tr_b16 v[186:187], v70 offset:512
    v_mfma_f32_16x16x32_bf16 v[36:39], v[160:163], a[60:63], v[36:39]
    ds_read_b64_tr_b16 v[188:189], v71 offset:0
    v_mul_f32 v130, v98, v130
    v_mfma_f32_16x16x32_bf16 a[252:255], v[148:151], v[160:163], a[252:255]
    v_exp_f32 v227, v227
    v_mul_f32 v131, v99, v131
    v_mfma_f32_16x16x32_bf16 v[40:43], v[164:167], a[56:59], v[40:43]
    ds_read_b64_tr_b16 v[190:191], v71 offset:512
    ds_read_b64_tr_b16 v[192:193], v68 offset:2048
    v_fma_f32 v224, v224, v218, v218
    v_mfma_f32_16x16x32_bf16 v[44:47], v[164:167], a[60:63], v[44:47]
    v_fma_f32 v225, v225, v218, v218
    v_fma_f32 v226, v226, v218, v218
    v_fma_f32 v227, v227, v218, v218
    v_mfma_f32_16x16x32_bf16 v[48:51], v[168:171], a[56:59], v[48:51]
    buffer_load_dwordx4 v209, s[20:23], s45 offen offset:2048 sc1 lds
    ds_read_b64_tr_b16 v[194:195], v68 offset:2560
    v_mfma_f32_16x16x32_bf16 v[52:55], v[168:171], a[60:63], v[52:55]
    ds_read_b64_tr_b16 v[196:197], v69 offset:2048
    v_rcp_f32 v224, v224
    v_mfma_f32_16x16x32_bf16 v[56:59], v[172:175], a[56:59], v[56:59]
    ds_read_b64_tr_b16 v[198:199], v69 offset:2560
    ds_read_b64_tr_b16 v[160:161], v70 offset:2048
    v_mfma_f32_16x16x32_bf16 v[60:63], v[172:175], a[60:63], v[60:63]
    v_rcp_f32 v225, v225
    v_rcp_f32 v226, v226
    s_waitcnt lgkmcnt(5)
    v_mfma_f32_16x16x32_bf16 v[0:3], v[176:179], a[64:67], v[0:3]
    buffer_load_dwordx4 v209, s[20:23], s45 offen offset:3072 sc1 lds
    ds_read_b64_tr_b16 v[162:163], v70 offset:2560
    v_mfma_f32_16x16x32_bf16 v[4:7], v[176:179], a[68:71], v[4:7]
    ds_read_b64_tr_b16 v[164:165], v71 offset:2048
    v_rcp_f32 v227, v227
    v_mfma_f32_16x16x32_bf16 a[248:251], v[148:151], v[176:179], a[248:251]
    v_mul_f32 v128, v128, v224
    v_mul_f32 v129, v129, v225
    v_mul_f32 v130, v130, v226
    v_mfma_f32_16x16x32_bf16 v[8:11], v[180:183], a[64:67], v[8:11]
    buffer_load_dwordx4 a[56:59], v159, s[20:23], s100 offen offset:0 sc1
    ds_read_b64_tr_b16 v[166:167], v71 offset:2560
    v_mfma_f32_16x16x32_bf16 v[12:15], v[180:183], a[68:71], v[12:15]
    ds_read_b64_tr_b16 v[168:169], v68 offset:8192
    ds_read_b64_tr_b16 v[170:171], v68 offset:8704
    s_add_u32 m0, s58, 106496
    v_mfma_f32_16x16x32_bf16 v[16:19], v[184:187], a[64:67], v[16:19]
    buffer_load_dwordx4 v159, s[20:23], s45 offen offset:0 sc1 lds
    ds_read_b64_tr_b16 v[172:173], v69 offset:8192
    v_mfma_f32_16x16x32_bf16 v[20:23], v[184:187], a[68:71], v[20:23]
    ds_read_b64_tr_b16 v[174:175], v69 offset:8704
    v_mul_f32 v131, v131, v227
    v_cvt_pk_bf16_f32 v232, v128, v129
    v_mfma_f32_16x16x32_bf16 v[24:27], v[188:191], a[64:67], v[24:27]
    ds_read_b64_tr_b16 v[176:177], v70 offset:8192
    ds_read_b64_tr_b16 v[178:179], v70 offset:8704
    v_cvt_pk_bf16_f32 v233, v130, v131
    v_mfma_f32_16x16x32_bf16 v[28:31], v[188:191], a[68:71], v[28:31]
    s_add_u32 s45, s101, 35840
    s_add_u32 m0, s58, 122880
    s_waitcnt lgkmcnt(6)
    v_mfma_f32_16x16x32_bf16 v[32:35], v[192:195], a[64:67], v[32:35]
    buffer_load_dwordx4 v209, s[20:23], s45 offen offset:0 sc1 lds
    ds_read_b64_tr_b16 v[180:181], v71 offset:8192
    v_mfma_f32_16x16x32_bf16 v[36:39], v[192:195], a[68:71], v[36:39]
    ds_read_b64_tr_b16 v[182:183], v71 offset:8704
    v_mul_f32 v228, v104, v104
    v_mul_f32 v229, v105, v105
    v_mfma_f32_16x16x32_bf16 a[252:255], v[148:151], v[192:195], a[252:255]
    v_mul_f32 v230, v106, v106
    v_mul_f32 v231, v107, v107
    s_add_u32 s100, s101, 0
    v_mfma_f32_16x16x32_bf16 v[40:43], v[196:199], a[64:67], v[40:43]
    buffer_load_dwordx4 a[60:63], v209, s[20:23], s100 offen offset:0 sc1
    ds_read_b64_tr_b16 v[184:185], v68 offset:10240
    v_mfma_f32_16x16x32_bf16 v[44:47], v[196:199], a[68:71], v[44:47]
    ds_read_b64_tr_b16 v[186:187], v68 offset:10752
    v_fma_f32 v228, v228, v217, v216
    v_fma_f32 v229, v229, v217, v216
    v_mfma_f32_16x16x32_bf16 v[48:51], v[160:163], a[64:67], v[48:51]
    buffer_load_dwordx4 v209, s[20:23], s45 offen offset:1024 sc1 lds
    ds_read_b64_tr_b16 v[188:189], v69 offset:10240
    v_mfma_f32_16x16x32_bf16 v[52:55], v[160:163], a[68:71], v[52:55]
    ds_read_b64_tr_b16 v[190:191], v69 offset:10752
    v_fma_f32 v230, v230, v217, v216
    v_fma_f32 v231, v231, v217, v216
    v_mfma_f32_16x16x32_bf16 v[56:59], v[164:167], a[64:67], v[56:59]
    ds_read_b64_tr_b16 v[192:193], v70 offset:10240
    ds_read_b64_tr_b16 v[194:195], v70 offset:10752
    v_mul_f32 v228, v228, v104
    v_mfma_f32_16x16x32_bf16 v[60:63], v[164:167], a[68:71], v[60:63]
    v_mul_f32 v229, v229, v105
    v_mul_f32 v230, v230, v106
    v_mul_f32 v231, v231, v107
    s_waitcnt lgkmcnt(6)
    v_mfma_f32_16x16x32_bf16 v[0:3], v[168:171], a[72:75], v[0:3]
    buffer_load_dwordx4 v209, s[20:23], s45 offen offset:2048 sc1 lds
    ds_read_b64_tr_b16 v[196:197], v71 offset:10240
    v_mfma_f32_16x16x32_bf16 v[4:7], v[168:171], a[76:79], v[4:7]
    ds_read_b64_tr_b16 v[198:199], v71 offset:10752
    v_exp_f32 v228, v228
    v_mfma_f32_16x16x32_bf16 a[248:251], v[148:151], v[168:171], a[248:251]
    v_mul_f32 v136, v104, v136
    v_exp_f32 v229, v229
    v_mfma_f32_16x16x32_bf16 v[8:11], v[172:175], a[72:75], v[8:11]
    buffer_load_dwordx4 a[64:67], v209, s[20:23], s100 offen offset:1024 sc1
    ds_read_b64_tr_b16 v[160:161], v68 offset:16384
    v_mfma_f32_16x16x32_bf16 v[12:15], v[172:175], a[76:79], v[12:15]
    ds_read_b64_tr_b16 v[162:163], v68 offset:16896
    ds_read_b64_tr_b16 v[164:165], v69 offset:16384
    v_mul_f32 v137, v105, v137
    v_mfma_f32_16x16x32_bf16 v[16:19], v[176:179], a[72:75], v[16:19]
    buffer_load_dwordx4 v209, s[20:23], s45 offen offset:3072 sc1 lds
    ds_read_b64_tr_b16 v[166:167], v69 offset:16896
    v_mfma_f32_16x16x32_bf16 v[20:23], v[176:179], a[76:79], v[20:23]
    ds_read_b64_tr_b16 v[168:169], v70 offset:16384
    v_exp_f32 v230, v230
    v_mul_f32 v138, v106, v138
    v_mfma_f32_16x16x32_bf16 v[24:27], v[180:183], a[72:75], v[24:27]
    ds_read_b64_tr_b16 v[170:171], v70 offset:16896
    ds_read_b64_tr_b16 v[172:173], v71 offset:16384
    v_exp_f32 v231, v231
    v_mfma_f32_16x16x32_bf16 v[28:31], v[180:183], a[76:79], v[28:31]
    v_mul_f32 v139, v107, v139
    s_add_u32 m0, s58, 126976
    s_waitcnt lgkmcnt(7)
    v_mfma_f32_16x16x32_bf16 v[32:35], v[184:187], a[72:75], v[32:35]
    buffer_load_dwordx4 v159, s[20:23], s45 offen offset:0 sc1 lds
    ds_read_b64_tr_b16 v[174:175], v71 offset:16896
    v_mfma_f32_16x16x32_bf16 v[36:39], v[184:187], a[76:79], v[36:39]
    ds_read_b64_tr_b16 v[176:177], v68 offset:18432
    v_fma_f32 v228, v228, v218, v218
    v_mfma_f32_16x16x32_bf16 a[252:255], v[148:151], v[184:187], a[252:255]
    v_fma_f32 v229, v229, v218, v218
    v_fma_f32 v230, v230, v218, v218
    v_fma_f32 v231, v231, v218, v218
    v_mfma_f32_16x16x32_bf16 v[40:43], v[188:191], a[72:75], v[40:43]
    buffer_load_dwordx4 a[68:71], v209, s[20:23], s100 offen offset:2048 sc1
    ds_read_b64_tr_b16 v[178:179], v68 offset:18944
    v_mfma_f32_16x16x32_bf16 v[44:47], v[188:191], a[76:79], v[44:47]
    ds_read_b64_tr_b16 v[180:181], v69 offset:18432
    v_rcp_f32 v228, v228
    v_mfma_f32_16x16x32_bf16 v[48:51], v[192:195], a[72:75], v[48:51]
    ds_read_b64_tr_b16 v[182:183], v69 offset:18944
    ds_read_b64_tr_b16 v[184:185], v70 offset:18432
    v_mfma_f32_16x16x32_bf16 v[52:55], v[192:195], a[76:79], v[52:55]
    v_rcp_f32 v229, v229
    v_rcp_f32 v230, v230
    v_mfma_f32_16x16x32_bf16 v[56:59], v[196:199], a[72:75], v[56:59]
    ds_read_b64_tr_b16 v[186:187], v70 offset:18944
    ds_read_b64_tr_b16 v[188:189], v71 offset:18432
    v_mfma_f32_16x16x32_bf16 v[60:63], v[196:199], a[76:79], v[60:63]
    v_rcp_f32 v231, v231
    v_mul_f32 v136, v136, v228
    v_mul_f32 v137, v137, v229
    s_waitcnt lgkmcnt(7)
    v_mfma_f32_16x16x32_bf16 v[0:3], v[160:163], a[80:83], v[0:3]
    buffer_load_dwordx4 a[72:75], v209, s[20:23], s100 offen offset:3072 sc1
    ds_read_b64_tr_b16 v[190:191], v71 offset:18944
    v_mfma_f32_16x16x32_bf16 v[4:7], v[160:163], a[84:87], v[4:7]
    ds_read_b64_tr_b16 v[192:193], v68 offset:24576
    ds_read_b64_tr_b16 v[194:195], v68 offset:25088
    v_mfma_f32_16x16x32_bf16 a[248:251], v[148:151], v[160:163], a[248:251]
    v_mul_f32 v138, v138, v230
    v_mul_f32 v139, v139, v231
    v_cvt_pk_bf16_f32 v234, v136, v137
    v_mfma_f32_16x16x32_bf16 v[8:11], v[164:167], a[80:83], v[8:11]
    ds_read_b64_tr_b16 v[196:197], v69 offset:24576
    ds_read_b64_tr_b16 v[198:199], v69 offset:25088
    v_cvt_pk_bf16_f32 v235, v138, v139
    v_mfma_f32_16x16x32_bf16 v[12:15], v[164:167], a[84:87], v[12:15]
    v_mul_f32 v224, v100, v100
    v_mul_f32 v225, v101, v101
    v_mul_f32 v226, v102, v102
    v_mfma_f32_16x16x32_bf16 v[16:19], v[168:171], a[80:83], v[16:19]
    ds_read_b64_tr_b16 v[160:161], v70 offset:24576
    ds_read_b64_tr_b16 v[162:163], v70 offset:25088
    v_mul_f32 v227, v103, v103
    v_mfma_f32_16x16x32_bf16 v[20:23], v[168:171], a[84:87], v[20:23]
    v_permlane16_swap_b32 v232, v234
    v_permlane16_swap_b32 v233, v235
    buffer_store_dwordx4 v[232:235], v153, s[20:23], s61 offen offset:0 sc1
    v_mfma_f32_16x16x32_bf16 v[24:27], v[172:175], a[80:83], v[24:27]
    buffer_load_dwordx4 a[76:79], v159, s[20:23], s100 offen offset:0 sc1
    ds_read_b64_tr_b16 v[164:165], v71 offset:24576
    v_mfma_f32_16x16x32_bf16 v[28:31], v[172:175], a[84:87], v[28:31]
    ds_read_b64_tr_b16 v[166:167], v71 offset:25088
    v_fma_f32 v224, v224, v221, v220
    v_fma_f32 v225, v225, v221, v220
    s_waitcnt lgkmcnt(8)
    v_mfma_f32_16x16x32_bf16 v[32:35], v[176:179], a[80:83], v[32:35]
    ds_read_b64_tr_b16 v[168:169], v68 offset:26624
    ds_read_b64_tr_b16 v[170:171], v68 offset:27136
    v_mfma_f32_16x16x32_bf16 v[36:39], v[176:179], a[84:87], v[36:39]
    v_fma_f32 v226, v226, v221, v220
    v_fma_f32 v227, v227, v221, v220
    v_mul_f32 v224, v224, v100
    v_mfma_f32_16x16x32_bf16 a[252:255], v[148:151], v[176:179], a[252:255]
    v_mul_f32 v225, v225, v101
    v_mul_f32 v226, v226, v102
    v_mul_f32 v227, v227, v103
    v_mfma_f32_16x16x32_bf16 v[40:43], v[180:183], a[80:83], v[40:43]
    ds_read_b64_tr_b16 v[172:173], v69 offset:26624
    ds_read_b64_tr_b16 v[174:175], v69 offset:27136
    v_exp_f32 v224, v224
    v_mfma_f32_16x16x32_bf16 v[44:47], v[180:183], a[84:87], v[44:47]
    v_mul_f32 v132, v100, v132
    v_exp_f32 v225, v225
    v_mfma_f32_16x16x32_bf16 v[48:51], v[184:187], a[80:83], v[48:51]
    ds_read_b64_tr_b16 v[176:177], v70 offset:26624
    ds_read_b64_tr_b16 v[178:179], v70 offset:27136
    v_mul_f32 v133, v101, v133
    v_mfma_f32_16x16x32_bf16 v[52:55], v[184:187], a[84:87], v[52:55]
    v_exp_f32 v226, v226
    v_mul_f32 v134, v102, v134
    v_mfma_f32_16x16x32_bf16 v[56:59], v[188:191], a[80:83], v[56:59]
    ds_read_b64_tr_b16 v[180:181], v71 offset:26624
    ds_read_b64_tr_b16 v[182:183], v71 offset:27136
    v_exp_f32 v227, v227
    v_mfma_f32_16x16x32_bf16 v[60:63], v[188:191], a[84:87], v[60:63]
    v_mul_f32 v135, v103, v135
    s_add_u32 s100, s101, 5120
    s_waitcnt lgkmcnt(8)
    v_mfma_f32_16x16x32_bf16 v[0:3], v[192:195], a[88:91], v[0:3]
    buffer_load_dwordx4 a[80:83], v209, s[20:23], s100 offen offset:0 sc1
    v_lshrrev_b32 v155, 2, v209
    v_mfma_f32_16x16x32_bf16 v[4:7], v[192:195], a[92:95], v[4:7]
    v_min_u32 v155, 16, v155
    buffer_load_dword v147, v155, s[20:23], s36 offen sc1
    v_mfma_f32_16x16x32_bf16 a[248:251], v[148:151], v[192:195], a[248:251]
    v_fma_f32 v224, v224, v222, v222
    v_fma_f32 v225, v225, v222, v222
    v_mfma_f32_16x16x32_bf16 v[8:11], v[196:199], a[88:91], v[8:11]
    v_mfma_f32_16x16x32_bf16 v[12:15], v[196:199], a[92:95], v[12:15]
    s_waitcnt vmcnt(45) lgkmcnt(0)
    s_barrier
    s_add_u32 s45, s0, 0
    s_add_u32 m0, s58, 81920
    v_mfma_f32_16x16x32_bf16 v[16:19], v[160:163], a[88:91], v[16:19]
    buffer_load_dwordx4 v209, s[20:23], s45 offen offset:0 sc1 lds
    ds_read_b64_tr_b16 v[184:185], v64 offset:32768
    v_mfma_f32_16x16x32_bf16 v[20:23], v[160:163], a[92:95], v[20:23]
    ds_read_b64_tr_b16 v[186:187], v64 offset:33280
    ds_read_b64_tr_b16 v[188:189], v65 offset:32768
    v_fma_f32 v226, v226, v222, v222
    v_mfma_f32_16x16x32_bf16 v[24:27], v[164:167], a[88:91], v[24:27]
    buffer_load_dwordx4 a[84:87], v209, s[20:23], s100 offen offset:1024 sc1
    ds_read_b64_tr_b16 v[190:191], v65 offset:33280
    v_mfma_f32_16x16x32_bf16 v[28:31], v[164:167], a[92:95], v[28:31]
    ds_read_b64_tr_b16 v[192:193], v66 offset:32768
    v_fma_f32 v227, v227, v222, v222
    v_mfma_f32_16x16x32_bf16 v[32:35], v[168:171], a[88:91], v[32:35]
    buffer_load_dwordx4 v209, s[20:23], s45 offen offset:1024 sc1 lds
    ds_read_b64_tr_b16 v[194:195], v66 offset:33280
    v_mfma_f32_16x16x32_bf16 v[36:39], v[168:171], a[92:95], v[36:39]
    ds_read_b64_tr_b16 v[196:197], v67 offset:32768
    v_rcp_f32 v224, v224
    v_mfma_f32_16x16x32_bf16 a[252:255], v[148:151], v[168:171], a[252:255]
    v_rcp_f32 v225, v225
    v_mfma_f32_16x16x32_bf16 v[40:43], v[172:175], a[88:91], v[40:43]
    ds_read_b64_tr_b16 v[198:199], v67 offset:33280
    ds_read_b64_tr_b16 v[160:161], v64 offset:34816
    v_rcp_f32 v226, v226
    v_mfma_f32_16x16x32_bf16 v[44:47], v[172:175], a[92:95], v[44:47]
    v_rcp_f32 v227, v227
    v_mul_f32 v132, v132, v224
    v_mfma_f32_16x16x32_bf16 v[48:51], v[176:179], a[88:91], v[48:51]
    buffer_load_dwordx4 v209, s[20:23], s45 offen offset:2048 sc1 lds
    ds_read_b64_tr_b16 v[162:163], v64 offset:35328
    v_mfma_f32_16x16x32_bf16 v[52:55], v[176:179], a[92:95], v[52:55]
    ds_read_b64_tr_b16 v[164:165], v65 offset:34816
    v_mul_f32 v133, v133, v225
    v_mul_f32 v134, v134, v226
    v_mul_f32 v135, v135, v227
    v_mfma_f32_16x16x32_bf16 v[56:59], v[180:183], a[88:91], v[56:59]
    ds_read_b64_tr_b16 v[166:167], v65 offset:35328
    ds_read_b64_tr_b16 v[168:169], v66 offset:34816
    v_cvt_pk_bf16_f32 v236, v132, v133
    v_mfma_f32_16x16x32_bf16 v[60:63], v[180:183], a[92:95], v[60:63]
    v_cvt_pk_bf16_f32 v237, v134, v135
    v_mul_f32 v228, v108, v108
    v_mul_f32 v229, v109, v109
    s_waitcnt lgkmcnt(5)
    v_mfma_f32_16x16x32_bf16 v[0:3], v[184:187], a[96:99], v[0:3]
    buffer_load_dwordx4 v209, s[20:23], s45 offen offset:3072 sc1 lds
    ds_read_b64_tr_b16 v[170:171], v66 offset:35328
    v_mfma_f32_16x16x32_bf16 v[4:7], v[184:187], a[100:103], v[4:7]
    ds_read_b64_tr_b16 v[172:173], v67 offset:34816
    v_mul_f32 v230, v110, v110
    v_mul_f32 v231, v111, v111
    v_mfma_f32_16x16x32_bf16 a[248:251], v[148:151], v[184:187], a[248:251]
    v_fma_f32 v228, v228, v221, v220
    v_fma_f32 v229, v229, v221, v220
    v_mfma_f32_16x16x32_bf16 v[8:11], v[188:191], a[96:99], v[8:11]
    buffer_load_dwordx4 a[88:91], v209, s[20:23], s100 offen offset:2048 sc1
    ds_read_b64_tr_b16 v[174:175], v67 offset:35328
    v_mfma_f32_16x16x32_bf16 v[12:15], v[188:191], a[100:103], v[12:15]
    ds_read_b64_tr_b16 v[176:177], v64 offset:40960
    ds_read_b64_tr_b16 v[178:179], v64 offset:41472
    s_add_u32 m0, s58, 86016
    v_mfma_f32_16x16x32_bf16 v[16:19], v[192:195], a[96:99], v[16:19]
    buffer_load_dwordx4 v159, s[20:23], s45 offen offset:0 sc1 lds
    ds_read_b64_tr_b16 v[180:181], v65 offset:40960
    v_mfma_f32_16x16x32_bf16 v[20:23], v[192:195], a[100:103], v[20:23]
    ds_read_b64_tr_b16 v[182:183], v65 offset:41472
    v_fma_f32 v230, v230, v221, v220
    v_fma_f32 v231, v231, v221, v220
    v_mfma_f32_16x16x32_bf16 v[24:27], v[196:199], a[96:99], v[24:27]
    ds_read_b64_tr_b16 v[184:185], v66 offset:40960
    ds_read_b64_tr_b16 v[186:187], v66 offset:41472
    v_mul_f32 v228, v228, v108
    v_mfma_f32_16x16x32_bf16 v[28:31], v[196:199], a[100:103], v[28:31]
    v_mul_f32 v229, v229, v109
    v_mul_f32 v230, v230, v110
    v_mul_f32 v231, v231, v111
    s_waitcnt lgkmcnt(6)
    v_mfma_f32_16x16x32_bf16 v[32:35], v[160:163], a[96:99], v[32:35]
    buffer_load_dwordx4 a[92:95], v209, s[20:23], s100 offen offset:3072 sc1
    ds_read_b64_tr_b16 v[188:189], v67 offset:40960
    v_mfma_f32_16x16x32_bf16 v[36:39], v[160:163], a[100:103], v[36:39]
    ds_read_b64_tr_b16 v[190:191], v67 offset:41472
    v_exp_f32 v228, v228
    v_mfma_f32_16x16x32_bf16 a[252:255], v[148:151], v[160:163], a[252:255]
    v_mul_f32 v140, v108, v140
    v_exp_f32 v229, v229
    v_mfma_f32_16x16x32_bf16 v[40:43], v[164:167], a[96:99], v[40:43]
    ds_read_b64_tr_b16 v[192:193], v64 offset:43008
    ds_read_b64_tr_b16 v[194:195], v64 offset:43520
    v_mul_f32 v141, v109, v141
    v_mfma_f32_16x16x32_bf16 v[44:47], v[164:167], a[100:103], v[44:47]
    v_exp_f32 v230, v230
    v_mul_f32 v142, v110, v142
    v_mfma_f32_16x16x32_bf16 v[48:51], v[168:171], a[96:99], v[48:51]
    ds_read_b64_tr_b16 v[196:197], v65 offset:43008
    ds_read_b64_tr_b16 v[198:199], v65 offset:43520
    v_mfma_f32_16x16x32_bf16 v[52:55], v[168:171], a[100:103], v[52:55]
    v_exp_f32 v231, v231
    v_mul_f32 v143, v111, v143
    v_fma_f32 v228, v228, v222, v222
    v_mfma_f32_16x16x32_bf16 v[56:59], v[172:175], a[96:99], v[56:59]
    ds_read_b64_tr_b16 v[160:161], v66 offset:43008
    ds_read_b64_tr_b16 v[162:163], v66 offset:43520
    v_fma_f32 v229, v229, v222, v222
    v_mfma_f32_16x16x32_bf16 v[60:63], v[172:175], a[100:103], v[60:63]
    v_fma_f32 v230, v230, v222, v222
    v_fma_f32 v231, v231, v222, v222
    s_waitcnt lgkmcnt(6)
    v_mfma_f32_16x16x32_bf16 v[0:3], v[176:179], a[104:107], v[0:3]
    buffer_load_dwordx4 a[96:99], v159, s[20:23], s100 offen offset:0 sc1
    ds_read_b64_tr_b16 v[164:165], v67 offset:43008
    v_mfma_f32_16x16x32_bf16 v[4:7], v[176:179], a[108:111], v[4:7]
    ds_read_b64_tr_b16 v[166:167], v67 offset:43520
    v_rcp_f32 v228, v228
    v_mfma_f32_16x16x32_bf16 a[248:251], v[148:151], v[176:179], a[248:251]
    v_rcp_f32 v229, v229
    v_mfma_f32_16x16x32_bf16 v[8:11], v[180:183], a[104:107], v[8:11]
    ds_read_b64_tr_b16 v[168:169], v64 offset:49152
    ds_read_b64_tr_b16 v[170:171], v64 offset:49664
    v_mfma_f32_16x16x32_bf16 v[12:15], v[180:183], a[108:111], v[12:15]
    ds_read_b64_tr_b16 v[172:173], v65 offset:49152
    v_rcp_f32 v230, v230
    v_mfma_f32_16x16x32_bf16 v[16:19], v[184:187], a[104:107], v[16:19]
    ds_read_b64_tr_b16 v[174:175], v65 offset:49664
    ds_read_b64_tr_b16 v[176:177], v66 offset:49152
    v_mfma_f32_16x16x32_bf16 v[20:23], v[184:187], a[108:111], v[20:23]
    v_rcp_f32 v231, v231
    v_mul_f32 v140, v140, v228
    s_add_u32 s100, s101, 10240
    v_mfma_f32_16x16x32_bf16 v[24:27], v[188:191], a[104:107], v[24:27]
    buffer_load_dwordx4 a[100:103], v209, s[20:23], s100 offen offset:0 sc1
    ds_read_b64_tr_b16 v[178:179], v66 offset:49664
    v_mfma_f32_16x16x32_bf16 v[28:31], v[188:191], a[108:111], v[28:31]
    ds_read_b64_tr_b16 v[180:181], v67 offset:49152
    v_mul_f32 v141, v141, v229
    v_mul_f32 v142, v142, v230
    s_waitcnt lgkmcnt(7)
    v_mfma_f32_16x16x32_bf16 v[32:35], v[192:195], a[104:107], v[32:35]
    ds_read_b64_tr_b16 v[182:183], v67 offset:49664
    ds_read_b64_tr_b16 v[184:185], v64 offset:51200
    v_mfma_f32_16x16x32_bf16 v[36:39], v[192:195], a[108:111], v[36:39]
    v_mul_f32 v143, v143, v231
    v_cvt_pk_bf16_f32 v238, v140, v141
    v_mfma_f32_16x16x32_bf16 a[252:255], v[148:151], v[192:195], a[252:255]
    v_cvt_pk_bf16_f32 v239, v142, v143
    v_permlane16_swap_b32 v236, v238
    s_nop 0
    v_permlane16_swap_b32 v237, v239
    v_mfma_f32_16x16x32_bf16 v[40:43], v[196:199], a[104:107], v[40:43]
    ds_read_b64_tr_b16 v[186:187], v64 offset:51712
    ds_read_b64_tr_b16 v[188:189], v65 offset:51200
    v_mfma_f32_16x16x32_bf16 v[44:47], v[196:199], a[108:111], v[44:47]
    buffer_store_dwordx4 v[236:239], v153, s[20:23], s61 offen offset:256 sc1
    v_mfma_f32_16x16x32_bf16 v[48:51], v[160:163], a[104:107], v[48:51]
    ds_read_b64_tr_b16 v[190:191], v65 offset:51712
    v_mfma_f32_16x16x32_bf16 v[52:55], v[160:163], a[108:111], v[52:55]
    ds_read_b64_tr_b16 v[192:193], v66 offset:51200
    v_mfma_f32_16x16x32_bf16 v[56:59], v[164:167], a[104:107], v[56:59]
    ds_read_b64_tr_b16 v[194:195], v66 offset:51712
    v_mfma_f32_16x16x32_bf16 v[60:63], v[164:167], a[108:111], v[60:63]
    ds_read_b64_tr_b16 v[196:197], v67 offset:51200
    s_waitcnt lgkmcnt(7)
    v_mfma_f32_16x16x32_bf16 v[0:3], v[168:171], a[112:115], v[0:3]
    buffer_load_dwordx4 a[104:107], v209, s[20:23], s100 offen offset:1024 sc1
    v_mfma_f32_16x16x32_bf16 v[4:7], v[168:171], a[116:119], v[4:7]
    ds_read_b64_tr_b16 v[198:199], v67 offset:51712
    ds_read_b64_tr_b16 v[160:161], v64 offset:57344
    v_mfma_f32_16x16x32_bf16 a[248:251], v[148:151], v[168:171], a[248:251]
    ds_read_b64_tr_b16 v[162:163], v64 offset:57856
    v_add_u32 v202, 152576, v209
    v_mfma_f32_16x16x32_bf16 v[8:11], v[172:175], a[112:115], v[8:11]
    ds_read_b64_tr_b16 v[164:165], v65 offset:57344
    ds_read_b64_tr_b16 v[166:167], v65 offset:57856
    v_mfma_f32_16x16x32_bf16 v[12:15], v[172:175], a[116:119], v[12:15]
    ds_read_b128 v[96:99], v202 offset:0
    ds_read_b128 v[100:103], v202 offset:1024
    v_mfma_f32_16x16x32_bf16 v[16:19], v[176:179], a[112:115], v[16:19]
    ds_read_b64_tr_b16 v[168:169], v66 offset:57344
    ds_read_b64_tr_b16 v[170:171], v66 offset:57856
    v_mfma_f32_16x16x32_bf16 v[20:23], v[176:179], a[116:119], v[20:23]
    ds_read_b128 v[104:107], v202 offset:2048
    v_and_b32 v208, 0x1f0, v209
    s_waitcnt vmcnt(12)
    v_mfma_f32_16x16x32_bf16 v[24:27], v[180:183], a[112:115], v[24:27]
    buffer_load_dwordx4 a[108:111], v209, s[20:23], s100 offen offset:2048 sc1
    v_mfma_f32_16x16x32_bf16 v[28:31], v[180:183], a[116:119], v[28:31]
    ds_read_b64_tr_b16 v[172:173], v67 offset:57344
    ds_read_b64_tr_b16 v[174:175], v67 offset:57856
    s_waitcnt lgkmcnt(11)
    v_mfma_f32_16x16x32_bf16 v[32:35], v[184:187], a[112:115], v[32:35]
    ds_read_b64_tr_b16 v[176:177], v64 offset:59392
    ds_read_b64_tr_b16 v[178:179], v64 offset:59904
    v_mfma_f32_16x16x32_bf16 v[36:39], v[184:187], a[116:119], v[36:39]
    s_nop 0
P_qg_chk:
    v_cmp_ne_u32 vcc, v147, v145
    s_nop 4
    s_cbranch_vccnz P_qg_slow
P_qg_done:
    v_mfma_f32_16x16x32_bf16 a[252:255], v[148:151], v[184:187], a[252:255]
    buffer_load_dwordx4 v[72:75], v209, s[20:23], s76 offen offset:0 sc1
    v_mfma_f32_16x16x32_bf16 v[40:43], v[188:191], a[112:115], v[40:43]
    ds_read_b64_tr_b16 v[180:181], v65 offset:59392
    ds_read_b64_tr_b16 v[182:183], v65 offset:59904
    v_mfma_f32_16x16x32_bf16 v[44:47], v[188:191], a[116:119], v[44:47]
    buffer_load_dwordx4 v[76:79], v209, s[20:23], s76 offen offset:1024 sc1
    v_mfma_f32_16x16x32_bf16 v[48:51], v[192:195], a[112:115], v[48:51]
    ds_read_b64_tr_b16 v[184:185], v66 offset:59392
    ds_read_b64_tr_b16 v[186:187], v66 offset:59904
    v_mfma_f32_16x16x32_bf16 v[52:55], v[192:195], a[116:119], v[52:55]
    buffer_load_dwordx4 v[204:207], v208, s[20:23], s76 offen offset:2048 sc1
    s_waitcnt lgkmcnt(8)
    v_mfma_f32_16x16x32_bf16 v[56:59], v[196:199], a[112:115], v[56:59]
    ds_read_b64_tr_b16 v[188:189], v67 offset:59392
    ds_read_b64_tr_b16 v[190:191], v67 offset:59904
    v_mfma_f32_16x16x32_bf16 v[60:63], v[196:199], a[116:119], v[60:63]
    ds_read_b64_tr_b16 v[112:113], v96
    ds_read_b64_tr_b16 v[114:115], v97
    s_waitcnt lgkmcnt(10)
    v_mfma_f32_16x16x32_bf16 v[0:3], v[160:163], a[120:123], v[0:3]
    buffer_load_dwordx4 a[112:115], v209, s[20:23], s100 offen offset:3072 sc1
    v_mfma_f32_16x16x32_bf16 v[4:7], v[160:163], a[124:127], v[4:7]
    ds_read_b64_tr_b16 v[116:117], v98
    ds_read_b64_tr_b16 v[118:119], v99
    v_mfma_f32_16x16x32_bf16 a[248:251], v[148:151], v[160:163], a[248:251]
    ds_read_b64_tr_b16 v[120:121], v100
    ds_read_b64_tr_b16 v[122:123], v101
    v_mfma_f32_16x16x32_bf16 v[8:11], v[164:167], a[120:123], v[8:11]
    v_mfma_f32_16x16x32_bf16 v[12:15], v[164:167], a[124:127], v[12:15]
    s_waitcnt lgkmcnt(0)
    s_barrier
    s_add_u32 s45, s0, 5120
    s_add_u32 m0, s58, 61440
    v_mfma_f32_16x16x32_bf16 v[16:19], v[168:171], a[120:123], v[16:19]
    buffer_load_dwordx4 v209, s[20:23], s45 offen offset:0 sc1 lds
    v_mfma_f32_16x16x32_bf16 v[20:23], v[168:171], a[124:127], v[20:23]
    ds_read_b64_tr_b16 v[192:193], v64 offset:0
    ds_read_b64_tr_b16 v[194:195], v64 offset:512
    v_mfma_f32_16x16x32_bf16 v[24:27], v[172:175], a[120:123], v[24:27]
    buffer_load_dwordx4 a[116:119], v159, s[20:23], s100 offen offset:0 sc1
    v_mfma_f32_16x16x32_bf16 v[28:31], v[172:175], a[124:127], v[28:31]
    ds_read_b64_tr_b16 v[196:197], v64 offset:2048
    ds_read_b64_tr_b16 v[198:199], v64 offset:2560
    v_mfma_f32_16x16x32_bf16 v[32:35], v[176:179], a[120:123], v[32:35]
    buffer_load_dwordx4 v209, s[20:23], s45 offen offset:1024 sc1 lds
    v_mfma_f32_16x16x32_bf16 v[36:39], v[176:179], a[124:127], v[36:39]
    ds_read_b64_tr_b16 v[160:161], v64 offset:8192
    ds_read_b64_tr_b16 v[162:163], v64 offset:8704
    v_mfma_f32_16x16x32_bf16 a[252:255], v[148:151], v[176:179], a[252:255]
    ds_read_b64_tr_b16 v[124:125], v102
    ds_read_b64_tr_b16 v[126:127], v103
    v_mfma_f32_16x16x32_bf16 v[40:43], v[180:183], a[120:123], v[40:43]
    ds_read_b64_tr_b16 v[164:165], v64 offset:10240
    ds_read_b64_tr_b16 v[166:167], v64 offset:10752
    v_mfma_f32_16x16x32_bf16 v[44:47], v[180:183], a[124:127], v[44:47]
    ds_read_b64_tr_b16 v[128:129], v104
    ds_read_b64_tr_b16 v[130:131], v105
    v_mfma_f32_16x16x32_bf16 v[48:51], v[184:187], a[120:123], v[48:51]
    buffer_load_dwordx4 v209, s[20:23], s45 offen offset:2048 sc1 lds
    v_mfma_f32_16x16x32_bf16 v[52:55], v[184:187], a[124:127], v[52:55]
    ds_read_b64_tr_b16 v[168:169], v64 offset:16384
    ds_read_b64_tr_b16 v[170:171], v64 offset:16896
    v_mfma_f32_16x16x32_bf16 v[56:59], v[188:191], a[120:123], v[56:59]
    ds_read_b64_tr_b16 v[172:173], v64 offset:18432
    ds_read_b64_tr_b16 v[174:175], v64 offset:18944
    v_mfma_f32_16x16x32_bf16 v[60:63], v[188:191], a[124:127], v[60:63]
    ds_read_b64_tr_b16 v[132:133], v106
    ds_read_b64_tr_b16 v[134:135], v107
    s_waitcnt lgkmcnt(8)
    v_mfma_f32_16x16x32_bf16 v[0:3], v[192:195], a[128:131], v[0:3]
    buffer_load_dwordx4 v209, s[20:23], s45 offen offset:3072 sc1 lds
    ds_read_b64_tr_b16 v[176:177], v64 offset:24576
    v_mfma_f32_16x16x32_bf16 v[4:7], v[192:195], a[132:135], v[4:7]
    ds_read_b64_tr_b16 v[178:179], v64 offset:25088
    s_and_b32 s54, s2, 6
    s_lshl_b32 s54, s54, 2
    v_mfma_f32_16x16x32_bf16 a[248:251], v[148:151], v[192:195], a[248:251]
    s_bfe_u32 s70, s2, 0x30003
    s_add_u32 s100, s101, 15360
    v_mfma_f32_16x16x32_bf16 v[32:35], v[196:199], a[128:131], v[32:35]
    buffer_load_dwordx4 a[120:123], v209, s[20:23], s100 offen offset:0 sc1
    ds_read_b64_tr_b16 v[180:181], v64 offset:26624
    v_mfma_f32_16x16x32_bf16 v[36:39], v[196:199], a[132:135], v[36:39]
    ds_read_b64_tr_b16 v[182:183], v64 offset:27136
    s_add_u32 s54, s54, s70
    v_mfma_f32_16x16x32_bf16 a[252:255], v[148:151], v[196:199], a[252:255]
    s_mul_i32 s55, s2, 257
    s_add_u32 m0, s58, 65536
    v_mfma_f32_16x16x32_bf16 v[0:3], v[160:163], a[136:139], v[0:3]
    buffer_load_dwordx4 v159, s[20:23], s45 offen offset:0 sc1 lds
    ds_read_b64_tr_b16 v[184:185], v65 offset:0
    v_mfma_f32_16x16x32_bf16 v[4:7], v[160:163], a[140:143], v[4:7]
    ds_read_b64_tr_b16 v[186:187], v65 offset:512
    s_bfe_u32 s55, s55, 0x30006
    v_mfma_f32_16x16x32_bf16 a[248:251], v[148:151], v[160:163], a[248:251]
    s_mul_i32 s70, s40, 3
    s_min_u32 s70, s70, 5
    s_lshl_b32 s51, s54, 4
    v_mfma_f32_16x16x32_bf16 v[32:35], v[164:167], a[136:139], v[32:35]
    ds_read_b64_tr_b16 v[188:189], v66 offset:0
    ds_read_b64_tr_b16 v[190:191], v66 offset:512
    v_mfma_f32_16x16x32_bf16 v[36:39], v[164:167], a[140:143], v[36:39]
    s_add_u32 s51, s51, s70
    s_lshl_b32 s51, s51, 7
    s_add_u32 s51, s51, 19450880
    v_mfma_f32_16x16x32_bf16 a[252:255], v[148:151], v[164:167], a[252:255]
    s_add_u32 s45, s0, 10240
    s_add_u32 m0, s58, 40960
    s_waitcnt lgkmcnt(4)
    v_mfma_f32_16x16x32_bf16 v[0:3], v[168:171], a[144:147], v[0:3]
    buffer_load_dwordx4 v209, s[20:23], s45 offen offset:0 sc1 lds
    ds_read_b64_tr_b16 v[192:193], v67 offset:0
    v_mfma_f32_16x16x32_bf16 v[4:7], v[168:171], a[148:151], v[4:7]
    ds_read_b64_tr_b16 v[194:195], v67 offset:512
    s_add_u32 s57, s76, 2621440
    v_mfma_f32_16x16x32_bf16 a[248:251], v[148:151], v[168:171], a[248:251]
    s_add_u32 s47, s43, 65536
    s_mul_i32 s76, s54, 221184
    v_mfma_f32_16x16x32_bf16 v[32:35], v[172:175], a[144:147], v[32:35]
    buffer_load_dwordx4 a[124:127], v209, s[20:23], s100 offen offset:1024 sc1
    ds_read_b64_tr_b16 v[196:197], v65 offset:2048
    v_mfma_f32_16x16x32_bf16 v[36:39], v[172:175], a[148:151], v[36:39]
    ds_read_b64_tr_b16 v[198:199], v65 offset:2560
    s_add_u32 s76, s76, 2621440
    s_mul_i32 s70, s40, 12288
    s_add_u32 s53, s76, s70
    v_mfma_f32_16x16x32_bf16 a[252:255], v[148:151], v[172:175], a[252:255]
    s_lshl_b32 s70, s40, 14
    s_waitcnt vmcnt(15)
    buffer_store_dword v145, v144, s[20:23], s43 offen sc1
    v_mfma_f32_16x16x32_bf16 v[0:3], v[176:179], a[152:155], v[0:3]
    buffer_load_dwordx4 v209, s[20:23], s45 offen offset:1024 sc1 lds
    ds_read_b64_tr_b16 v[160:161], v66 offset:2048
    v_mfma_f32_16x16x32_bf16 v[4:7], v[176:179], a[156:159], v[4:7]
    ds_read_b64_tr_b16 v[162:163], v66 offset:2560
    s_add_u32 s76, s76, s70
    v_mfma_f32_16x16x32_bf16 a[248:251], v[148:151], v[176:179], a[248:251]
    s_add_u32 s76, s76, 45056
    ds_read_b128 v[212:215], v202 offset:3072
    v_mfma_f32_16x16x32_bf16 v[32:35], v[180:183], a[152:155], v[32:35]
    ds_read_b64_tr_b16 v[164:165], v67 offset:2048
    ds_read_b64_tr_b16 v[166:167], v67 offset:2560
    v_mfma_f32_16x16x32_bf16 v[36:39], v[180:183], a[156:159], v[36:39]
    ds_read_b128 v[140:143], v202 offset:4096
    s_lshr_b32 s71, s40, 1
    s_and_b32 s70, s40, 1
    v_mfma_f32_16x16x32_bf16 a[252:255], v[148:151], v[180:183], a[252:255]
    s_lshl_b32 s70, s70, 8
    s_mul_i32 s72, s71, 110592
    s_waitcnt lgkmcnt(6)
    v_mfma_f32_16x16x32_bf16 v[8:11], v[184:187], a[128:131], v[8:11]
    buffer_load_dwordx4 v209, s[20:23], s45 offen offset:2048 sc1 lds
    ds_read_b64_tr_b16 v[168:169], v65 offset:8192
    v_mfma_f32_16x16x32_bf16 v[12:15], v[184:187], a[132:135], v[12:15]
    ds_read_b64_tr_b16 v[170:171], v65 offset:8704
    s_sub_u32 s73, 110592, s72
    s_add_u32 s72, s72, s70
    v_mfma_f32_16x16x32_bf16 v[16:19], v[188:191], a[128:131], v[16:19]
    ds_read_b64_tr_b16 v[172:173], v66 offset:8192
    ds_read_b64_tr_b16 v[174:175], v66 offset:8704
    v_accvgpr_read_b32 v240, a248
    v_mfma_f32_16x16x32_bf16 v[20:23], v[188:191], a[132:135], v[20:23]
    v_accvgpr_read_b32 v241, a252
    v_xor_b32 v244, 8, v156
    s_add_u32 s73, s73, s70
    v_mfma_f32_16x16x32_bf16 v[24:27], v[192:195], a[128:131], v[24:27]
    buffer_load_dwordx4 v209, s[20:23], s45 offen offset:3072 sc1 lds
    ds_read_b64_tr_b16 v[176:177], v67 offset:8192
    v_mfma_f32_16x16x32_bf16 v[28:31], v[192:195], a[132:135], v[28:31]
    ds_read_b64_tr_b16 v[178:179], v67 offset:8704
    v_xor_b32 v245, 16, v156
    v_xor_b32 v246, 24, v156
    v_mfma_f32_16x16x32_bf16 v[40:43], v[196:199], a[128:131], v[40:43]
    ds_read_b64_tr_b16 v[180:181], v65 offset:10240
    ds_read_b64_tr_b16 v[182:183], v65 offset:10752
    v_and_b32 v242, 0xffff0000, v240
    v_mfma_f32_16x16x32_bf16 v[44:47], v[196:199], a[132:135], v[44:47]
    v_sub_f32 v240, v240, v242
    s_add_u32 m0, s58, 45056
    s_waitcnt lgkmcnt(4)
    v_mfma_f32_16x16x32_bf16 v[48:51], v[160:163], a[128:131], v[48:51]
    buffer_load_dwordx4 v159, s[20:23], s45 offen offset:0 sc1 lds
    ds_read_b64_tr_b16 v[184:185], v66 offset:10240
    v_mfma_f32_16x16x32_bf16 v[52:55], v[160:163], a[132:135], v[52:55]
    ds_read_b64_tr_b16 v[186:187], v66 offset:10752
    v_cvt_pk_bf16_f32 v240, v242, v240
    s_lshl_b32 s52, s54, 1
    v_mfma_f32_16x16x32_bf16 v[56:59], v[164:167], a[128:131], v[56:59]
    ds_read_b64_tr_b16 v[188:189], v67 offset:10240
    ds_read_b64_tr_b16 v[190:191], v67 offset:10752
    v_and_b32 v243, 0xffff0000, v241
    v_mfma_f32_16x16x32_bf16 v[60:63], v[164:167], a[132:135], v[60:63]
    v_sub_f32 v241, v241, v243
    v_cvt_pk_bf16_f32 v241, v243, v241
    s_add_u32 s52, s52, s71
    v_mfma_f32_16x16x32_bf16 v[8:11], v[168:171], a[136:139], v[8:11]
    buffer_load_dwordx4 a[128:131], v209, s[20:23], s100 offen offset:2048 sc1
    ds_read_b64_tr_b16 v[192:193], v65 offset:16384
    v_mfma_f32_16x16x32_bf16 v[12:15], v[168:171], a[140:143], v[12:15]
    ds_read_b64_tr_b16 v[194:195], v65 offset:16896
    ds_write_b64 v156, v[240:241] offset:0
    v_mfma_f32_16x16x32_bf16 v[16:19], v[172:175], a[136:139], v[16:19]
    ds_read_b64_tr_b16 v[196:197], v66 offset:16384
    ds_read_b64_tr_b16 v[198:199], v66 offset:16896
    v_mfma_f32_16x16x32_bf16 v[20:23], v[172:175], a[140:143], v[20:23]
    ds_write_b64 v244, v[240:241] offset:2048
    s_mul_i32 s52, s52, 40960
    s_waitcnt lgkmcnt(6)
    v_mfma_f32_16x16x32_bf16 v[24:27], v[176:179], a[136:139], v[24:27]
    ds_read_b64_tr_b16 v[160:161], v67 offset:16384
    ds_read_b64_tr_b16 v[162:163], v67 offset:16896
    v_mfma_f32_16x16x32_bf16 v[28:31], v[176:179], a[140:143], v[28:31]
    ds_write_b64 v245, v[240:241] offset:4096
    ds_write_b64 v246, v[240:241] offset:6144
    v_mfma_f32_16x16x32_bf16 v[40:43], v[180:183], a[136:139], v[40:43]
    buffer_load_dwordx4 a[132:135], v209, s[20:23], s100 offen offset:3072 sc1
    ds_read_b64_tr_b16 v[164:165], v65 offset:18432
    v_mfma_f32_16x16x32_bf16 v[44:47], v[180:183], a[140:143], v[44:47]
    ds_read_b64_tr_b16 v[166:167], v65 offset:18944
    s_add_u32 s52, s52, s70
    s_add_u32 s52, s52, 12320768
    v_mfma_f32_16x16x32_bf16 v[48:51], v[184:187], a[136:139], v[48:51]
    ds_read_b64_tr_b16 v[168:169], v66 offset:18432
    ds_read_b64_tr_b16 v[170:171], v66 offset:18944
    s_lshl_b32 s48, s54, 11
    v_mfma_f32_16x16x32_bf16 v[52:55], v[184:187], a[140:143], v[52:55]
    s_lshl_b32 s71, s71, 2
    s_add_u32 s49, s48, s71
    s_add_u32 s49, s49, 19580928
    v_mfma_f32_16x16x32_bf16 v[56:59], v[188:191], a[136:139], v[56:59]
    v_mfma_f32_16x16x32_bf16 v[60:63], v[188:191], a[140:143], v[60:63]
    s_waitcnt lgkmcnt(4)
    s_barrier
    ds_read_b64_tr_b16 v[172:173], v67 offset:18432
    ds_read_b64_tr_b16 v[174:175], v67 offset:18944
    s_waitcnt lgkmcnt(4)
    v_mfma_f32_16x16x32_bf16 v[8:11], v[192:195], a[144:147], v[8:11]
    buffer_load_dwordx4 a[136:139], v159, s[20:23], s100 offen offset:0 sc1
    ds_read_b64_tr_b16 v[176:177], v65 offset:24576
    v_mfma_f32_16x16x32_bf16 v[12:15], v[192:195], a[148:151], v[12:15]
    ds_read_b64_tr_b16 v[178:179], v65 offset:25088
    ds_read_b128 v[240:243], v157 offset:0
    ds_read_b128 v[244:247], v157 offset:16
    v_mfma_f32_16x16x32_bf16 v[16:19], v[196:199], a[144:147], v[16:19]
    ds_read_b64_tr_b16 v[180:181], v66 offset:24576
    ds_read_b64_tr_b16 v[182:183], v66 offset:25088
    s_lshl_b32 s71, s40, 9
    s_add_u32 s48, s48, s71
    v_mfma_f32_16x16x32_bf16 v[20:23], v[196:199], a[148:151], v[20:23]
    s_add_u32 s48, s48, 19515392
    v_bfe_u32 v155, v209, 2, 4
    v_min_u32 v155, s35, v155
    v_mfma_f32_16x16x32_bf16 v[24:27], v[160:163], a[144:147], v[24:27]
    ds_read_b64_tr_b16 v[184:185], v67 offset:24576
    v_mfma_f32_16x16x32_bf16 v[28:31], v[160:163], a[148:151], v[28:31]
    ds_read_b64_tr_b16 v[186:187], v67 offset:25088
    s_waitcnt vmcnt(18)
    v_mfma_f32_32x32x16_bf16 v[80:95], v[112:115], v[72:75], 0
    v_mfma_f32_32x32x16_bf16 v[80:95], v[120:123], v[76:79], v[80:95]
    v_mfma_f32_32x32x16_bf16 v[80:95], v[128:131], v[204:207], v[80:95]
    v_mfma_f32_32x32x16_bf16 v[96:111], v[116:119], v[72:75], 0
    v_mfma_f32_16x16x32_bf16 v[40:43], v[164:167], a[144:147], v[40:43]
    ds_read_b64_tr_b16 v[188:189], v65 offset:26624
    ds_read_b64_tr_b16 v[190:191], v65 offset:27136
    s_waitcnt lgkmcnt(6)
    v_mfma_f32_16x16x16_bf16 v[8:11], v[242:243], v[248:249], v[8:11]
    v_mfma_f32_16x16x16_bf16 v[12:15], v[242:243], v[252:253], v[12:15]
    v_mfma_f32_16x16x16_bf16 v[0:3], v[240:241], v[248:249], v[0:3]
    v_add_u32 v148, s72, v140
    v_mfma_f32_16x16x32_bf16 v[44:47], v[164:167], a[148:151], v[44:47]
    v_add_u32 v150, s73, v140
    v_xor_b32 v149, 256, v148
    v_xor_b32 v151, 256, v150
    v_bfe_u32 v156, v209, 5, 2
    v_mfma_f32_32x32x16_bf16 v[96:111], v[124:127], v[76:79], v[96:111]
    v_mfma_f32_32x32x16_bf16 v[96:111], v[132:135], v[204:207], v[96:111]
    s_waitcnt lgkmcnt(4)
    v_mfma_f32_16x16x32_bf16 v[48:51], v[168:171], a[144:147], v[48:51]
    ds_read_b64_tr_b16 v[192:193], v66 offset:26624
    ds_read_b64_tr_b16 v[194:195], v66 offset:27136
    v_mfma_f32_16x16x16_bf16 v[16:19], v[244:245], v[248:249], v[16:19]
    v_mfma_f32_16x16x16_bf16 v[20:23], v[244:245], v[252:253], v[20:23]
    v_mfma_f32_16x16x16_bf16 v[32:35], v[240:241], v[250:251], v[32:35]
    v_bfe_u32 v157, v209, 2, 3
    v_min_u32 v158, 2, v156
    v_mfma_f32_16x16x32_bf16 v[52:55], v[168:171], a[148:151], v[52:55]
    v_lshl_add_u32 v158, v158, 7, v157
    v_lshl_add_u32 v156, v156, 7, v157
    v_and_b32 v157, 0xf0, v209
    v_lshlrev_b32 v157, 3, v157
    v_mfma_f32_16x16x32_bf16 v[56:59], v[172:175], a[144:147], v[56:59]
    ds_read_b64_tr_b16 v[196:197], v67 offset:26624
    v_mfma_f32_16x16x32_bf16 v[60:63], v[172:175], a[148:151], v[60:63]
    ds_read_b64_tr_b16 v[198:199], v67 offset:27136
    v_mfma_f32_16x16x16_bf16 v[24:27], v[246:247], v[248:249], v[24:27]
    v_mfma_f32_16x16x16_bf16 v[28:31], v[246:247], v[252:253], v[28:31]
    v_mfma_f32_16x16x16_bf16 v[4:7], v[240:241], v[252:253], v[4:7]
    v_mfma_f32_16x16x32_bf16 v[8:11], v[176:179], a[152:155], v[8:11]
    v_mfma_f32_16x16x16_bf16 v[40:43], v[242:243], v[250:251], v[40:43]
    v_mfma_f32_16x16x16_bf16 v[44:47], v[242:243], v[254:255], v[44:47]
    v_mfma_f32_16x16x16_bf16 v[36:39], v[240:241], v[254:255], v[36:39]
    v_mfma_f32_16x16x32_bf16 v[12:15], v[176:179], a[156:159], v[12:15]
    v_mfma_f32_16x16x32_bf16 v[16:19], v[180:183], a[152:155], v[16:19]
    v_mfma_f32_16x16x16_bf16 v[48:51], v[244:245], v[250:251], v[48:51]
    v_mfma_f32_16x16x16_bf16 v[52:55], v[244:245], v[254:255], v[52:55]
    v_mfma_f32_16x16x32_bf16 v[20:23], v[180:183], a[156:159], v[20:23]
    s_waitcnt lgkmcnt(0)
    v_mfma_f32_16x16x32_bf16 v[24:27], v[184:187], a[152:155], v[24:27]
    v_mfma_f32_16x16x16_bf16 v[56:59], v[246:247], v[250:251], v[56:59]
    v_mfma_f32_16x16x16_bf16 v[60:63], v[246:247], v[254:255], v[60:63]
    v_mfma_f32_16x16x32_bf16 v[28:31], v[184:187], a[156:159], v[28:31]
    v_mfma_f32_16x16x32_bf16 v[40:43], v[188:191], a[152:155], v[40:43]
    v_mfma_f32_16x16x32_bf16 v[44:47], v[188:191], a[156:159], v[44:47]
    v_mfma_f32_16x16x32_bf16 v[48:51], v[192:195], a[152:155], v[48:51]
    v_mfma_f32_16x16x32_bf16 v[52:55], v[192:195], a[156:159], v[52:55]
    v_mfma_f32_16x16x32_bf16 v[56:59], v[196:199], a[152:155], v[56:59]
    v_mfma_f32_16x16x32_bf16 v[60:63], v[196:199], a[156:159], v[60:63]
    s_branch KP_join
K1_q:
    v_mul_u32_u24 v3, 3840, v1
    v_add_u32 v202, v3, v2
    v_xor_b32 v3, 64, v202
    v_add_u32 v203, 29696, v3
    s_mov_b32 s12, s30
    s_mov_b32 s13, s31
    s_mov_b32 s14, 2457600
    s_mov_b32 s15, 0x20000
    s_sub_u32 s16, s30, 1920
    s_subb_u32 s17, s31, 0
    s_mov_b32 s18, 2459520
    s_mov_b32 s19, 0x20000
    s_lshl_b32 s71, s44, 8
    s_mul_i32 s46, s40, 61440
    s_add_u32 s46, s46, s71
    s_and_b32 s50, s71, 0xffffff80
    s_add_u32 m0, s66, 65536
    s_nop 0
    buffer_load_dwordx4 v202, s[12:15], s46 offen offset:0 lds
    buffer_load_dwordx4 v203, s[12:15], s46 offen offset:1024 lds
    buffer_load_dwordx4 v202, s[16:19], s46 offen offset:2048 lds
    buffer_load_dwordx4 v203, s[16:19], s46 offen offset:3072 lds
    s_add_u32 s46, s46, 245760
    s_mul_i32 s70, s42, 10
    v_mov_b32 v3, 1073741824
    v_lshrrev_b32 v4, 2, v0
    v_add_u32 v4, s70, v4
    v_mul_u32_u24 v4, 3840, v4
    v_and_b32 v5, 1, v0
    v_lshl_add_u32 v4, v5, 7, v4
    v_cmp_gt_u32 vcc, 40, v0
    s_nop 1
    v_cndmask_b32 v207, v3, v4, vcc
    v_add_u32 v4, s70, v0
    v_cmp_gt_u32 vcc, 10, v0
    v_mul_u32_u24 v4, 3456, v4
    s_nop 0
    v_cndmask_b32 v206, v3, v4, vcc
    buffer_load_dword a211, v207, s[12:15], s50 offen
    v_lshrrev_b32 v6, 4, v0
    v_mul_u32_u24 v6, 1280, v6
    v_and_b32 v7, 15, v0
    v_lshl_add_u32 v247, v7, 4, v6
    s_lshl_b32 s64, s41, 3
    s_add_u32 s64, s64, s44
    s_lshl_b32 s64, s64, 2
    s_add_u32 s64, s64, s40
    s_lshl_b32 s69, s64, 5
    s_add_u32 s69, s69, 19671040
    s_mul_i32 s64, s64, 5120
    buffer_load_dwordx4 v[224:227], v247, s[24:27], s64 offen offset:0
    buffer_load_dwordx4 v[228:231], v247, s[24:27], s64 offen offset:256
    buffer_load_dwordx4 v[232:235], v247, s[24:27], s64 offen offset:512
    buffer_load_dwordx4 v[236:239], v247, s[24:27], s64 offen offset:768
    buffer_load_dwordx4 v[240:243], v247, s[24:27], s64 offen offset:1024
    v_mul_u32_u24 v3, 3456, v1
    v_add_u32 v200, v3, v2
    v_xor_b32 v3, 64, v200
    v_add_u32 v201, 26624, v3
    s_mov_b32 s4, s32
    s_mov_b32 s5, s33
    s_mov_b32 s6, 2211840
    s_mov_b32 s7, 0x20000
    s_sub_u32 s8, s34, 2048
    s_subb_u32 s9, s35, 0
    s_mov_b32 s10, 2213888
    s_mov_b32 s11, 0x20000
    s_and_b32 s3, s74, 2
    s_lshl_b32 s3, s3, 2
    s_add_u32 s3, s3, s44
    s_add_u32 s49, s49, 128
    s_add_u32 s45, s49, 18432
    s_mov_b32 s20, s36
    s_mov_b32 s21, s37
    s_mov_b32 s22, 19972096
    s_mov_b32 s23, 0x20000
    s_add_u32 s36, s36, 19447808
    s_addc_u32 s37, s37, 0
    s_load_dword s38, s[36:37], 0
    s_load_dwordx2 s[28:29], s[0:1], 16
    s_load_dwordx2 s[30:31], s[0:1], 64
    s_load_dwordx2 s[96:97], s[0:1], 24
    s_load_dwordx2 s[98:99], s[0:1], 56
    v_lshlrev_b32 v209, 4, v0
    v_bfe_u32 v1, v0, 4, 1
    v_bfe_u32 v2, v0, 2, 2
    v_lshl_add_u32 v3, v1, 3, v2
    v_lshrrev_b32 v4, 5, v0
    v_and_b32 v5, 3, v0
    v_lshlrev_b32 v5, 3, v5
    v_bfe_u32 v2, v0, 3, 2
    v_xor_b32 v2, s40, v2
    v_lshl_add_u32 v2, v2, 5, v5
    v_lshl_add_u32 v2, v3, 7, v2
    v_lshl_add_u32 v64, v4, 12, v2
    v_xor_b32 v65, 32, v64
    v_xor_b32 v66, 64, v64
    v_xor_b32 v67, 96, v64
    v_xor_b32 v68, 65536, v64
    v_xor_b32 v69, 65536, v65
    v_xor_b32 v70, 65536, v66
    v_xor_b32 v71, 65536, v67
    v_xor_b32 v2, s40, v1
    v_lshl_add_u32 v2, v2, 1, v4
    v_and_b32 v5, 15, v0
    v_lshlrev_b32 v6, 4, v5
    v_lshl_add_u32 v152, v2, 9, v6
    v_xor_b32 v153, 2048, v152
    v_lshrrev_b32 v2, 4, v0
    v_bfe_u32 v3, v0, 1, 3
    v_xor_b32 v2, v2, v3
    v_lshlrev_b32 v2, 4, v2
    v_lshl_add_u32 v2, v5, 7, v2
    v_add_u32 v144, s59, v2
    v_xor_b32 v145, 64, v144
    v_mov_b32 v146, 0x3f803f80
    v_lshrrev_b32 v2, 4, v0
    v_lshlrev_b32 v2, 2, v2
    v_cmp_eq_u32 vcc, v5, v2
    v_lshlrev_b32 v1, 5, v0
    v_add_u32 v1, 143360, v1
    v_lshl_add_u32 v156, s40, 3, v1
    v_lshl_add_u32 v157, s40, 11, v1
    v_cndmask_b32 v148, 0, v146, vcc
    v_cndmask_b32 v149, 0, v146, vcc
    v_cndmask_b32 v150, 0, v146, vcc
    v_cndmask_b32 v151, 0, v146, vcc
    v_mov_b32 v90, v0
    s_waitcnt vmcnt(6) lgkmcnt(0)
    s_barrier
    ds_read_b128 a[0:3], v144 offset:0
    ds_read_b128 a[4:7], v144 offset:2048
    ds_read_b128 a[8:11], v145 offset:0
    ds_read_b128 a[12:15], v145 offset:2048
    ds_read_b64_tr_b16 v[160:161], v68 offset:0
    ds_read_b64_tr_b16 v[162:163], v68 offset:512
    ds_read_b64_tr_b16 v[164:165], v69 offset:0
    ds_read_b64_tr_b16 v[166:167], v69 offset:512
    ds_read_b64_tr_b16 v[168:169], v70 offset:0
    ds_read_b64_tr_b16 v[170:171], v70 offset:512
    ds_read_b64_tr_b16 v[172:173], v71 offset:0
    ds_read_b64_tr_b16 v[174:175], v71 offset:512
    ds_read_b64_tr_b16 v[176:177], v68 offset:2048
    ds_read_b64_tr_b16 v[178:179], v68 offset:2560
    ds_read_b64_tr_b16 v[180:181], v69 offset:2048
    ds_read_b64_tr_b16 v[182:183], v69 offset:2560
    ds_read_b64_tr_b16 v[184:185], v70 offset:2048
    ds_read_b64_tr_b16 v[186:187], v70 offset:2560
    s_add_u32 m0, s66, 81920
    s_waitcnt lgkmcnt(6)
    v_mfma_f32_16x16x32_bf16 v[0:3], v[160:163], a[0:3], 0
    buffer_load_dwordx4 v202, s[12:15], s46 offen offset:0 lds
    v_mfma_f32_16x16x32_bf16 v[4:7], v[160:163], a[4:7], 0
    ds_read_b64_tr_b16 v[188:189], v71 offset:2048
    v_mfma_f32_16x16x32_bf16 a[248:251], v[148:151], v[160:163], 0
    ds_read_b64_tr_b16 v[190:191], v71 offset:2560
    v_mfma_f32_16x16x32_bf16 v[8:11], v[164:167], a[0:3], 0
    buffer_load_dwordx4 v203, s[12:15], s46 offen offset:1024 lds
    ds_read_b64_tr_b16 v[192:193], v68 offset:8192
    v_mfma_f32_16x16x32_bf16 v[12:15], v[164:167], a[4:7], 0
    ds_read_b64_tr_b16 v[194:195], v68 offset:8704
    ds_read_b64_tr_b16 v[196:197], v69 offset:8192
    v_mfma_f32_16x16x32_bf16 v[16:19], v[168:171], a[0:3], 0
    buffer_load_dwordx4 v202, s[16:19], s46 offen offset:2048 lds
    v_mfma_f32_16x16x32_bf16 v[20:23], v[168:171], a[4:7], 0
    ds_read_b64_tr_b16 v[198:199], v69 offset:8704
    ds_read_b64_tr_b16 v[160:161], v70 offset:8192
    v_mfma_f32_16x16x32_bf16 v[24:27], v[172:175], a[0:3], 0
    buffer_load_dwordx4 v203, s[16:19], s46 offen offset:3072 lds
    ds_read_b64_tr_b16 v[162:163], v70 offset:8704
    v_mfma_f32_16x16x32_bf16 v[28:31], v[172:175], a[4:7], 0
    ds_read_b64_tr_b16 v[164:165], v71 offset:8192
    s_add_u32 s46, s46, 245760
    s_add_u32 m0, s59, 16384
    s_waitcnt lgkmcnt(7)
    v_mfma_f32_16x16x32_bf16 v[32:35], v[176:179], a[0:3], 0
    buffer_load_dwordx4 v204, s[24:27], s49 offen offset:0 lds
    v_mfma_f32_16x16x32_bf16 v[36:39], v[176:179], a[4:7], 0
    ds_read_b64_tr_b16 v[166:167], v71 offset:8704
    v_mfma_f32_16x16x32_bf16 a[252:255], v[148:151], v[176:179], 0
    ds_read_b64_tr_b16 v[168:169], v68 offset:10240
    ds_read_b64_tr_b16 v[170:171], v68 offset:10752
    v_mfma_f32_16x16x32_bf16 v[40:43], v[180:183], a[0:3], 0
    buffer_load_dwordx4 v205, s[24:27], s49 offen offset:1024 lds
    v_mfma_f32_16x16x32_bf16 v[44:47], v[180:183], a[4:7], 0
    ds_read_b64_tr_b16 v[172:173], v69 offset:10240
    ds_read_b64_tr_b16 v[174:175], v69 offset:10752
    v_mfma_f32_16x16x32_bf16 v[48:51], v[184:187], a[0:3], 0
    buffer_load_dwordx4 v204, s[24:27], s45 offen offset:2048 lds
    v_mfma_f32_16x16x32_bf16 v[52:55], v[184:187], a[4:7], 0
    ds_read_b64_tr_b16 v[176:177], v70 offset:10240
    ds_read_b64_tr_b16 v[178:179], v70 offset:10752
    v_mfma_f32_16x16x32_bf16 v[56:59], v[188:191], a[0:3], 0
    buffer_load_dwordx4 v205, s[24:27], s45 offen offset:3072 lds
    ds_read_b64_tr_b16 v[180:181], v71 offset:10240
    ds_read_b64_tr_b16 v[182:183], v71 offset:10752
    v_mfma_f32_16x16x32_bf16 v[60:63], v[188:191], a[4:7], 0
    s_add_u32 s49, s49, 128
    s_add_u32 s45, s49, 18432
    s_add_u32 m0, s66, 0
    s_waitcnt lgkmcnt(8)
    v_mfma_f32_16x16x32_bf16 v[0:3], v[192:195], a[8:11], v[0:3]
    v_mfma_f32_16x16x32_bf16 v[4:7], v[192:195], a[12:15], v[4:7]
    v_mfma_f32_16x16x32_bf16 a[248:251], v[148:151], v[192:195], a[248:251]
    buffer_load_dwordx4 v202, s[12:15], s46 offen offset:0 lds
    s_mul_i32 s72, s42, 40960
    s_lshl_b32 s79, s44, 13
    s_add_u32 s72, s72, s79
    s_add_u32 s72, s72, 9699328
    s_add_u32 s73, s72, 4096
    s_lshl_b32 s71, s44, 7
    s_mul_i32 s47, s40, 55296
    s_add_u32 s47, s47, s71
    s_and_b32 s51, s71, 0xffffff80
    s_mul_i32 s61, s42, 110592
    s_lshl_b32 s79, s44, 12
    s_add_u32 s61, s61, s79
    s_add_u32 s61, s61, 2621440
    s_add_u32 s77, s44, 19
    s_movk_i32 s65, 2432
    s_mul_i32 s62, s42, 110592
    s_lshl_b32 s79, s77, 12
    s_add_u32 s62, s62, s79
    s_add_u32 s62, s62, 2621440
    s_lshl_b32 s74, s42, 5
    s_add_u32 s74, s74, s44
    s_lshl_b32 s74, s74, 2
    s_add_u32 s74, s74, 19646464
    s_mul_i32 s58, s40, 5120
    s_mov_b32 s53, s28
    s_mov_b32 s57, s29
    s_mul_i32 s38, s38, 0x9E3779B1
    s_add_u32 s38, s38, 0x7F4A7C15
    v_mov_b32 v80, s38
    v_mov_b32 v81, 1073741824
    v_cmp_eq_u32 vcc, 0, v90
    v_bfe_u32 v82, v209, 1, 8
    v_and_b32 v91, 15, v90
    v_cndmask_b32 v81, v81, v90, vcc
    v_cmp_eq_u32 vcc, 0, v91
    v_lshrrev_b32 v91, 1, v90
    v_mov_b32 v246, 1073741824
    v_mov_b32 v244, 0
    v_mov_b32 v245, 0
    v_cndmask_b32 v246, v246, v91, vcc
    s_lshl_b32 s70, s40, 10
    s_and_b32 s75, s2, 7
    s_lshl_b32 s75, s75, 1
    s_bfe_u32 s71, s2, 0x10003
    s_add_u32 s75, s75, s71
    s_and_b32 s70, s70, 1024
    s_mul_i32 s100, s75, 1600
    s_add_u32 s100, s100, s70
    v_lshrrev_b32 v92, 5, v209
    v_min_u32 v92, 18, v92
    s_mul_i32 s70, s40, 6
    v_add_u32 v91, s70, v92
    v_min_u32 v91, 21, v91
    v_add_u32 v91, 20, v91
    s_lshl_b32 s70, s40, 3
    s_add_u32 s70, s70, 36
    v_add_u32 v93, s70, v92
    v_cmp_lt_u32 vcc, 5, v92
    s_nop 1
    v_cndmask_b32 v91, v91, v93, vcc
    s_mul_i32 s70, s40, 5
    s_sub_u32 s70, s70, 14
    v_add_u32 v93, s70, v92
    v_cmp_lt_u32 vcc, 13, v92
    s_nop 1
    v_cndmask_b32 v91, v91, v93, vcc
    v_cndmask_b32 v92, 1, 0, vcc
    v_mad_u32_u24 v91, v91, 10, v92
    v_bfe_u32 v92, v209, 4, 1
    s_mul_i32 s70, s2, 257
    s_bfe_u32 s70, s70, 0x30006
    s_mul_i32 s70, s70, 5
    s_lshr_b32 s70, s70, 2
    v_add3_u32 v91, v91, v92, s70
    v_mul_u32_u24 v91, 21846, v91
    v_lshrrev_b32 v91, 16, v91
    v_lshlrev_b32 v91, 4, v91
    v_accvgpr_write_b32 a212, v91
    s_lshl_b32 s1, s2, 2
    s_add_u32 s1, s1, 19448832
    s_cmp_eq_u32 s40, 0
    s_cselect_b32 s1, s1, 1073741824
    s_lshr_b32 s70, s2, 4
    s_lshl_b32 s70, s70, 2
    s_add_u32 s70, s70, s40
    s_lshl_b32 s36, s70, 7
    s_add_u32 s36, s36, 19646464
    s_mul_i32 s76, s70, 40960
    s_mul_i32 s71, s75, 2560
    s_add_u32 s76, s76, s71
    s_add_u32 s76, s76, 9699328
    s_lshr_b32 s28, s70, 1
    s_lshl_b32 s28, s28, 4
    s_add_u32 s28, s28, s75
    s_lshl_b32 s28, s28, 7
    s_and_b32 s70, s40, 1
    s_lshl_b32 s70, s70, 2
    s_add_u32 s70, s70, 19447808
    s_add_u32 s28, s28, s70
    s_add_u32 s28, s28, 133120
    s_lshl_b32 s77, s75, 2
    s_add_u32 s77, s77, s40
    s_lshl_b32 s33, s77, 7
    s_add_u32 s33, s33, 19687424
    s_lshl_b32 s77, s77, 10
    s_add_u32 s77, s77, 18857984
    s_cmp_lt_u32 s40, 3
    s_cselect_b32 s35, 12, 4
    s_lshr_b32 s43, s42, 1
    s_lshl_b32 s43, s43, 4
    s_add_u32 s43, s43, s3
    s_lshl_b32 s43, s43, 7
    s_add_u32 s43, s43, s70
    s_add_u32 s43, s43, 2048
    s_lshl_b32 s67, s42, 8
    s_add_u32 s67, s67, 19671040
    s_add_u32 s48, s47, 221184
    s_add_u32 s51, s47, 442368
    s_add_u32 s52, s47, 663552
    s_add_u32 s55, s47, 884736
    s_add_u32 s56, s47, 1105920
    s_add_u32 s41, s47, 1327104
    s_add_u32 s42, s47, 1548288
    s_add_u32 s44, s47, 1769472
    s_add_u32 s3, s47, 1990656
    s_mul_i32 s68, s2, 257
    s_bfe_u32 s68, s68, 0x30006
    s_mul_i32 s0, s68, 378880
    s_add_u32 s0, s0, 14942208
    s_mul_i32 s75, s58, 6
    s_add_u32 s75, s75, s0
    s_add_u32 s75, s75, 102400
    s_lshl_b32 s101, s58, 3
    s_add_u32 s101, s101, s0
    s_add_u32 s101, s101, 215040
    s_mul_i32 s68, s58, 5
    s_add_u32 s0, s0, s68
    v_lshrrev_b32 v91, 4, v90
    v_mul_u32_u24 v91, 3072, v91
    v_bfe_u32 v92, v90, 2, 2
    v_lshl_add_u32 v91, v92, 7, v91
    v_bfe_u32 v92, v90, 3, 1
    v_bfe_u32 v93, v90, 1, 1
    v_xor_b32 v92, v92, v93
    v_lshl_add_u32 v91, v92, 4, v91
    v_and_b32 v92, 1, v90
    v_lshl_add_u32 v91, v92, 3, v91
    v_lshl_add_u32 v91, s40, 5, v91
    v_add_u32 v104, 49152, v91
    v_xor_b32 v105, 32, v104
    s_cmp_lt_u32 s2, 67
    s_cselect_b32 s96, s96, s98
    s_cselect_b32 s97, s97, s99
    s_mov_b32 s98, 2211840
    s_cselect_b32 s98, 819200, s98
    s_mov_b32 s99, 0x20000
    s_cselect_b32 s29, 0, 67
    s_cselect_b32 s79, 0, 100
    s_cselect_b32 s63, 20, 54
    s_sub_u32 s29, s2, s29
    s_mul_i32 s29, s29, 3
    s_add_u32 s79, s79, s40
    v_add_u32 v91, s29, v90
    v_mul_u32_u24 v92, 6554, v91
    v_lshrrev_b32 v92, 16, v92
    v_mul_u32_u24 v93, 10, v92
    v_sub_u32 v91, v91, v93
    v_cmp_gt_u32 vcc, s63, v92
    v_lshl_add_u32 v93, v91, 2, s40
    v_mul_u32_u24 v93, 52, v93
    v_lshrrev_b32 v93, 8, v93
    v_mul_u32_u24 v93, 365, v93
    v_lshl_add_u32 v93, v91, 2, v93
    v_mad_u32_u24 v93, v92, 5, v93
    v_add_u32 v93, s79, v93
    v_lshlrev_b32 v93, 10, v93
    v_add_u32 v93, 14942208, v93
    v_mov_b32 v94, 1073741824
    v_cndmask_b32 v93, v94, v93, vcc
    v_lshl_add_u32 v92, v92, 2, s40
    v_mul_u32_u24 v92, 10240, v92
    v_lshl_add_u32 v92, v91, 7, v92
    v_readlane_b32 s68, v93, 0
    v_readlane_b32 s63, v92, 0
    v_readlane_b32 s37, v93, 1
    v_readlane_b32 s78, v92, 1
    v_readlane_b32 s54, v93, 2
    v_readlane_b32 s32, v92, 2
    s_lshl_b32 s29, s2, 4
    s_add_u32 s29, s29, 19695616
    s_cmp_eq_u32 s40, 0
    s_cselect_b32 s29, s29, 1073741824
    s_mul_i32 s79, s40, 3072
    s_bfe_u32 s70, s2, 0x10006
    s_and_b32 s71, s2, 6
    s_add_u32 s71, s71, s70
    s_lshl_b32 s34, s71, 8
    s_lshl_b32 s70, s71, 7
    s_add_u32 s71, s70, 2432
    s_mov_b32 s39, 20000
    v_mfma_f32_16x16x32_bf16 v[8:11], v[196:199], a[8:11], v[8:11]
    v_mfma_f32_16x16x32_bf16 v[12:15], v[196:199], a[12:15], v[12:15]
    s_waitcnt vmcnt(1) lgkmcnt(0)
    s_barrier
    v_mfma_f32_16x16x32_bf16 v[16:19], v[160:163], a[8:11], v[16:19]
    buffer_load_dwordx4 v203, s[12:15], s46 offen offset:1024 lds
    ds_read_b128 a[16:19], v144 offset:16384
    v_mfma_f32_16x16x32_bf16 v[20:23], v[160:163], a[12:15], v[20:23]
    ds_read_b64_tr_b16 v[184:185], v68 offset:16384
    ds_read_b64_tr_b16 v[186:187], v68 offset:16896
    ds_read_b64_tr_b16 v[188:189], v69 offset:16384
    v_mfma_f32_16x16x32_bf16 v[24:27], v[164:167], a[8:11], v[24:27]
    buffer_load_dwordx4 v202, s[16:19], s46 offen offset:2048 lds
    ds_read_b128 a[20:23], v144 offset:18432
    v_mfma_f32_16x16x32_bf16 v[28:31], v[164:167], a[12:15], v[28:31]
    ds_read_b64_tr_b16 v[190:191], v69 offset:16896
    ds_read_b64_tr_b16 v[192:193], v70 offset:16384
    v_mfma_f32_16x16x32_bf16 v[32:35], v[168:171], a[8:11], v[32:35]
    buffer_load_dwordx4 v203, s[16:19], s46 offen offset:3072 lds
    ds_read_b128 a[24:27], v145 offset:16384
    v_mfma_f32_16x16x32_bf16 v[36:39], v[168:171], a[12:15], v[36:39]
    ds_read_b64_tr_b16 v[194:195], v70 offset:16896
    ds_read_b64_tr_b16 v[196:197], v71 offset:16384
    v_mfma_f32_16x16x32_bf16 a[252:255], v[148:151], v[168:171], a[252:255]
    s_add_u32 s46, s46, 245760
    s_add_u32 m0, s59, 32768
    v_mfma_f32_16x16x32_bf16 v[40:43], v[172:175], a[8:11], v[40:43]
    buffer_load_dwordx4 v204, s[24:27], s49 offen offset:0 lds
    ds_read_b128 a[28:31], v145 offset:18432
    v_mfma_f32_16x16x32_bf16 v[44:47], v[172:175], a[12:15], v[44:47]
    ds_read_b64_tr_b16 v[198:199], v71 offset:16896
    ds_read_b64_tr_b16 v[160:161], v68 offset:18432
    ds_read_b64_tr_b16 v[162:163], v68 offset:18944
    v_mfma_f32_16x16x32_bf16 v[48:51], v[176:179], a[8:11], v[48:51]
    buffer_load_dwordx4 v205, s[24:27], s49 offen offset:1024 lds
    v_mfma_f32_16x16x32_bf16 v[52:55], v[176:179], a[12:15], v[52:55]
    ds_read_b64_tr_b16 v[164:165], v69 offset:18432
    ds_read_b64_tr_b16 v[166:167], v69 offset:18944
    v_mfma_f32_16x16x32_bf16 v[56:59], v[180:183], a[8:11], v[56:59]
    buffer_load_dwordx4 v204, s[24:27], s45 offen offset:2048 lds
    v_mfma_f32_16x16x32_bf16 v[60:63], v[180:183], a[12:15], v[60:63]
    ds_read_b64_tr_b16 v[168:169], v70 offset:18432
    ds_read_b64_tr_b16 v[170:171], v70 offset:18944
    s_waitcnt lgkmcnt(6)
    v_mfma_f32_16x16x32_bf16 v[0:3], v[184:187], a[16:19], v[0:3]
    buffer_load_dwordx4 v205, s[24:27], s45 offen offset:3072 lds
    ds_read_b64_tr_b16 v[172:173], v71 offset:18432
    v_mfma_f32_16x16x32_bf16 v[4:7], v[184:187], a[20:23], v[4:7]
    ds_read_b64_tr_b16 v[174:175], v71 offset:18944
    s_add_u32 s49, s49, 128
    v_mfma_f32_16x16x32_bf16 a[248:251], v[148:151], v[184:187], a[248:251]
    s_add_u32 s45, s49, 18432
    s_add_u32 m0, s66, 16384
    v_mfma_f32_16x16x32_bf16 v[8:11], v[188:191], a[16:19], v[8:11]
    buffer_load_dwordx4 v202, s[12:15], s46 offen offset:0 lds
    ds_read_b64_tr_b16 v[176:177], v68 offset:24576
    v_mfma_f32_16x16x32_bf16 v[12:15], v[188:191], a[20:23], v[12:15]
    ds_read_b64_tr_b16 v[178:179], v68 offset:25088
    ds_read_b64_tr_b16 v[180:181], v69 offset:24576
    v_mfma_f32_16x16x32_bf16 v[16:19], v[192:195], a[16:19], v[16:19]
    buffer_load_dwordx4 v203, s[12:15], s46 offen offset:1024 lds
    v_mfma_f32_16x16x32_bf16 v[20:23], v[192:195], a[20:23], v[20:23]
    ds_read_b64_tr_b16 v[182:183], v69 offset:25088
    ds_read_b64_tr_b16 v[184:185], v70 offset:24576
    v_mfma_f32_16x16x32_bf16 v[24:27], v[196:199], a[16:19], v[24:27]
    buffer_load_dwordx4 v202, s[16:19], s46 offen offset:2048 lds
    v_mfma_f32_16x16x32_bf16 v[28:31], v[196:199], a[20:23], v[28:31]
    ds_read_b64_tr_b16 v[186:187], v70 offset:25088
    ds_read_b64_tr_b16 v[188:189], v71 offset:24576
    s_waitcnt lgkmcnt(7)
    v_mfma_f32_16x16x32_bf16 v[32:35], v[160:163], a[16:19], v[32:35]
    buffer_load_dwordx4 v203, s[16:19], s46 offen offset:3072 lds
    ds_read_b64_tr_b16 v[190:191], v71 offset:25088
    v_mfma_f32_16x16x32_bf16 v[36:39], v[160:163], a[20:23], v[36:39]
    ds_read_b64_tr_b16 v[192:193], v68 offset:26624
    ds_read_b64_tr_b16 v[194:195], v68 offset:27136
    v_mfma_f32_16x16x32_bf16 a[252:255], v[148:151], v[160:163], a[252:255]
    s_add_u32 s46, s46, 245760
    s_add_u32 m0, s59, 0
    v_mfma_f32_16x16x32_bf16 v[40:43], v[164:167], a[16:19], v[40:43]
    buffer_load_dwordx4 v204, s[24:27], s49 offen offset:0 lds
    v_mfma_f32_16x16x32_bf16 v[44:47], v[164:167], a[20:23], v[44:47]
    ds_read_b64_tr_b16 v[196:197], v69 offset:26624
    ds_read_b64_tr_b16 v[198:199], v69 offset:27136
    v_mfma_f32_16x16x32_bf16 v[48:51], v[168:171], a[16:19], v[48:51]
    buffer_load_dwordx4 v205, s[24:27], s49 offen offset:1024 lds
    v_mfma_f32_16x16x32_bf16 v[52:55], v[168:171], a[20:23], v[52:55]
    ds_read_b64_tr_b16 v[160:161], v70 offset:26624
    ds_read_b64_tr_b16 v[162:163], v70 offset:27136
    v_mfma_f32_16x16x32_bf16 v[56:59], v[172:175], a[16:19], v[56:59]
    buffer_load_dwordx4 v204, s[24:27], s45 offen offset:2048 lds
    v_mfma_f32_16x16x32_bf16 v[60:63], v[172:175], a[20:23], v[60:63]
    ds_read_b64_tr_b16 v[164:165], v71 offset:26624
    ds_read_b64_tr_b16 v[166:167], v71 offset:27136
    s_waitcnt lgkmcnt(8)
    v_mfma_f32_16x16x32_bf16 v[0:3], v[176:179], a[24:27], v[0:3]
    v_mfma_f32_16x16x32_bf16 v[4:7], v[176:179], a[28:31], v[4:7]
    v_mfma_f32_16x16x32_bf16 a[248:251], v[148:151], v[176:179], a[248:251]
    buffer_load_dwordx4 v205, s[24:27], s45 offen offset:3072 lds
    s_add_u32 s49, s49, 128
    s_add_u32 s45, s49, 18432
    v_dot2c_f32_bf16 v244, v224, v146
    v_dot2c_f32_bf16 v245, v224, v224
    v_dot2c_f32_bf16 v244, v225, v146
    v_dot2c_f32_bf16 v245, v225, v225
    v_dot2c_f32_bf16 v244, v226, v146
    v_dot2c_f32_bf16 v245, v226, v226
    v_dot2c_f32_bf16 v244, v227, v146
    v_dot2c_f32_bf16 v245, v227, v227
    v_dot2c_f32_bf16 v244, v228, v146
    v_dot2c_f32_bf16 v245, v228, v228
    v_dot2c_f32_bf16 v244, v229, v146
    v_dot2c_f32_bf16 v245, v229, v229
    v_dot2c_f32_bf16 v244, v230, v146
    v_dot2c_f32_bf16 v245, v230, v230
    v_dot2c_f32_bf16 v244, v231, v146
    v_dot2c_f32_bf16 v245, v231, v231
    v_dot2c_f32_bf16 v244, v232, v146
    v_dot2c_f32_bf16 v245, v232, v232
    v_dot2c_f32_bf16 v244, v233, v146
    v_dot2c_f32_bf16 v245, v233, v233
    v_dot2c_f32_bf16 v244, v234, v146
    v_dot2c_f32_bf16 v245, v234, v234
    v_dot2c_f32_bf16 v244, v235, v146
    v_dot2c_f32_bf16 v245, v235, v235
    v_dot2c_f32_bf16 v244, v236, v146
    v_dot2c_f32_bf16 v245, v236, v236
    v_dot2c_f32_bf16 v244, v237, v146
    v_dot2c_f32_bf16 v245, v237, v237
    v_dot2c_f32_bf16 v244, v238, v146
    v_dot2c_f32_bf16 v245, v238, v238
    v_dot2c_f32_bf16 v244, v239, v146
    v_dot2c_f32_bf16 v245, v239, v239
    v_dot2c_f32_bf16 v244, v240, v146
    v_dot2c_f32_bf16 v245, v240, v240
    v_dot2c_f32_bf16 v244, v241, v146
    v_dot2c_f32_bf16 v245, v241, v241
    v_dot2c_f32_bf16 v244, v242, v146
    v_dot2c_f32_bf16 v245, v242, v242
    v_dot2c_f32_bf16 v244, v243, v146
    v_dot2c_f32_bf16 v245, v243, v243
    s_nop 1
    v_add_f32_dpp v244, v244, v244 row_ror:8 row_mask:0xf bank_mask:0xf
    v_add_f32_dpp v245, v245, v245 row_ror:8 row_mask:0xf bank_mask:0xf
    s_nop 0
    v_add_f32_dpp v244, v244, v244 row_ror:4 row_mask:0xf bank_mask:0xf
    v_add_f32_dpp v245, v245, v245 row_ror:4 row_mask:0xf bank_mask:0xf
    s_nop 0
    v_add_f32_dpp v244, v244, v244 row_ror:2 row_mask:0xf bank_mask:0xf
    v_add_f32_dpp v245, v245, v245 row_ror:2 row_mask:0xf bank_mask:0xf
    s_nop 0
    v_add_f32_dpp v244, v244, v244 row_ror:1 row_mask:0xf bank_mask:0xf
    v_add_f32_dpp v245, v245, v245 row_ror:1 row_mask:0xf bank_mask:0xf
    v_mul_f32 v244, 0xbacccccd, v244
    v_mul_f32 v245, 0x3acccccd, v245
    v_fma_f32 v245, -v244, v244, v245
    v_max_f32 v245, 0, v245
    v_cvt_pk_bf16_f32 v245, v245, v245
    v_lshlrev_b32 v245, 16, v245
    v_add_f32 v245, 0x3727c5ac, v245
    v_cvt_pk_bf16_f32 v245, v245, v245
    v_lshlrev_b32 v245, 16, v245
    v_sqrt_f32 v245, v245
    s_nop 0
    v_cvt_pk_bf16_f32 v244, v244, v245
    v_mov_b32 v245, s38
    buffer_store_dwordx2 v[244:245], v246, s[20:23], s69 offen sc1
    v_mfma_f32_16x16x32_bf16 v[8:11], v[180:183], a[24:27], v[8:11]
    v_mfma_f32_16x16x32_bf16 v[12:15], v[180:183], a[28:31], v[12:15]
    s_waitcnt vmcnt(9) lgkmcnt(0)
    s_barrier
    v_mfma_f32_16x16x32_bf16 v[16:19], v[184:187], a[24:27], v[16:19]
    buffer_load_dword a247, v206, s[4:7], s70 offen
    ds_read_b128 a[32:35], v144 offset:32768
    v_mfma_f32_16x16x32_bf16 v[20:23], v[184:187], a[28:31], v[20:23]
    ds_read_b64_tr_b16 v[168:169], v64 offset:0
    ds_read_b64_tr_b16 v[170:171], v64 offset:512
    ds_read_b64_tr_b16 v[172:173], v65 offset:0
    v_mfma_f32_16x16x32_bf16 v[24:27], v[188:191], a[24:27], v[24:27]
    buffer_load_dword a246, v206, s[8:11], s70 offen offset:2048
    ds_read_b128 a[36:39], v144 offset:34816
    v_mfma_f32_16x16x32_bf16 v[28:31], v[188:191], a[28:31], v[28:31]
    ds_read_b64_tr_b16 v[174:175], v65 offset:512
    ds_read_b64_tr_b16 v[176:177], v66 offset:0
    s_add_u32 m0, s66, 65536
    v_mfma_f32_16x16x32_bf16 v[32:35], v[192:195], a[24:27], v[32:35]
    buffer_load_dwordx4 v202, s[12:15], s46 offen offset:0 lds
    v_mfma_f32_16x16x32_bf16 v[36:39], v[192:195], a[28:31], v[36:39]
    ds_read_b128 a[40:43], v145 offset:32768
    v_mfma_f32_16x16x32_bf16 a[252:255], v[148:151], v[192:195], a[252:255]
    ds_read_b64_tr_b16 v[178:179], v66 offset:512
    ds_read_b64_tr_b16 v[180:181], v67 offset:0
    v_mfma_f32_16x16x32_bf16 v[40:43], v[196:199], a[24:27], v[40:43]
    buffer_load_dwordx4 v203, s[12:15], s46 offen offset:1024 lds
    ds_read_b128 a[44:47], v145 offset:34816
    v_mfma_f32_16x16x32_bf16 v[44:47], v[196:199], a[28:31], v[44:47]
    ds_read_b64_tr_b16 v[182:183], v67 offset:512
    ds_read_b64_tr_b16 v[184:185], v64 offset:2048
    ds_read_b64_tr_b16 v[186:187], v64 offset:2560
    v_mfma_f32_16x16x32_bf16 v[48:51], v[160:163], a[24:27], v[48:51]
    buffer_load_dwordx4 v202, s[16:19], s46 offen offset:2048 lds
    v_mfma_f32_16x16x32_bf16 v[52:55], v[160:163], a[28:31], v[52:55]
    ds_read_b64_tr_b16 v[188:189], v65 offset:2048
    ds_read_b64_tr_b16 v[190:191], v65 offset:2560
    v_mfma_f32_16x16x32_bf16 v[56:59], v[164:167], a[24:27], v[56:59]
    buffer_load_dwordx4 v203, s[16:19], s46 offen offset:3072 lds
    ds_read_b64_tr_b16 v[192:193], v66 offset:2048
    v_mfma_f32_16x16x32_bf16 v[60:63], v[164:167], a[28:31], v[60:63]
    ds_read_b64_tr_b16 v[194:195], v66 offset:2560
    s_add_u32 s46, s46, 245760
    s_add_u32 m0, s59, 16384
    s_waitcnt lgkmcnt(6)
    v_mfma_f32_16x16x32_bf16 v[0:3], v[168:171], a[32:35], v[0:3]
    buffer_load_dwordx4 v204, s[24:27], s49 offen offset:0 lds
    v_mfma_f32_16x16x32_bf16 v[4:7], v[168:171], a[36:39], v[4:7]
    ds_read_b64_tr_b16 v[196:197], v67 offset:2048
    v_mfma_f32_16x16x32_bf16 a[248:251], v[148:151], v[168:171], a[248:251]
    ds_read_b64_tr_b16 v[198:199], v67 offset:2560
    v_mfma_f32_16x16x32_bf16 v[8:11], v[172:175], a[32:35], v[8:11]
    ds_read_b64_tr_b16 v[160:161], v64 offset:8192
    ds_read_b64_tr_b16 v[162:163], v64 offset:8704
    v_mfma_f32_16x16x32_bf16 v[12:15], v[172:175], a[36:39], v[12:15]
    ds_read_b64_tr_b16 v[164:165], v65 offset:8192
    v_mfma_f32_16x16x32_bf16 v[16:19], v[176:179], a[32:35], v[16:19]
    buffer_load_dwordx4 v205, s[24:27], s49 offen offset:1024 lds
    v_mfma_f32_16x16x32_bf16 v[20:23], v[176:179], a[36:39], v[20:23]
    ds_read_b64_tr_b16 v[166:167], v65 offset:8704
    ds_read_b64_tr_b16 v[168:169], v66 offset:8192
    v_mfma_f32_16x16x32_bf16 v[24:27], v[180:183], a[32:35], v[24:27]
    ds_read_b64_tr_b16 v[170:171], v66 offset:8704
    v_mfma_f32_16x16x32_bf16 v[28:31], v[180:183], a[36:39], v[28:31]
    ds_read_b64_tr_b16 v[172:173], v67 offset:8192
    s_waitcnt lgkmcnt(7)
    v_mfma_f32_16x16x32_bf16 v[32:35], v[184:187], a[32:35], v[32:35]
    buffer_load_dwordx4 v204, s[24:27], s45 offen offset:2048 lds
    v_mfma_f32_16x16x32_bf16 v[36:39], v[184:187], a[36:39], v[36:39]
    ds_read_b64_tr_b16 v[174:175], v67 offset:8704
    v_mfma_f32_16x16x32_bf16 a[252:255], v[148:151], v[184:187], a[252:255]
    ds_read_b64_tr_b16 v[176:177], v64 offset:10240
    ds_read_b64_tr_b16 v[178:179], v64 offset:10752
    v_mfma_f32_16x16x32_bf16 v[40:43], v[188:191], a[32:35], v[40:43]
    ds_read_b64_tr_b16 v[180:181], v65 offset:10240
    v_mfma_f32_16x16x32_bf16 v[44:47], v[188:191], a[36:39], v[44:47]
    ds_read_b64_tr_b16 v[182:183], v65 offset:10752
    v_mfma_f32_16x16x32_bf16 v[48:51], v[192:195], a[32:35], v[48:51]
    buffer_load_dwordx4 v205, s[24:27], s45 offen offset:3072 lds
    v_mfma_f32_16x16x32_bf16 v[52:55], v[192:195], a[36:39], v[52:55]
    ds_read_b64_tr_b16 v[184:185], v66 offset:10240
    ds_read_b64_tr_b16 v[186:187], v66 offset:10752
    v_mfma_f32_16x16x32_bf16 v[56:59], v[196:199], a[32:35], v[56:59]
    ds_read_b64_tr_b16 v[188:189], v67 offset:10240
    ds_read_b64_tr_b16 v[190:191], v67 offset:10752
    v_mfma_f32_16x16x32_bf16 v[60:63], v[196:199], a[36:39], v[60:63]
    s_add_u32 s49, s49, 128
    s_add_u32 s45, s49, 18432
    s_waitcnt lgkmcnt(8)
    v_mfma_f32_16x16x32_bf16 v[0:3], v[160:163], a[40:43], v[0:3]
    v_mfma_f32_16x16x32_bf16 v[4:7], v[160:163], a[44:47], v[4:7]
    v_mfma_f32_16x16x32_bf16 a[248:251], v[148:151], v[160:163], a[248:251]
    v_mfma_f32_16x16x32_bf16 v[8:11], v[164:167], a[40:43], v[8:11]
    v_mfma_f32_16x16x32_bf16 v[12:15], v[164:167], a[44:47], v[12:15]
    s_waitcnt vmcnt(11) lgkmcnt(0)
    s_barrier
    s_add_u32 m0, s66, 81920
    v_mfma_f32_16x16x32_bf16 v[16:19], v[168:171], a[40:43], v[16:19]
    buffer_load_dwordx4 v202, s[12:15], s46 offen offset:0 lds
    ds_read_b128 a[48:51], v144 offset:0
    v_mfma_f32_16x16x32_bf16 v[20:23], v[168:171], a[44:47], v[20:23]
    ds_read_b64_tr_b16 v[192:193], v64 offset:16384
    ds_read_b64_tr_b16 v[194:195], v64 offset:16896
    ds_read_b64_tr_b16 v[196:197], v65 offset:16384
    v_mfma_f32_16x16x32_bf16 v[24:27], v[172:175], a[40:43], v[24:27]
    ds_read_b128 a[52:55], v144 offset:2048
    ds_read_b64_tr_b16 v[198:199], v65 offset:16896
    v_mfma_f32_16x16x32_bf16 v[28:31], v[172:175], a[44:47], v[28:31]
    ds_read_b64_tr_b16 v[160:161], v66 offset:16384
    v_mfma_f32_16x16x32_bf16 v[32:35], v[176:179], a[40:43], v[32:35]
    buffer_load_dwordx4 v203, s[12:15], s46 offen offset:1024 lds
    v_mfma_f32_16x16x32_bf16 v[36:39], v[176:179], a[44:47], v[36:39]
    ds_read_b128 a[56:59], v145 offset:0
    v_mfma_f32_16x16x32_bf16 a[252:255], v[148:151], v[176:179], a[252:255]
    ds_read_b64_tr_b16 v[162:163], v66 offset:16896
    ds_read_b64_tr_b16 v[164:165], v67 offset:16384
    v_mfma_f32_16x16x32_bf16 v[40:43], v[180:183], a[40:43], v[40:43]
    ds_read_b128 a[60:63], v145 offset:2048
    ds_read_b64_tr_b16 v[166:167], v67 offset:16896
    v_mfma_f32_16x16x32_bf16 v[44:47], v[180:183], a[44:47], v[44:47]
    ds_read_b64_tr_b16 v[168:169], v64 offset:18432
    ds_read_b64_tr_b16 v[170:171], v64 offset:18944
    v_mfma_f32_16x16x32_bf16 v[48:51], v[184:187], a[40:43], v[48:51]
    buffer_load_dwordx4 v202, s[16:19], s46 offen offset:2048 lds
    v_mfma_f32_16x16x32_bf16 v[52:55], v[184:187], a[44:47], v[52:55]
    ds_read_b64_tr_b16 v[172:173], v65 offset:18432
    ds_read_b64_tr_b16 v[174:175], v65 offset:18944
    v_mfma_f32_16x16x32_bf16 v[56:59], v[188:191], a[40:43], v[56:59]
    ds_read_b64_tr_b16 v[176:177], v66 offset:18432
    v_mfma_f32_16x16x32_bf16 v[60:63], v[188:191], a[44:47], v[60:63]
    ds_read_b64_tr_b16 v[178:179], v66 offset:18944
    s_waitcnt lgkmcnt(6)
    v_mfma_f32_16x16x32_bf16 v[0:3], v[192:195], a[48:51], v[0:3]
    buffer_load_dwordx4 v203, s[16:19], s46 offen offset:3072 lds
    v_mfma_f32_16x16x32_bf16 v[4:7], v[192:195], a[52:55], v[4:7]
    ds_read_b64_tr_b16 v[180:181], v67 offset:18432
    v_mfma_f32_16x16x32_bf16 a[248:251], v[148:151], v[192:195], a[248:251]
    ds_read_b64_tr_b16 v[182:183], v67 offset:18944
    v_mfma_f32_16x16x32_bf16 v[8:11], v[196:199], a[48:51], v[8:11]
    ds_read_b64_tr_b16 v[184:185], v64 offset:24576
    ds_read_b64_tr_b16 v[186:187], v64 offset:25088
    ds_read_b64_tr_b16 v[188:189], v65 offset:24576
    v_mfma_f32_16x16x32_bf16 v[12:15], v[196:199], a[52:55], v[12:15]
    s_add_u32 s46, s46, 245760
    s_add_u32 m0, s59, 32768
    v_mfma_f32_16x16x32_bf16 v[16:19], v[160:163], a[48:51], v[16:19]
    buffer_load_dwordx4 v204, s[24:27], s49 offen offset:0 lds
    v_mfma_f32_16x16x32_bf16 v[20:23], v[160:163], a[52:55], v[20:23]
    ds_read_b64_tr_b16 v[190:191], v65 offset:25088
    ds_read_b64_tr_b16 v[192:193], v66 offset:24576
    v_mfma_f32_16x16x32_bf16 v[24:27], v[164:167], a[48:51], v[24:27]
    ds_read_b64_tr_b16 v[194:195], v66 offset:25088
    v_mfma_f32_16x16x32_bf16 v[28:31], v[164:167], a[52:55], v[28:31]
    ds_read_b64_tr_b16 v[196:197], v67 offset:24576
    s_waitcnt lgkmcnt(7)
    v_mfma_f32_16x16x32_bf16 v[32:35], v[168:171], a[48:51], v[32:35]
    buffer_load_dwordx4 v205, s[24:27], s49 offen offset:1024 lds
    v_mfma_f32_16x16x32_bf16 v[36:39], v[168:171], a[52:55], v[36:39]
    ds_read_b64_tr_b16 v[198:199], v67 offset:25088
    v_mfma_f32_16x16x32_bf16 a[252:255], v[148:151], v[168:171], a[252:255]
    ds_read_b64_tr_b16 v[160:161], v64 offset:26624
    ds_read_b64_tr_b16 v[162:163], v64 offset:27136
    v_mfma_f32_16x16x32_bf16 v[40:43], v[172:175], a[48:51], v[40:43]
    ds_read_b64_tr_b16 v[164:165], v65 offset:26624
    v_mfma_f32_16x16x32_bf16 v[44:47], v[172:175], a[52:55], v[44:47]
    ds_read_b64_tr_b16 v[166:167], v65 offset:27136
    v_mfma_f32_16x16x32_bf16 v[48:51], v[176:179], a[48:51], v[48:51]
    buffer_load_dwordx4 v204, s[24:27], s45 offen offset:2048 lds
    v_mfma_f32_16x16x32_bf16 v[52:55], v[176:179], a[52:55], v[52:55]
    ds_read_b64_tr_b16 v[168:169], v66 offset:26624
    ds_read_b64_tr_b16 v[170:171], v66 offset:27136
    v_mfma_f32_16x16x32_bf16 v[56:59], v[180:183], a[48:51], v[56:59]
    ds_read_b64_tr_b16 v[172:173], v67 offset:26624
    v_mfma_f32_16x16x32_bf16 v[60:63], v[180:183], a[52:55], v[60:63]
    ds_read_b64_tr_b16 v[174:175], v67 offset:27136
    s_waitcnt lgkmcnt(8)
    v_mfma_f32_16x16x32_bf16 v[0:3], v[184:187], a[56:59], v[0:3]
    buffer_load_dwordx4 v205, s[24:27], s45 offen offset:3072 lds
    v_mfma_f32_16x16x32_bf16 v[4:7], v[184:187], a[60:63], v[4:7]
    s_add_u32 s49, s49, 128
    v_mfma_f32_16x16x32_bf16 a[248:251], v[148:151], v[184:187], a[248:251]
    s_add_u32 s45, s49, 18432
    v_mfma_f32_16x16x32_bf16 v[8:11], v[188:191], a[56:59], v[8:11]
    v_mfma_f32_16x16x32_bf16 v[12:15], v[188:191], a[60:63], v[12:15]
    s_waitcnt vmcnt(8) lgkmcnt(0)
    s_barrier
    s_add_u32 m0, s66, 0
    v_mfma_f32_16x16x32_bf16 v[16:19], v[192:195], a[56:59], v[16:19]
    buffer_load_dwordx4 v202, s[12:15], s46 offen offset:0 lds
    ds_read_b128 a[64:67], v144 offset:16384
    v_mfma_f32_16x16x32_bf16 v[20:23], v[192:195], a[60:63], v[20:23]
    ds_read_b64_tr_b16 v[176:177], v68 offset:0
    ds_read_b64_tr_b16 v[178:179], v68 offset:512
    ds_read_b64_tr_b16 v[180:181], v69 offset:0
    v_mfma_f32_16x16x32_bf16 v[24:27], v[196:199], a[56:59], v[24:27]
    ds_read_b128 a[68:71], v144 offset:18432
    ds_read_b64_tr_b16 v[182:183], v69 offset:512
    v_mfma_f32_16x16x32_bf16 v[28:31], v[196:199], a[60:63], v[28:31]
    ds_read_b64_tr_b16 v[184:185], v70 offset:0
    v_mfma_f32_16x16x32_bf16 v[32:35], v[160:163], a[56:59], v[32:35]
    buffer_load_dwordx4 v203, s[12:15], s46 offen offset:1024 lds
    v_mfma_f32_16x16x32_bf16 v[36:39], v[160:163], a[60:63], v[36:39]
    ds_read_b128 a[72:75], v145 offset:16384
    v_mfma_f32_16x16x32_bf16 a[252:255], v[148:151], v[160:163], a[252:255]
    ds_read_b64_tr_b16 v[186:187], v70 offset:512
    ds_read_b64_tr_b16 v[188:189], v71 offset:0
    v_mfma_f32_16x16x32_bf16 v[40:43], v[164:167], a[56:59], v[40:43]
    ds_read_b128 a[76:79], v145 offset:18432
    ds_read_b64_tr_b16 v[190:191], v71 offset:512
    v_mfma_f32_16x16x32_bf16 v[44:47], v[164:167], a[60:63], v[44:47]
    ds_read_b64_tr_b16 v[192:193], v68 offset:2048
    ds_read_b64_tr_b16 v[194:195], v68 offset:2560
    v_mfma_f32_16x16x32_bf16 v[48:51], v[168:171], a[56:59], v[48:51]
    buffer_load_dwordx4 v202, s[16:19], s46 offen offset:2048 lds
    v_mfma_f32_16x16x32_bf16 v[52:55], v[168:171], a[60:63], v[52:55]
    ds_read_b64_tr_b16 v[196:197], v69 offset:2048
    ds_read_b64_tr_b16 v[198:199], v69 offset:2560
    v_mfma_f32_16x16x32_bf16 v[56:59], v[172:175], a[56:59], v[56:59]
    ds_read_b64_tr_b16 v[160:161], v70 offset:2048
    v_mfma_f32_16x16x32_bf16 v[60:63], v[172:175], a[60:63], v[60:63]
    ds_read_b64_tr_b16 v[162:163], v70 offset:2560
    s_waitcnt lgkmcnt(6)
    v_mfma_f32_16x16x32_bf16 v[0:3], v[176:179], a[64:67], v[0:3]
    buffer_load_dwordx4 v203, s[16:19], s46 offen offset:3072 lds
    v_mfma_f32_16x16x32_bf16 v[4:7], v[176:179], a[68:71], v[4:7]
    ds_read_b64_tr_b16 v[164:165], v71 offset:2048
    v_mfma_f32_16x16x32_bf16 a[248:251], v[148:151], v[176:179], a[248:251]
    ds_read_b64_tr_b16 v[166:167], v71 offset:2560
    v_mfma_f32_16x16x32_bf16 v[8:11], v[180:183], a[64:67], v[8:11]
    ds_read_b64_tr_b16 v[168:169], v68 offset:8192
    ds_read_b64_tr_b16 v[170:171], v68 offset:8704
    v_mfma_f32_16x16x32_bf16 v[12:15], v[180:183], a[68:71], v[12:15]
    ds_read_b64_tr_b16 v[172:173], v69 offset:8192
    s_add_u32 s46, s46, 245760
    s_add_u32 m0, s59, 0
    v_mfma_f32_16x16x32_bf16 v[16:19], v[184:187], a[64:67], v[16:19]
    buffer_load_dwordx4 v204, s[24:27], s49 offen offset:0 lds
    v_mfma_f32_16x16x32_bf16 v[20:23], v[184:187], a[68:71], v[20:23]
    ds_read_b64_tr_b16 v[174:175], v69 offset:8704
    ds_read_b64_tr_b16 v[176:177], v70 offset:8192
    v_mfma_f32_16x16x32_bf16 v[24:27], v[188:191], a[64:67], v[24:27]
    ds_read_b64_tr_b16 v[178:179], v70 offset:8704
    v_mfma_f32_16x16x32_bf16 v[28:31], v[188:191], a[68:71], v[28:31]
    ds_read_b64_tr_b16 v[180:181], v71 offset:8192
    s_waitcnt lgkmcnt(7)
    v_mfma_f32_16x16x32_bf16 v[32:35], v[192:195], a[64:67], v[32:35]
    buffer_load_dwordx4 v205, s[24:27], s49 offen offset:1024 lds
    v_mfma_f32_16x16x32_bf16 v[36:39], v[192:195], a[68:71], v[36:39]
    ds_read_b64_tr_b16 v[182:183], v71 offset:8704
    v_mfma_f32_16x16x32_bf16 a[252:255], v[148:151], v[192:195], a[252:255]
    ds_read_b64_tr_b16 v[184:185], v68 offset:10240
    ds_read_b64_tr_b16 v[186:187], v68 offset:10752
    v_mfma_f32_16x16x32_bf16 v[40:43], v[196:199], a[64:67], v[40:43]
    ds_read_b64_tr_b16 v[188:189], v69 offset:10240
    v_mfma_f32_16x16x32_bf16 v[44:47], v[196:199], a[68:71], v[44:47]
    ds_read_b64_tr_b16 v[190:191], v69 offset:10752
    v_mfma_f32_16x16x32_bf16 v[48:51], v[160:163], a[64:67], v[48:51]
    buffer_load_dwordx4 v204, s[24:27], s45 offen offset:2048 lds
    v_mfma_f32_16x16x32_bf16 v[52:55], v[160:163], a[68:71], v[52:55]
    ds_read_b64_tr_b16 v[192:193], v70 offset:10240
    ds_read_b64_tr_b16 v[194:195], v70 offset:10752
    v_mfma_f32_16x16x32_bf16 v[56:59], v[164:167], a[64:67], v[56:59]
    ds_read_b64_tr_b16 v[196:197], v71 offset:10240
    v_mfma_f32_16x16x32_bf16 v[60:63], v[164:167], a[68:71], v[60:63]
    ds_read_b64_tr_b16 v[198:199], v71 offset:10752
    s_waitcnt lgkmcnt(8)
    v_mfma_f32_16x16x32_bf16 v[0:3], v[168:171], a[72:75], v[0:3]
    buffer_load_dwordx4 v205, s[24:27], s45 offen offset:3072 lds
    v_mfma_f32_16x16x32_bf16 v[4:7], v[168:171], a[76:79], v[4:7]
    s_add_u32 s49, s49, 128
    v_mfma_f32_16x16x32_bf16 a[248:251], v[148:151], v[168:171], a[248:251]
    s_add_u32 s45, s49, 18432
    v_mfma_f32_16x16x32_bf16 v[8:11], v[172:175], a[72:75], v[8:11]
    v_mfma_f32_16x16x32_bf16 v[12:15], v[172:175], a[76:79], v[12:15]
    s_waitcnt vmcnt(8) lgkmcnt(0)
    s_barrier
    s_add_u32 m0, s79, 49152
    v_mfma_f32_16x16x32_bf16 v[16:19], v[176:179], a[72:75], v[16:19]
    buffer_load_dwordx4 v204, s[96:99], s63 offen lds
    ds_read_b128 a[80:83], v144 offset:32768
    v_mfma_f32_16x16x32_bf16 v[20:23], v[176:179], a[76:79], v[20:23]
    ds_read_b64_tr_b16 v[160:161], v68 offset:16384
    ds_read_b64_tr_b16 v[162:163], v68 offset:16896
    ds_read_b64_tr_b16 v[164:165], v69 offset:16384
    v_mfma_f32_16x16x32_bf16 v[24:27], v[180:183], a[72:75], v[24:27]
    ds_read_b128 a[84:87], v144 offset:34816
    ds_read_b64_tr_b16 v[166:167], v69 offset:16896
    v_mfma_f32_16x16x32_bf16 v[28:31], v[180:183], a[76:79], v[28:31]
    ds_read_b64_tr_b16 v[168:169], v70 offset:16384
    s_add_u32 m0, s79, 50176
    v_mfma_f32_16x16x32_bf16 v[32:35], v[184:187], a[72:75], v[32:35]
    buffer_load_dwordx4 v204, s[96:99], s78 offen lds
    v_mfma_f32_16x16x32_bf16 v[36:39], v[184:187], a[76:79], v[36:39]
    ds_read_b128 a[88:91], v145 offset:32768
    v_mfma_f32_16x16x32_bf16 a[252:255], v[148:151], v[184:187], a[252:255]
    ds_read_b64_tr_b16 v[170:171], v70 offset:16896
    ds_read_b64_tr_b16 v[172:173], v71 offset:16384
    v_mfma_f32_16x16x32_bf16 v[40:43], v[188:191], a[72:75], v[40:43]
    ds_read_b128 a[92:95], v145 offset:34816
    ds_read_b64_tr_b16 v[174:175], v71 offset:16896
    ds_read_b64_tr_b16 v[176:177], v68 offset:18432
    v_mfma_f32_16x16x32_bf16 v[44:47], v[188:191], a[76:79], v[44:47]
    ds_read_b64_tr_b16 v[178:179], v68 offset:18944
    s_add_u32 m0, s79, 51200
    v_mfma_f32_16x16x32_bf16 v[48:51], v[192:195], a[72:75], v[48:51]
    buffer_load_dwordx4 v204, s[96:99], s32 offen lds
    v_mfma_f32_16x16x32_bf16 v[52:55], v[192:195], a[76:79], v[52:55]
    ds_read_b64_tr_b16 v[180:181], v69 offset:18432
    ds_read_b64_tr_b16 v[182:183], v69 offset:18944
    v_mfma_f32_16x16x32_bf16 v[56:59], v[196:199], a[72:75], v[56:59]
    ds_read_b64_tr_b16 v[184:185], v70 offset:18432
    ds_read_b64_tr_b16 v[186:187], v70 offset:18944
    v_mfma_f32_16x16x32_bf16 v[60:63], v[196:199], a[76:79], v[60:63]
    s_add_u32 m0, s66, 16384
    s_waitcnt lgkmcnt(6)
    v_mfma_f32_16x16x32_bf16 v[0:3], v[160:163], a[80:83], v[0:3]
    buffer_load_dwordx4 v202, s[12:15], s46 offen offset:0 lds
    v_mfma_f32_16x16x32_bf16 v[4:7], v[160:163], a[84:87], v[4:7]
    ds_read_b64_tr_b16 v[188:189], v71 offset:18432
    v_mfma_f32_16x16x32_bf16 a[248:251], v[148:151], v[160:163], a[248:251]
    ds_read_b64_tr_b16 v[190:191], v71 offset:18944
    v_mfma_f32_16x16x32_bf16 v[8:11], v[164:167], a[80:83], v[8:11]
    ds_read_b64_tr_b16 v[192:193], v68 offset:24576
    ds_read_b64_tr_b16 v[194:195], v68 offset:25088
    v_mfma_f32_16x16x32_bf16 v[12:15], v[164:167], a[84:87], v[12:15]
    ds_read_b64_tr_b16 v[196:197], v69 offset:24576
    v_mfma_f32_16x16x32_bf16 v[16:19], v[168:171], a[80:83], v[16:19]
    buffer_load_dwordx4 v203, s[12:15], s46 offen offset:1024 lds
    v_mfma_f32_16x16x32_bf16 v[20:23], v[168:171], a[84:87], v[20:23]
    ds_read_b64_tr_b16 v[198:199], v69 offset:25088
    ds_read_b64_tr_b16 v[160:161], v70 offset:24576
    v_mfma_f32_16x16x32_bf16 v[24:27], v[172:175], a[80:83], v[24:27]
    ds_read_b64_tr_b16 v[162:163], v70 offset:25088
    v_mfma_f32_16x16x32_bf16 v[28:31], v[172:175], a[84:87], v[28:31]
    ds_read_b64_tr_b16 v[164:165], v71 offset:24576
    s_waitcnt lgkmcnt(7)
    v_mfma_f32_16x16x32_bf16 v[32:35], v[176:179], a[80:83], v[32:35]
    buffer_load_dwordx4 v202, s[16:19], s46 offen offset:2048 lds
    v_mfma_f32_16x16x32_bf16 v[36:39], v[176:179], a[84:87], v[36:39]
    ds_read_b64_tr_b16 v[166:167], v71 offset:25088
    v_mfma_f32_16x16x32_bf16 a[252:255], v[148:151], v[176:179], a[252:255]
    ds_read_b64_tr_b16 v[168:169], v68 offset:26624
    ds_read_b64_tr_b16 v[170:171], v68 offset:27136
    v_mfma_f32_16x16x32_bf16 v[40:43], v[180:183], a[80:83], v[40:43]
    ds_read_b64_tr_b16 v[172:173], v69 offset:26624
    v_mfma_f32_16x16x32_bf16 v[44:47], v[180:183], a[84:87], v[44:47]
    ds_read_b64_tr_b16 v[174:175], v69 offset:27136
    v_mfma_f32_16x16x32_bf16 v[48:51], v[184:187], a[80:83], v[48:51]
    buffer_load_dwordx4 v203, s[16:19], s46 offen offset:3072 lds
    v_mfma_f32_16x16x32_bf16 v[52:55], v[184:187], a[84:87], v[52:55]
    ds_read_b64_tr_b16 v[176:177], v70 offset:26624
    ds_read_b64_tr_b16 v[178:179], v70 offset:27136
    v_mfma_f32_16x16x32_bf16 v[56:59], v[188:191], a[80:83], v[56:59]
    ds_read_b64_tr_b16 v[180:181], v71 offset:26624
    ds_read_b64_tr_b16 v[182:183], v71 offset:27136
    v_mfma_f32_16x16x32_bf16 v[60:63], v[188:191], a[84:87], v[60:63]
    s_add_u32 s46, s46, 245760
    s_add_u32 m0, s59, 16384
    s_waitcnt lgkmcnt(8)
    v_mfma_f32_16x16x32_bf16 v[0:3], v[192:195], a[88:91], v[0:3]
    buffer_load_dwordx4 v204, s[24:27], s49 offen offset:0 lds
    v_mfma_f32_16x16x32_bf16 v[4:7], v[192:195], a[92:95], v[4:7]
    v_mfma_f32_16x16x32_bf16 a[248:251], v[148:151], v[192:195], a[248:251]
    buffer_load_dwordx2 v[158:159], v82, s[20:23], s67 offen sc1
    v_mfma_f32_16x16x32_bf16 v[8:11], v[196:199], a[88:91], v[8:11]
    v_mfma_f32_16x16x32_bf16 v[12:15], v[196:199], a[92:95], v[12:15]
    s_waitcnt vmcnt(9) lgkmcnt(0)
    s_barrier
    v_mfma_f32_16x16x32_bf16 v[16:19], v[160:163], a[88:91], v[16:19]
    buffer_load_dwordx4 v205, s[24:27], s49 offen offset:1024 lds
    ds_read_b128 a[96:99], v144 offset:0
    v_mfma_f32_16x16x32_bf16 v[20:23], v[160:163], a[92:95], v[20:23]
    ds_read_b64_tr_b16 v[184:185], v64 offset:0
    ds_read_b64_tr_b16 v[186:187], v64 offset:512
    ds_read_b64_tr_b16 v[188:189], v65 offset:0
    v_mfma_f32_16x16x32_bf16 v[24:27], v[164:167], a[88:91], v[24:27]
    ds_read_b128 a[100:103], v144 offset:2048
    ds_read_b64_tr_b16 v[190:191], v65 offset:512
    v_mfma_f32_16x16x32_bf16 v[28:31], v[164:167], a[92:95], v[28:31]
    ds_read_b64_tr_b16 v[192:193], v66 offset:0
    v_mfma_f32_16x16x32_bf16 v[32:35], v[168:171], a[88:91], v[32:35]
    buffer_load_dwordx4 v204, s[24:27], s45 offen offset:2048 lds
    v_mfma_f32_16x16x32_bf16 v[36:39], v[168:171], a[92:95], v[36:39]
    ds_read_b128 a[104:107], v145 offset:0
    v_mfma_f32_16x16x32_bf16 a[252:255], v[148:151], v[168:171], a[252:255]
    ds_read_b64_tr_b16 v[194:195], v66 offset:512
    ds_read_b64_tr_b16 v[196:197], v67 offset:0
    v_mfma_f32_16x16x32_bf16 v[40:43], v[172:175], a[88:91], v[40:43]
    ds_read_b128 a[108:111], v145 offset:2048
    ds_read_b64_tr_b16 v[198:199], v67 offset:512
    v_mfma_f32_16x16x32_bf16 v[44:47], v[172:175], a[92:95], v[44:47]
    ds_read_b64_tr_b16 v[160:161], v64 offset:2048
    ds_read_b64_tr_b16 v[162:163], v64 offset:2560
    v_mfma_f32_16x16x32_bf16 v[48:51], v[176:179], a[88:91], v[48:51]
    buffer_load_dwordx4 v205, s[24:27], s45 offen offset:3072 lds
    v_mfma_f32_16x16x32_bf16 v[52:55], v[176:179], a[92:95], v[52:55]
    ds_read_b64_tr_b16 v[164:165], v65 offset:2048
    ds_read_b64_tr_b16 v[166:167], v65 offset:2560
    v_mfma_f32_16x16x32_bf16 v[56:59], v[180:183], a[88:91], v[56:59]
    ds_read_b64_tr_b16 v[168:169], v66 offset:2048
    ds_read_b64_tr_b16 v[170:171], v66 offset:2560
    s_add_u32 s49, s49, 128
    v_mfma_f32_16x16x32_bf16 v[60:63], v[180:183], a[92:95], v[60:63]
    s_add_u32 s45, s49, 18432
    s_add_u32 m0, s66, 65536
    s_waitcnt lgkmcnt(6)
    v_mfma_f32_16x16x32_bf16 v[0:3], v[184:187], a[96:99], v[0:3]
    buffer_load_dwordx4 v202, s[12:15], s46 offen offset:0 lds
    v_mfma_f32_16x16x32_bf16 v[4:7], v[184:187], a[100:103], v[4:7]
    ds_read_b64_tr_b16 v[172:173], v67 offset:2048
    v_mfma_f32_16x16x32_bf16 a[248:251], v[148:151], v[184:187], a[248:251]
    ds_read_b64_tr_b16 v[174:175], v67 offset:2560
    v_mfma_f32_16x16x32_bf16 v[8:11], v[188:191], a[96:99], v[8:11]
    ds_read_b64_tr_b16 v[176:177], v64 offset:8192
    ds_read_b64_tr_b16 v[178:179], v64 offset:8704
    v_mfma_f32_16x16x32_bf16 v[12:15], v[188:191], a[100:103], v[12:15]
    ds_read_b64_tr_b16 v[180:181], v65 offset:8192
    v_mfma_f32_16x16x32_bf16 v[16:19], v[192:195], a[96:99], v[16:19]
    buffer_load_dwordx4 v203, s[12:15], s46 offen offset:1024 lds
    v_mfma_f32_16x16x32_bf16 v[20:23], v[192:195], a[100:103], v[20:23]
    ds_read_b64_tr_b16 v[182:183], v65 offset:8704
    ds_read_b64_tr_b16 v[184:185], v66 offset:8192
    v_mfma_f32_16x16x32_bf16 v[24:27], v[196:199], a[96:99], v[24:27]
    ds_read_b64_tr_b16 v[186:187], v66 offset:8704
    v_mfma_f32_16x16x32_bf16 v[28:31], v[196:199], a[100:103], v[28:31]
    ds_read_b64_tr_b16 v[188:189], v67 offset:8192
    s_waitcnt lgkmcnt(7)
    v_mfma_f32_16x16x32_bf16 v[32:35], v[160:163], a[96:99], v[32:35]
    buffer_load_dwordx4 v202, s[16:19], s46 offen offset:2048 lds
    v_mfma_f32_16x16x32_bf16 v[36:39], v[160:163], a[100:103], v[36:39]
    ds_read_b64_tr_b16 v[190:191], v67 offset:8704
    v_mfma_f32_16x16x32_bf16 a[252:255], v[148:151], v[160:163], a[252:255]
    ds_read_b64_tr_b16 v[192:193], v64 offset:10240
    ds_read_b64_tr_b16 v[194:195], v64 offset:10752
    v_mfma_f32_16x16x32_bf16 v[40:43], v[164:167], a[96:99], v[40:43]
    ds_read_b64_tr_b16 v[196:197], v65 offset:10240
    v_mfma_f32_16x16x32_bf16 v[44:47], v[164:167], a[100:103], v[44:47]
    ds_read_b64_tr_b16 v[198:199], v65 offset:10752
    v_mfma_f32_16x16x32_bf16 v[48:51], v[168:171], a[96:99], v[48:51]
    buffer_load_dwordx4 v203, s[16:19], s46 offen offset:3072 lds
    v_mfma_f32_16x16x32_bf16 v[52:55], v[168:171], a[100:103], v[52:55]
    ds_read_b64_tr_b16 v[160:161], v66 offset:10240
    ds_read_b64_tr_b16 v[162:163], v66 offset:10752
    v_mfma_f32_16x16x32_bf16 v[56:59], v[172:175], a[96:99], v[56:59]
    ds_read_b64_tr_b16 v[164:165], v67 offset:10240
    ds_read_b64_tr_b16 v[166:167], v67 offset:10752
    v_mfma_f32_16x16x32_bf16 v[60:63], v[172:175], a[100:103], v[60:63]
    s_add_u32 s46, s46, 245760
    s_waitcnt vmcnt(13)
    s_add_u32 m0, s59, 32768
    s_waitcnt lgkmcnt(8)
    v_mfma_f32_16x16x32_bf16 v[0:3], v[176:179], a[104:107], v[0:3]
    v_mfma_f32_16x16x32_bf16 v[4:7], v[176:179], a[108:111], v[4:7]
    buffer_load_dwordx4 v204, s[24:27], s49 offen offset:0 lds
    v_mfma_f32_16x16x32_bf16 a[248:251], v[148:151], v[176:179], a[248:251]
    v_mfma_f32_16x16x32_bf16 v[8:11], v[180:183], a[104:107], v[8:11]
    v_mfma_f32_16x16x32_bf16 v[12:15], v[180:183], a[108:111], v[12:15]
    s_waitcnt vmcnt(5) lgkmcnt(0)
    s_barrier
    v_mfma_f32_16x16x32_bf16 v[16:19], v[184:187], a[104:107], v[16:19]
    buffer_load_dwordx4 v205, s[24:27], s49 offen offset:1024 lds
    ds_read_b128 a[112:115], v144 offset:16384
    v_mfma_f32_16x16x32_bf16 v[20:23], v[184:187], a[108:111], v[20:23]
    ds_read_b64_tr_b16 v[168:169], v64 offset:16384
    ds_read_b64_tr_b16 v[170:171], v64 offset:16896
    ds_read_b64_tr_b16 v[172:173], v65 offset:16384
    v_mfma_f32_16x16x32_bf16 v[24:27], v[188:191], a[104:107], v[24:27]
    ds_read_b128 a[116:119], v144 offset:18432
    ds_read_b64_tr_b16 v[174:175], v65 offset:16896
    v_mfma_f32_16x16x32_bf16 v[28:31], v[188:191], a[108:111], v[28:31]
    ds_read_b64_tr_b16 v[176:177], v66 offset:16384
    ds_read_b64_tr_b16 v[108:109], v104 offset:0
    v_mfma_f32_16x16x32_bf16 v[32:35], v[192:195], a[104:107], v[32:35]
    buffer_load_dwordx4 v204, s[24:27], s45 offen offset:2048 lds
    ds_read_b128 a[120:123], v145 offset:16384
    v_mfma_f32_16x16x32_bf16 v[36:39], v[192:195], a[108:111], v[36:39]
    ds_read_b64_tr_b16 v[178:179], v66 offset:16896
    ds_read_b64_tr_b16 v[180:181], v67 offset:16384
    v_mfma_f32_16x16x32_bf16 a[252:255], v[148:151], v[192:195], a[252:255]
    ds_read_b64_tr_b16 v[110:111], v105 offset:512
    ds_read_b64_tr_b16 v[112:113], v104 offset:1024
    v_mfma_f32_16x16x32_bf16 v[40:43], v[196:199], a[104:107], v[40:43]
    ds_read_b128 a[124:127], v145 offset:18432
    ds_read_b64_tr_b16 v[182:183], v67 offset:16896
    ds_read_b64_tr_b16 v[184:185], v64 offset:18432
    v_mfma_f32_16x16x32_bf16 v[44:47], v[196:199], a[108:111], v[44:47]
    ds_read_b64_tr_b16 v[186:187], v64 offset:18944
    ds_read_b64_tr_b16 v[114:115], v105 offset:1536
    v_mfma_f32_16x16x32_bf16 v[48:51], v[160:163], a[104:107], v[48:51]
    buffer_load_dwordx4 v205, s[24:27], s45 offen offset:3072 lds
    ds_read_b64_tr_b16 v[188:189], v65 offset:18432
    v_mfma_f32_16x16x32_bf16 v[52:55], v[160:163], a[108:111], v[52:55]
    ds_read_b64_tr_b16 v[190:191], v65 offset:18944
    ds_read_b64_tr_b16 v[116:117], v104 offset:2048
    v_mfma_f32_16x16x32_bf16 v[56:59], v[164:167], a[104:107], v[56:59]
    ds_read_b64_tr_b16 v[192:193], v66 offset:18432
    ds_read_b64_tr_b16 v[194:195], v66 offset:18944
    s_add_u32 s49, s49, 128
    v_mfma_f32_16x16x32_bf16 v[60:63], v[164:167], a[108:111], v[60:63]
    s_add_u32 s45, s49, 18432
    s_add_u32 m0, s66, 81920
    s_waitcnt lgkmcnt(8)
    v_mfma_f32_16x16x32_bf16 v[0:3], v[168:171], a[112:115], v[0:3]
    buffer_load_dwordx4 v202, s[12:15], s46 offen offset:0 lds
    ds_read_b64_tr_b16 v[196:197], v67 offset:18432
    v_mfma_f32_16x16x32_bf16 v[4:7], v[168:171], a[116:119], v[4:7]
    ds_read_b64_tr_b16 v[198:199], v67 offset:18944
    ds_read_b64_tr_b16 v[118:119], v105 offset:2560
    v_mfma_f32_16x16x32_bf16 a[248:251], v[148:151], v[168:171], a[248:251]
    buffer_store_dwordx4 v[108:111], v209, s[20:23], s68 offen sc1
    s_waitcnt lgkmcnt(8)
    v_mfma_f32_16x16x32_bf16 v[8:11], v[172:175], a[112:115], v[8:11]
    ds_read_b64_tr_b16 v[160:161], v64 offset:24576
    ds_read_b64_tr_b16 v[162:163], v64 offset:25088
    v_mfma_f32_16x16x32_bf16 v[12:15], v[172:175], a[116:119], v[12:15]
    ds_read_b64_tr_b16 v[164:165], v65 offset:24576
    buffer_store_dwordx4 v[112:115], v209, s[20:23], s37 offen sc1
    s_waitcnt lgkmcnt(3)
    v_mfma_f32_16x16x32_bf16 v[16:19], v[176:179], a[112:115], v[16:19]
    buffer_load_dwordx4 v203, s[12:15], s46 offen offset:1024 lds
    ds_read_b64_tr_b16 v[166:167], v65 offset:25088
    v_mfma_f32_16x16x32_bf16 v[20:23], v[176:179], a[116:119], v[20:23]
    ds_read_b64_tr_b16 v[168:169], v66 offset:24576
    buffer_store_dwordx4 v[116:119], v209, s[20:23], s54 offen sc1
    v_mfma_f32_16x16x32_bf16 v[24:27], v[180:183], a[112:115], v[24:27]
    ds_read_b64_tr_b16 v[170:171], v66 offset:25088
    v_mfma_f32_16x16x32_bf16 v[28:31], v[180:183], a[116:119], v[28:31]
    ds_read_b64_tr_b16 v[172:173], v67 offset:24576
    v_mfma_f32_16x16x32_bf16 v[32:35], v[184:187], a[112:115], v[32:35]
    buffer_load_dwordx4 v202, s[16:19], s46 offen offset:2048 lds
    v_mfma_f32_16x16x32_bf16 v[36:39], v[184:187], a[116:119], v[36:39]
    ds_read_b64_tr_b16 v[174:175], v67 offset:25088
    v_mfma_f32_16x16x32_bf16 a[252:255], v[148:151], v[184:187], a[252:255]
    ds_read_b64_tr_b16 v[176:177], v64 offset:26624
    ds_read_b64_tr_b16 v[178:179], v64 offset:27136
    v_mfma_f32_16x16x32_bf16 v[40:43], v[188:191], a[112:115], v[40:43]
    ds_read_b64_tr_b16 v[180:181], v65 offset:26624
    v_mfma_f32_16x16x32_bf16 v[44:47], v[188:191], a[116:119], v[44:47]
    ds_read_b64_tr_b16 v[182:183], v65 offset:27136
    v_mfma_f32_16x16x32_bf16 v[48:51], v[192:195], a[112:115], v[48:51]
    buffer_load_dwordx4 v203, s[16:19], s46 offen offset:3072 lds
    v_mfma_f32_16x16x32_bf16 v[52:55], v[192:195], a[116:119], v[52:55]
    ds_read_b64_tr_b16 v[184:185], v66 offset:26624
    ds_read_b64_tr_b16 v[186:187], v66 offset:27136
    v_mfma_f32_16x16x32_bf16 v[56:59], v[196:199], a[112:115], v[56:59]
    ds_read_b64_tr_b16 v[188:189], v67 offset:26624
    ds_read_b64_tr_b16 v[190:191], v67 offset:27136
    v_mfma_f32_16x16x32_bf16 v[60:63], v[196:199], a[116:119], v[60:63]
    s_add_u32 m0, s59, 0
    s_waitcnt lgkmcnt(8)
    v_mfma_f32_16x16x32_bf16 v[0:3], v[160:163], a[120:123], v[0:3]
    v_mfma_f32_16x16x32_bf16 v[4:7], v[160:163], a[124:127], v[4:7]
    buffer_load_dwordx4 v204, s[24:27], s49 offen offset:0 lds
    v_mfma_f32_16x16x32_bf16 a[248:251], v[148:151], v[160:163], a[248:251]
    v_mfma_f32_16x16x32_bf16 v[8:11], v[164:167], a[120:123], v[8:11]
    v_mfma_f32_16x16x32_bf16 v[12:15], v[164:167], a[124:127], v[12:15]
    s_waitcnt vmcnt(8) lgkmcnt(0)
    s_barrier
    v_mfma_f32_16x16x32_bf16 v[16:19], v[168:171], a[120:123], v[16:19]
    buffer_load_dwordx4 v205, s[24:27], s49 offen offset:1024 lds
    ds_read_b128 a[128:131], v144 offset:32768
    v_mfma_f32_16x16x32_bf16 v[20:23], v[168:171], a[124:127], v[20:23]
    ds_read_b64_tr_b16 v[192:193], v68 offset:0
    ds_read_b64_tr_b16 v[194:195], v68 offset:512
    ds_read_b64_tr_b16 v[196:197], v69 offset:0
    v_mfma_f32_16x16x32_bf16 v[24:27], v[172:175], a[120:123], v[24:27]
    ds_read_b128 a[132:135], v144 offset:34816
    ds_read_b64_tr_b16 v[198:199], v69 offset:512
    v_mfma_f32_16x16x32_bf16 v[28:31], v[172:175], a[124:127], v[28:31]
    ds_read_b64_tr_b16 v[160:161], v70 offset:0
    v_mfma_f32_16x16x32_bf16 v[32:35], v[176:179], a[120:123], v[32:35]
    buffer_load_dwordx4 v204, s[24:27], s45 offen offset:2048 lds
    v_mfma_f32_16x16x32_bf16 v[36:39], v[176:179], a[124:127], v[36:39]
    ds_read_b128 a[136:139], v145 offset:32768
    v_mfma_f32_16x16x32_bf16 a[252:255], v[148:151], v[176:179], a[252:255]
    ds_read_b64_tr_b16 v[162:163], v70 offset:512
    ds_read_b64_tr_b16 v[164:165], v71 offset:0
    v_mfma_f32_16x16x32_bf16 v[40:43], v[180:183], a[120:123], v[40:43]
    ds_read_b128 a[140:143], v145 offset:34816
    ds_read_b64_tr_b16 v[166:167], v71 offset:512
    v_mfma_f32_16x16x32_bf16 v[44:47], v[180:183], a[124:127], v[44:47]
    ds_read_b64_tr_b16 v[168:169], v68 offset:2048
    ds_read_b64_tr_b16 v[170:171], v68 offset:2560
    v_mfma_f32_16x16x32_bf16 v[48:51], v[184:187], a[120:123], v[48:51]
    buffer_load_dwordx4 v205, s[24:27], s45 offen offset:3072 lds
    v_mfma_f32_16x16x32_bf16 v[52:55], v[184:187], a[124:127], v[52:55]
    ds_read_b64_tr_b16 v[172:173], v69 offset:2048
    ds_read_b64_tr_b16 v[174:175], v69 offset:2560
    v_mfma_f32_16x16x32_bf16 v[56:59], v[188:191], a[120:123], v[56:59]
    ds_read_b64_tr_b16 v[176:177], v70 offset:2048
    ds_read_b64_tr_b16 v[178:179], v70 offset:2560
    v_mfma_f32_16x16x32_bf16 v[60:63], v[188:191], a[124:127], v[60:63]
    s_add_u32 m0, s66, 32768
    s_waitcnt lgkmcnt(6)
    v_mfma_f32_16x16x32_bf16 v[0:3], v[192:195], a[128:131], v[0:3]
    buffer_load_dwordx4 v200, s[4:7], s47 offen offset:0 lds
    v_mfma_f32_16x16x32_bf16 v[4:7], v[192:195], a[132:135], v[4:7]
    ds_read_b64_tr_b16 v[180:181], v71 offset:2048
    v_mfma_f32_16x16x32_bf16 a[248:251], v[148:151], v[192:195], a[248:251]
    ds_read_b64_tr_b16 v[182:183], v71 offset:2560
    v_mfma_f32_16x16x32_bf16 v[8:11], v[196:199], a[128:131], v[8:11]
    ds_read_b64_tr_b16 v[184:185], v68 offset:8192
    ds_read_b64_tr_b16 v[186:187], v68 offset:8704
    v_mfma_f32_16x16x32_bf16 v[12:15], v[196:199], a[132:135], v[12:15]
    ds_read_b64_tr_b16 v[188:189], v69 offset:8192
    v_mfma_f32_16x16x32_bf16 v[16:19], v[160:163], a[128:131], v[16:19]
    buffer_load_dwordx4 v201, s[4:7], s47 offen offset:1024 lds
    v_mfma_f32_16x16x32_bf16 v[20:23], v[160:163], a[132:135], v[20:23]
    ds_read_b64_tr_b16 v[190:191], v69 offset:8704
    ds_read_b64_tr_b16 v[192:193], v70 offset:8192
    v_mfma_f32_16x16x32_bf16 v[24:27], v[164:167], a[128:131], v[24:27]
    ds_read_b64_tr_b16 v[194:195], v70 offset:8704
    v_mfma_f32_16x16x32_bf16 v[28:31], v[164:167], a[132:135], v[28:31]
    ds_read_b64_tr_b16 v[196:197], v71 offset:8192
    s_waitcnt lgkmcnt(7)
    v_mfma_f32_16x16x32_bf16 v[32:35], v[168:171], a[128:131], v[32:35]
    buffer_load_dwordx4 v200, s[8:11], s47 offen offset:2048 lds
    ds_read_b64_tr_b16 v[198:199], v71 offset:8704
    v_mfma_f32_16x16x32_bf16 v[36:39], v[168:171], a[132:135], v[36:39]
    ds_read_b64_tr_b16 v[160:161], v68 offset:10240
    ds_read_b64_tr_b16 v[162:163], v68 offset:10752
    v_mfma_f32_16x16x32_bf16 a[252:255], v[148:151], v[168:171], a[252:255]
    s_nop 0
P_stq_chk:
    v_cmp_ne_u32 vcc, v159, v80
    s_nop 4
    s_cbranch_vccnz P_stq_slow
P_stq_done:
    v_mov_b32 v159, v158
    v_mov_b32 v249, 0
    v_mfma_f32_16x16x32_bf16 v[40:43], v[172:175], a[128:131], v[40:43]
    ds_read_b64_tr_b16 v[164:165], v69 offset:10240
    ds_read_b64_tr_b16 v[166:167], v69 offset:10752
    v_mov_b32 v250, 0
    v_mfma_f32_16x16x32_bf16 v[44:47], v[172:175], a[132:135], v[44:47]
    v_permlane16_swap_b32 v158, v159
    v_mov_b32 v253, 0
    v_mov_b32 v254, 0
    v_mfma_f32_16x16x32_bf16 v[48:51], v[176:179], a[128:131], v[48:51]
    buffer_load_dwordx4 v201, s[8:11], s47 offen offset:3072 lds
    ds_read_b64_tr_b16 v[168:169], v70 offset:10240
    v_mfma_f32_16x16x32_bf16 v[52:55], v[176:179], a[132:135], v[52:55]
    ds_read_b64_tr_b16 v[170:171], v70 offset:10752
    v_and_b32 v218, 0xffff0000, v158
    v_and_b32 v248, 0xffff, v158
    v_mfma_f32_16x16x32_bf16 v[56:59], v[180:183], a[128:131], v[56:59]
    ds_read_b64_tr_b16 v[172:173], v71 offset:10240
    ds_read_b64_tr_b16 v[174:175], v71 offset:10752
    v_rcp_f32 v219, v218
    v_mfma_f32_16x16x32_bf16 v[60:63], v[180:183], a[132:135], v[60:63]
    v_lshl_or_b32 v248, v158, 16, v248
    s_waitcnt vmcnt(10)
    s_add_u32 m0, s66, 49152
    s_waitcnt lgkmcnt(8)
    v_mfma_f32_16x16x32_bf16 v[0:3], v[184:187], a[136:139], v[0:3]
    buffer_load_dwordx4 v200, s[4:7], s48 offen offset:0 lds
    v_mul_f32 v218, v218, v218
    v_mfma_f32_16x16x32_bf16 v[4:7], v[184:187], a[140:143], v[4:7]
    v_mov_b32 v251, v248
    v_mul_f32 v216, 0xc0135761, v219
    v_mfma_f32_16x16x32_bf16 a[248:251], v[148:151], v[184:187], a[248:251]
    v_mul_f32 v217, v219, v219
    v_mul_f32 v217, 0x3d372713, v217
    v_mul_f32 v217, v217, v216
    v_mfma_f32_16x16x32_bf16 v[8:11], v[188:191], a[136:139], v[8:11]
    v_mfma_f32_16x16x32_bf16 v[12:15], v[188:191], a[140:143], v[12:15]
    s_waitcnt vmcnt(5) lgkmcnt(0)
    s_barrier
    v_mfma_f32_16x16x32_bf16 v[16:19], v[192:195], a[136:139], v[16:19]
    buffer_load_dwordx4 v201, s[4:7], s48 offen offset:1024 lds
    ds_read_b128 a[144:147], v144 offset:0
    ds_read_b64_tr_b16 v[176:177], v68 offset:16384
    v_mfma_f32_16x16x32_bf16 v[20:23], v[192:195], a[140:143], v[20:23]
    ds_read_b64_tr_b16 v[178:179], v68 offset:16896
    ds_read_b64_tr_b16 v[180:181], v68 offset:18432
    buffer_store_dword v80, v81, s[20:23], s29 offen sc1
    v_mfma_f32_16x16x32_bf16 v[24:27], v[196:199], a[136:139], v[24:27]
    ds_read_b128 a[148:151], v144 offset:2048
    ds_read_b64_tr_b16 v[182:183], v68 offset:18944
    ds_read_b64_tr_b16 v[184:185], v68 offset:24576
    v_mfma_f32_16x16x32_bf16 v[28:31], v[196:199], a[140:143], v[28:31]
    v_and_b32 v222, 0xffff0000, v159
    v_and_b32 v252, 0xffff, v159
    v_mfma_f32_16x16x32_bf16 v[32:35], v[160:163], a[136:139], v[32:35]
    buffer_load_dwordx4 v200, s[8:11], s48 offen offset:2048 lds
    ds_read_b128 a[152:155], v145 offset:0
    v_mfma_f32_16x16x32_bf16 v[36:39], v[160:163], a[140:143], v[36:39]
    ds_read_b64_tr_b16 v[186:187], v68 offset:25088
    ds_read_b64_tr_b16 v[188:189], v68 offset:26624
    v_mfma_f32_16x16x32_bf16 a[252:255], v[148:151], v[160:163], a[252:255]
    v_rcp_f32 v223, v222
    v_lshl_or_b32 v252, v159, 16, v252
    v_mfma_f32_16x16x32_bf16 v[40:43], v[164:167], a[136:139], v[40:43]
    ds_read_b128 a[156:159], v145 offset:2048
    ds_read_b64_tr_b16 v[190:191], v68 offset:27136
    ds_read_b64_tr_b16 v[192:193], v69 offset:16384
    v_mfma_f32_16x16x32_bf16 v[44:47], v[164:167], a[140:143], v[44:47]
    ds_read_b64_tr_b16 v[194:195], v69 offset:16896
    v_mul_f32 v222, v222, v222
    v_mov_b32 v255, v252
    v_mfma_f32_16x16x32_bf16 v[48:51], v[168:171], a[136:139], v[48:51]
    buffer_load_dwordx4 v201, s[8:11], s48 offen offset:3072 lds
    ds_read_b64_tr_b16 v[196:197], v70 offset:16384
    v_mfma_f32_16x16x32_bf16 v[52:55], v[168:171], a[140:143], v[52:55]
    ds_read_b64_tr_b16 v[198:199], v70 offset:16896
    v_mul_f32 v220, 0xc0135761, v223
    v_mul_f32 v221, v223, v223
    v_mfma_f32_16x16x32_bf16 v[56:59], v[172:175], a[136:139], v[56:59]
    ds_read_b64_tr_b16 v[160:161], v71 offset:16384
    ds_read_b64_tr_b16 v[162:163], v71 offset:16896
    v_mfma_f32_16x16x32_bf16 v[60:63], v[172:175], a[140:143], v[60:63]
    v_mul_f32 v221, 0x3d372713, v221
    v_mul_f32 v221, v221, v220
    s_add_u32 m0, s66, 0
    s_waitcnt lgkmcnt(6)
    v_mfma_f32_16x16x32_bf16 v[0:3], v[176:179], a[144:147], v[0:3]
    buffer_load_dwordx4 v200, s[4:7], s51 offen offset:0 lds
    v_mfma_f32_16x16x32_bf16 v[4:7], v[176:179], a[148:151], v[4:7]
    ds_read_b64_tr_b16 v[164:165], v69 offset:18432
    v_mfma_f32_16x16x32_bf16 a[248:251], v[148:151], v[176:179], a[248:251]
    ds_read_b64_tr_b16 v[166:167], v69 offset:18944
    v_mfma_f32_16x16x32_bf16 v[32:35], v[180:183], a[144:147], v[32:35]
    ds_read_b64_tr_b16 v[168:169], v70 offset:18432
    v_mfma_f32_16x16x32_bf16 v[36:39], v[180:183], a[148:151], v[36:39]
    ds_read_b64_tr_b16 v[170:171], v70 offset:18944
    v_mfma_f32_16x16x32_bf16 a[252:255], v[148:151], v[180:183], a[252:255]
    ds_read_b64_tr_b16 v[172:173], v71 offset:18432
    v_mfma_f32_16x16x32_bf16 v[0:3], v[184:187], a[152:155], v[0:3]
    buffer_load_dwordx4 v201, s[4:7], s51 offen offset:1024 lds
    v_mfma_f32_16x16x32_bf16 v[4:7], v[184:187], a[156:159], v[4:7]
    ds_read_b64_tr_b16 v[174:175], v71 offset:18944
    v_mfma_f32_16x16x32_bf16 a[248:251], v[148:151], v[184:187], a[248:251]
    ds_read_b64_tr_b16 v[176:177], v69 offset:24576
    v_mfma_f32_16x16x32_bf16 v[32:35], v[188:191], a[152:155], v[32:35]
    ds_read_b64_tr_b16 v[178:179], v69 offset:25088
    v_mfma_f32_16x16x32_bf16 v[36:39], v[188:191], a[156:159], v[36:39]
    ds_read_b64_tr_b16 v[180:181], v70 offset:24576
    v_mfma_f32_16x16x32_bf16 a[252:255], v[148:151], v[188:191], a[252:255]
    s_waitcnt lgkmcnt(7)
    v_mfma_f32_16x16x32_bf16 v[8:11], v[192:195], a[144:147], v[8:11]
    buffer_load_dwordx4 v200, s[8:11], s51 offen offset:2048 lds
    ds_read_b64_tr_b16 v[182:183], v70 offset:25088
    v_mfma_f32_16x16x32_bf16 v[12:15], v[192:195], a[148:151], v[12:15]
    ds_read_b64_tr_b16 v[184:185], v71 offset:24576
    ds_read_b64_tr_b16 v[186:187], v71 offset:25088
    v_mfma_f32_16x16x32_bf16 v[16:19], v[196:199], a[144:147], v[16:19]
    ds_read_b64_tr_b16 v[188:189], v69 offset:26624
    ds_read_b64_tr_b16 v[190:191], v69 offset:27136
    v_accvgpr_read_b32 v240, a248
    v_mfma_f32_16x16x32_bf16 v[20:23], v[196:199], a[148:151], v[20:23]
    v_accvgpr_read_b32 v241, a252
    v_xor_b32 v244, 8, v156
    v_xor_b32 v245, 16, v156
    v_xor_b32 v246, 24, v156
    v_mfma_f32_16x16x32_bf16 v[24:27], v[160:163], a[144:147], v[24:27]
    buffer_load_dwordx4 v201, s[8:11], s51 offen offset:3072 lds
    ds_read_b64_tr_b16 v[192:193], v70 offset:26624
    ds_read_b64_tr_b16 v[194:195], v70 offset:27136
    v_mfma_f32_16x16x32_bf16 v[28:31], v[160:163], a[148:151], v[28:31]
    v_and_b32 v242, 0xffff0000, v240
    v_sub_f32 v240, v240, v242
    v_cvt_pk_bf16_f32 v240, v242, v240
    v_mfma_f32_16x16x32_bf16 v[40:43], v[164:167], a[144:147], v[40:43]
    ds_read_b64_tr_b16 v[196:197], v71 offset:26624
    ds_read_b64_tr_b16 v[198:199], v71 offset:27136
    v_and_b32 v243, 0xffff0000, v241
    v_mfma_f32_16x16x32_bf16 v[44:47], v[164:167], a[148:151], v[44:47]
    v_sub_f32 v241, v241, v243
    v_cvt_pk_bf16_f32 v241, v243, v241
    ds_write_b64 v156, v[240:241] offset:0
    s_waitcnt lgkmcnt(9)
    v_mfma_f32_16x16x32_bf16 v[48:51], v[168:171], a[144:147], v[48:51]
    buffer_load_dword a247, v206, s[4:7], s71 offen
    ds_write_b64 v244, v[240:241] offset:2048
    v_mfma_f32_16x16x32_bf16 v[52:55], v[168:171], a[148:151], v[52:55]
    ds_write_b64 v245, v[240:241] offset:4096
    ds_write_b64 v246, v[240:241] offset:6144
    v_mfma_f32_16x16x32_bf16 v[56:59], v[172:175], a[144:147], v[56:59]
    v_mfma_f32_16x16x32_bf16 v[60:63], v[172:175], a[148:151], v[60:63]
    s_waitcnt vmcnt(10) lgkmcnt(0)
    s_barrier
    v_mfma_f32_16x16x32_bf16 v[8:11], v[176:179], a[152:155], v[8:11]
    buffer_load_dword a246, v206, s[8:11], s71 offen offset:2048
    ds_read_b64_tr_b16 v[160:161], v64 offset:32768
    ds_read_b64_tr_b16 v[162:163], v64 offset:33280
    v_mfma_f32_16x16x32_bf16 v[12:15], v[176:179], a[156:159], v[12:15]
    ds_read_b64_tr_b16 v[164:165], v65 offset:32768
    ds_read_b128 v[240:243], v157 offset:0
    ds_read_b128 v[244:247], v157 offset:16
    v_mfma_f32_16x16x32_bf16 v[16:19], v[180:183], a[152:155], v[16:19]
    ds_read_b64_tr_b16 v[166:167], v65 offset:33280
    ds_read_b64_tr_b16 v[168:169], v66 offset:32768
    v_mfma_f32_16x16x32_bf16 v[20:23], v[180:183], a[156:159], v[20:23]
    s_add_u32 m0, s66, 16384
    v_mfma_f32_16x16x32_bf16 v[24:27], v[184:187], a[152:155], v[24:27]
    buffer_load_dwordx4 v200, s[4:7], s52 offen offset:0 lds
    v_mfma_f32_16x16x32_bf16 v[28:31], v[184:187], a[156:159], v[28:31]
    ds_read_b64_tr_b16 v[170:171], v66 offset:33280
    ds_read_b64_tr_b16 v[172:173], v67 offset:32768
    v_mfma_f32_16x16x32_bf16 v[40:43], v[188:191], a[152:155], v[40:43]
    ds_read_b64_tr_b16 v[174:175], v67 offset:33280
    ds_read_b64_tr_b16 v[176:177], v64 offset:34816
    v_mfma_f32_16x16x32_bf16 v[44:47], v[188:191], a[156:159], v[44:47]
    ds_read_b64_tr_b16 v[178:179], v64 offset:35328
    s_waitcnt lgkmcnt(7)
    v_mfma_f32_16x16x16_bf16 v[0:3], v[240:241], v[248:249], v[0:3]
    v_mfma_f32_16x16x16_bf16 v[8:11], v[242:243], v[248:249], v[8:11]
    v_mfma_f32_16x16x32_bf16 v[48:51], v[192:195], a[152:155], v[48:51]
    buffer_load_dwordx4 v201, s[4:7], s52 offen offset:1024 lds
    v_mfma_f32_16x16x32_bf16 v[52:55], v[192:195], a[156:159], v[52:55]
    ds_read_b64_tr_b16 v[180:181], v65 offset:34816
    ds_read_b64_tr_b16 v[182:183], v65 offset:35328
    v_mfma_f32_16x16x16_bf16 v[4:7], v[240:241], v[252:253], v[4:7]
    v_mfma_f32_16x16x16_bf16 v[12:15], v[242:243], v[252:253], v[12:15]
    v_mfma_f32_16x16x32_bf16 v[56:59], v[196:199], a[152:155], v[56:59]
    ds_read_b64_tr_b16 v[184:185], v66 offset:34816
    v_mfma_f32_16x16x32_bf16 v[60:63], v[196:199], a[156:159], v[60:63]
    ds_read_b64_tr_b16 v[186:187], v66 offset:35328
    v_mfma_f32_16x16x16_bf16 v[16:19], v[244:245], v[248:249], v[16:19]
    v_mfma_f32_16x16x16_bf16 v[24:27], v[246:247], v[248:249], v[24:27]
    s_waitcnt lgkmcnt(6)
    v_mfma_f32_16x16x32_bf16 v[80:83], v[160:163], a[0:3], 0
    buffer_load_dwordx4 v200, s[8:11], s52 offen offset:2048 lds
    v_mfma_f32_16x16x32_bf16 v[84:87], v[160:163], a[4:7], 0
    ds_read_b64_tr_b16 v[188:189], v67 offset:34816
    ds_read_b64_tr_b16 v[190:191], v67 offset:35328
    v_mfma_f32_16x16x32_bf16 a[248:251], v[148:151], v[160:163], 0
    s_mov_b32 s37, 19695616
    v_mov_b32 v145, s38
    v_mfma_f32_16x16x32_bf16 v[88:91], v[164:167], a[0:3], 0
    ds_read_b64_tr_b16 v[192:193], v64 offset:40960
    ds_read_b64_tr_b16 v[194:195], v64 offset:41472
    ds_read_b64_tr_b16 v[196:197], v65 offset:40960
    v_mfma_f32_16x16x32_bf16 v[92:95], v[164:167], a[4:7], 0
    v_mul_f32 v224, 0x3fb8aa3b, v219
    v_mfma_f32_16x16x16_bf16 v[20:23], v[244:245], v[252:253], v[20:23]
    v_mul_f32 v225, 0x3fb8aa3b, v223
    v_mul_f32 v0, v224, v0
    v_mfma_f32_16x16x32_bf16 v[96:99], v[168:171], a[0:3], 0
    buffer_load_dwordx4 v201, s[8:11], s52 offen offset:3072 lds
    v_mfma_f32_16x16x32_bf16 v[100:103], v[168:171], a[4:7], 0
    ds_read_b64_tr_b16 v[198:199], v65 offset:41472
    ds_read_b64_tr_b16 v[160:161], v66 offset:40960
    v_mfma_f32_16x16x32_bf16 v[104:107], v[172:175], a[0:3], 0
    ds_read_b64_tr_b16 v[162:163], v66 offset:41472
    ds_read_b64_tr_b16 v[164:165], v67 offset:40960
    v_mul_f32 v1, v224, v1
    v_mfma_f32_16x16x16_bf16 v[28:31], v[246:247], v[252:253], v[28:31]
    v_mfma_f32_16x16x32_bf16 v[108:111], v[172:175], a[4:7], 0
    v_mul_f32 v2, v224, v2
    v_mul_f32 v3, v224, v3
    s_add_u32 m0, s66, 98304
    s_waitcnt lgkmcnt(7)
    v_mfma_f32_16x16x32_bf16 v[112:115], v[176:179], a[0:3], 0
    buffer_load_dwordx4 v200, s[4:7], s55 offen offset:0 lds
    ds_read_b64_tr_b16 v[166:167], v67 offset:41472
    v_mfma_f32_16x16x32_bf16 v[116:119], v[176:179], a[4:7], 0
    ds_read_b64_tr_b16 v[168:169], v64 offset:43008
    ds_read_b64_tr_b16 v[170:171], v64 offset:43520
    v_mfma_f32_16x16x32_bf16 a[252:255], v[148:151], v[176:179], 0
    v_cvt_pk_bf16_f32 v232, v0, v1
    v_mfma_f32_16x16x16_bf16 v[32:35], v[240:241], v[250:251], v[32:35]
    v_cvt_pk_bf16_f32 v233, v2, v3
    v_mul_f32 v8, v224, v8
    v_mfma_f32_16x16x32_bf16 v[120:123], v[180:183], a[0:3], 0
    ds_read_b64_tr_b16 v[172:173], v65 offset:43008
    ds_read_b64_tr_b16 v[174:175], v65 offset:43520
    v_mfma_f32_16x16x32_bf16 v[124:127], v[180:183], a[4:7], 0
    v_mov_b32 v144, 1073741824
    v_cmp_eq_u32 vcc, 0, v209
    v_mfma_f32_16x16x32_bf16 v[128:131], v[184:187], a[0:3], 0
    buffer_load_dwordx4 v201, s[4:7], s55 offen offset:1024 lds
    v_mfma_f32_16x16x32_bf16 v[132:135], v[184:187], a[4:7], 0
    ds_read_b64_tr_b16 v[176:177], v66 offset:43008
    ds_read_b64_tr_b16 v[178:179], v66 offset:43520
    v_mfma_f32_16x16x32_bf16 v[136:139], v[188:191], a[0:3], 0
    ds_read_b64_tr_b16 v[180:181], v67 offset:43008
    ds_read_b64_tr_b16 v[182:183], v67 offset:43520
    v_add_u32 v159, 4096, v209
    v_mfma_f32_16x16x32_bf16 v[140:143], v[188:191], a[4:7], 0
    v_mul_f32 v9, v224, v9
    v_mfma_f32_16x16x16_bf16 v[40:43], v[242:243], v[250:251], v[40:43]
    v_mul_f32 v10, v224, v10
    v_mul_f32 v11, v224, v11
    s_waitcnt lgkmcnt(8)
    v_mfma_f32_16x16x32_bf16 v[80:83], v[192:195], a[8:11], v[80:83]
    buffer_load_dwordx4 v200, s[8:11], s55 offen offset:2048 lds
    v_mfma_f32_16x16x32_bf16 v[84:87], v[192:195], a[12:15], v[84:87]
    v_accvgpr_read_b32 v158, a212
    v_cndmask_b32 v144, v144, v209, vcc
    v_mfma_f32_16x16x32_bf16 a[248:251], v[148:151], v[192:195], a[248:251]
    buffer_store_dword v145, v144, s[20:23], s1 offen sc1
    v_mfma_f32_16x16x32_bf16 v[88:91], v[196:199], a[8:11], v[88:91]
    v_mfma_f32_16x16x32_bf16 v[92:95], v[196:199], a[12:15], v[92:95]
    s_waitcnt vmcnt(14) lgkmcnt(0)
    s_barrier
    v_mfma_f32_16x16x32_bf16 v[96:99], v[160:163], a[8:11], v[96:99]
    buffer_load_dwordx4 v201, s[8:11], s55 offen offset:3072 lds
    ds_read_b64_tr_b16 v[184:185], v64 offset:49152
    v_mfma_f32_16x16x32_bf16 v[100:103], v[160:163], a[12:15], v[100:103]
    ds_read_b64_tr_b16 v[186:187], v64 offset:49664
    ds_read_b64_tr_b16 v[188:189], v65 offset:49152
    v_mfma_f32_16x16x32_bf16 v[104:107], v[164:167], a[8:11], v[104:107]
    ds_read_b64_tr_b16 v[190:191], v65 offset:49664
    ds_read_b64_tr_b16 v[192:193], v66 offset:49152
    v_mfma_f32_16x16x32_bf16 v[108:111], v[164:167], a[12:15], v[108:111]
    s_add_u32 m0, s66, 114688
    v_mfma_f32_16x16x32_bf16 v[112:115], v[168:171], a[8:11], v[112:115]
    buffer_load_dwordx4 v200, s[4:7], s56 offen offset:0 lds
    ds_read_b64_tr_b16 v[194:195], v66 offset:49664
    v_mfma_f32_16x16x32_bf16 v[116:119], v[168:171], a[12:15], v[116:119]
    ds_read_b64_tr_b16 v[196:197], v67 offset:49152
    v_cvt_pk_bf16_f32 v234, v8, v9
    v_mfma_f32_16x16x16_bf16 v[36:39], v[240:241], v[254:255], v[36:39]
    v_cvt_pk_bf16_f32 v235, v10, v11
    v_mfma_f32_16x16x32_bf16 a[252:255], v[148:151], v[168:171], a[252:255]
    v_mul_f32 v4, v225, v4
    v_mul_f32 v5, v225, v5
    v_mfma_f32_16x16x16_bf16 v[44:47], v[242:243], v[254:255], v[44:47]
    v_mul_f32 v6, v225, v6
    v_mul_f32 v7, v225, v7
    v_mfma_f32_16x16x32_bf16 v[120:123], v[172:175], a[8:11], v[120:123]
    ds_read_b64_tr_b16 v[198:199], v67 offset:49664
    ds_read_b64_tr_b16 v[160:161], v64 offset:51200
    v_mfma_f32_16x16x32_bf16 v[124:127], v[172:175], a[12:15], v[124:127]
    ds_read_b64_tr_b16 v[162:163], v64 offset:51712
    v_permlane16_swap_b32 v232, v234
    v_mfma_f32_16x16x16_bf16 v[48:51], v[244:245], v[250:251], v[48:51]
    v_permlane16_swap_b32 v233, v235
    v_mfma_f32_16x16x32_bf16 v[128:131], v[176:179], a[8:11], v[128:131]
    buffer_load_dwordx4 v201, s[4:7], s56 offen offset:1024 lds
    v_mfma_f32_16x16x32_bf16 v[132:135], v[176:179], a[12:15], v[132:135]
    ds_read_b64_tr_b16 v[164:165], v65 offset:51200
    ds_read_b64_tr_b16 v[166:167], v65 offset:51712
    v_mfma_f32_16x16x32_bf16 v[136:139], v[180:183], a[8:11], v[136:139]
    ds_read_b64_tr_b16 v[168:169], v66 offset:51200
    ds_read_b64_tr_b16 v[170:171], v66 offset:51712
    v_mfma_f32_16x16x32_bf16 v[140:143], v[180:183], a[12:15], v[140:143]
    buffer_store_dwordx4 v[232:235], v152, s[20:23], s72 offen offset:0 sc1
    s_waitcnt lgkmcnt(6)
    v_mfma_f32_16x16x32_bf16 v[80:83], v[184:187], a[16:19], v[80:83]
    buffer_load_dwordx4 v200, s[8:11], s56 offen offset:2048 lds
    v_mfma_f32_16x16x32_bf16 v[84:87], v[184:187], a[20:23], v[84:87]
    ds_read_b64_tr_b16 v[172:173], v67 offset:51200
    ds_read_b64_tr_b16 v[174:175], v67 offset:51712
    v_mfma_f32_16x16x32_bf16 a[248:251], v[148:151], v[184:187], a[248:251]
    s_getpc_b64 s[12:13]
KR_pcq:
    s_sub_u32 s12, s12, KR_pcq-K1_pf
    s_subb_u32 s13, s13, 0
    s_mov_b32 s14, CODE_END-K1_pf
    v_mfma_f32_16x16x32_bf16 v[88:91], v[188:191], a[16:19], v[88:91]
    ds_read_b64_tr_b16 v[176:177], v64 offset:57344
    ds_read_b64_tr_b16 v[178:179], v64 offset:57856
    ds_read_b64_tr_b16 v[180:181], v65 offset:57344
    v_mfma_f32_16x16x32_bf16 v[92:95], v[188:191], a[20:23], v[92:95]
    v_cvt_pk_bf16_f32 v236, v4, v5
    v_mfma_f32_16x16x16_bf16 v[56:59], v[246:247], v[250:251], v[56:59]
    v_cvt_pk_bf16_f32 v237, v6, v7
    v_mul_f32 v12, v225, v12
    v_mfma_f32_16x16x32_bf16 v[96:99], v[192:195], a[16:19], v[96:99]
    buffer_load_dwordx4 v201, s[8:11], s56 offen offset:3072 lds
    v_mfma_f32_16x16x32_bf16 v[100:103], v[192:195], a[20:23], v[100:103]
    ds_read_b64_tr_b16 v[182:183], v65 offset:57856
    ds_read_b64_tr_b16 v[184:185], v66 offset:57344
    v_mfma_f32_16x16x32_bf16 v[104:107], v[196:199], a[16:19], v[104:107]
    ds_read_b64_tr_b16 v[186:187], v66 offset:57856
    ds_read_b64_tr_b16 v[188:189], v67 offset:57344
    v_mul_f32 v13, v225, v13
    v_mfma_f32_16x16x16_bf16 v[52:55], v[244:245], v[254:255], v[52:55]
    v_mfma_f32_16x16x32_bf16 v[108:111], v[196:199], a[20:23], v[108:111]
    v_mul_f32 v14, v225, v14
    v_mul_f32 v15, v225, v15
    s_add_u32 m0, s66, 65536
    s_waitcnt lgkmcnt(7)
    v_mfma_f32_16x16x32_bf16 v[112:115], v[160:163], a[16:19], v[112:115]
    buffer_load_dwordx4 v200, s[4:7], s41 offen offset:0 lds
    ds_read_b64_tr_b16 v[190:191], v67 offset:57856
    v_mfma_f32_16x16x32_bf16 v[116:119], v[160:163], a[20:23], v[116:119]
    ds_read_b64_tr_b16 v[192:193], v64 offset:59392
    ds_read_b64_tr_b16 v[194:195], v64 offset:59904
    v_mfma_f32_16x16x32_bf16 a[252:255], v[148:151], v[160:163], a[252:255]
    v_cvt_pk_bf16_f32 v238, v12, v13
    v_mfma_f32_16x16x16_bf16 v[60:63], v[246:247], v[254:255], v[60:63]
    v_cvt_pk_bf16_f32 v239, v14, v15
    v_mul_f32 v16, v224, v16
    v_mfma_f32_16x16x32_bf16 v[120:123], v[164:167], a[16:19], v[120:123]
    ds_read_b64_tr_b16 v[196:197], v65 offset:59392
    ds_read_b64_tr_b16 v[198:199], v65 offset:59904
    v_mfma_f32_16x16x32_bf16 v[124:127], v[164:167], a[20:23], v[124:127]
    s_mov_b32 s15, 0x20000
    s_lshr_b32 s16, s2, 3
    v_mfma_f32_16x16x32_bf16 v[128:131], v[168:171], a[16:19], v[128:131]
    buffer_load_dwordx4 v201, s[4:7], s41 offen offset:1024 lds
    v_mfma_f32_16x16x32_bf16 v[132:135], v[168:171], a[20:23], v[132:135]
    ds_read_b64_tr_b16 v[160:161], v66 offset:59392
    ds_read_b64_tr_b16 v[162:163], v66 offset:59904
    v_mfma_f32_16x16x32_bf16 v[136:139], v[172:175], a[16:19], v[136:139]
    ds_read_b64_tr_b16 v[164:165], v67 offset:59392
    ds_read_b64_tr_b16 v[166:167], v67 offset:59904
    v_mfma_f32_16x16x32_bf16 v[140:143], v[172:175], a[20:23], v[140:143]
    s_lshl_b32 s16, s16, 2
    v_mul_f32 v17, v224, v17
    s_waitcnt lgkmcnt(8)
    v_mfma_f32_16x16x32_bf16 v[80:83], v[176:179], a[24:27], v[80:83]
    buffer_load_dwordx4 v200, s[8:11], s41 offen offset:2048 lds
    v_mfma_f32_16x16x32_bf16 v[84:87], v[176:179], a[28:31], v[84:87]
    s_add_u32 s16, s16, s40
    s_lshl_b32 s16, s16, 10
    v_mfma_f32_16x16x32_bf16 a[248:251], v[148:151], v[176:179], a[248:251]
    buffer_load_dwordx4 a[244:247], v209, s[12:15], s16 offen
    v_mul_f32 v18, v224, v18
    v_mfma_f32_16x16x32_bf16 v[88:91], v[180:183], a[24:27], v[88:91]
    v_mfma_f32_16x16x32_bf16 v[92:95], v[180:183], a[28:31], v[92:95]
    s_waitcnt vmcnt(14) lgkmcnt(0)
    s_barrier
    v_mfma_f32_16x16x32_bf16 v[96:99], v[184:187], a[24:27], v[96:99]
    buffer_load_dwordx4 v201, s[8:11], s41 offen offset:3072 lds
    ds_read_b64_tr_b16 v[168:169], v64 offset:0
    v_mfma_f32_16x16x32_bf16 v[100:103], v[184:187], a[28:31], v[100:103]
    ds_read_b64_tr_b16 v[170:171], v64 offset:512
    ds_read_b64_tr_b16 v[172:173], v65 offset:0
    v_mfma_f32_16x16x32_bf16 v[104:107], v[188:191], a[24:27], v[104:107]
    ds_read_b64_tr_b16 v[174:175], v65 offset:512
    ds_read_b64_tr_b16 v[176:177], v66 offset:0
    v_mfma_f32_16x16x32_bf16 v[108:111], v[188:191], a[28:31], v[108:111]
    v_mul_f32 v19, v224, v19
    s_add_u32 m0, s66, 81920
    v_mfma_f32_16x16x32_bf16 v[112:115], v[192:195], a[24:27], v[112:115]
    buffer_load_dwordx4 v200, s[4:7], s42 offen offset:0 lds
    v_mfma_f32_16x16x32_bf16 v[116:119], v[192:195], a[28:31], v[116:119]
    ds_read_b64_tr_b16 v[178:179], v66 offset:512
    ds_read_b64_tr_b16 v[180:181], v67 offset:0
    v_mfma_f32_16x16x32_bf16 a[252:255], v[148:151], v[192:195], a[252:255]
    v_permlane16_swap_b32 v236, v238
    v_permlane16_swap_b32 v237, v239
    v_mfma_f32_16x16x32_bf16 v[120:123], v[196:199], a[24:27], v[120:123]
    ds_read_b64_tr_b16 v[182:183], v67 offset:512
    ds_read_b64_tr_b16 v[184:185], v64 offset:2048
    v_mfma_f32_16x16x32_bf16 v[124:127], v[196:199], a[28:31], v[124:127]
    buffer_store_dwordx4 v[236:239], v152, s[20:23], s72 offen offset:256 sc1
    v_mfma_f32_16x16x32_bf16 v[128:131], v[160:163], a[24:27], v[128:131]
    buffer_load_dwordx4 v201, s[4:7], s42 offen offset:1024 lds
    v_mfma_f32_16x16x32_bf16 v[132:135], v[160:163], a[28:31], v[132:135]
    ds_read_b64_tr_b16 v[186:187], v64 offset:2560
    ds_read_b64_tr_b16 v[188:189], v65 offset:2048
    v_mfma_f32_16x16x32_bf16 v[136:139], v[164:167], a[24:27], v[136:139]
    ds_read_b64_tr_b16 v[190:191], v65 offset:2560
    ds_read_b64_tr_b16 v[192:193], v66 offset:2048
    v_mfma_f32_16x16x32_bf16 v[140:143], v[164:167], a[28:31], v[140:143]
    v_cvt_pk_bf16_f32 v232, v16, v17
    s_waitcnt lgkmcnt(5)
    v_mfma_f32_16x16x32_bf16 v[80:83], v[168:171], a[32:35], v[80:83]
    buffer_load_dwordx4 v200, s[8:11], s42 offen offset:2048 lds
    v_mfma_f32_16x16x32_bf16 v[84:87], v[168:171], a[36:39], v[84:87]
    ds_read_b64_tr_b16 v[194:195], v66 offset:2560
    ds_read_b64_tr_b16 v[196:197], v67 offset:2048
    v_mfma_f32_16x16x32_bf16 a[248:251], v[148:151], v[168:171], a[248:251]
    v_cvt_pk_bf16_f32 v233, v18, v19
    v_mul_f32 v24, v224, v24
    v_mfma_f32_16x16x32_bf16 v[88:91], v[172:175], a[32:35], v[88:91]
    ds_read_b64_tr_b16 v[198:199], v67 offset:2560
    ds_read_b64_tr_b16 v[160:161], v64 offset:8192
    v_mfma_f32_16x16x32_bf16 v[92:95], v[172:175], a[36:39], v[92:95]
    ds_read_b64_tr_b16 v[162:163], v64 offset:8704
    v_mul_f32 v25, v224, v25
    v_mfma_f32_16x16x32_bf16 v[96:99], v[176:179], a[32:35], v[96:99]
    buffer_load_dwordx4 v201, s[8:11], s42 offen offset:3072 lds
    v_mfma_f32_16x16x32_bf16 v[100:103], v[176:179], a[36:39], v[100:103]
    ds_read_b64_tr_b16 v[164:165], v65 offset:8192
    ds_read_b64_tr_b16 v[166:167], v65 offset:8704
    v_mfma_f32_16x16x32_bf16 v[104:107], v[180:183], a[32:35], v[104:107]
    ds_read_b64_tr_b16 v[168:169], v66 offset:8192
    ds_read_b64_tr_b16 v[170:171], v66 offset:8704
    v_mfma_f32_16x16x32_bf16 v[108:111], v[180:183], a[36:39], v[108:111]
    s_mov_b32 s96, s53
    s_mov_b32 s97, s57
    s_mov_b32 s98, 25600
    s_mov_b32 s99, 0x20000
    s_lshl_b32 s64, s40, 10
    s_and_b32 s64, s64, 1024
    s_add_u32 m0, s64, 160768
    s_waitcnt lgkmcnt(6)
    v_mfma_f32_16x16x32_bf16 v[112:115], v[184:187], a[32:35], v[112:115]
    buffer_load_dwordx4 v209, s[96:99], s100 offen lds
    v_mfma_f32_16x16x32_bf16 v[116:119], v[184:187], a[36:39], v[116:119]
    ds_read_b64_tr_b16 v[172:173], v67 offset:8192
    ds_read_b64_tr_b16 v[174:175], v67 offset:8704
    v_mfma_f32_16x16x32_bf16 a[252:255], v[148:151], v[184:187], a[252:255]
    v_mul_f32 v26, v224, v26
    v_mul_f32 v27, v224, v27
    v_mfma_f32_16x16x32_bf16 v[120:123], v[188:191], a[32:35], v[120:123]
    ds_read_b64_tr_b16 v[176:177], v64 offset:10240
    ds_read_b64_tr_b16 v[178:179], v64 offset:10752
    v_mfma_f32_16x16x32_bf16 v[124:127], v[188:191], a[36:39], v[124:127]
    s_getpc_b64 s[96:97]
KC_pcq:
    s_add_u32 s96, s96, KC_tab-KC_pcq
    s_addc_u32 s97, s97, 0
    s_movk_i32 s98, 6144
    s_lshl_b32 s64, s40, 10
    s_add_u32 m0, s64, 152576
    v_mfma_f32_16x16x32_bf16 v[128:131], v[192:195], a[32:35], v[128:131]
    buffer_load_dwordx4 v209, s[96:99], s64 offen lds
    v_mfma_f32_16x16x32_bf16 v[132:135], v[192:195], a[36:39], v[132:135]
    ds_read_b64_tr_b16 v[180:181], v65 offset:10240
    ds_read_b64_tr_b16 v[182:183], v65 offset:10752
    v_mfma_f32_16x16x32_bf16 v[136:139], v[196:199], a[32:35], v[136:139]
    ds_read_b64_tr_b16 v[184:185], v66 offset:10240
    ds_read_b64_tr_b16 v[186:187], v66 offset:10752
    v_mfma_f32_16x16x32_bf16 v[140:143], v[196:199], a[36:39], v[140:143]
    s_add_u32 s64, s64, 4096
    s_add_u32 m0, s64, 152576
    s_waitcnt lgkmcnt(6)
    v_mfma_f32_16x16x32_bf16 v[80:83], v[160:163], a[40:43], v[80:83]
    buffer_load_dwordx4 v209, s[96:99], s64 offen lds
    v_mfma_f32_16x16x32_bf16 v[84:87], v[160:163], a[44:47], v[84:87]
    ds_read_b64_tr_b16 v[188:189], v67 offset:10240
    ds_read_b64_tr_b16 v[190:191], v67 offset:10752
    v_mfma_f32_16x16x32_bf16 a[248:251], v[148:151], v[160:163], a[248:251]
    v_cvt_pk_bf16_f32 v234, v24, v25
    v_cvt_pk_bf16_f32 v235, v26, v27
    v_mfma_f32_16x16x32_bf16 v[88:91], v[164:167], a[40:43], v[88:91]
    ds_read_b64_tr_b16 v[192:193], v64 offset:16384
    ds_read_b64_tr_b16 v[194:195], v64 offset:16896
    v_mfma_f32_16x16x32_bf16 v[92:95], v[164:167], a[44:47], v[92:95]
    ds_read_b64_tr_b16 v[196:197], v65 offset:16384
    s_add_u32 m0, s66, 32768
    v_mfma_f32_16x16x32_bf16 v[96:99], v[168:171], a[40:43], v[96:99]
    buffer_load_dwordx4 v200, s[4:7], s44 offen offset:0 lds
    v_mfma_f32_16x16x32_bf16 v[100:103], v[168:171], a[44:47], v[100:103]
    ds_read_b64_tr_b16 v[198:199], v65 offset:16896
    ds_read_b64_tr_b16 v[160:161], v66 offset:16384
    v_mfma_f32_16x16x32_bf16 v[104:107], v[172:175], a[40:43], v[104:107]
    ds_read_b64_tr_b16 v[162:163], v66 offset:16896
    ds_read_b64_tr_b16 v[164:165], v67 offset:16384
    v_mfma_f32_16x16x32_bf16 v[108:111], v[172:175], a[44:47], v[108:111]
    v_mul_f32 v20, v225, v20
    v_mul_f32 v21, v225, v21
    s_waitcnt lgkmcnt(7)
    v_mfma_f32_16x16x32_bf16 v[112:115], v[176:179], a[40:43], v[112:115]
    buffer_load_dwordx4 v201, s[4:7], s44 offen offset:1024 lds
    v_mfma_f32_16x16x32_bf16 v[116:119], v[176:179], a[44:47], v[116:119]
    ds_read_b64_tr_b16 v[166:167], v67 offset:16896
    ds_read_b64_tr_b16 v[168:169], v64 offset:18432
    v_mfma_f32_16x16x32_bf16 a[252:255], v[148:151], v[176:179], a[252:255]
    v_mul_f32 v22, v225, v22
    v_mul_f32 v23, v225, v23
    v_mfma_f32_16x16x32_bf16 v[120:123], v[180:183], a[40:43], v[120:123]
    ds_read_b64_tr_b16 v[170:171], v64 offset:18944
    ds_read_b64_tr_b16 v[172:173], v65 offset:18432
    v_mfma_f32_16x16x32_bf16 v[124:127], v[180:183], a[44:47], v[124:127]
    v_permlane16_swap_b32 v232, v234
    v_permlane16_swap_b32 v233, v235
    v_mfma_f32_16x16x32_bf16 v[128:131], v[184:187], a[40:43], v[128:131]
    buffer_load_dwordx4 v200, s[8:11], s44 offen offset:2048 lds
    v_mfma_f32_16x16x32_bf16 v[132:135], v[184:187], a[44:47], v[132:135]
    ds_read_b64_tr_b16 v[174:175], v65 offset:18944
    ds_read_b64_tr_b16 v[176:177], v66 offset:18432
    v_mfma_f32_16x16x32_bf16 v[136:139], v[188:191], a[40:43], v[136:139]
    ds_read_b64_tr_b16 v[178:179], v66 offset:18944
    ds_read_b64_tr_b16 v[180:181], v67 offset:18432
    v_mfma_f32_16x16x32_bf16 v[140:143], v[188:191], a[44:47], v[140:143]
    buffer_store_dwordx4 v[232:235], v153, s[20:23], s72 offen offset:0 sc1
    s_waitcnt lgkmcnt(7)
    v_mfma_f32_16x16x32_bf16 v[80:83], v[192:195], a[48:51], v[80:83]
    buffer_load_dwordx4 v201, s[8:11], s44 offen offset:3072 lds
    v_mfma_f32_16x16x32_bf16 v[84:87], v[192:195], a[52:55], v[84:87]
    ds_read_b64_tr_b16 v[182:183], v67 offset:18944
    ds_read_b64_tr_b16 v[184:185], v64 offset:24576
    v_mfma_f32_16x16x32_bf16 a[248:251], v[148:151], v[192:195], a[248:251]
    ds_read_b64_tr_b16 v[186:187], v64 offset:25088
    v_cvt_pk_bf16_f32 v236, v20, v21
    v_mfma_f32_16x16x32_bf16 v[88:91], v[196:199], a[48:51], v[88:91]
    ds_read_b64_tr_b16 v[188:189], v65 offset:24576
    ds_read_b64_tr_b16 v[190:191], v65 offset:25088
    v_mfma_f32_16x16x32_bf16 v[92:95], v[196:199], a[52:55], v[92:95]
    v_cvt_pk_bf16_f32 v237, v22, v23
    s_add_u32 m0, s66, 49152
    v_mfma_f32_16x16x32_bf16 v[96:99], v[160:163], a[48:51], v[96:99]
    buffer_load_dwordx4 v200, s[4:7], s3 offen offset:0 lds
    v_mfma_f32_16x16x32_bf16 v[100:103], v[160:163], a[52:55], v[100:103]
    ds_read_b64_tr_b16 v[192:193], v66 offset:24576
    ds_read_b64_tr_b16 v[194:195], v66 offset:25088
    v_mfma_f32_16x16x32_bf16 v[104:107], v[164:167], a[48:51], v[104:107]
    ds_read_b64_tr_b16 v[196:197], v67 offset:24576
    ds_read_b64_tr_b16 v[198:199], v67 offset:25088
    v_mfma_f32_16x16x32_bf16 v[108:111], v[164:167], a[52:55], v[108:111]
    v_mul_f32 v28, v225, v28
    v_mul_f32 v29, v225, v29
    s_waitcnt lgkmcnt(8)
    v_mfma_f32_16x16x32_bf16 v[112:115], v[168:171], a[48:51], v[112:115]
    buffer_load_dwordx4 v201, s[4:7], s3 offen offset:1024 lds
    v_mfma_f32_16x16x32_bf16 v[116:119], v[168:171], a[52:55], v[116:119]
    ds_read_b64_tr_b16 v[160:161], v64 offset:26624
    ds_read_b64_tr_b16 v[162:163], v64 offset:27136
    v_mfma_f32_16x16x32_bf16 a[252:255], v[148:151], v[168:171], a[252:255]
    v_mul_f32 v30, v225, v30
    v_mul_f32 v31, v225, v31
    v_mfma_f32_16x16x32_bf16 v[120:123], v[172:175], a[48:51], v[120:123]
    ds_read_b64_tr_b16 v[164:165], v65 offset:26624
    ds_read_b64_tr_b16 v[166:167], v65 offset:27136
    v_mfma_f32_16x16x32_bf16 v[124:127], v[172:175], a[52:55], v[124:127]
    v_cvt_pk_bf16_f32 v238, v28, v29
    v_cvt_pk_bf16_f32 v239, v30, v31
    v_mfma_f32_16x16x32_bf16 v[128:131], v[176:179], a[48:51], v[128:131]
    buffer_load_dwordx4 v200, s[8:11], s3 offen offset:2048 lds
    v_mfma_f32_16x16x32_bf16 v[132:135], v[176:179], a[52:55], v[132:135]
    ds_read_b64_tr_b16 v[168:169], v66 offset:26624
    ds_read_b64_tr_b16 v[170:171], v66 offset:27136
    v_mfma_f32_16x16x32_bf16 v[136:139], v[180:183], a[48:51], v[136:139]
    ds_read_b64_tr_b16 v[172:173], v67 offset:26624
    ds_read_b64_tr_b16 v[174:175], v67 offset:27136
    v_mfma_f32_16x16x32_bf16 v[140:143], v[180:183], a[52:55], v[140:143]
    v_mul_f32 v32, v224, v32
    v_mul_f32 v33, v224, v33
    s_waitcnt lgkmcnt(8)
    v_mfma_f32_16x16x32_bf16 v[80:83], v[184:187], a[56:59], v[80:83]
    buffer_load_dwordx4 v201, s[8:11], s3 offen offset:3072 lds
    v_mfma_f32_16x16x32_bf16 v[84:87], v[184:187], a[60:63], v[84:87]
    v_mul_f32 v34, v224, v34
    v_mul_f32 v35, v224, v35
    v_mfma_f32_16x16x32_bf16 a[248:251], v[148:151], v[184:187], a[248:251]
    v_permlane16_swap_b32 v236, v238
    v_permlane16_swap_b32 v237, v239
    v_mfma_f32_16x16x32_bf16 v[88:91], v[188:191], a[56:59], v[88:91]
    v_mfma_f32_16x16x32_bf16 v[92:95], v[188:191], a[60:63], v[92:95]
    s_waitcnt vmcnt(22) lgkmcnt(0)
    s_barrier
    s_add_u32 s4, s4, s65
    s_addc_u32 s5, s5, 0
    s_sub_u32 s6, s6, s65
    s_add_u32 s8, s8, s65
    s_addc_u32 s9, s9, 0
    s_sub_u32 s10, s10, s65
    s_add_u32 m0, s66, 0
    v_mfma_f32_16x16x32_bf16 v[96:99], v[192:195], a[56:59], v[96:99]
    buffer_load_dwordx4 v200, s[4:7], s47 offen offset:0 lds
    ds_read_b64_tr_b16 v[176:177], v68 offset:32768
    v_mfma_f32_16x16x32_bf16 v[100:103], v[192:195], a[60:63], v[100:103]
    ds_read_b64_tr_b16 v[178:179], v68 offset:33280
    ds_read_b64_tr_b16 v[180:181], v69 offset:32768
    v_mfma_f32_16x16x32_bf16 v[104:107], v[196:199], a[56:59], v[104:107]
    ds_read_b64_tr_b16 v[182:183], v69 offset:33280
    ds_read_b64_tr_b16 v[184:185], v70 offset:32768
    v_mfma_f32_16x16x32_bf16 v[108:111], v[196:199], a[60:63], v[108:111]
    buffer_store_dwordx4 v[236:239], v153, s[20:23], s72 offen offset:256 sc1
    v_mfma_f32_16x16x32_bf16 v[112:115], v[160:163], a[56:59], v[112:115]
    buffer_load_dwordx4 v201, s[4:7], s47 offen offset:1024 lds
    v_mfma_f32_16x16x32_bf16 v[116:119], v[160:163], a[60:63], v[116:119]
    ds_read_b64_tr_b16 v[186:187], v70 offset:33280
    ds_read_b64_tr_b16 v[188:189], v71 offset:32768
    v_mfma_f32_16x16x32_bf16 a[252:255], v[148:151], v[160:163], a[252:255]
    v_cvt_pk_bf16_f32 v232, v32, v33
    v_cvt_pk_bf16_f32 v233, v34, v35
    v_mfma_f32_16x16x32_bf16 v[120:123], v[164:167], a[56:59], v[120:123]
    ds_read_b64_tr_b16 v[190:191], v71 offset:33280
    ds_read_b64_tr_b16 v[192:193], v68 offset:34816
    v_mfma_f32_16x16x32_bf16 v[124:127], v[164:167], a[60:63], v[124:127]
    v_mul_f32 v40, v224, v40
    v_mul_f32 v41, v224, v41
    v_mfma_f32_16x16x32_bf16 v[128:131], v[168:171], a[56:59], v[128:131]
    buffer_load_dwordx4 v200, s[8:11], s47 offen offset:2048 lds
    v_mfma_f32_16x16x32_bf16 v[132:135], v[168:171], a[60:63], v[132:135]
    ds_read_b64_tr_b16 v[194:195], v68 offset:35328
    ds_read_b64_tr_b16 v[196:197], v69 offset:34816
    v_mfma_f32_16x16x32_bf16 v[136:139], v[172:175], a[56:59], v[136:139]
    ds_read_b64_tr_b16 v[198:199], v69 offset:35328
    ds_read_b64_tr_b16 v[160:161], v70 offset:34816
    v_mfma_f32_16x16x32_bf16 v[140:143], v[172:175], a[60:63], v[140:143]
    v_mul_f32 v42, v224, v42
    v_mul_f32 v43, v224, v43
    s_waitcnt lgkmcnt(5)
    v_mfma_f32_16x16x32_bf16 v[80:83], v[176:179], a[64:67], v[80:83]
    buffer_load_dwordx4 v201, s[8:11], s47 offen offset:3072 lds
    v_mfma_f32_16x16x32_bf16 v[84:87], v[176:179], a[68:71], v[84:87]
    ds_read_b64_tr_b16 v[162:163], v70 offset:35328
    ds_read_b64_tr_b16 v[164:165], v71 offset:34816
    v_mfma_f32_16x16x32_bf16 a[248:251], v[148:151], v[176:179], a[248:251]
    v_cvt_pk_bf16_f32 v234, v40, v41
    v_cvt_pk_bf16_f32 v235, v42, v43
    v_mfma_f32_16x16x32_bf16 v[88:91], v[180:183], a[64:67], v[88:91]
    ds_read_b64_tr_b16 v[166:167], v71 offset:35328
    ds_read_b64_tr_b16 v[168:169], v68 offset:40960
    v_mfma_f32_16x16x32_bf16 v[92:95], v[180:183], a[68:71], v[92:95]
    ds_read_b64_tr_b16 v[170:171], v68 offset:41472
    s_add_u32 m0, s66, 16384
    v_mfma_f32_16x16x32_bf16 v[96:99], v[184:187], a[64:67], v[96:99]
    buffer_load_dwordx4 v200, s[4:7], s48 offen offset:0 lds
    v_mfma_f32_16x16x32_bf16 v[100:103], v[184:187], a[68:71], v[100:103]
    ds_read_b64_tr_b16 v[172:173], v69 offset:40960
    ds_read_b64_tr_b16 v[174:175], v69 offset:41472
    v_mfma_f32_16x16x32_bf16 v[104:107], v[188:191], a[64:67], v[104:107]
    ds_read_b64_tr_b16 v[176:177], v70 offset:40960
    ds_read_b64_tr_b16 v[178:179], v70 offset:41472
    v_mfma_f32_16x16x32_bf16 v[108:111], v[188:191], a[68:71], v[108:111]
    v_mul_f32 v36, v225, v36
    v_mul_f32 v37, v225, v37
    s_waitcnt lgkmcnt(6)
    v_mfma_f32_16x16x32_bf16 v[112:115], v[192:195], a[64:67], v[112:115]
    buffer_load_dwordx4 v201, s[4:7], s48 offen offset:1024 lds
    v_mfma_f32_16x16x32_bf16 v[116:119], v[192:195], a[68:71], v[116:119]
    ds_read_b64_tr_b16 v[180:181], v71 offset:40960
    ds_read_b64_tr_b16 v[182:183], v71 offset:41472
    v_mfma_f32_16x16x32_bf16 a[252:255], v[148:151], v[192:195], a[252:255]
    v_mul_f32 v38, v225, v38
    v_mul_f32 v39, v225, v39
    v_mfma_f32_16x16x32_bf16 v[120:123], v[196:199], a[64:67], v[120:123]
    ds_read_b64_tr_b16 v[184:185], v68 offset:43008
    ds_read_b64_tr_b16 v[186:187], v68 offset:43520
    v_mfma_f32_16x16x32_bf16 v[124:127], v[196:199], a[68:71], v[124:127]
    v_permlane16_swap_b32 v232, v234
    v_permlane16_swap_b32 v233, v235
    v_mfma_f32_16x16x32_bf16 v[128:131], v[160:163], a[64:67], v[128:131]
    buffer_load_dwordx4 v200, s[8:11], s48 offen offset:2048 lds
    v_mfma_f32_16x16x32_bf16 v[132:135], v[160:163], a[68:71], v[132:135]
    ds_read_b64_tr_b16 v[188:189], v69 offset:43008
    ds_read_b64_tr_b16 v[190:191], v69 offset:43520
    v_mfma_f32_16x16x32_bf16 v[136:139], v[164:167], a[64:67], v[136:139]
    ds_read_b64_tr_b16 v[192:193], v70 offset:43008
    ds_read_b64_tr_b16 v[194:195], v70 offset:43520
    v_mfma_f32_16x16x32_bf16 v[140:143], v[164:167], a[68:71], v[140:143]
    buffer_store_dwordx4 v[232:235], v152, s[20:23], s73 offen offset:0 sc1
    s_waitcnt lgkmcnt(6)
    v_mfma_f32_16x16x32_bf16 v[80:83], v[168:171], a[72:75], v[80:83]
    buffer_load_dwordx4 v201, s[8:11], s48 offen offset:3072 lds
    v_mfma_f32_16x16x32_bf16 v[84:87], v[168:171], a[76:79], v[84:87]
    ds_read_b64_tr_b16 v[196:197], v71 offset:43008
    ds_read_b64_tr_b16 v[198:199], v71 offset:43520
    v_mfma_f32_16x16x32_bf16 a[248:251], v[148:151], v[168:171], a[248:251]
    buffer_load_dword v146, v158, s[20:23], s37 offen sc1
    v_mfma_f32_16x16x32_bf16 v[88:91], v[172:175], a[72:75], v[88:91]
    ds_read_b64_tr_b16 v[160:161], v68 offset:49152
    ds_read_b64_tr_b16 v[162:163], v68 offset:49664
    v_mfma_f32_16x16x32_bf16 v[92:95], v[172:175], a[76:79], v[92:95]
    ds_read_b64_tr_b16 v[164:165], v69 offset:49152
    v_cvt_pk_bf16_f32 v236, v36, v37
    v_mfma_f32_16x16x32_bf16 v[96:99], v[176:179], a[72:75], v[96:99]
    ds_read_b64_tr_b16 v[166:167], v69 offset:49664
    ds_read_b64_tr_b16 v[168:169], v70 offset:49152
    v_mfma_f32_16x16x32_bf16 v[100:103], v[176:179], a[76:79], v[100:103]
    v_cvt_pk_bf16_f32 v237, v38, v39
    v_mul_f32 v44, v225, v44
    v_mfma_f32_16x16x32_bf16 v[104:107], v[180:183], a[72:75], v[104:107]
    ds_read_b64_tr_b16 v[170:171], v70 offset:49664
    ds_read_b64_tr_b16 v[172:173], v71 offset:49152
    v_mfma_f32_16x16x32_bf16 v[108:111], v[180:183], a[76:79], v[108:111]
    v_mul_f32 v45, v225, v45
    v_mul_f32 v46, v225, v46
    s_waitcnt lgkmcnt(7)
    v_mfma_f32_16x16x32_bf16 v[112:115], v[184:187], a[72:75], v[112:115]
    ds_read_b64_tr_b16 v[174:175], v71 offset:49664
    ds_read_b64_tr_b16 v[176:177], v68 offset:51200
    v_mfma_f32_16x16x32_bf16 v[116:119], v[184:187], a[76:79], v[116:119]
    v_mul_f32 v47, v225, v47
    v_cvt_pk_bf16_f32 v238, v44, v45
    v_mfma_f32_16x16x32_bf16 a[252:255], v[148:151], v[184:187], a[252:255]
    v_cvt_pk_bf16_f32 v239, v46, v47
    v_mul_f32 v48, v224, v48
    v_mfma_f32_16x16x32_bf16 v[120:123], v[188:191], a[72:75], v[120:123]
    ds_read_b64_tr_b16 v[178:179], v68 offset:51712
    ds_read_b64_tr_b16 v[180:181], v69 offset:51200
    v_mfma_f32_16x16x32_bf16 v[124:127], v[188:191], a[76:79], v[124:127]
    v_mul_f32 v49, v224, v49
    v_mul_f32 v50, v224, v50
    v_mfma_f32_16x16x32_bf16 v[128:131], v[192:195], a[72:75], v[128:131]
    ds_read_b64_tr_b16 v[182:183], v69 offset:51712
    ds_read_b64_tr_b16 v[184:185], v70 offset:51200
    v_mfma_f32_16x16x32_bf16 v[132:135], v[192:195], a[76:79], v[132:135]
    v_mul_f32 v51, v224, v51
    v_permlane16_swap_b32 v236, v238
    v_mfma_f32_16x16x32_bf16 v[136:139], v[196:199], a[72:75], v[136:139]
    ds_read_b64_tr_b16 v[186:187], v70 offset:51712
    ds_read_b64_tr_b16 v[188:189], v71 offset:51200
    v_mfma_f32_16x16x32_bf16 v[140:143], v[196:199], a[76:79], v[140:143]
    v_permlane16_swap_b32 v237, v239
    s_waitcnt lgkmcnt(7)
    v_mfma_f32_16x16x32_bf16 v[80:83], v[160:163], a[80:83], v[80:83]
    ds_read_b64_tr_b16 v[190:191], v71 offset:51712
    ds_read_b64_tr_b16 v[192:193], v68 offset:57344
    v_mfma_f32_16x16x32_bf16 v[84:87], v[160:163], a[84:87], v[84:87]
    ds_read_b64_tr_b16 v[194:195], v68 offset:57856
    v_mfma_f32_16x16x32_bf16 a[248:251], v[148:151], v[160:163], a[248:251]
    buffer_store_dwordx4 v[236:239], v152, s[20:23], s73 offen offset:256 sc1
    v_cvt_pk_bf16_f32 v232, v48, v49
    v_mfma_f32_16x16x32_bf16 v[88:91], v[164:167], a[80:83], v[88:91]
    ds_read_b64_tr_b16 v[196:197], v69 offset:57344
    ds_read_b64_tr_b16 v[198:199], v69 offset:57856
    v_mfma_f32_16x16x32_bf16 v[92:95], v[164:167], a[84:87], v[92:95]
    v_cvt_pk_bf16_f32 v233, v50, v51
    v_mul_f32 v56, v224, v56
    v_mfma_f32_16x16x32_bf16 v[96:99], v[168:171], a[80:83], v[96:99]
    ds_read_b64_tr_b16 v[160:161], v70 offset:57344
    ds_read_b64_tr_b16 v[162:163], v70 offset:57856
    v_mfma_f32_16x16x32_bf16 v[100:103], v[168:171], a[84:87], v[100:103]
    v_mul_f32 v57, v224, v57
    v_mul_f32 v58, v224, v58
    v_mfma_f32_16x16x32_bf16 v[104:107], v[172:175], a[80:83], v[104:107]
    ds_read_b64_tr_b16 v[164:165], v71 offset:57344
    ds_read_b64_tr_b16 v[166:167], v71 offset:57856
    v_mfma_f32_16x16x32_bf16 v[108:111], v[172:175], a[84:87], v[108:111]
    v_mul_f32 v59, v224, v59
    v_cvt_pk_bf16_f32 v234, v56, v57
    s_waitcnt lgkmcnt(8)
    v_mfma_f32_16x16x32_bf16 v[112:115], v[176:179], a[80:83], v[112:115]
    ds_read_b64_tr_b16 v[168:169], v68 offset:59392
    ds_read_b64_tr_b16 v[170:171], v68 offset:59904
    v_mfma_f32_16x16x32_bf16 v[116:119], v[176:179], a[84:87], v[116:119]
    v_cvt_pk_bf16_f32 v235, v58, v59
    v_mul_f32 v52, v225, v52
    v_mfma_f32_16x16x32_bf16 a[252:255], v[148:151], v[176:179], a[252:255]
    v_mul_f32 v53, v225, v53
    v_mul_f32 v54, v225, v54
    v_mfma_f32_16x16x32_bf16 v[120:123], v[180:183], a[80:83], v[120:123]
    ds_read_b64_tr_b16 v[172:173], v69 offset:59392
    ds_read_b64_tr_b16 v[174:175], v69 offset:59904
    v_mfma_f32_16x16x32_bf16 v[124:127], v[180:183], a[84:87], v[124:127]
    v_mul_f32 v55, v225, v55
    v_permlane16_swap_b32 v232, v234
    v_mfma_f32_16x16x32_bf16 v[128:131], v[184:187], a[80:83], v[128:131]
    ds_read_b64_tr_b16 v[176:177], v70 offset:59392
    v_mfma_f32_16x16x32_bf16 v[132:135], v[184:187], a[84:87], v[132:135]
    ds_read_b64_tr_b16 v[178:179], v70 offset:59904
    v_permlane16_swap_b32 v233, v235
    v_mfma_f32_16x16x32_bf16 v[136:139], v[188:191], a[80:83], v[136:139]
    ds_read_b64_tr_b16 v[180:181], v71 offset:59392
    ds_read_b64_tr_b16 v[182:183], v71 offset:59904
    v_mfma_f32_16x16x32_bf16 v[140:143], v[188:191], a[84:87], v[140:143]
    buffer_store_dwordx4 v[232:235], v153, s[20:23], s73 offen offset:0 sc1
    s_waitcnt lgkmcnt(8)
    v_mfma_f32_16x16x32_bf16 v[80:83], v[192:195], a[88:91], v[80:83]
    v_cvt_pk_bf16_f32 v236, v52, v53
    v_cvt_pk_bf16_f32 v237, v54, v55
    v_mfma_f32_16x16x32_bf16 v[84:87], v[192:195], a[92:95], v[84:87]
    v_mul_f32 v60, v225, v60
    v_mul_f32 v61, v225, v61
    v_mfma_f32_16x16x32_bf16 a[248:251], v[148:151], v[192:195], a[248:251]
    v_mul_f32 v62, v225, v62
    v_mul_f32 v63, v225, v63
    v_mfma_f32_16x16x32_bf16 v[88:91], v[196:199], a[88:91], v[88:91]
    v_mfma_f32_16x16x32_bf16 v[92:95], v[196:199], a[92:95], v[92:95]
    s_waitcnt vmcnt(25) lgkmcnt(0)
    s_barrier
    s_add_u32 m0, s66, 98304
    v_mfma_f32_16x16x32_bf16 v[96:99], v[160:163], a[88:91], v[96:99]
    buffer_load_dwordx4 v200, s[4:7], s51 offen offset:0 lds
    ds_read_b64_tr_b16 v[184:185], v68 offset:0
    v_mfma_f32_16x16x32_bf16 v[100:103], v[160:163], a[92:95], v[100:103]
    ds_read_b64_tr_b16 v[186:187], v68 offset:512
    ds_read_b64_tr_b16 v[188:189], v69 offset:0
    v_mfma_f32_16x16x32_bf16 v[104:107], v[164:167], a[88:91], v[104:107]
    ds_read_b64_tr_b16 v[190:191], v69 offset:512
    ds_read_b64_tr_b16 v[192:193], v70 offset:0
    v_mfma_f32_16x16x32_bf16 v[108:111], v[164:167], a[92:95], v[108:111]
    v_cvt_pk_bf16_f32 v238, v60, v61
    v_mfma_f32_16x16x32_bf16 v[112:115], v[168:171], a[88:91], v[112:115]
    buffer_load_dwordx4 v201, s[4:7], s51 offen offset:1024 lds
    v_mfma_f32_16x16x32_bf16 v[116:119], v[168:171], a[92:95], v[116:119]
    ds_read_b64_tr_b16 v[194:195], v70 offset:512
    ds_read_b64_tr_b16 v[196:197], v71 offset:0
    v_mfma_f32_16x16x32_bf16 a[252:255], v[148:151], v[168:171], a[252:255]
    v_cvt_pk_bf16_f32 v239, v62, v63
    v_permlane16_swap_b32 v236, v238
    v_mfma_f32_16x16x32_bf16 v[120:123], v[172:175], a[88:91], v[120:123]
    ds_read_b64_tr_b16 v[198:199], v71 offset:512
    v_mfma_f32_16x16x32_bf16 v[124:127], v[172:175], a[92:95], v[124:127]
    ds_read_b64_tr_b16 v[160:161], v68 offset:2048
    v_permlane16_swap_b32 v237, v239
    v_mfma_f32_16x16x32_bf16 v[128:131], v[176:179], a[88:91], v[128:131]
    buffer_load_dwordx4 v200, s[8:11], s51 offen offset:2048 lds
    v_mfma_f32_16x16x32_bf16 v[132:135], v[176:179], a[92:95], v[132:135]
    ds_read_b64_tr_b16 v[162:163], v68 offset:2560
    ds_read_b64_tr_b16 v[164:165], v69 offset:2048
    v_mfma_f32_16x16x32_bf16 v[136:139], v[180:183], a[88:91], v[136:139]
    ds_read_b64_tr_b16 v[166:167], v69 offset:2560
    ds_read_b64_tr_b16 v[168:169], v70 offset:2048
    v_mfma_f32_16x16x32_bf16 v[140:143], v[180:183], a[92:95], v[140:143]
    buffer_store_dwordx4 v[236:239], v153, s[20:23], s73 offen offset:256 sc1
    s_waitcnt lgkmcnt(5)
    v_mfma_f32_16x16x32_bf16 v[80:83], v[184:187], a[96:99], v[80:83]
    buffer_load_dwordx4 v201, s[8:11], s51 offen offset:3072 lds
    v_mfma_f32_16x16x32_bf16 v[84:87], v[184:187], a[100:103], v[84:87]
    ds_read_b64_tr_b16 v[170:171], v70 offset:2560
    v_mfma_f32_16x16x32_bf16 a[248:251], v[148:151], v[184:187], a[248:251]
    ds_read_b64_tr_b16 v[172:173], v71 offset:2048
    v_mfma_f32_16x16x32_bf16 v[88:91], v[188:191], a[96:99], v[88:91]
    ds_read_b64_tr_b16 v[174:175], v71 offset:2560
    ds_read_b64_tr_b16 v[176:177], v68 offset:8192
    v_mfma_f32_16x16x32_bf16 v[92:95], v[188:191], a[100:103], v[92:95]
    ds_read_b64_tr_b16 v[178:179], v68 offset:8704
    s_add_u32 m0, s66, 114688
    v_mfma_f32_16x16x32_bf16 v[96:99], v[192:195], a[96:99], v[96:99]
    buffer_load_dwordx4 v200, s[4:7], s52 offen offset:0 lds
    v_mfma_f32_16x16x32_bf16 v[100:103], v[192:195], a[100:103], v[100:103]
    ds_read_b64_tr_b16 v[180:181], v69 offset:8192
    ds_read_b64_tr_b16 v[182:183], v69 offset:8704
    v_mfma_f32_16x16x32_bf16 v[104:107], v[196:199], a[96:99], v[104:107]
    ds_read_b64_tr_b16 v[184:185], v70 offset:8192
    v_mfma_f32_16x16x32_bf16 v[108:111], v[196:199], a[100:103], v[108:111]
    ds_read_b64_tr_b16 v[186:187], v70 offset:8704
    s_waitcnt lgkmcnt(6)
    v_mfma_f32_16x16x32_bf16 v[112:115], v[160:163], a[96:99], v[112:115]
    buffer_load_dwordx4 v201, s[4:7], s52 offen offset:1024 lds
    v_mfma_f32_16x16x32_bf16 v[116:119], v[160:163], a[100:103], v[116:119]
    ds_read_b64_tr_b16 v[188:189], v71 offset:8192
    ds_read_b64_tr_b16 v[190:191], v71 offset:8704
    v_mfma_f32_16x16x32_bf16 a[252:255], v[148:151], v[160:163], a[252:255]
    s_waitcnt vmcnt(9)
    v_cmp_ne_u32 vcc, v146, v145
    s_nop 3
    s_cmp_eq_u64 vcc, 0
    s_cselect_b32 s101, s101, 1073741824
    s_cselect_b32 s75, s75, 1073741824
    s_cselect_b32 s0, s0, 1073741824
    v_mfma_f32_16x16x32_bf16 v[120:123], v[164:167], a[96:99], v[120:123]
    ds_read_b64_tr_b16 v[192:193], v68 offset:10240
    v_mfma_f32_16x16x32_bf16 v[124:127], v[164:167], a[100:103], v[124:127]
    ds_read_b64_tr_b16 v[194:195], v68 offset:10752
    v_mfma_f32_16x16x32_bf16 v[128:131], v[168:171], a[96:99], v[128:131]
    buffer_load_dwordx4 v200, s[8:11], s52 offen offset:2048 lds
    v_mfma_f32_16x16x32_bf16 v[132:135], v[168:171], a[100:103], v[132:135]
    ds_read_b64_tr_b16 v[196:197], v69 offset:10240
    ds_read_b64_tr_b16 v[198:199], v69 offset:10752
    v_mfma_f32_16x16x32_bf16 v[136:139], v[172:175], a[96:99], v[136:139]
    ds_read_b64_tr_b16 v[160:161], v70 offset:10240
    v_mfma_f32_16x16x32_bf16 v[140:143], v[172:175], a[100:103], v[140:143]
    ds_read_b64_tr_b16 v[162:163], v70 offset:10752
    s_waitcnt lgkmcnt(6)
    v_mfma_f32_16x16x32_bf16 v[80:83], v[176:179], a[104:107], v[80:83]
    buffer_load_dwordx4 v201, s[8:11], s52 offen offset:3072 lds
    v_mfma_f32_16x16x32_bf16 v[84:87], v[176:179], a[108:111], v[84:87]
    ds_read_b64_tr_b16 v[164:165], v71 offset:10240
    v_mfma_f32_16x16x32_bf16 a[248:251], v[148:151], v[176:179], a[248:251]
    ds_read_b64_tr_b16 v[166:167], v71 offset:10752
    s_add_u32 s100, s75, 0
    v_mfma_f32_16x16x32_bf16 v[88:91], v[180:183], a[104:107], v[88:91]
    buffer_load_dwordx4 a[160:163], v209, s[20:23], s100 offen offset:0 sc1
    ds_read_b64_tr_b16 v[168:169], v68 offset:16384
    v_mfma_f32_16x16x32_bf16 v[92:95], v[180:183], a[108:111], v[92:95]
    ds_read_b64_tr_b16 v[170:171], v68 offset:16896
    ds_read_b64_tr_b16 v[172:173], v69 offset:16384
    v_mfma_f32_16x16x32_bf16 v[96:99], v[184:187], a[104:107], v[96:99]
    ds_read_b64_tr_b16 v[174:175], v69 offset:16896
    v_mfma_f32_16x16x32_bf16 v[100:103], v[184:187], a[108:111], v[100:103]
    ds_read_b64_tr_b16 v[176:177], v70 offset:16384
    v_mfma_f32_16x16x32_bf16 v[104:107], v[188:191], a[104:107], v[104:107]
    ds_read_b64_tr_b16 v[178:179], v70 offset:16896
    v_mfma_f32_16x16x32_bf16 v[108:111], v[188:191], a[108:111], v[108:111]
    ds_read_b64_tr_b16 v[180:181], v71 offset:16384
    s_waitcnt lgkmcnt(7)
    v_mfma_f32_16x16x32_bf16 v[112:115], v[192:195], a[104:107], v[112:115]
    buffer_load_dwordx4 a[164:167], v209, s[20:23], s100 offen offset:1024 sc1
    v_mfma_f32_16x16x32_bf16 v[116:119], v[192:195], a[108:111], v[116:119]
    ds_read_b64_tr_b16 v[182:183], v71 offset:16896
    v_mfma_f32_16x16x32_bf16 a[252:255], v[148:151], v[192:195], a[252:255]
    ds_read_b64_tr_b16 v[184:185], v68 offset:18432
    v_mfma_f32_16x16x32_bf16 v[120:123], v[196:199], a[104:107], v[120:123]
    ds_read_b64_tr_b16 v[186:187], v68 offset:18944
    v_mfma_f32_16x16x32_bf16 v[124:127], v[196:199], a[108:111], v[124:127]
    ds_read_b64_tr_b16 v[188:189], v69 offset:18432
    v_mfma_f32_16x16x32_bf16 v[128:131], v[160:163], a[104:107], v[128:131]
    ds_read_b64_tr_b16 v[190:191], v69 offset:18944
    v_mfma_f32_16x16x32_bf16 v[132:135], v[160:163], a[108:111], v[132:135]
    ds_read_b64_tr_b16 v[192:193], v70 offset:18432
    v_mfma_f32_16x16x32_bf16 v[136:139], v[164:167], a[104:107], v[136:139]
    buffer_load_dwordx4 a[168:171], v209, s[20:23], s100 offen offset:2048 sc1
    v_mfma_f32_16x16x32_bf16 v[140:143], v[164:167], a[108:111], v[140:143]
    ds_read_b64_tr_b16 v[194:195], v70 offset:18944
    ds_read_b64_tr_b16 v[196:197], v71 offset:18432
    s_waitcnt lgkmcnt(7)
    v_mfma_f32_16x16x32_bf16 v[80:83], v[168:171], a[112:115], v[80:83]
    ds_read_b64_tr_b16 v[198:199], v71 offset:18944
    v_mfma_f32_16x16x32_bf16 v[84:87], v[168:171], a[116:119], v[84:87]
    ds_read_b64_tr_b16 v[160:161], v68 offset:24576
    v_mfma_f32_16x16x32_bf16 a[248:251], v[148:151], v[168:171], a[248:251]
    ds_read_b64_tr_b16 v[162:163], v68 offset:25088
    v_mfma_f32_16x16x32_bf16 v[88:91], v[172:175], a[112:115], v[88:91]
    ds_read_b64_tr_b16 v[164:165], v69 offset:24576
    v_mfma_f32_16x16x32_bf16 v[92:95], v[172:175], a[116:119], v[92:95]
    ds_read_b64_tr_b16 v[166:167], v69 offset:25088
    v_mfma_f32_16x16x32_bf16 v[96:99], v[176:179], a[112:115], v[96:99]
    buffer_load_dwordx4 a[172:175], v209, s[20:23], s100 offen offset:3072 sc1
    v_mfma_f32_16x16x32_bf16 v[100:103], v[176:179], a[116:119], v[100:103]
    ds_read_b64_tr_b16 v[168:169], v70 offset:24576
    ds_read_b64_tr_b16 v[170:171], v70 offset:25088
    v_mfma_f32_16x16x32_bf16 v[104:107], v[180:183], a[112:115], v[104:107]
    ds_read_b64_tr_b16 v[172:173], v71 offset:24576
    v_mfma_f32_16x16x32_bf16 v[108:111], v[180:183], a[116:119], v[108:111]
    ds_read_b64_tr_b16 v[174:175], v71 offset:25088
    s_waitcnt lgkmcnt(8)
    v_mfma_f32_16x16x32_bf16 v[112:115], v[184:187], a[112:115], v[112:115]
    ds_read_b64_tr_b16 v[176:177], v68 offset:26624
    v_mfma_f32_16x16x32_bf16 v[116:119], v[184:187], a[116:119], v[116:119]
    v_mfma_f32_16x16x32_bf16 a[252:255], v[148:151], v[184:187], a[252:255]
    ds_read_b64_tr_b16 v[178:179], v68 offset:27136
    v_mfma_f32_16x16x32_bf16 v[120:123], v[188:191], a[112:115], v[120:123]
    buffer_load_dwordx4 a[176:179], v159, s[20:23], s100 offen offset:0 sc1
    v_mfma_f32_16x16x32_bf16 v[124:127], v[188:191], a[116:119], v[124:127]
    ds_read_b64_tr_b16 v[180:181], v69 offset:26624
    ds_read_b64_tr_b16 v[182:183], v69 offset:27136
    v_mfma_f32_16x16x32_bf16 v[128:131], v[192:195], a[112:115], v[128:131]
    ds_read_b64_tr_b16 v[184:185], v70 offset:26624
    v_mfma_f32_16x16x32_bf16 v[132:135], v[192:195], a[116:119], v[132:135]
    ds_read_b64_tr_b16 v[186:187], v70 offset:27136
    v_mfma_f32_16x16x32_bf16 v[136:139], v[196:199], a[112:115], v[136:139]
    ds_read_b64_tr_b16 v[188:189], v71 offset:26624
    ds_read_b64_tr_b16 v[190:191], v71 offset:27136
    v_mfma_f32_16x16x32_bf16 v[140:143], v[196:199], a[116:119], v[140:143]
    s_add_u32 s100, s75, 5120
    s_waitcnt lgkmcnt(8)
    v_mfma_f32_16x16x32_bf16 v[80:83], v[160:163], a[120:123], v[80:83]
    v_mfma_f32_16x16x32_bf16 v[84:87], v[160:163], a[124:127], v[84:87]
    buffer_load_dwordx4 a[180:183], v209, s[20:23], s100 offen offset:0 sc1
    v_mfma_f32_16x16x32_bf16 a[248:251], v[148:151], v[160:163], a[248:251]
    v_mfma_f32_16x16x32_bf16 v[88:91], v[164:167], a[120:123], v[88:91]
    v_mfma_f32_16x16x32_bf16 v[92:95], v[164:167], a[124:127], v[92:95]
    s_waitcnt lgkmcnt(0)
    s_barrier
    s_add_u32 m0, s66, 65536
    v_mfma_f32_16x16x32_bf16 v[96:99], v[168:171], a[120:123], v[96:99]
    buffer_load_dwordx4 v200, s[4:7], s55 offen offset:0 lds
    ds_read_b64_tr_b16 v[192:193], v64 offset:32768
    v_mfma_f32_16x16x32_bf16 v[100:103], v[168:171], a[124:127], v[100:103]
    ds_read_b64_tr_b16 v[194:195], v64 offset:33280
    ds_read_b64_tr_b16 v[196:197], v64 offset:34816
    v_mfma_f32_16x16x32_bf16 v[104:107], v[172:175], a[120:123], v[104:107]
    buffer_load_dwordx4 a[184:187], v209, s[20:23], s100 offen offset:1024 sc1
    v_mfma_f32_16x16x32_bf16 v[108:111], v[172:175], a[124:127], v[108:111]
    ds_read_b64_tr_b16 v[198:199], v64 offset:35328
    ds_read_b64_tr_b16 v[160:161], v64 offset:40960
    v_mfma_f32_16x16x32_bf16 v[112:115], v[176:179], a[120:123], v[112:115]
    buffer_load_dwordx4 v201, s[4:7], s55 offen offset:1024 lds
    v_mfma_f32_16x16x32_bf16 v[116:119], v[176:179], a[124:127], v[116:119]
    ds_read_b64_tr_b16 v[162:163], v64 offset:41472
    v_mfma_f32_16x16x32_bf16 a[252:255], v[148:151], v[176:179], a[252:255]
    ds_read_b64_tr_b16 v[164:165], v64 offset:43008
    v_mfma_f32_16x16x32_bf16 v[120:123], v[180:183], a[120:123], v[120:123]
    ds_read_b64_tr_b16 v[166:167], v64 offset:43520
    v_mfma_f32_16x16x32_bf16 v[124:127], v[180:183], a[124:127], v[124:127]
    ds_read_b64_tr_b16 v[168:169], v64 offset:49152
    v_mfma_f32_16x16x32_bf16 v[128:131], v[184:187], a[120:123], v[128:131]
    buffer_load_dwordx4 v200, s[8:11], s55 offen offset:2048 lds
    v_mfma_f32_16x16x32_bf16 v[132:135], v[184:187], a[124:127], v[132:135]
    ds_read_b64_tr_b16 v[170:171], v64 offset:49664
    ds_read_b64_tr_b16 v[172:173], v64 offset:51200
    v_mfma_f32_16x16x32_bf16 v[136:139], v[188:191], a[120:123], v[136:139]
    buffer_load_dwordx4 a[188:191], v209, s[20:23], s100 offen offset:2048 sc1
    v_mfma_f32_16x16x32_bf16 v[140:143], v[188:191], a[124:127], v[140:143]
    ds_read_b64_tr_b16 v[174:175], v64 offset:51712
    ds_read_b64_tr_b16 v[176:177], v64 offset:57344
    s_waitcnt lgkmcnt(5)
    v_mfma_f32_16x16x32_bf16 v[80:83], v[192:195], a[128:131], v[80:83]
    buffer_load_dwordx4 v201, s[8:11], s55 offen offset:3072 lds
    v_mfma_f32_16x16x32_bf16 v[84:87], v[192:195], a[132:135], v[84:87]
    ds_read_b64_tr_b16 v[178:179], v64 offset:57856
    v_mfma_f32_16x16x32_bf16 a[248:251], v[148:151], v[192:195], a[248:251]
    ds_read_b64_tr_b16 v[180:181], v64 offset:59392
    v_mfma_f32_16x16x32_bf16 v[112:115], v[196:199], a[128:131], v[112:115]
    ds_read_b64_tr_b16 v[182:183], v64 offset:59904
    v_mfma_f32_16x16x32_bf16 v[116:119], v[196:199], a[132:135], v[116:119]
    ds_read_b64_tr_b16 v[184:185], v65 offset:32768
    ds_read_b64_tr_b16 v[186:187], v65 offset:33280
    v_mfma_f32_16x16x32_bf16 a[252:255], v[148:151], v[196:199], a[252:255]
    s_add_u32 m0, s66, 81920
    v_mfma_f32_16x16x32_bf16 v[80:83], v[160:163], a[136:139], v[80:83]
    buffer_load_dwordx4 v200, s[4:7], s56 offen offset:0 lds
    v_mfma_f32_16x16x32_bf16 v[84:87], v[160:163], a[140:143], v[84:87]
    ds_read_b64_tr_b16 v[188:189], v66 offset:32768
    v_mfma_f32_16x16x32_bf16 a[248:251], v[148:151], v[160:163], a[248:251]
    ds_read_b64_tr_b16 v[190:191], v66 offset:33280
    v_mfma_f32_16x16x32_bf16 v[112:115], v[164:167], a[136:139], v[112:115]
    buffer_load_dwordx4 a[192:195], v209, s[20:23], s100 offen offset:3072 sc1
    v_mfma_f32_16x16x32_bf16 v[116:119], v[164:167], a[140:143], v[116:119]
    ds_read_b64_tr_b16 v[192:193], v67 offset:32768
    v_mfma_f32_16x16x32_bf16 a[252:255], v[148:151], v[164:167], a[252:255]
    ds_read_b64_tr_b16 v[194:195], v67 offset:33280
    s_waitcnt lgkmcnt(6)
    v_mfma_f32_16x16x32_bf16 v[80:83], v[168:171], a[144:147], v[80:83]
    buffer_load_dwordx4 v201, s[4:7], s56 offen offset:1024 lds
    v_mfma_f32_16x16x32_bf16 v[84:87], v[168:171], a[148:151], v[84:87]
    ds_read_b64_tr_b16 v[196:197], v65 offset:34816
    v_mfma_f32_16x16x32_bf16 a[248:251], v[148:151], v[168:171], a[248:251]
    ds_read_b64_tr_b16 v[198:199], v65 offset:35328
    v_mfma_f32_16x16x32_bf16 v[112:115], v[172:175], a[144:147], v[112:115]
    ds_read_b64_tr_b16 v[160:161], v66 offset:34816
    v_mfma_f32_16x16x32_bf16 v[116:119], v[172:175], a[148:151], v[116:119]
    v_mfma_f32_16x16x32_bf16 a[252:255], v[148:151], v[172:175], a[252:255]
    ds_read_b64_tr_b16 v[162:163], v66 offset:35328
    v_mfma_f32_16x16x32_bf16 v[80:83], v[176:179], a[152:155], v[80:83]
    buffer_load_dwordx4 v200, s[8:11], s56 offen offset:2048 lds
    v_mfma_f32_16x16x32_bf16 v[84:87], v[176:179], a[156:159], v[84:87]
    ds_read_b64_tr_b16 v[164:165], v67 offset:34816
    v_mfma_f32_16x16x32_bf16 a[248:251], v[148:151], v[176:179], a[248:251]
    ds_read_b64_tr_b16 v[166:167], v67 offset:35328
    v_mfma_f32_16x16x32_bf16 v[112:115], v[180:183], a[152:155], v[112:115]
    buffer_load_dwordx4 a[196:199], v159, s[20:23], s100 offen offset:0 sc1
    v_mfma_f32_16x16x32_bf16 v[116:119], v[180:183], a[156:159], v[116:119]
    ds_read_b64_tr_b16 v[168:169], v65 offset:40960
    v_mfma_f32_16x16x32_bf16 a[252:255], v[148:151], v[180:183], a[252:255]
    ds_read_b64_tr_b16 v[170:171], v65 offset:41472
    s_waitcnt lgkmcnt(6)
    v_mfma_f32_16x16x32_bf16 v[88:91], v[184:187], a[128:131], v[88:91]
    buffer_load_dwordx4 v201, s[8:11], s56 offen offset:3072 lds
    v_mfma_f32_16x16x32_bf16 v[92:95], v[184:187], a[132:135], v[92:95]
    ds_read_b64_tr_b16 v[172:173], v66 offset:40960
    ds_read_b64_tr_b16 v[174:175], v66 offset:41472
    v_mfma_f32_16x16x32_bf16 v[96:99], v[188:191], a[128:131], v[96:99]
    ds_read_b64_tr_b16 v[176:177], v67 offset:40960
    ds_read_b64_tr_b16 v[178:179], v67 offset:41472
    v_mfma_f32_16x16x32_bf16 v[100:103], v[188:191], a[132:135], v[100:103]
    ds_read_b64_tr_b16 v[180:181], v65 offset:43008
    s_add_u32 s100, s75, 10240
    v_mfma_f32_16x16x32_bf16 v[104:107], v[192:195], a[128:131], v[104:107]
    buffer_load_dwordx4 a[200:203], v209, s[20:23], s100 offen offset:0 sc1
    ds_read_b64_tr_b16 v[182:183], v65 offset:43520
    v_mfma_f32_16x16x32_bf16 v[108:111], v[192:195], a[132:135], v[108:111]
    ds_read_b64_tr_b16 v[184:185], v66 offset:43008
    v_accvgpr_read_b32 v240, a248
    v_mfma_f32_16x16x32_bf16 v[120:123], v[196:199], a[128:131], v[120:123]
    ds_read_b64_tr_b16 v[186:187], v66 offset:43520
    ds_read_b64_tr_b16 v[188:189], v67 offset:43008
    v_mfma_f32_16x16x32_bf16 v[124:127], v[196:199], a[132:135], v[124:127]
    v_accvgpr_read_b32 v241, a252
    v_xor_b32 v244, 8, v156
    s_waitcnt lgkmcnt(7)
    v_mfma_f32_16x16x32_bf16 v[128:131], v[160:163], a[128:131], v[128:131]
    ds_read_b64_tr_b16 v[190:191], v67 offset:43520
    ds_read_b64_tr_b16 v[192:193], v65 offset:49152
    v_mfma_f32_16x16x32_bf16 v[132:135], v[160:163], a[132:135], v[132:135]
    v_xor_b32 v245, 16, v156
    v_xor_b32 v246, 24, v156
    v_and_b32 v242, 0xffff0000, v240
    v_mfma_f32_16x16x32_bf16 v[136:139], v[164:167], a[128:131], v[136:139]
    buffer_load_dwordx4 a[204:207], v209, s[20:23], s100 offen offset:1024 sc1
    ds_read_b64_tr_b16 v[194:195], v65 offset:49664
    v_mfma_f32_16x16x32_bf16 v[140:143], v[164:167], a[132:135], v[140:143]
    ds_read_b64_tr_b16 v[196:197], v66 offset:49152
    v_sub_f32 v240, v240, v242
    v_mfma_f32_16x16x32_bf16 v[88:91], v[168:171], a[136:139], v[88:91]
    ds_read_b64_tr_b16 v[198:199], v66 offset:49664
    ds_read_b64_tr_b16 v[160:161], v67 offset:49152
    v_mfma_f32_16x16x32_bf16 v[92:95], v[168:171], a[140:143], v[92:95]
    v_cvt_pk_bf16_f32 v240, v242, v240
    v_and_b32 v243, 0xffff0000, v241
    v_mfma_f32_16x16x32_bf16 v[96:99], v[172:175], a[136:139], v[96:99]
    ds_read_b64_tr_b16 v[162:163], v67 offset:49664
    ds_read_b64_tr_b16 v[164:165], v65 offset:51200
    v_mfma_f32_16x16x32_bf16 v[100:103], v[172:175], a[140:143], v[100:103]
    v_sub_f32 v241, v241, v243
    v_cvt_pk_bf16_f32 v241, v243, v241
    s_waitcnt lgkmcnt(7)
    v_mfma_f32_16x16x32_bf16 v[104:107], v[176:179], a[136:139], v[104:107]
    buffer_load_dwordx4 a[208:211], v209, s[20:23], s100 offen offset:2048 sc1
    ds_read_b64_tr_b16 v[166:167], v65 offset:51712
    v_mfma_f32_16x16x32_bf16 v[108:111], v[176:179], a[140:143], v[108:111]
    ds_read_b64_tr_b16 v[168:169], v66 offset:51200
    ds_read_b64_tr_b16 v[170:171], v66 offset:51712
    v_mfma_f32_16x16x32_bf16 v[120:123], v[180:183], a[136:139], v[120:123]
    ds_read_b64_tr_b16 v[172:173], v67 offset:51200
    ds_read_b64_tr_b16 v[174:175], v67 offset:51712
    v_mfma_f32_16x16x32_bf16 v[124:127], v[180:183], a[140:143], v[124:127]
    ds_write_b64 v156, v[240:241] offset:0
    v_mfma_f32_16x16x32_bf16 v[128:131], v[184:187], a[136:139], v[128:131]
    ds_read_b64_tr_b16 v[176:177], v65 offset:57344
    ds_read_b64_tr_b16 v[178:179], v65 offset:57856
    v_mfma_f32_16x16x32_bf16 v[132:135], v[184:187], a[140:143], v[132:135]
    ds_write_b64 v244, v[240:241] offset:2048
    v_mfma_f32_16x16x32_bf16 v[136:139], v[188:191], a[136:139], v[136:139]
    buffer_load_dwordx4 a[212:215], v209, s[20:23], s100 offen offset:3072 sc1
    v_mfma_f32_16x16x32_bf16 v[140:143], v[188:191], a[140:143], v[140:143]
    ds_read_b64_tr_b16 v[180:181], v66 offset:57344
    ds_read_b64_tr_b16 v[182:183], v66 offset:57856
    s_waitcnt lgkmcnt(10)
    v_mfma_f32_16x16x32_bf16 v[88:91], v[192:195], a[144:147], v[88:91]
    ds_read_b64_tr_b16 v[184:185], v67 offset:57344
    ds_read_b64_tr_b16 v[186:187], v67 offset:57856
    v_mfma_f32_16x16x32_bf16 v[92:95], v[192:195], a[148:151], v[92:95]
    ds_write_b64 v245, v[240:241] offset:4096
    v_mfma_f32_16x16x32_bf16 v[96:99], v[196:199], a[144:147], v[96:99]
    ds_read_b64_tr_b16 v[188:189], v65 offset:59392
    ds_read_b64_tr_b16 v[190:191], v65 offset:59904
    v_mfma_f32_16x16x32_bf16 v[100:103], v[196:199], a[148:151], v[100:103]
    ds_write_b64 v246, v[240:241] offset:6144
    v_mfma_f32_16x16x32_bf16 v[104:107], v[160:163], a[144:147], v[104:107]
    buffer_load_dwordx4 a[216:219], v159, s[20:23], s100 offen offset:0 sc1
    v_mfma_f32_16x16x32_bf16 v[108:111], v[160:163], a[148:151], v[108:111]
    ds_read_b64_tr_b16 v[192:193], v66 offset:59392
    ds_read_b64_tr_b16 v[194:195], v66 offset:59904
    v_mfma_f32_16x16x32_bf16 v[120:123], v[164:167], a[144:147], v[120:123]
    ds_read_b64_tr_b16 v[196:197], v67 offset:59392
    v_mfma_f32_16x16x32_bf16 v[124:127], v[164:167], a[148:151], v[124:127]
    ds_read_b64_tr_b16 v[198:199], v67 offset:59904
    s_waitcnt lgkmcnt(10)
    v_mfma_f32_16x16x32_bf16 v[128:131], v[168:171], a[144:147], v[128:131]
    v_mfma_f32_16x16x32_bf16 v[132:135], v[168:171], a[148:151], v[132:135]
    v_mfma_f32_16x16x32_bf16 v[136:139], v[172:175], a[144:147], v[136:139]
    v_mfma_f32_16x16x32_bf16 v[140:143], v[172:175], a[148:151], v[140:143]
    s_waitcnt lgkmcnt(0)
    s_barrier
    s_add_u32 m0, s66, 32768
    v_mfma_f32_16x16x32_bf16 v[88:91], v[176:179], a[152:155], v[88:91]
    buffer_load_dwordx4 v200, s[4:7], s41 offen offset:0 lds
    ds_read_b64_tr_b16 v[160:161], v64 offset:0
    ds_read_b64_tr_b16 v[162:163], v64 offset:512
    v_mfma_f32_16x16x32_bf16 v[92:95], v[176:179], a[156:159], v[92:95]
    ds_read_b64_tr_b16 v[164:165], v65 offset:0
    ds_read_b128 v[240:243], v157 offset:0
    ds_read_b128 v[244:247], v157 offset:16
    s_add_u32 s100, s101, 25600
    v_mfma_f32_16x16x32_bf16 v[96:99], v[180:183], a[152:155], v[96:99]
    buffer_load_dwordx4 a[220:223], v209, s[20:23], s100 offen offset:0 sc1
    ds_read_b64_tr_b16 v[166:167], v65 offset:512
    v_mfma_f32_16x16x32_bf16 v[100:103], v[180:183], a[156:159], v[100:103]
    ds_read_b64_tr_b16 v[168:169], v66 offset:0
    s_waitcnt vmcnt(30)
    buffer_store_dword v145, v144, s[20:23], s74 offen sc1
    v_mfma_f32_16x16x32_bf16 v[104:107], v[184:187], a[152:155], v[104:107]
    buffer_load_dwordx4 v201, s[4:7], s41 offen offset:1024 lds
    v_mfma_f32_16x16x32_bf16 v[108:111], v[184:187], a[156:159], v[108:111]
    ds_read_b64_tr_b16 v[170:171], v66 offset:512
    ds_read_b64_tr_b16 v[172:173], v67 offset:0
    v_mfma_f32_16x16x32_bf16 v[120:123], v[188:191], a[152:155], v[120:123]
    ds_read_b64_tr_b16 v[174:175], v67 offset:512
    v_mfma_f32_16x16x32_bf16 v[124:127], v[188:191], a[156:159], v[124:127]
    ds_read_b64_tr_b16 v[176:177], v64 offset:2048
    s_waitcnt lgkmcnt(6)
    v_mfma_f32_16x16x16_bf16 v[80:83], v[240:241], v[248:249], v[80:83]
    v_mfma_f32_16x16x16_bf16 v[112:115], v[240:241], v[250:251], v[112:115]
    v_mfma_f32_16x16x32_bf16 v[128:131], v[192:195], a[152:155], v[128:131]
    buffer_load_dwordx4 v200, s[8:11], s41 offen offset:2048 lds
    v_mfma_f32_16x16x32_bf16 v[132:135], v[192:195], a[156:159], v[132:135]
    ds_read_b64_tr_b16 v[178:179], v64 offset:2560
    ds_read_b64_tr_b16 v[180:181], v65 offset:2048
    v_mfma_f32_16x16x16_bf16 v[88:91], v[242:243], v[248:249], v[88:91]
    v_mfma_f32_16x16x16_bf16 v[120:123], v[242:243], v[250:251], v[120:123]
    v_mfma_f32_16x16x32_bf16 v[136:139], v[196:199], a[152:155], v[136:139]
    buffer_load_dwordx4 a[224:227], v209, s[20:23], s100 offen offset:1024 sc1
    v_mfma_f32_16x16x32_bf16 v[140:143], v[196:199], a[156:159], v[140:143]
    ds_read_b64_tr_b16 v[182:183], v65 offset:2560
    ds_read_b64_tr_b16 v[184:185], v66 offset:2048
    v_mfma_f32_16x16x16_bf16 v[84:87], v[240:241], v[252:253], v[84:87]
    v_mfma_f32_16x16x16_bf16 v[116:119], v[240:241], v[254:255], v[116:119]
    s_waitcnt lgkmcnt(5)
    v_mfma_f32_16x16x32_bf16 v[0:3], v[160:163], a[0:3], 0
    buffer_load_dwordx4 v201, s[8:11], s41 offen offset:3072 lds
    v_mfma_f32_16x16x32_bf16 v[4:7], v[160:163], a[4:7], 0
    ds_read_b64_tr_b16 v[186:187], v66 offset:2560
    v_mfma_f32_16x16x32_bf16 a[248:251], v[148:151], v[160:163], 0
    ds_read_b64_tr_b16 v[188:189], v67 offset:2048
    v_mfma_f32_16x16x32_bf16 v[8:11], v[164:167], a[0:3], 0
    ds_read_b64_tr_b16 v[190:191], v67 offset:2560
    ds_read_b64_tr_b16 v[192:193], v64 offset:8192
    ds_read_b64_tr_b16 v[194:195], v64 offset:8704
    v_mul_f32 v224, v80, v80
    v_mfma_f32_16x16x16_bf16 v[92:95], v[242:243], v[252:253], v[92:95]
    v_mul_f32 v225, v81, v81
    v_mfma_f32_16x16x32_bf16 v[12:15], v[164:167], a[4:7], 0
    v_mul_f32 v226, v82, v82
    v_mul_f32 v227, v83, v83
    v_mfma_f32_16x16x16_bf16 v[124:127], v[242:243], v[254:255], v[124:127]
    v_fma_f32 v224, v224, v217, v216
    v_fma_f32 v225, v225, v217, v216
    s_add_u32 m0, s66, 49152
    v_mfma_f32_16x16x32_bf16 v[16:19], v[168:171], a[0:3], 0
    buffer_load_dwordx4 v200, s[4:7], s42 offen offset:0 lds
    ds_read_b64_tr_b16 v[196:197], v65 offset:8192
    ds_read_b64_tr_b16 v[198:199], v65 offset:8704
    v_fma_f32 v226, v226, v217, v216
    v_mfma_f32_16x16x32_bf16 v[20:23], v[168:171], a[4:7], 0
    v_mfma_f32_16x16x16_bf16 v[96:99], v[244:245], v[248:249], v[96:99]
    v_fma_f32 v227, v227, v217, v216
    v_mul_f32 v224, v224, v80
    v_mul_f32 v225, v225, v81
    v_mfma_f32_16x16x16_bf16 v[128:131], v[244:245], v[250:251], v[128:131]
    v_mul_f32 v226, v226, v82
    v_mul_f32 v227, v227, v83
    v_mfma_f32_16x16x32_bf16 v[24:27], v[172:175], a[0:3], 0
    buffer_load_dwordx4 a[228:231], v209, s[20:23], s100 offen offset:2048 sc1
    ds_read_b64_tr_b16 v[160:161], v66 offset:8192
    ds_read_b64_tr_b16 v[162:163], v66 offset:8704
    v_mfma_f32_16x16x32_bf16 v[28:31], v[172:175], a[4:7], 0
    v_exp_f32 v224, v224
    v_mfma_f32_16x16x16_bf16 v[104:107], v[246:247], v[248:249], v[104:107]
    v_mul_f32 v112, v80, v112
    s_waitcnt lgkmcnt(6)
    v_mfma_f32_16x16x32_bf16 v[32:35], v[176:179], a[0:3], 0
    buffer_load_dwordx4 v201, s[4:7], s42 offen offset:1024 lds
    ds_read_b64_tr_b16 v[164:165], v67 offset:8192
    v_mfma_f32_16x16x32_bf16 v[36:39], v[176:179], a[4:7], 0
    ds_read_b64_tr_b16 v[166:167], v67 offset:8704
    v_exp_f32 v225, v225
    v_mul_f32 v113, v81, v113
    v_mfma_f32_16x16x32_bf16 a[252:255], v[148:151], v[176:179], 0
    v_mfma_f32_16x16x16_bf16 v[136:139], v[246:247], v[250:251], v[136:139]
    v_exp_f32 v226, v226
    v_mul_f32 v114, v82, v114
    v_mfma_f32_16x16x32_bf16 v[40:43], v[180:183], a[0:3], 0
    ds_read_b64_tr_b16 v[168:169], v64 offset:10240
    ds_read_b64_tr_b16 v[170:171], v64 offset:10752
    v_exp_f32 v227, v227
    v_mfma_f32_16x16x16_bf16 v[100:103], v[244:245], v[252:253], v[100:103]
    v_mul_f32 v115, v83, v115
    v_mfma_f32_16x16x32_bf16 v[44:47], v[180:183], a[4:7], 0
    v_fma_f32 v224, v224, v218, v218
    v_fma_f32 v225, v225, v218, v218
    v_mfma_f32_16x16x16_bf16 v[132:135], v[244:245], v[254:255], v[132:135]
    v_fma_f32 v226, v226, v218, v218
    v_fma_f32 v227, v227, v218, v218
    v_mfma_f32_16x16x32_bf16 v[48:51], v[184:187], a[0:3], 0
    buffer_load_dwordx4 v200, s[8:11], s42 offen offset:2048 lds
    ds_read_b64_tr_b16 v[172:173], v65 offset:10240
    ds_read_b64_tr_b16 v[174:175], v65 offset:10752
    v_mfma_f32_16x16x32_bf16 v[52:55], v[184:187], a[4:7], 0
    v_rcp_f32 v224, v224
    v_mfma_f32_16x16x16_bf16 v[108:111], v[246:247], v[252:253], v[108:111]
    v_rcp_f32 v225, v225
    v_mfma_f32_16x16x32_bf16 v[56:59], v[188:191], a[0:3], 0
    buffer_load_dwordx4 a[232:235], v209, s[20:23], s100 offen offset:3072 sc1
    ds_read_b64_tr_b16 v[176:177], v66 offset:10240
    v_mfma_f32_16x16x32_bf16 v[60:63], v[188:191], a[4:7], 0
    ds_read_b64_tr_b16 v[178:179], v66 offset:10752
    v_rcp_f32 v226, v226
    s_waitcnt lgkmcnt(6)
    v_mfma_f32_16x16x32_bf16 v[0:3], v[192:195], a[8:11], v[0:3]
    buffer_load_dwordx4 v201, s[8:11], s42 offen offset:3072 lds
    ds_read_b64_tr_b16 v[180:181], v67 offset:10240
    v_mfma_f32_16x16x32_bf16 v[4:7], v[192:195], a[12:15], v[4:7]
    ds_read_b64_tr_b16 v[182:183], v67 offset:10752
    v_rcp_f32 v227, v227
    v_mfma_f32_16x16x16_bf16 v[140:143], v[246:247], v[254:255], v[140:143]
    v_mul_f32 v112, v112, v224
    v_mfma_f32_16x16x32_bf16 a[248:251], v[148:151], v[192:195], a[248:251]
    v_mul_f32 v113, v113, v225
    v_mul_f32 v114, v114, v226
    v_mul_f32 v115, v115, v227
    v_mfma_f32_16x16x32_bf16 v[8:11], v[196:199], a[8:11], v[8:11]
    ds_read_b64_tr_b16 v[184:185], v64 offset:16384
    ds_read_b64_tr_b16 v[186:187], v64 offset:16896
    ds_read_b64_tr_b16 v[188:189], v65 offset:16384
    v_mfma_f32_16x16x32_bf16 v[12:15], v[196:199], a[12:15], v[12:15]
    v_cvt_pk_bf16_f32 v232, v112, v113
    v_cvt_pk_bf16_f32 v233, v114, v115
    v_mul_f32 v228, v88, v88
    v_mfma_f32_16x16x32_bf16 v[16:19], v[160:163], a[8:11], v[16:19]
    buffer_load_dwordx4 a[236:239], v159, s[20:23], s100 offen offset:0 sc1
    ds_read_b64_tr_b16 v[190:191], v65 offset:16896
    v_mfma_f32_16x16x32_bf16 v[20:23], v[160:163], a[12:15], v[20:23]
    ds_read_b64_tr_b16 v[192:193], v66 offset:16384
    v_mul_f32 v229, v89, v89
    v_mul_f32 v230, v90, v90
    v_mul_f32 v231, v91, v91
    v_mfma_f32_16x16x32_bf16 v[24:27], v[164:167], a[8:11], v[24:27]
    ds_read_b64_tr_b16 v[194:195], v66 offset:16896
    ds_read_b64_tr_b16 v[196:197], v67 offset:16384
    v_fma_f32 v228, v228, v217, v216
    v_mfma_f32_16x16x32_bf16 v[28:31], v[164:167], a[12:15], v[28:31]
    v_fma_f32 v229, v229, v217, v216
    v_fma_f32 v230, v230, v217, v216
    s_waitcnt lgkmcnt(7)
    v_mfma_f32_16x16x32_bf16 v[32:35], v[168:171], a[8:11], v[32:35]
    ds_read_b64_tr_b16 v[198:199], v67 offset:16896
    ds_read_b64_tr_b16 v[160:161], v64 offset:18432
    v_mfma_f32_16x16x32_bf16 v[36:39], v[168:171], a[12:15], v[36:39]
    v_fma_f32 v231, v231, v217, v216
    v_mul_f32 v228, v228, v88
    v_mul_f32 v229, v229, v89
    v_mfma_f32_16x16x32_bf16 a[252:255], v[148:151], v[168:171], a[252:255]
    v_mul_f32 v230, v230, v90
    v_mul_f32 v231, v231, v91
    s_add_u32 s100, s75, 15360
    v_mfma_f32_16x16x32_bf16 v[40:43], v[172:175], a[8:11], v[40:43]
    buffer_load_dwordx4 a[0:3], v209, s[20:23], s100 offen offset:0 sc1
    ds_read_b64_tr_b16 v[162:163], v64 offset:18944
    v_mfma_f32_16x16x32_bf16 v[44:47], v[172:175], a[12:15], v[44:47]
    ds_read_b64_tr_b16 v[164:165], v65 offset:18432
    v_exp_f32 v228, v228
    v_mul_f32 v120, v88, v120
    v_mfma_f32_16x16x32_bf16 v[48:51], v[176:179], a[8:11], v[48:51]
    ds_read_b64_tr_b16 v[166:167], v65 offset:18944
    ds_read_b64_tr_b16 v[168:169], v66 offset:18432
    v_exp_f32 v229, v229
    v_mfma_f32_16x16x32_bf16 v[52:55], v[176:179], a[12:15], v[52:55]
    v_mul_f32 v121, v89, v121
    v_exp_f32 v230, v230
    v_mfma_f32_16x16x32_bf16 v[56:59], v[180:183], a[8:11], v[56:59]
    ds_read_b64_tr_b16 v[170:171], v66 offset:18944
    ds_read_b64_tr_b16 v[172:173], v67 offset:18432
    v_mul_f32 v122, v90, v122
    v_mfma_f32_16x16x32_bf16 v[60:63], v[180:183], a[12:15], v[60:63]
    v_exp_f32 v231, v231
    v_mul_f32 v123, v91, v123
    s_waitcnt lgkmcnt(7)
    v_mfma_f32_16x16x32_bf16 v[0:3], v[184:187], a[16:19], v[0:3]
    buffer_load_dwordx4 a[4:7], v209, s[20:23], s100 offen offset:1024 sc1
    ds_read_b64_tr_b16 v[174:175], v67 offset:18944
    v_mfma_f32_16x16x32_bf16 v[4:7], v[184:187], a[20:23], v[4:7]
    ds_read_b64_tr_b16 v[176:177], v64 offset:24576
    ds_read_b64_tr_b16 v[178:179], v64 offset:25088
    v_mfma_f32_16x16x32_bf16 a[248:251], v[148:151], v[184:187], a[248:251]
    v_fma_f32 v228, v228, v218, v218
    v_fma_f32 v229, v229, v218, v218
    v_fma_f32 v230, v230, v218, v218
    v_mfma_f32_16x16x32_bf16 v[8:11], v[188:191], a[16:19], v[8:11]
    ds_read_b64_tr_b16 v[180:181], v65 offset:24576
    ds_read_b64_tr_b16 v[182:183], v65 offset:25088
    v_mfma_f32_16x16x32_bf16 v[12:15], v[188:191], a[20:23], v[12:15]
    v_fma_f32 v231, v231, v218, v218
    v_rcp_f32 v228, v228
    v_mfma_f32_16x16x32_bf16 v[16:19], v[192:195], a[16:19], v[16:19]
    ds_read_b64_tr_b16 v[184:185], v66 offset:24576
    ds_read_b64_tr_b16 v[186:187], v66 offset:25088
    v_mfma_f32_16x16x32_bf16 v[20:23], v[192:195], a[20:23], v[20:23]
    v_rcp_f32 v229, v229
    v_rcp_f32 v230, v230
    v_mfma_f32_16x16x32_bf16 v[24:27], v[196:199], a[16:19], v[24:27]
    buffer_load_dwordx4 a[8:11], v209, s[20:23], s100 offen offset:2048 sc1
    ds_read_b64_tr_b16 v[188:189], v67 offset:24576
    v_mfma_f32_16x16x32_bf16 v[28:31], v[196:199], a[20:23], v[28:31]
    ds_read_b64_tr_b16 v[190:191], v67 offset:25088
    v_rcp_f32 v231, v231
    s_waitcnt lgkmcnt(8)
    v_mfma_f32_16x16x32_bf16 v[32:35], v[160:163], a[16:19], v[32:35]
    ds_read_b64_tr_b16 v[192:193], v64 offset:26624
    ds_read_b64_tr_b16 v[194:195], v64 offset:27136
    v_mul_f32 v120, v120, v228
    v_mfma_f32_16x16x32_bf16 v[36:39], v[160:163], a[20:23], v[36:39]
    v_mul_f32 v121, v121, v229
    v_mul_f32 v122, v122, v230
    v_mul_f32 v123, v123, v231
    v_mfma_f32_16x16x32_bf16 a[252:255], v[148:151], v[160:163], a[252:255]
    v_cvt_pk_bf16_f32 v234, v120, v121
    v_cvt_pk_bf16_f32 v235, v122, v123
    v_mfma_f32_16x16x32_bf16 v[40:43], v[164:167], a[16:19], v[40:43]
    ds_read_b64_tr_b16 v[196:197], v65 offset:26624
    ds_read_b64_tr_b16 v[198:199], v65 offset:27136
    v_mul_f32 v224, v84, v84
    v_mfma_f32_16x16x32_bf16 v[44:47], v[164:167], a[20:23], v[44:47]
    v_mul_f32 v225, v85, v85
    v_mul_f32 v226, v86, v86
    v_mul_f32 v227, v87, v87
    v_permlane16_swap_b32 v232, v234
    v_mfma_f32_16x16x32_bf16 v[48:51], v[168:171], a[16:19], v[48:51]
    buffer_load_dwordx4 a[12:15], v209, s[20:23], s100 offen offset:3072 sc1
    ds_read_b64_tr_b16 v[160:161], v66 offset:26624
    v_mfma_f32_16x16x32_bf16 v[52:55], v[168:171], a[20:23], v[52:55]
    ds_read_b64_tr_b16 v[162:163], v66 offset:27136
    v_permlane16_swap_b32 v233, v235
    buffer_store_dwordx4 v[232:235], v152, s[20:23], s61 offen offset:0 sc1
    v_mfma_f32_16x16x32_bf16 v[56:59], v[172:175], a[16:19], v[56:59]
    ds_read_b64_tr_b16 v[164:165], v67 offset:26624
    ds_read_b64_tr_b16 v[166:167], v67 offset:27136
    v_fma_f32 v224, v224, v221, v220
    v_mfma_f32_16x16x32_bf16 v[60:63], v[172:175], a[20:23], v[60:63]
    v_fma_f32 v225, v225, v221, v220
    v_fma_f32 v226, v226, v221, v220
    s_waitcnt lgkmcnt(8)
    v_mfma_f32_16x16x32_bf16 v[0:3], v[176:179], a[24:27], v[0:3]
    v_fma_f32 v227, v227, v221, v220
    v_mul_f32 v224, v224, v84
    v_mul_f32 v225, v225, v85
    v_mfma_f32_16x16x32_bf16 v[4:7], v[176:179], a[28:31], v[4:7]
    v_mul_f32 v226, v226, v86
    v_mul_f32 v227, v227, v87
    v_mfma_f32_16x16x32_bf16 a[248:251], v[148:151], v[176:179], a[248:251]
    v_exp_f32 v224, v224
    v_mul_f32 v116, v84, v116
    v_mfma_f32_16x16x32_bf16 v[8:11], v[180:183], a[24:27], v[8:11]
    v_mfma_f32_16x16x32_bf16 v[12:15], v[180:183], a[28:31], v[12:15]
    s_waitcnt vmcnt(42) lgkmcnt(0)
    s_barrier
    s_add_u32 m0, s66, 0
    v_mfma_f32_16x16x32_bf16 v[16:19], v[184:187], a[24:27], v[16:19]
    buffer_load_dwordx4 v200, s[4:7], s44 offen offset:0 lds
    ds_read_b64_tr_b16 v[168:169], v68 offset:32768
    v_mfma_f32_16x16x32_bf16 v[20:23], v[184:187], a[28:31], v[20:23]
    ds_read_b64_tr_b16 v[170:171], v68 offset:33280
    ds_read_b64_tr_b16 v[172:173], v69 offset:32768
    v_mfma_f32_16x16x32_bf16 v[24:27], v[188:191], a[24:27], v[24:27]
    buffer_load_dwordx4 a[16:19], v159, s[20:23], s100 offen offset:0 sc1
    ds_read_b64_tr_b16 v[174:175], v69 offset:33280
    v_mfma_f32_16x16x32_bf16 v[28:31], v[188:191], a[28:31], v[28:31]
    ds_read_b64_tr_b16 v[176:177], v70 offset:32768
    v_exp_f32 v225, v225
    v_mfma_f32_16x16x32_bf16 v[32:35], v[192:195], a[24:27], v[32:35]
    buffer_load_dwordx4 v201, s[4:7], s44 offen offset:1024 lds
    ds_read_b64_tr_b16 v[178:179], v70 offset:33280
    v_mfma_f32_16x16x32_bf16 v[36:39], v[192:195], a[28:31], v[36:39]
    ds_read_b64_tr_b16 v[180:181], v71 offset:32768
    v_mul_f32 v117, v85, v117
    v_mfma_f32_16x16x32_bf16 a[252:255], v[148:151], v[192:195], a[252:255]
    v_exp_f32 v226, v226
    v_mul_f32 v118, v86, v118
    v_mfma_f32_16x16x32_bf16 v[40:43], v[196:199], a[24:27], v[40:43]
    ds_read_b64_tr_b16 v[182:183], v71 offset:33280
    ds_read_b64_tr_b16 v[184:185], v68 offset:34816
    v_mfma_f32_16x16x32_bf16 v[44:47], v[196:199], a[28:31], v[44:47]
    v_exp_f32 v227, v227
    v_mul_f32 v119, v87, v119
    v_fma_f32 v224, v224, v222, v222
    v_mfma_f32_16x16x32_bf16 v[48:51], v[160:163], a[24:27], v[48:51]
    buffer_load_dwordx4 v200, s[8:11], s44 offen offset:2048 lds
    ds_read_b64_tr_b16 v[186:187], v68 offset:35328
    ds_read_b64_tr_b16 v[188:189], v69 offset:34816
    v_mfma_f32_16x16x32_bf16 v[52:55], v[160:163], a[28:31], v[52:55]
    s_add_u32 s100, s75, 20480
    s_cmp_lt_u32 s40, 3
    s_cselect_b32 s100, s100, 1073741824
    v_mfma_f32_16x16x32_bf16 v[56:59], v[164:167], a[24:27], v[56:59]
    buffer_load_dwordx4 a[20:23], v209, s[20:23], s100 offen offset:0 sc1
    ds_read_b64_tr_b16 v[190:191], v69 offset:35328
    v_mfma_f32_16x16x32_bf16 v[60:63], v[164:167], a[28:31], v[60:63]
    ds_read_b64_tr_b16 v[192:193], v70 offset:34816
    v_fma_f32 v225, v225, v222, v222
    v_fma_f32 v226, v226, v222, v222
    s_waitcnt lgkmcnt(5)
    v_mfma_f32_16x16x32_bf16 v[0:3], v[168:171], a[32:35], v[0:3]
    buffer_load_dwordx4 v201, s[8:11], s44 offen offset:3072 lds
    v_mfma_f32_16x16x32_bf16 v[4:7], v[168:171], a[36:39], v[4:7]
    ds_read_b64_tr_b16 v[194:195], v70 offset:35328
    ds_read_b64_tr_b16 v[196:197], v71 offset:34816
    v_fma_f32 v227, v227, v222, v222
    v_mfma_f32_16x16x32_bf16 a[248:251], v[148:151], v[168:171], a[248:251]
    v_rcp_f32 v224, v224
    v_mfma_f32_16x16x32_bf16 v[8:11], v[172:175], a[32:35], v[8:11]
    ds_read_b64_tr_b16 v[198:199], v71 offset:35328
    ds_read_b64_tr_b16 v[160:161], v68 offset:40960
    ds_read_b64_tr_b16 v[162:163], v68 offset:41472
    v_mfma_f32_16x16x32_bf16 v[12:15], v[172:175], a[36:39], v[12:15]
    v_rcp_f32 v225, v225
    s_add_u32 m0, s66, 16384
    v_mfma_f32_16x16x32_bf16 v[16:19], v[176:179], a[32:35], v[16:19]
    buffer_load_dwordx4 v200, s[4:7], s3 offen offset:0 lds
    ds_read_b64_tr_b16 v[164:165], v69 offset:40960
    v_mfma_f32_16x16x32_bf16 v[20:23], v[176:179], a[36:39], v[20:23]
    ds_read_b64_tr_b16 v[166:167], v69 offset:41472
    v_rcp_f32 v226, v226
    v_mfma_f32_16x16x32_bf16 v[24:27], v[180:183], a[32:35], v[24:27]
    buffer_load_dwordx4 a[24:27], v209, s[20:23], s100 offen offset:1024 sc1
    ds_read_b64_tr_b16 v[168:169], v70 offset:40960
    v_mfma_f32_16x16x32_bf16 v[28:31], v[180:183], a[36:39], v[28:31]
    ds_read_b64_tr_b16 v[170:171], v70 offset:41472
    v_rcp_f32 v227, v227
    s_waitcnt lgkmcnt(6)
    v_mfma_f32_16x16x32_bf16 v[32:35], v[184:187], a[32:35], v[32:35]
    buffer_load_dwordx4 v201, s[4:7], s3 offen offset:1024 lds
    ds_read_b64_tr_b16 v[172:173], v71 offset:40960
    v_mfma_f32_16x16x32_bf16 v[36:39], v[184:187], a[36:39], v[36:39]
    ds_read_b64_tr_b16 v[174:175], v71 offset:41472
    v_mul_f32 v116, v116, v224
    v_mfma_f32_16x16x32_bf16 a[252:255], v[148:151], v[184:187], a[252:255]
    v_mul_f32 v117, v117, v225
    v_mul_f32 v118, v118, v226
    v_mul_f32 v119, v119, v227
    v_mfma_f32_16x16x32_bf16 v[40:43], v[188:191], a[32:35], v[40:43]
    ds_read_b64_tr_b16 v[176:177], v68 offset:43008
    ds_read_b64_tr_b16 v[178:179], v68 offset:43520
    v_cvt_pk_bf16_f32 v236, v116, v117
    v_mfma_f32_16x16x32_bf16 v[44:47], v[188:191], a[36:39], v[44:47]
    v_cvt_pk_bf16_f32 v237, v118, v119
    v_mul_f32 v228, v92, v92
    v_mul_f32 v229, v93, v93
    v_mfma_f32_16x16x32_bf16 v[48:51], v[192:195], a[32:35], v[48:51]
    buffer_load_dwordx4 v200, s[8:11], s3 offen offset:2048 lds
    ds_read_b64_tr_b16 v[180:181], v69 offset:43008
    v_mfma_f32_16x16x32_bf16 v[52:55], v[192:195], a[36:39], v[52:55]
    ds_read_b64_tr_b16 v[182:183], v69 offset:43520
    v_mul_f32 v230, v94, v94
    v_mul_f32 v231, v95, v95
    v_mfma_f32_16x16x32_bf16 v[56:59], v[196:199], a[32:35], v[56:59]
    buffer_load_dwordx4 a[28:31], v209, s[20:23], s100 offen offset:2048 sc1
    ds_read_b64_tr_b16 v[184:185], v70 offset:43008
    v_mfma_f32_16x16x32_bf16 v[60:63], v[196:199], a[36:39], v[60:63]
    ds_read_b64_tr_b16 v[186:187], v70 offset:43520
    v_fma_f32 v228, v228, v221, v220
    v_fma_f32 v229, v229, v221, v220
    s_waitcnt lgkmcnt(6)
    v_mfma_f32_16x16x32_bf16 v[0:3], v[160:163], a[40:43], v[0:3]
    buffer_load_dwordx4 v201, s[8:11], s3 offen offset:3072 lds
    ds_read_b64_tr_b16 v[188:189], v71 offset:43008
    v_mfma_f32_16x16x32_bf16 v[4:7], v[160:163], a[44:47], v[4:7]
    ds_read_b64_tr_b16 v[190:191], v71 offset:43520
    v_fma_f32 v230, v230, v221, v220
    v_mfma_f32_16x16x32_bf16 a[248:251], v[148:151], v[160:163], a[248:251]
    v_fma_f32 v231, v231, v221, v220
    v_mul_f32 v228, v228, v92
    v_mul_f32 v229, v229, v93
    v_mfma_f32_16x16x32_bf16 v[8:11], v[164:167], a[40:43], v[8:11]
    ds_read_b64_tr_b16 v[192:193], v68 offset:49152
    ds_read_b64_tr_b16 v[194:195], v68 offset:49664
    v_mfma_f32_16x16x32_bf16 v[12:15], v[164:167], a[44:47], v[12:15]
    ds_read_b64_tr_b16 v[196:197], v69 offset:49152
    v_mul_f32 v230, v230, v94
    v_mul_f32 v231, v231, v95
    v_mfma_f32_16x16x32_bf16 v[16:19], v[168:171], a[40:43], v[16:19]
    buffer_load_dwordx4 a[32:35], v209, s[20:23], s100 offen offset:3072 sc1
    ds_read_b64_tr_b16 v[198:199], v69 offset:49664
    v_mfma_f32_16x16x32_bf16 v[20:23], v[168:171], a[44:47], v[20:23]
    ds_read_b64_tr_b16 v[160:161], v70 offset:49152
    v_exp_f32 v228, v228
    v_mul_f32 v124, v92, v124
    v_mfma_f32_16x16x32_bf16 v[24:27], v[172:175], a[40:43], v[24:27]
    ds_read_b64_tr_b16 v[162:163], v70 offset:49664
    ds_read_b64_tr_b16 v[164:165], v71 offset:49152
    v_mfma_f32_16x16x32_bf16 v[28:31], v[172:175], a[44:47], v[28:31]
    v_exp_f32 v229, v229
    v_mul_f32 v125, v93, v125
    s_waitcnt lgkmcnt(7)
    v_mfma_f32_16x16x32_bf16 v[32:35], v[176:179], a[40:43], v[32:35]
    ds_read_b64_tr_b16 v[166:167], v71 offset:49664
    ds_read_b64_tr_b16 v[168:169], v68 offset:51200
    v_mfma_f32_16x16x32_bf16 v[36:39], v[176:179], a[44:47], v[36:39]
    buffer_load_dwordx4 a[244:247], v209, s[12:15], s16 offen
    v_exp_f32 v230, v230
    v_mfma_f32_16x16x32_bf16 a[252:255], v[148:151], v[176:179], a[252:255]
    v_mul_f32 v126, v94, v126
    v_exp_f32 v231, v231
    v_mfma_f32_16x16x32_bf16 v[40:43], v[180:183], a[40:43], v[40:43]
    buffer_load_dwordx4 a[36:39], v159, s[20:23], s100 offen offset:0 sc1
    ds_read_b64_tr_b16 v[170:171], v68 offset:51712
    v_mfma_f32_16x16x32_bf16 v[44:47], v[180:183], a[44:47], v[44:47]
    ds_read_b64_tr_b16 v[172:173], v69 offset:51200
    v_mul_f32 v127, v95, v127
    v_fma_f32 v228, v228, v222, v222
    v_mfma_f32_16x16x32_bf16 v[48:51], v[184:187], a[40:43], v[48:51]
    ds_read_b64_tr_b16 v[174:175], v69 offset:51712
    ds_read_b64_tr_b16 v[176:177], v70 offset:51200
    v_fma_f32 v229, v229, v222, v222
    v_mfma_f32_16x16x32_bf16 v[52:55], v[184:187], a[44:47], v[52:55]
    v_fma_f32 v230, v230, v222, v222
    v_fma_f32 v231, v231, v222, v222
    v_mfma_f32_16x16x32_bf16 v[56:59], v[188:191], a[40:43], v[56:59]
    ds_read_b64_tr_b16 v[178:179], v70 offset:51712
    ds_read_b64_tr_b16 v[180:181], v71 offset:51200
    v_mfma_f32_16x16x32_bf16 v[60:63], v[188:191], a[44:47], v[60:63]
    s_add_u32 s100, s75, 25600
    s_cmp_lt_u32 s40, 3
    s_cselect_b32 s100, s100, 1073741824
    s_waitcnt lgkmcnt(7)
    v_mfma_f32_16x16x32_bf16 v[0:3], v[192:195], a[48:51], v[0:3]
    buffer_load_dwordx4 a[40:43], v209, s[20:23], s100 offen offset:0 sc1
    v_mfma_f32_16x16x32_bf16 v[4:7], v[192:195], a[52:55], v[4:7]
    ds_read_b64_tr_b16 v[182:183], v71 offset:51712
    ds_read_b64_tr_b16 v[184:185], v68 offset:57344
    ds_read_b64_tr_b16 v[186:187], v68 offset:57856
    v_mfma_f32_16x16x32_bf16 a[248:251], v[148:151], v[192:195], a[248:251]
    v_rcp_f32 v228, v228
    v_mfma_f32_16x16x32_bf16 v[8:11], v[196:199], a[48:51], v[8:11]
    ds_read_b64_tr_b16 v[188:189], v69 offset:57344
    ds_read_b64_tr_b16 v[190:191], v69 offset:57856
    v_mfma_f32_16x16x32_bf16 v[12:15], v[196:199], a[52:55], v[12:15]
    v_rcp_f32 v229, v229
    v_rcp_f32 v230, v230
    v_mfma_f32_16x16x32_bf16 v[16:19], v[160:163], a[48:51], v[16:19]
    ds_read_b64_tr_b16 v[192:193], v70 offset:57344
    ds_read_b64_tr_b16 v[194:195], v70 offset:57856
    v_rcp_f32 v231, v231
    v_mfma_f32_16x16x32_bf16 v[20:23], v[160:163], a[52:55], v[20:23]
    v_mul_f32 v124, v124, v228
    v_mul_f32 v125, v125, v229
    v_mul_f32 v126, v126, v230
    v_mfma_f32_16x16x32_bf16 v[24:27], v[164:167], a[48:51], v[24:27]
    buffer_load_dwordx4 a[44:47], v209, s[20:23], s100 offen offset:1024 sc1
    ds_read_b64_tr_b16 v[196:197], v71 offset:57344
    v_mfma_f32_16x16x32_bf16 v[28:31], v[164:167], a[52:55], v[28:31]
    ds_read_b64_tr_b16 v[198:199], v71 offset:57856
    v_mul_f32 v127, v127, v231
    v_cvt_pk_bf16_f32 v238, v124, v125
    s_waitcnt lgkmcnt(8)
    v_mfma_f32_16x16x32_bf16 v[32:35], v[168:171], a[48:51], v[32:35]
    ds_read_b64_tr_b16 v[160:161], v68 offset:59392
    ds_read_b64_tr_b16 v[162:163], v68 offset:59904
    v_mfma_f32_16x16x32_bf16 v[36:39], v[168:171], a[52:55], v[36:39]
    v_cvt_pk_bf16_f32 v239, v126, v127
    v_mul_f32 v224, v96, v96
    v_mul_f32 v225, v97, v97
    v_mfma_f32_16x16x32_bf16 a[252:255], v[148:151], v[168:171], a[252:255]
    v_mul_f32 v226, v98, v98
    v_mul_f32 v227, v99, v99
    v_permlane16_swap_b32 v236, v238
    v_mfma_f32_16x16x32_bf16 v[40:43], v[172:175], a[48:51], v[40:43]
    ds_read_b64_tr_b16 v[164:165], v69 offset:59392
    ds_read_b64_tr_b16 v[166:167], v69 offset:59904
    v_permlane16_swap_b32 v237, v239
    v_mfma_f32_16x16x32_bf16 v[44:47], v[172:175], a[52:55], v[44:47]
    buffer_store_dwordx4 v[236:239], v152, s[20:23], s61 offen offset:256 sc1
    v_fma_f32 v224, v224, v217, v216
    v_mfma_f32_16x16x32_bf16 v[48:51], v[176:179], a[48:51], v[48:51]
    ds_read_b64_tr_b16 v[168:169], v70 offset:59392
    ds_read_b64_tr_b16 v[170:171], v70 offset:59904
    v_fma_f32 v225, v225, v217, v216
    v_mfma_f32_16x16x32_bf16 v[52:55], v[176:179], a[52:55], v[52:55]
    v_fma_f32 v226, v226, v217, v216
    v_fma_f32 v227, v227, v217, v216
    v_mul_f32 v224, v224, v96
    v_mfma_f32_16x16x32_bf16 v[56:59], v[180:183], a[48:51], v[56:59]
    ds_read_b64_tr_b16 v[172:173], v71 offset:59392
    ds_read_b64_tr_b16 v[174:175], v71 offset:59904
    v_mfma_f32_16x16x32_bf16 v[60:63], v[180:183], a[52:55], v[60:63]
    v_mul_f32 v225, v225, v97
    v_mul_f32 v226, v226, v98
    v_mul_f32 v227, v227, v99
    s_waitcnt lgkmcnt(8)
    v_mfma_f32_16x16x32_bf16 v[0:3], v[184:187], a[56:59], v[0:3]
    buffer_load_dwordx4 a[48:51], v209, s[20:23], s100 offen offset:2048 sc1
    v_mfma_f32_16x16x32_bf16 v[4:7], v[184:187], a[60:63], v[4:7]
    v_exp_f32 v224, v224
    v_mul_f32 v128, v96, v128
    v_mfma_f32_16x16x32_bf16 a[248:251], v[148:151], v[184:187], a[248:251]
    v_exp_f32 v225, v225
    v_mul_f32 v129, v97, v129
    v_mfma_f32_16x16x32_bf16 v[8:11], v[188:191], a[56:59], v[8:11]
    v_mfma_f32_16x16x32_bf16 v[12:15], v[188:191], a[60:63], v[12:15]
    s_waitcnt vmcnt(43) lgkmcnt(0)
    s_barrier
    s_add_u32 s45, s101, 30720
    s_add_u32 m0, s58, 102400
    v_mfma_f32_16x16x32_bf16 v[16:19], v[192:195], a[56:59], v[16:19]
    buffer_load_dwordx4 v209, s[20:23], s45 offen offset:0 sc1 lds
    ds_read_b64_tr_b16 v[176:177], v68 offset:0
    v_mfma_f32_16x16x32_bf16 v[20:23], v[192:195], a[60:63], v[20:23]
    ds_read_b64_tr_b16 v[178:179], v68 offset:512
    ds_read_b64_tr_b16 v[180:181], v69 offset:0
    v_mfma_f32_16x16x32_bf16 v[24:27], v[196:199], a[56:59], v[24:27]
    buffer_load_dwordx4 a[52:55], v209, s[20:23], s100 offen offset:3072 sc1
    ds_read_b64_tr_b16 v[182:183], v69 offset:512
    v_mfma_f32_16x16x32_bf16 v[28:31], v[196:199], a[60:63], v[28:31]
    ds_read_b64_tr_b16 v[184:185], v70 offset:0
    v_exp_f32 v226, v226
    v_mfma_f32_16x16x32_bf16 v[32:35], v[160:163], a[56:59], v[32:35]
    buffer_load_dwordx4 v209, s[20:23], s45 offen offset:1024 sc1 lds
    ds_read_b64_tr_b16 v[186:187], v70 offset:512
    v_mfma_f32_16x16x32_bf16 v[36:39], v[160:163], a[60:63], v[36:39]
    ds_read_b64_tr_b16 v[188:189], v71 offset:0
    v_mul_f32 v130, v98, v130
    v_mfma_f32_16x16x32_bf16 a[252:255], v[148:151], v[160:163], a[252:255]
    v_exp_f32 v227, v227
    v_mul_f32 v131, v99, v131
    v_mfma_f32_16x16x32_bf16 v[40:43], v[164:167], a[56:59], v[40:43]
    ds_read_b64_tr_b16 v[190:191], v71 offset:512
    ds_read_b64_tr_b16 v[192:193], v68 offset:2048
    v_fma_f32 v224, v224, v218, v218
    v_mfma_f32_16x16x32_bf16 v[44:47], v[164:167], a[60:63], v[44:47]
    v_fma_f32 v225, v225, v218, v218
    v_fma_f32 v226, v226, v218, v218
    v_fma_f32 v227, v227, v218, v218
    v_mfma_f32_16x16x32_bf16 v[48:51], v[168:171], a[56:59], v[48:51]
    buffer_load_dwordx4 v209, s[20:23], s45 offen offset:2048 sc1 lds
    ds_read_b64_tr_b16 v[194:195], v68 offset:2560
    v_mfma_f32_16x16x32_bf16 v[52:55], v[168:171], a[60:63], v[52:55]
    ds_read_b64_tr_b16 v[196:197], v69 offset:2048
    v_rcp_f32 v224, v224
    v_mfma_f32_16x16x32_bf16 v[56:59], v[172:175], a[56:59], v[56:59]
    ds_read_b64_tr_b16 v[198:199], v69 offset:2560
    ds_read_b64_tr_b16 v[160:161], v70 offset:2048
    v_mfma_f32_16x16x32_bf16 v[60:63], v[172:175], a[60:63], v[60:63]
    v_rcp_f32 v225, v225
    v_rcp_f32 v226, v226
    s_waitcnt lgkmcnt(5)
    v_mfma_f32_16x16x32_bf16 v[0:3], v[176:179], a[64:67], v[0:3]
    buffer_load_dwordx4 v209, s[20:23], s45 offen offset:3072 sc1 lds
    ds_read_b64_tr_b16 v[162:163], v70 offset:2560
    v_mfma_f32_16x16x32_bf16 v[4:7], v[176:179], a[68:71], v[4:7]
    ds_read_b64_tr_b16 v[164:165], v71 offset:2048
    v_rcp_f32 v227, v227
    v_mfma_f32_16x16x32_bf16 a[248:251], v[148:151], v[176:179], a[248:251]
    v_mul_f32 v128, v128, v224
    v_mul_f32 v129, v129, v225
    v_mul_f32 v130, v130, v226
    v_mfma_f32_16x16x32_bf16 v[8:11], v[180:183], a[64:67], v[8:11]
    buffer_load_dwordx4 a[56:59], v159, s[20:23], s100 offen offset:0 sc1
    ds_read_b64_tr_b16 v[166:167], v71 offset:2560
    v_mfma_f32_16x16x32_bf16 v[12:15], v[180:183], a[68:71], v[12:15]
    ds_read_b64_tr_b16 v[168:169], v68 offset:8192
    ds_read_b64_tr_b16 v[170:171], v68 offset:8704
    s_add_u32 m0, s58, 106496
    v_mfma_f32_16x16x32_bf16 v[16:19], v[184:187], a[64:67], v[16:19]
    buffer_load_dwordx4 v159, s[20:23], s45 offen offset:0 sc1 lds
    ds_read_b64_tr_b16 v[172:173], v69 offset:8192
    v_mfma_f32_16x16x32_bf16 v[20:23], v[184:187], a[68:71], v[20:23]
    ds_read_b64_tr_b16 v[174:175], v69 offset:8704
    v_mul_f32 v131, v131, v227
    v_cvt_pk_bf16_f32 v232, v128, v129
    v_mfma_f32_16x16x32_bf16 v[24:27], v[188:191], a[64:67], v[24:27]
    ds_read_b64_tr_b16 v[176:177], v70 offset:8192
    ds_read_b64_tr_b16 v[178:179], v70 offset:8704
    v_cvt_pk_bf16_f32 v233, v130, v131
    v_mfma_f32_16x16x32_bf16 v[28:31], v[188:191], a[68:71], v[28:31]
    s_add_u32 s45, s101, 35840
    s_add_u32 m0, s58, 122880
    s_waitcnt lgkmcnt(6)
    v_mfma_f32_16x16x32_bf16 v[32:35], v[192:195], a[64:67], v[32:35]
    buffer_load_dwordx4 v209, s[20:23], s45 offen offset:0 sc1 lds
    ds_read_b64_tr_b16 v[180:181], v71 offset:8192
    v_mfma_f32_16x16x32_bf16 v[36:39], v[192:195], a[68:71], v[36:39]
    ds_read_b64_tr_b16 v[182:183], v71 offset:8704
    v_mul_f32 v228, v104, v104
    v_mul_f32 v229, v105, v105
    v_mfma_f32_16x16x32_bf16 a[252:255], v[148:151], v[192:195], a[252:255]
    v_mul_f32 v230, v106, v106
    v_mul_f32 v231, v107, v107
    s_add_u32 s100, s101, 0
    v_mfma_f32_16x16x32_bf16 v[40:43], v[196:199], a[64:67], v[40:43]
    buffer_load_dwordx4 a[60:63], v209, s[20:23], s100 offen offset:0 sc1
    ds_read_b64_tr_b16 v[184:185], v68 offset:10240
    v_mfma_f32_16x16x32_bf16 v[44:47], v[196:199], a[68:71], v[44:47]
    ds_read_b64_tr_b16 v[186:187], v68 offset:10752
    v_fma_f32 v228, v228, v217, v216
    v_fma_f32 v229, v229, v217, v216
    v_mfma_f32_16x16x32_bf16 v[48:51], v[160:163], a[64:67], v[48:51]
    buffer_load_dwordx4 v209, s[20:23], s45 offen offset:1024 sc1 lds
    ds_read_b64_tr_b16 v[188:189], v69 offset:10240
    v_mfma_f32_16x16x32_bf16 v[52:55], v[160:163], a[68:71], v[52:55]
    ds_read_b64_tr_b16 v[190:191], v69 offset:10752
    v_fma_f32 v230, v230, v217, v216
    v_fma_f32 v231, v231, v217, v216
    v_mfma_f32_16x16x32_bf16 v[56:59], v[164:167], a[64:67], v[56:59]
    ds_read_b64_tr_b16 v[192:193], v70 offset:10240
    ds_read_b64_tr_b16 v[194:195], v70 offset:10752
    v_mul_f32 v228, v228, v104
    v_mfma_f32_16x16x32_bf16 v[60:63], v[164:167], a[68:71], v[60:63]
    v_mul_f32 v229, v229, v105
    v_mul_f32 v230, v230, v106
    v_mul_f32 v231, v231, v107
    s_waitcnt lgkmcnt(6)
    v_mfma_f32_16x16x32_bf16 v[0:3], v[168:171], a[72:75], v[0:3]
    buffer_load_dwordx4 v209, s[20:23], s45 offen offset:2048 sc1 lds
    ds_read_b64_tr_b16 v[196:197], v71 offset:10240
    v_mfma_f32_16x16x32_bf16 v[4:7], v[168:171], a[76:79], v[4:7]
    ds_read_b64_tr_b16 v[198:199], v71 offset:10752
    v_exp_f32 v228, v228
    v_mfma_f32_16x16x32_bf16 a[248:251], v[148:151], v[168:171], a[248:251]
    v_mul_f32 v136, v104, v136
    v_exp_f32 v229, v229
    v_mfma_f32_16x16x32_bf16 v[8:11], v[172:175], a[72:75], v[8:11]
    buffer_load_dwordx4 a[64:67], v209, s[20:23], s100 offen offset:1024 sc1
    ds_read_b64_tr_b16 v[160:161], v68 offset:16384
    v_mfma_f32_16x16x32_bf16 v[12:15], v[172:175], a[76:79], v[12:15]
    ds_read_b64_tr_b16 v[162:163], v68 offset:16896
    ds_read_b64_tr_b16 v[164:165], v69 offset:16384
    v_mul_f32 v137, v105, v137
    v_mfma_f32_16x16x32_bf16 v[16:19], v[176:179], a[72:75], v[16:19]
    buffer_load_dwordx4 v209, s[20:23], s45 offen offset:3072 sc1 lds
    ds_read_b64_tr_b16 v[166:167], v69 offset:16896
    v_mfma_f32_16x16x32_bf16 v[20:23], v[176:179], a[76:79], v[20:23]
    ds_read_b64_tr_b16 v[168:169], v70 offset:16384
    v_exp_f32 v230, v230
    v_mul_f32 v138, v106, v138
    v_mfma_f32_16x16x32_bf16 v[24:27], v[180:183], a[72:75], v[24:27]
    ds_read_b64_tr_b16 v[170:171], v70 offset:16896
    ds_read_b64_tr_b16 v[172:173], v71 offset:16384
    v_exp_f32 v231, v231
    v_mfma_f32_16x16x32_bf16 v[28:31], v[180:183], a[76:79], v[28:31]
    v_mul_f32 v139, v107, v139
    s_add_u32 m0, s58, 126976
    s_waitcnt lgkmcnt(7)
    v_mfma_f32_16x16x32_bf16 v[32:35], v[184:187], a[72:75], v[32:35]
    buffer_load_dwordx4 v159, s[20:23], s45 offen offset:0 sc1 lds
    ds_read_b64_tr_b16 v[174:175], v71 offset:16896
    v_mfma_f32_16x16x32_bf16 v[36:39], v[184:187], a[76:79], v[36:39]
    ds_read_b64_tr_b16 v[176:177], v68 offset:18432
    v_fma_f32 v228, v228, v218, v218
    v_mfma_f32_16x16x32_bf16 a[252:255], v[148:151], v[184:187], a[252:255]
    v_fma_f32 v229, v229, v218, v218
    v_fma_f32 v230, v230, v218, v218
    v_fma_f32 v231, v231, v218, v218
    v_mfma_f32_16x16x32_bf16 v[40:43], v[188:191], a[72:75], v[40:43]
    buffer_load_dwordx4 a[68:71], v209, s[20:23], s100 offen offset:2048 sc1
    ds_read_b64_tr_b16 v[178:179], v68 offset:18944
    v_mfma_f32_16x16x32_bf16 v[44:47], v[188:191], a[76:79], v[44:47]
    ds_read_b64_tr_b16 v[180:181], v69 offset:18432
    v_rcp_f32 v228, v228
    v_mfma_f32_16x16x32_bf16 v[48:51], v[192:195], a[72:75], v[48:51]
    ds_read_b64_tr_b16 v[182:183], v69 offset:18944
    ds_read_b64_tr_b16 v[184:185], v70 offset:18432
    v_mfma_f32_16x16x32_bf16 v[52:55], v[192:195], a[76:79], v[52:55]
    v_rcp_f32 v229, v229
    v_rcp_f32 v230, v230
    v_mfma_f32_16x16x32_bf16 v[56:59], v[196:199], a[72:75], v[56:59]
    ds_read_b64_tr_b16 v[186:187], v70 offset:18944
    ds_read_b64_tr_b16 v[188:189], v71 offset:18432
    v_mfma_f32_16x16x32_bf16 v[60:63], v[196:199], a[76:79], v[60:63]
    v_rcp_f32 v231, v231
    v_mul_f32 v136, v136, v228
    v_mul_f32 v137, v137, v229
    s_waitcnt lgkmcnt(7)
    v_mfma_f32_16x16x32_bf16 v[0:3], v[160:163], a[80:83], v[0:3]
    buffer_load_dwordx4 a[72:75], v209, s[20:23], s100 offen offset:3072 sc1
    ds_read_b64_tr_b16 v[190:191], v71 offset:18944
    v_mfma_f32_16x16x32_bf16 v[4:7], v[160:163], a[84:87], v[4:7]
    ds_read_b64_tr_b16 v[192:193], v68 offset:24576
    ds_read_b64_tr_b16 v[194:195], v68 offset:25088
    v_mfma_f32_16x16x32_bf16 a[248:251], v[148:151], v[160:163], a[248:251]
    v_mul_f32 v138, v138, v230
    v_mul_f32 v139, v139, v231
    v_cvt_pk_bf16_f32 v234, v136, v137
    v_mfma_f32_16x16x32_bf16 v[8:11], v[164:167], a[80:83], v[8:11]
    ds_read_b64_tr_b16 v[196:197], v69 offset:24576
    ds_read_b64_tr_b16 v[198:199], v69 offset:25088
    v_cvt_pk_bf16_f32 v235, v138, v139
    v_mfma_f32_16x16x32_bf16 v[12:15], v[164:167], a[84:87], v[12:15]
    v_mul_f32 v224, v100, v100
    v_mul_f32 v225, v101, v101
    v_mul_f32 v226, v102, v102
    v_mfma_f32_16x16x32_bf16 v[16:19], v[168:171], a[80:83], v[16:19]
    ds_read_b64_tr_b16 v[160:161], v70 offset:24576
    ds_read_b64_tr_b16 v[162:163], v70 offset:25088
    v_mul_f32 v227, v103, v103
    v_mfma_f32_16x16x32_bf16 v[20:23], v[168:171], a[84:87], v[20:23]
    v_permlane16_swap_b32 v232, v234
    v_permlane16_swap_b32 v233, v235
    buffer_store_dwordx4 v[232:235], v153, s[20:23], s61 offen offset:0 sc1
    v_mfma_f32_16x16x32_bf16 v[24:27], v[172:175], a[80:83], v[24:27]
    buffer_load_dwordx4 a[76:79], v159, s[20:23], s100 offen offset:0 sc1
    ds_read_b64_tr_b16 v[164:165], v71 offset:24576
    v_mfma_f32_16x16x32_bf16 v[28:31], v[172:175], a[84:87], v[28:31]
    ds_read_b64_tr_b16 v[166:167], v71 offset:25088
    v_fma_f32 v224, v224, v221, v220
    v_fma_f32 v225, v225, v221, v220
    s_waitcnt lgkmcnt(8)
    v_mfma_f32_16x16x32_bf16 v[32:35], v[176:179], a[80:83], v[32:35]
    ds_read_b64_tr_b16 v[168:169], v68 offset:26624
    ds_read_b64_tr_b16 v[170:171], v68 offset:27136
    v_mfma_f32_16x16x32_bf16 v[36:39], v[176:179], a[84:87], v[36:39]
    v_fma_f32 v226, v226, v221, v220
    v_fma_f32 v227, v227, v221, v220
    v_mul_f32 v224, v224, v100
    v_mfma_f32_16x16x32_bf16 a[252:255], v[148:151], v[176:179], a[252:255]
    v_mul_f32 v225, v225, v101
    v_mul_f32 v226, v226, v102
    v_mul_f32 v227, v227, v103
    v_mfma_f32_16x16x32_bf16 v[40:43], v[180:183], a[80:83], v[40:43]
    ds_read_b64_tr_b16 v[172:173], v69 offset:26624
    ds_read_b64_tr_b16 v[174:175], v69 offset:27136
    v_exp_f32 v224, v224
    v_mfma_f32_16x16x32_bf16 v[44:47], v[180:183], a[84:87], v[44:47]
    v_mul_f32 v132, v100, v132
    v_exp_f32 v225, v225
    v_mfma_f32_16x16x32_bf16 v[48:51], v[184:187], a[80:83], v[48:51]
    ds_read_b64_tr_b16 v[176:177], v70 offset:26624
    ds_read_b64_tr_b16 v[178:179], v70 offset:27136
    v_mul_f32 v133, v101, v133
    v_mfma_f32_16x16x32_bf16 v[52:55], v[184:187], a[84:87], v[52:55]
    v_exp_f32 v226, v226
    v_mul_f32 v134, v102, v134
    v_mfma_f32_16x16x32_bf16 v[56:59], v[188:191], a[80:83], v[56:59]
    ds_read_b64_tr_b16 v[180:181], v71 offset:26624
    ds_read_b64_tr_b16 v[182:183], v71 offset:27136
    v_exp_f32 v227, v227
    v_mfma_f32_16x16x32_bf16 v[60:63], v[188:191], a[84:87], v[60:63]
    v_mul_f32 v135, v103, v135
    s_add_u32 s100, s101, 5120
    s_waitcnt lgkmcnt(8)
    v_mfma_f32_16x16x32_bf16 v[0:3], v[192:195], a[88:91], v[0:3]
    buffer_load_dwordx4 a[80:83], v209, s[20:23], s100 offen offset:0 sc1
    v_lshrrev_b32 v155, 2, v209
    v_mfma_f32_16x16x32_bf16 v[4:7], v[192:195], a[92:95], v[4:7]
    v_min_u32 v155, 16, v155
    buffer_load_dword v147, v155, s[20:23], s36 offen sc1
    v_mfma_f32_16x16x32_bf16 a[248:251], v[148:151], v[192:195], a[248:251]
    v_fma_f32 v224, v224, v222, v222
    v_fma_f32 v225, v225, v222, v222
    v_mfma_f32_16x16x32_bf16 v[8:11], v[196:199], a[88:91], v[8:11]
    v_mfma_f32_16x16x32_bf16 v[12:15], v[196:199], a[92:95], v[12:15]
    s_waitcnt vmcnt(45) lgkmcnt(0)
    s_barrier
    s_add_u32 s45, s0, 0
    s_add_u32 m0, s58, 81920
    v_mfma_f32_16x16x32_bf16 v[16:19], v[160:163], a[88:91], v[16:19]
    buffer_load_dwordx4 v209, s[20:23], s45 offen offset:0 sc1 lds
    ds_read_b64_tr_b16 v[184:185], v64 offset:32768
    v_mfma_f32_16x16x32_bf16 v[20:23], v[160:163], a[92:95], v[20:23]
    ds_read_b64_tr_b16 v[186:187], v64 offset:33280
    ds_read_b64_tr_b16 v[188:189], v65 offset:32768
    v_fma_f32 v226, v226, v222, v222
    v_mfma_f32_16x16x32_bf16 v[24:27], v[164:167], a[88:91], v[24:27]
    buffer_load_dwordx4 a[84:87], v209, s[20:23], s100 offen offset:1024 sc1
    ds_read_b64_tr_b16 v[190:191], v65 offset:33280
    v_mfma_f32_16x16x32_bf16 v[28:31], v[164:167], a[92:95], v[28:31]
    ds_read_b64_tr_b16 v[192:193], v66 offset:32768
    v_fma_f32 v227, v227, v222, v222
    v_mfma_f32_16x16x32_bf16 v[32:35], v[168:171], a[88:91], v[32:35]
    buffer_load_dwordx4 v209, s[20:23], s45 offen offset:1024 sc1 lds
    ds_read_b64_tr_b16 v[194:195], v66 offset:33280
    v_mfma_f32_16x16x32_bf16 v[36:39], v[168:171], a[92:95], v[36:39]
    ds_read_b64_tr_b16 v[196:197], v67 offset:32768
    v_rcp_f32 v224, v224
    v_mfma_f32_16x16x32_bf16 a[252:255], v[148:151], v[168:171], a[252:255]
    v_rcp_f32 v225, v225
    v_mfma_f32_16x16x32_bf16 v[40:43], v[172:175], a[88:91], v[40:43]
    ds_read_b64_tr_b16 v[198:199], v67 offset:33280
    ds_read_b64_tr_b16 v[160:161], v64 offset:34816
    v_rcp_f32 v226, v226
    v_mfma_f32_16x16x32_bf16 v[44:47], v[172:175], a[92:95], v[44:47]
    v_rcp_f32 v227, v227
    v_mul_f32 v132, v132, v224
    v_mfma_f32_16x16x32_bf16 v[48:51], v[176:179], a[88:91], v[48:51]
    buffer_load_dwordx4 v209, s[20:23], s45 offen offset:2048 sc1 lds
    ds_read_b64_tr_b16 v[162:163], v64 offset:35328
    v_mfma_f32_16x16x32_bf16 v[52:55], v[176:179], a[92:95], v[52:55]
    ds_read_b64_tr_b16 v[164:165], v65 offset:34816
    v_mul_f32 v133, v133, v225
    v_mul_f32 v134, v134, v226
    v_mul_f32 v135, v135, v227
    v_mfma_f32_16x16x32_bf16 v[56:59], v[180:183], a[88:91], v[56:59]
    ds_read_b64_tr_b16 v[166:167], v65 offset:35328
    ds_read_b64_tr_b16 v[168:169], v66 offset:34816
    v_cvt_pk_bf16_f32 v236, v132, v133
    v_mfma_f32_16x16x32_bf16 v[60:63], v[180:183], a[92:95], v[60:63]
    v_cvt_pk_bf16_f32 v237, v134, v135
    v_mul_f32 v228, v108, v108
    v_mul_f32 v229, v109, v109
    s_waitcnt lgkmcnt(5)
    v_mfma_f32_16x16x32_bf16 v[0:3], v[184:187], a[96:99], v[0:3]
    buffer_load_dwordx4 v209, s[20:23], s45 offen offset:3072 sc1 lds
    ds_read_b64_tr_b16 v[170:171], v66 offset:35328
    v_mfma_f32_16x16x32_bf16 v[4:7], v[184:187], a[100:103], v[4:7]
    ds_read_b64_tr_b16 v[172:173], v67 offset:34816
    v_mul_f32 v230, v110, v110
    v_mul_f32 v231, v111, v111
    v_mfma_f32_16x16x32_bf16 a[248:251], v[148:151], v[184:187], a[248:251]
    v_fma_f32 v228, v228, v221, v220
    v_fma_f32 v229, v229, v221, v220
    v_mfma_f32_16x16x32_bf16 v[8:11], v[188:191], a[96:99], v[8:11]
    buffer_load_dwordx4 a[88:91], v209, s[20:23], s100 offen offset:2048 sc1
    ds_read_b64_tr_b16 v[174:175], v67 offset:35328
    v_mfma_f32_16x16x32_bf16 v[12:15], v[188:191], a[100:103], v[12:15]
    ds_read_b64_tr_b16 v[176:177], v64 offset:40960
    ds_read_b64_tr_b16 v[178:179], v64 offset:41472
    s_add_u32 m0, s58, 86016
    v_mfma_f32_16x16x32_bf16 v[16:19], v[192:195], a[96:99], v[16:19]
    buffer_load_dwordx4 v159, s[20:23], s45 offen offset:0 sc1 lds
    ds_read_b64_tr_b16 v[180:181], v65 offset:40960
    v_mfma_f32_16x16x32_bf16 v[20:23], v[192:195], a[100:103], v[20:23]
    ds_read_b64_tr_b16 v[182:183], v65 offset:41472
    v_fma_f32 v230, v230, v221, v220
    v_fma_f32 v231, v231, v221, v220
    v_mfma_f32_16x16x32_bf16 v[24:27], v[196:199], a[96:99], v[24:27]
    ds_read_b64_tr_b16 v[184:185], v66 offset:40960
    ds_read_b64_tr_b16 v[186:187], v66 offset:41472
    v_mul_f32 v228, v228, v108
    v_mfma_f32_16x16x32_bf16 v[28:31], v[196:199], a[100:103], v[28:31]
    v_mul_f32 v229, v229, v109
    v_mul_f32 v230, v230, v110
    v_mul_f32 v231, v231, v111
    s_waitcnt lgkmcnt(6)
    v_mfma_f32_16x16x32_bf16 v[32:35], v[160:163], a[96:99], v[32:35]
    buffer_load_dwordx4 a[92:95], v209, s[20:23], s100 offen offset:3072 sc1
    ds_read_b64_tr_b16 v[188:189], v67 offset:40960
    v_mfma_f32_16x16x32_bf16 v[36:39], v[160:163], a[100:103], v[36:39]
    ds_read_b64_tr_b16 v[190:191], v67 offset:41472
    v_exp_f32 v228, v228
    v_mfma_f32_16x16x32_bf16 a[252:255], v[148:151], v[160:163], a[252:255]
    v_mul_f32 v140, v108, v140
    v_exp_f32 v229, v229
    v_mfma_f32_16x16x32_bf16 v[40:43], v[164:167], a[96:99], v[40:43]
    ds_read_b64_tr_b16 v[192:193], v64 offset:43008
    ds_read_b64_tr_b16 v[194:195], v64 offset:43520
    v_mul_f32 v141, v109, v141
    v_mfma_f32_16x16x32_bf16 v[44:47], v[164:167], a[100:103], v[44:47]
    v_exp_f32 v230, v230
    v_mul_f32 v142, v110, v142
    v_mfma_f32_16x16x32_bf16 v[48:51], v[168:171], a[96:99], v[48:51]
    ds_read_b64_tr_b16 v[196:197], v65 offset:43008
    ds_read_b64_tr_b16 v[198:199], v65 offset:43520
    v_mfma_f32_16x16x32_bf16 v[52:55], v[168:171], a[100:103], v[52:55]
    v_exp_f32 v231, v231
    v_mul_f32 v143, v111, v143
    v_fma_f32 v228, v228, v222, v222
    v_mfma_f32_16x16x32_bf16 v[56:59], v[172:175], a[96:99], v[56:59]
    ds_read_b64_tr_b16 v[160:161], v66 offset:43008
    ds_read_b64_tr_b16 v[162:163], v66 offset:43520
    v_fma_f32 v229, v229, v222, v222
    v_mfma_f32_16x16x32_bf16 v[60:63], v[172:175], a[100:103], v[60:63]
    v_fma_f32 v230, v230, v222, v222
    v_fma_f32 v231, v231, v222, v222
    s_waitcnt lgkmcnt(6)
    v_mfma_f32_16x16x32_bf16 v[0:3], v[176:179], a[104:107], v[0:3]
    buffer_load_dwordx4 a[96:99], v159, s[20:23], s100 offen offset:0 sc1
    ds_read_b64_tr_b16 v[164:165], v67 offset:43008
    v_mfma_f32_16x16x32_bf16 v[4:7], v[176:179], a[108:111], v[4:7]
    ds_read_b64_tr_b16 v[166:167], v67 offset:43520
    v_rcp_f32 v228, v228
    v_mfma_f32_16x16x32_bf16 a[248:251], v[148:151], v[176:179], a[248:251]
    v_rcp_f32 v229, v229
    v_mfma_f32_16x16x32_bf16 v[8:11], v[180:183], a[104:107], v[8:11]
    ds_read_b64_tr_b16 v[168:169], v64 offset:49152
    ds_read_b64_tr_b16 v[170:171], v64 offset:49664
    v_mfma_f32_16x16x32_bf16 v[12:15], v[180:183], a[108:111], v[12:15]
    ds_read_b64_tr_b16 v[172:173], v65 offset:49152
    v_rcp_f32 v230, v230
    v_mfma_f32_16x16x32_bf16 v[16:19], v[184:187], a[104:107], v[16:19]
    ds_read_b64_tr_b16 v[174:175], v65 offset:49664
    ds_read_b64_tr_b16 v[176:177], v66 offset:49152
    v_mfma_f32_16x16x32_bf16 v[20:23], v[184:187], a[108:111], v[20:23]
    v_rcp_f32 v231, v231
    v_mul_f32 v140, v140, v228
    s_add_u32 s100, s101, 10240
    v_mfma_f32_16x16x32_bf16 v[24:27], v[188:191], a[104:107], v[24:27]
    buffer_load_dwordx4 a[100:103], v209, s[20:23], s100 offen offset:0 sc1
    ds_read_b64_tr_b16 v[178:179], v66 offset:49664
    v_mfma_f32_16x16x32_bf16 v[28:31], v[188:191], a[108:111], v[28:31]
    ds_read_b64_tr_b16 v[180:181], v67 offset:49152
    v_mul_f32 v141, v141, v229
    v_mul_f32 v142, v142, v230
    s_waitcnt lgkmcnt(7)
    v_mfma_f32_16x16x32_bf16 v[32:35], v[192:195], a[104:107], v[32:35]
    ds_read_b64_tr_b16 v[182:183], v67 offset:49664
    ds_read_b64_tr_b16 v[184:185], v64 offset:51200
    v_mfma_f32_16x16x32_bf16 v[36:39], v[192:195], a[108:111], v[36:39]
    v_mul_f32 v143, v143, v231
    v_cvt_pk_bf16_f32 v238, v140, v141
    v_mfma_f32_16x16x32_bf16 a[252:255], v[148:151], v[192:195], a[252:255]
    v_cvt_pk_bf16_f32 v239, v142, v143
    v_permlane16_swap_b32 v236, v238
    s_nop 0
    v_permlane16_swap_b32 v237, v239
    v_mfma_f32_16x16x32_bf16 v[40:43], v[196:199], a[104:107], v[40:43]
    ds_read_b64_tr_b16 v[186:187], v64 offset:51712
    ds_read_b64_tr_b16 v[188:189], v65 offset:51200
    v_mfma_f32_16x16x32_bf16 v[44:47], v[196:199], a[108:111], v[44:47]
    buffer_store_dwordx4 v[236:239], v153, s[20:23], s61 offen offset:256 sc1
    v_mfma_f32_16x16x32_bf16 v[48:51], v[160:163], a[104:107], v[48:51]
    ds_read_b64_tr_b16 v[190:191], v65 offset:51712
    v_mfma_f32_16x16x32_bf16 v[52:55], v[160:163], a[108:111], v[52:55]
    ds_read_b64_tr_b16 v[192:193], v66 offset:51200
    v_mfma_f32_16x16x32_bf16 v[56:59], v[164:167], a[104:107], v[56:59]
    ds_read_b64_tr_b16 v[194:195], v66 offset:51712
    v_mfma_f32_16x16x32_bf16 v[60:63], v[164:167], a[108:111], v[60:63]
    ds_read_b64_tr_b16 v[196:197], v67 offset:51200
    s_waitcnt lgkmcnt(7)
    v_mfma_f32_16x16x32_bf16 v[0:3], v[168:171], a[112:115], v[0:3]
    buffer_load_dwordx4 a[104:107], v209, s[20:23], s100 offen offset:1024 sc1
    v_mfma_f32_16x16x32_bf16 v[4:7], v[168:171], a[116:119], v[4:7]
    ds_read_b64_tr_b16 v[198:199], v67 offset:51712
    ds_read_b64_tr_b16 v[160:161], v64 offset:57344
    v_mfma_f32_16x16x32_bf16 a[248:251], v[148:151], v[168:171], a[248:251]
    ds_read_b64_tr_b16 v[162:163], v64 offset:57856
    v_add_u32 v202, 152576, v209
    v_mfma_f32_16x16x32_bf16 v[8:11], v[172:175], a[112:115], v[8:11]
    ds_read_b64_tr_b16 v[164:165], v65 offset:57344
    ds_read_b64_tr_b16 v[166:167], v65 offset:57856
    v_mfma_f32_16x16x32_bf16 v[12:15], v[172:175], a[116:119], v[12:15]
    ds_read_b128 v[96:99], v202 offset:0
    ds_read_b128 v[100:103], v202 offset:1024
    v_mfma_f32_16x16x32_bf16 v[16:19], v[176:179], a[112:115], v[16:19]
    ds_read_b64_tr_b16 v[168:169], v66 offset:57344
    ds_read_b64_tr_b16 v[170:171], v66 offset:57856
    v_mfma_f32_16x16x32_bf16 v[20:23], v[176:179], a[116:119], v[20:23]
    ds_read_b128 v[104:107], v202 offset:2048
    v_and_b32 v208, 0x1f0, v209
    s_waitcnt vmcnt(12)
    v_mfma_f32_16x16x32_bf16 v[24:27], v[180:183], a[112:115], v[24:27]
    buffer_load_dwordx4 a[108:111], v209, s[20:23], s100 offen offset:2048 sc1
    v_mfma_f32_16x16x32_bf16 v[28:31], v[180:183], a[116:119], v[28:31]
    ds_read_b64_tr_b16 v[172:173], v67 offset:57344
    ds_read_b64_tr_b16 v[174:175], v67 offset:57856
    s_waitcnt lgkmcnt(11)
    v_mfma_f32_16x16x32_bf16 v[32:35], v[184:187], a[112:115], v[32:35]
    ds_read_b64_tr_b16 v[176:177], v64 offset:59392
    ds_read_b64_tr_b16 v[178:179], v64 offset:59904
    v_mfma_f32_16x16x32_bf16 v[36:39], v[184:187], a[116:119], v[36:39]
    s_nop 0
P_qq_chk:
    v_cmp_ne_u32 vcc, v147, v145
    s_nop 4
    s_cbranch_vccnz P_qq_slow
P_qq_done:
    v_mfma_f32_16x16x32_bf16 a[252:255], v[148:151], v[184:187], a[252:255]
    buffer_load_dwordx4 v[72:75], v209, s[20:23], s76 offen offset:0 sc1
    v_mfma_f32_16x16x32_bf16 v[40:43], v[188:191], a[112:115], v[40:43]
    ds_read_b64_tr_b16 v[180:181], v65 offset:59392
    ds_read_b64_tr_b16 v[182:183], v65 offset:59904
    v_mfma_f32_16x16x32_bf16 v[44:47], v[188:191], a[116:119], v[44:47]
    buffer_load_dwordx4 v[76:79], v209, s[20:23], s76 offen offset:1024 sc1
    v_mfma_f32_16x16x32_bf16 v[48:51], v[192:195], a[112:115], v[48:51]
    ds_read_b64_tr_b16 v[184:185], v66 offset:59392
    ds_read_b64_tr_b16 v[186:187], v66 offset:59904
    v_mfma_f32_16x16x32_bf16 v[52:55], v[192:195], a[116:119], v[52:55]
    buffer_load_dwordx4 v[204:207], v208, s[20:23], s76 offen offset:2048 sc1
    s_waitcnt lgkmcnt(8)
    v_mfma_f32_16x16x32_bf16 v[56:59], v[196:199], a[112:115], v[56:59]
    ds_read_b64_tr_b16 v[188:189], v67 offset:59392
    ds_read_b64_tr_b16 v[190:191], v67 offset:59904
    v_mfma_f32_16x16x32_bf16 v[60:63], v[196:199], a[116:119], v[60:63]
    ds_read_b64_tr_b16 v[112:113], v96
    ds_read_b64_tr_b16 v[114:115], v97
    s_waitcnt lgkmcnt(10)
    v_mfma_f32_16x16x32_bf16 v[0:3], v[160:163], a[120:123], v[0:3]
    buffer_load_dwordx4 a[112:115], v209, s[20:23], s100 offen offset:3072 sc1
    v_mfma_f32_16x16x32_bf16 v[4:7], v[160:163], a[124:127], v[4:7]
    ds_read_b64_tr_b16 v[116:117], v98
    ds_read_b64_tr_b16 v[118:119], v99
    v_mfma_f32_16x16x32_bf16 a[248:251], v[148:151], v[160:163], a[248:251]
    ds_read_b64_tr_b16 v[120:121], v100
    ds_read_b64_tr_b16 v[122:123], v101
    v_mfma_f32_16x16x32_bf16 v[8:11], v[164:167], a[120:123], v[8:11]
    v_mfma_f32_16x16x32_bf16 v[12:15], v[164:167], a[124:127], v[12:15]
    s_waitcnt lgkmcnt(0)
    s_barrier
    s_add_u32 s45, s0, 5120
    s_add_u32 m0, s58, 61440
    v_mfma_f32_16x16x32_bf16 v[16:19], v[168:171], a[120:123], v[16:19]
    buffer_load_dwordx4 v209, s[20:23], s45 offen offset:0 sc1 lds
    v_mfma_f32_16x16x32_bf16 v[20:23], v[168:171], a[124:127], v[20:23]
    ds_read_b64_tr_b16 v[192:193], v64 offset:0
    ds_read_b64_tr_b16 v[194:195], v64 offset:512
    v_mfma_f32_16x16x32_bf16 v[24:27], v[172:175], a[120:123], v[24:27]
    buffer_load_dwordx4 a[116:119], v159, s[20:23], s100 offen offset:0 sc1
    v_mfma_f32_16x16x32_bf16 v[28:31], v[172:175], a[124:127], v[28:31]
    ds_read_b64_tr_b16 v[196:197], v64 offset:2048
    ds_read_b64_tr_b16 v[198:199], v64 offset:2560
    v_mfma_f32_16x16x32_bf16 v[32:35], v[176:179], a[120:123], v[32:35]
    buffer_load_dwordx4 v209, s[20:23], s45 offen offset:1024 sc1 lds
    v_mfma_f32_16x16x32_bf16 v[36:39], v[176:179], a[124:127], v[36:39]
    ds_read_b64_tr_b16 v[160:161], v64 offset:8192
    ds_read_b64_tr_b16 v[162:163], v64 offset:8704
    v_mfma_f32_16x16x32_bf16 a[252:255], v[148:151], v[176:179], a[252:255]
    ds_read_b64_tr_b16 v[124:125], v102
    ds_read_b64_tr_b16 v[126:127], v103
    v_mfma_f32_16x16x32_bf16 v[40:43], v[180:183], a[120:123], v[40:43]
    ds_read_b64_tr_b16 v[164:165], v64 offset:10240
    ds_read_b64_tr_b16 v[166:167], v64 offset:10752
    v_mfma_f32_16x16x32_bf16 v[44:47], v[180:183], a[124:127], v[44:47]
    ds_read_b64_tr_b16 v[128:129], v104
    ds_read_b64_tr_b16 v[130:131], v105
    v_mfma_f32_16x16x32_bf16 v[48:51], v[184:187], a[120:123], v[48:51]
    buffer_load_dwordx4 v209, s[20:23], s45 offen offset:2048 sc1 lds
    v_mfma_f32_16x16x32_bf16 v[52:55], v[184:187], a[124:127], v[52:55]
    ds_read_b64_tr_b16 v[168:169], v64 offset:16384
    ds_read_b64_tr_b16 v[170:171], v64 offset:16896
    v_mfma_f32_16x16x32_bf16 v[56:59], v[188:191], a[120:123], v[56:59]
    ds_read_b64_tr_b16 v[172:173], v64 offset:18432
    ds_read_b64_tr_b16 v[174:175], v64 offset:18944
    v_mfma_f32_16x16x32_bf16 v[60:63], v[188:191], a[124:127], v[60:63]
    ds_read_b64_tr_b16 v[132:133], v106
    ds_read_b64_tr_b16 v[134:135], v107
    s_waitcnt lgkmcnt(8)
    v_mfma_f32_16x16x32_bf16 v[0:3], v[192:195], a[128:131], v[0:3]
    buffer_load_dwordx4 v209, s[20:23], s45 offen offset:3072 sc1 lds
    ds_read_b64_tr_b16 v[176:177], v64 offset:24576
    v_mfma_f32_16x16x32_bf16 v[4:7], v[192:195], a[132:135], v[4:7]
    ds_read_b64_tr_b16 v[178:179], v64 offset:25088
    s_and_b32 s54, s2, 6
    s_lshl_b32 s54, s54, 2
    v_mfma_f32_16x16x32_bf16 a[248:251], v[148:151], v[192:195], a[248:251]
    s_bfe_u32 s70, s2, 0x30003
    s_add_u32 s100, s101, 15360
    v_mfma_f32_16x16x32_bf16 v[32:35], v[196:199], a[128:131], v[32:35]
    buffer_load_dwordx4 a[120:123], v209, s[20:23], s100 offen offset:0 sc1
    ds_read_b64_tr_b16 v[180:181], v64 offset:26624
    v_mfma_f32_16x16x32_bf16 v[36:39], v[196:199], a[132:135], v[36:39]
    ds_read_b64_tr_b16 v[182:183], v64 offset:27136
    s_add_u32 s54, s54, s70
    v_mfma_f32_16x16x32_bf16 a[252:255], v[148:151], v[196:199], a[252:255]
    s_mul_i32 s55, s2, 257
    s_add_u32 m0, s58, 65536
    v_mfma_f32_16x16x32_bf16 v[0:3], v[160:163], a[136:139], v[0:3]
    buffer_load_dwordx4 v159, s[20:23], s45 offen offset:0 sc1 lds
    ds_read_b64_tr_b16 v[184:185], v65 offset:0
    v_mfma_f32_16x16x32_bf16 v[4:7], v[160:163], a[140:143], v[4:7]
    ds_read_b64_tr_b16 v[186:187], v65 offset:512
    s_bfe_u32 s55, s55, 0x30006
    v_mfma_f32_16x16x32_bf16 a[248:251], v[148:151], v[160:163], a[248:251]
    s_mul_i32 s70, s40, 3
    s_min_u32 s70, s70, 5
    s_lshl_b32 s51, s54, 4
    v_mfma_f32_16x16x32_bf16 v[32:35], v[164:167], a[136:139], v[32:35]
    ds_read_b64_tr_b16 v[188:189], v66 offset:0
    ds_read_b64_tr_b16 v[190:191], v66 offset:512
    v_mfma_f32_16x16x32_bf16 v[36:39], v[164:167], a[140:143], v[36:39]
    s_add_u32 s51, s51, s70
    s_lshl_b32 s51, s51, 7
    s_add_u32 s51, s51, 19450880
    v_mfma_f32_16x16x32_bf16 a[252:255], v[148:151], v[164:167], a[252:255]
    s_add_u32 s45, s0, 10240
    s_add_u32 m0, s58, 40960
    s_waitcnt lgkmcnt(4)
    v_mfma_f32_16x16x32_bf16 v[0:3], v[168:171], a[144:147], v[0:3]
    buffer_load_dwordx4 v209, s[20:23], s45 offen offset:0 sc1 lds
    ds_read_b64_tr_b16 v[192:193], v67 offset:0
    v_mfma_f32_16x16x32_bf16 v[4:7], v[168:171], a[148:151], v[4:7]
    ds_read_b64_tr_b16 v[194:195], v67 offset:512
    s_add_u32 s57, s76, 2621440
    v_mfma_f32_16x16x32_bf16 a[248:251], v[148:151], v[168:171], a[248:251]
    s_add_u32 s47, s43, 65536
    s_mul_i32 s76, s54, 221184
    v_mfma_f32_16x16x32_bf16 v[32:35], v[172:175], a[144:147], v[32:35]
    buffer_load_dwordx4 a[124:127], v209, s[20:23], s100 offen offset:1024 sc1
    ds_read_b64_tr_b16 v[196:197], v65 offset:2048
    v_mfma_f32_16x16x32_bf16 v[36:39], v[172:175], a[148:151], v[36:39]
    ds_read_b64_tr_b16 v[198:199], v65 offset:2560
    s_add_u32 s76, s76, 2621440
    s_mul_i32 s70, s40, 12288
    s_add_u32 s53, s76, s70
    v_mfma_f32_16x16x32_bf16 a[252:255], v[148:151], v[172:175], a[252:255]
    s_lshl_b32 s70, s40, 14
    s_waitcnt vmcnt(15)
    buffer_store_dword v145, v144, s[20:23], s43 offen sc1
    v_mfma_f32_16x16x32_bf16 v[0:3], v[176:179], a[152:155], v[0:3]
    buffer_load_dwordx4 v209, s[20:23], s45 offen offset:1024 sc1 lds
    ds_read_b64_tr_b16 v[160:161], v66 offset:2048
    v_mfma_f32_16x16x32_bf16 v[4:7], v[176:179], a[156:159], v[4:7]
    ds_read_b64_tr_b16 v[162:163], v66 offset:2560
    s_add_u32 s76, s76, s70
    v_mfma_f32_16x16x32_bf16 a[248:251], v[148:151], v[176:179], a[248:251]
    s_add_u32 s76, s76, 45056
    ds_read_b128 v[212:215], v202 offset:3072
    v_mfma_f32_16x16x32_bf16 v[32:35], v[180:183], a[152:155], v[32:35]
    ds_read_b64_tr_b16 v[164:165], v67 offset:2048
    ds_read_b64_tr_b16 v[166:167], v67 offset:2560
    v_mfma_f32_16x16x32_bf16 v[36:39], v[180:183], a[156:159], v[36:39]
    ds_read_b128 v[140:143], v202 offset:4096
    s_lshr_b32 s71, s40, 1
    s_and_b32 s70, s40, 1
    v_mfma_f32_16x16x32_bf16 a[252:255], v[148:151], v[180:183], a[252:255]
    s_lshl_b32 s70, s70, 8
    s_mul_i32 s72, s71, 110592
    s_waitcnt lgkmcnt(6)
    v_mfma_f32_16x16x32_bf16 v[8:11], v[184:187], a[128:131], v[8:11]
    buffer_load_dwordx4 v209, s[20:23], s45 offen offset:2048 sc1 lds
    ds_read_b64_tr_b16 v[168:169], v65 offset:8192
    v_mfma_f32_16x16x32_bf16 v[12:15], v[184:187], a[132:135], v[12:15]
    ds_read_b64_tr_b16 v[170:171], v65 offset:8704
    s_sub_u32 s73, 110592, s72
    s_add_u32 s72, s72, s70
    v_mfma_f32_16x16x32_bf16 v[16:19], v[188:191], a[128:131], v[16:19]
    ds_read_b64_tr_b16 v[172:173], v66 offset:8192
    ds_read_b64_tr_b16 v[174:175], v66 offset:8704
    v_accvgpr_read_b32 v240, a248
    v_mfma_f32_16x16x32_bf16 v[20:23], v[188:191], a[132:135], v[20:23]
    v_accvgpr_read_b32 v241, a252
    v_xor_b32 v244, 8, v156
    s_add_u32 s73, s73, s70
    v_mfma_f32_16x16x32_bf16 v[24:27], v[192:195], a[128:131], v[24:27]
    buffer_load_dwordx4 v209, s[20:23], s45 offen offset:3072 sc1 lds
    ds_read_b64_tr_b16 v[176:177], v67 offset:8192
    v_mfma_f32_16x16x32_bf16 v[28:31], v[192:195], a[132:135], v[28:31]
    ds_read_b64_tr_b16 v[178:179], v67 offset:8704
    v_xor_b32 v245, 16, v156
    v_xor_b32 v246, 24, v156
    v_mfma_f32_16x16x32_bf16 v[40:43], v[196:199], a[128:131], v[40:43]
    ds_read_b64_tr_b16 v[180:181], v65 offset:10240
    ds_read_b64_tr_b16 v[182:183], v65 offset:10752
    v_and_b32 v242, 0xffff0000, v240
    v_mfma_f32_16x16x32_bf16 v[44:47], v[196:199], a[132:135], v[44:47]
    v_sub_f32 v240, v240, v242
    s_add_u32 m0, s58, 45056
    s_waitcnt lgkmcnt(4)
    v_mfma_f32_16x16x32_bf16 v[48:51], v[160:163], a[128:131], v[48:51]
    buffer_load_dwordx4 v159, s[20:23], s45 offen offset:0 sc1 lds
    ds_read_b64_tr_b16 v[184:185], v66 offset:10240
    v_mfma_f32_16x16x32_bf16 v[52:55], v[160:163], a[132:135], v[52:55]
    ds_read_b64_tr_b16 v[186:187], v66 offset:10752
    v_cvt_pk_bf16_f32 v240, v242, v240
    s_lshl_b32 s52, s54, 1
    v_mfma_f32_16x16x32_bf16 v[56:59], v[164:167], a[128:131], v[56:59]
    ds_read_b64_tr_b16 v[188:189], v67 offset:10240
    ds_read_b64_tr_b16 v[190:191], v67 offset:10752
    v_and_b32 v243, 0xffff0000, v241
    v_mfma_f32_16x16x32_bf16 v[60:63], v[164:167], a[132:135], v[60:63]
    v_sub_f32 v241, v241, v243
    v_cvt_pk_bf16_f32 v241, v243, v241
    s_add_u32 s52, s52, s71
    v_mfma_f32_16x16x32_bf16 v[8:11], v[168:171], a[136:139], v[8:11]
    buffer_load_dwordx4 a[128:131], v209, s[20:23], s100 offen offset:2048 sc1
    ds_read_b64_tr_b16 v[192:193], v65 offset:16384
    v_mfma_f32_16x16x32_bf16 v[12:15], v[168:171], a[140:143], v[12:15]
    ds_read_b64_tr_b16 v[194:195], v65 offset:16896
    ds_write_b64 v156, v[240:241] offset:0
    v_mfma_f32_16x16x32_bf16 v[16:19], v[172:175], a[136:139], v[16:19]
    ds_read_b64_tr_b16 v[196:197], v66 offset:16384
    ds_read_b64_tr_b16 v[198:199], v66 offset:16896
    v_mfma_f32_16x16x32_bf16 v[20:23], v[172:175], a[140:143], v[20:23]
    ds_write_b64 v244, v[240:241] offset:2048
    s_mul_i32 s52, s52, 40960
    s_waitcnt lgkmcnt(6)
    v_mfma_f32_16x16x32_bf16 v[24:27], v[176:179], a[136:139], v[24:27]
    ds_read_b64_tr_b16 v[160:161], v67 offset:16384
    ds_read_b64_tr_b16 v[162:163], v67 offset:16896
    v_mfma_f32_16x16x32_bf16 v[28:31], v[176:179], a[140:143], v[28:31]
    ds_write_b64 v245, v[240:241] offset:4096
    ds_write_b64 v246, v[240:241] offset:6144
    v_mfma_f32_16x16x32_bf16 v[40:43], v[180:183], a[136:139], v[40:43]
    buffer_load_dwordx4 a[132:135], v209, s[20:23], s100 offen offset:3072 sc1
    ds_read_b64_tr_b16 v[164:165], v65 offset:18432
    v_mfma_f32_16x16x32_bf16 v[44:47], v[180:183], a[140:143], v[44:47]
    ds_read_b64_tr_b16 v[166:167], v65 offset:18944
    s_add_u32 s52, s52, s70
    s_add_u32 s52, s52, 12320768
    v_mfma_f32_16x16x32_bf16 v[48:51], v[184:187], a[136:139], v[48:51]
    ds_read_b64_tr_b16 v[168:169], v66 offset:18432
    ds_read_b64_tr_b16 v[170:171], v66 offset:18944
    s_lshl_b32 s48, s54, 11
    v_mfma_f32_16x16x32_bf16 v[52:55], v[184:187], a[140:143], v[52:55]
    s_lshl_b32 s71, s71, 2
    s_add_u32 s49, s48, s71
    s_add_u32 s49, s49, 19580928
    v_mfma_f32_16x16x32_bf16 v[56:59], v[188:191], a[136:139], v[56:59]
    v_mfma_f32_16x16x32_bf16 v[60:63], v[188:191], a[140:143], v[60:63]
    s_waitcnt lgkmcnt(4)
    s_barrier
    ds_read_b64_tr_b16 v[172:173], v67 offset:18432
    ds_read_b64_tr_b16 v[174:175], v67 offset:18944
    s_waitcnt lgkmcnt(4)
    v_mfma_f32_16x16x32_bf16 v[8:11], v[192:195], a[144:147], v[8:11]
    buffer_load_dwordx4 a[136:139], v159, s[20:23], s100 offen offset:0 sc1
    ds_read_b64_tr_b16 v[176:177], v65 offset:24576
    v_mfma_f32_16x16x32_bf16 v[12:15], v[192:195], a[148:151], v[12:15]
    ds_read_b64_tr_b16 v[178:179], v65 offset:25088
    ds_read_b128 v[240:243], v157 offset:0
    ds_read_b128 v[244:247], v157 offset:16
    v_mfma_f32_16x16x32_bf16 v[16:19], v[196:199], a[144:147], v[16:19]
    ds_read_b64_tr_b16 v[180:181], v66 offset:24576
    ds_read_b64_tr_b16 v[182:183], v66 offset:25088
    s_lshl_b32 s71, s40, 9
    s_add_u32 s48, s48, s71
    v_mfma_f32_16x16x32_bf16 v[20:23], v[196:199], a[148:151], v[20:23]
    s_add_u32 s48, s48, 19515392
    v_bfe_u32 v155, v209, 2, 4
    v_min_u32 v155, s35, v155
    v_mfma_f32_16x16x32_bf16 v[24:27], v[160:163], a[144:147], v[24:27]
    ds_read_b64_tr_b16 v[184:185], v67 offset:24576
    v_mfma_f32_16x16x32_bf16 v[28:31], v[160:163], a[148:151], v[28:31]
    ds_read_b64_tr_b16 v[186:187], v67 offset:25088
    s_waitcnt vmcnt(18)
    v_mfma_f32_32x32x16_bf16 v[80:95], v[112:115], v[72:75], 0
    v_mfma_f32_32x32x16_bf16 v[80:95], v[120:123], v[76:79], v[80:95]
    v_mfma_f32_32x32x16_bf16 v[80:95], v[128:131], v[204:207], v[80:95]
    v_mfma_f32_32x32x16_bf16 v[96:111], v[116:119], v[72:75], 0
    v_mfma_f32_16x16x32_bf16 v[40:43], v[164:167], a[144:147], v[40:43]
    ds_read_b64_tr_b16 v[188:189], v65 offset:26624
    ds_read_b64_tr_b16 v[190:191], v65 offset:27136
    s_waitcnt lgkmcnt(6)
    v_mfma_f32_16x16x16_bf16 v[8:11], v[242:243], v[248:249], v[8:11]
    v_mfma_f32_16x16x16_bf16 v[12:15], v[242:243], v[252:253], v[12:15]
    v_mfma_f32_16x16x16_bf16 v[0:3], v[240:241], v[248:249], v[0:3]
    v_add_u32 v148, s72, v140
    v_mfma_f32_16x16x32_bf16 v[44:47], v[164:167], a[148:151], v[44:47]
    v_add_u32 v150, s73, v140
    v_xor_b32 v149, 256, v148
    v_xor_b32 v151, 256, v150
    v_bfe_u32 v156, v209, 5, 2
    v_mfma_f32_32x32x16_bf16 v[96:111], v[124:127], v[76:79], v[96:111]
    v_mfma_f32_32x32x16_bf16 v[96:111], v[132:135], v[204:207], v[96:111]
    s_waitcnt lgkmcnt(4)
    v_mfma_f32_16x16x32_bf16 v[48:51], v[168:171], a[144:147], v[48:51]
    ds_read_b64_tr_b16 v[192:193], v66 offset:26624
    ds_read_b64_tr_b16 v[194:195], v66 offset:27136
    v_mfma_f32_16x16x16_bf16 v[16:19], v[244:245], v[248:249], v[16:19]
    v_mfma_f32_16x16x16_bf16 v[20:23], v[244:245], v[252:253], v[20:23]
    v_mfma_f32_16x16x16_bf16 v[32:35], v[240:241], v[250:251], v[32:35]
    v_bfe_u32 v157, v209, 2, 3
    v_min_u32 v158, 2, v156
    v_mfma_f32_16x16x32_bf16 v[52:55], v[168:171], a[148:151], v[52:55]
    v_lshl_add_u32 v158, v158, 7, v157
    v_lshl_add_u32 v156, v156, 7, v157
    v_and_b32 v157, 0xf0, v209
    v_lshlrev_b32 v157, 3, v157
    v_mfma_f32_16x16x32_bf16 v[56:59], v[172:175], a[144:147], v[56:59]
    ds_read_b64_tr_b16 v[196:197], v67 offset:26624
    v_mfma_f32_16x16x32_bf16 v[60:63], v[172:175], a[148:151], v[60:63]
    ds_read_b64_tr_b16 v[198:199], v67 offset:27136
    v_mfma_f32_16x16x16_bf16 v[24:27], v[246:247], v[248:249], v[24:27]
    v_mfma_f32_16x16x16_bf16 v[28:31], v[246:247], v[252:253], v[28:31]
    v_mfma_f32_16x16x16_bf16 v[4:7], v[240:241], v[252:253], v[4:7]
    v_mfma_f32_16x16x32_bf16 v[8:11], v[176:179], a[152:155], v[8:11]
    v_mfma_f32_16x16x16_bf16 v[40:43], v[242:243], v[250:251], v[40:43]
    v_mfma_f32_16x16x16_bf16 v[44:47], v[242:243], v[254:255], v[44:47]
    v_mfma_f32_16x16x16_bf16 v[36:39], v[240:241], v[254:255], v[36:39]
    v_mfma_f32_16x16x32_bf16 v[12:15], v[176:179], a[156:159], v[12:15]
    v_mfma_f32_16x16x32_bf16 v[16:19], v[180:183], a[152:155], v[16:19]
    v_mfma_f32_16x16x16_bf16 v[48:51], v[244:245], v[250:251], v[48:51]
    v_mfma_f32_16x16x16_bf16 v[52:55], v[244:245], v[254:255], v[52:55]
    v_mfma_f32_16x16x32_bf16 v[20:23], v[180:183], a[156:159], v[20:23]
    s_waitcnt lgkmcnt(0)
    v_mfma_f32_16x16x32_bf16 v[24:27], v[184:187], a[152:155], v[24:27]
    v_mfma_f32_16x16x16_bf16 v[56:59], v[246:247], v[250:251], v[56:59]
    v_mfma_f32_16x16x16_bf16 v[60:63], v[246:247], v[254:255], v[60:63]
    v_mfma_f32_16x16x32_bf16 v[28:31], v[184:187], a[156:159], v[28:31]
    v_mfma_f32_16x16x32_bf16 v[40:43], v[188:191], a[152:155], v[40:43]
    v_mfma_f32_16x16x32_bf16 v[44:47], v[188:191], a[156:159], v[44:47]
    v_mfma_f32_16x16x32_bf16 v[48:51], v[192:195], a[152:155], v[48:51]
    v_mfma_f32_16x16x32_bf16 v[52:55], v[192:195], a[156:159], v[52:55]
    v_mfma_f32_16x16x32_bf16 v[56:59], v[196:199], a[152:155], v[56:59]
    v_mfma_f32_16x16x32_bf16 v[60:63], v[196:199], a[156:159], v[60:63]
    s_branch KP_join
K1_kv:
    v_mul_u32_u24 v3, 3456, v1
    v_add_u32 v200, v3, v2
    v_xor_b32 v3, 64, v200
    v_add_u32 v201, 26624, v3
    s_mov_b32 s12, s30
    s_mov_b32 s13, s31
    s_mov_b32 s14, 2457600
    s_mov_b32 s15, 0x20000
    s_mul_i32 s58, s40, 5120
    s_mul_i32 s71, s44, 160
    s_add_u32 s71, s71, 1280
    s_mul_i32 s46, s40, 61440
    s_add_u32 s46, s46, s71
    s_and_b32 s50, s71, 0xffffff80
    s_movk_i32 s70, 3277
    v_add_u32 v1, 0, v0
    v_mul_u32_u24 v2, s70, v1
    v_lshrrev_b32 v2, 16, v2
    v_mul_u32_u24 v3, 20, v2
    v_sub_u32 v3, v1, v3
    v_cmp_lt_u32 vcc, 9, v3
    v_mul_u32_u24 v2, 3840, v2
    v_lshl_add_u32 v2, v3, 4, v2
    v_subrev_u32 v2, 0, v2
    v_add_u32 v3, 1120, v2
    v_cndmask_b32 v202, v2, v3, vcc
    v_add_u32 v1, 64, v0
    v_mul_u32_u24 v2, s70, v1
    v_lshrrev_b32 v2, 16, v2
    v_mul_u32_u24 v3, 20, v2
    v_sub_u32 v3, v1, v3
    v_cmp_lt_u32 vcc, 9, v3
    v_mul_u32_u24 v2, 3840, v2
    v_lshl_add_u32 v2, v3, 4, v2
    v_subrev_u32 v2, 1024, v2
    v_add_u32 v3, 1120, v2
    v_cndmask_b32 v203, v2, v3, vcc
    v_add_u32 v1, 128, v0
    v_mul_u32_u24 v2, s70, v1
    v_lshrrev_b32 v2, 16, v2
    v_mul_u32_u24 v3, 20, v2
    v_sub_u32 v3, v1, v3
    v_lshrrev_b32 v4, 2, v2
    v_and_b32 v4, 2, v4
    v_xor_b32 v3, v3, v4
    v_cmp_lt_u32 vcc, 9, v3
    v_mul_u32_u24 v2, 3840, v2
    v_lshl_add_u32 v2, v3, 4, v2
    v_subrev_u32 v2, 2048, v2
    v_add_u32 v3, 1120, v2
    v_cndmask_b32 v206, v2, v3, vcc
    v_add_u32 v1, 192, v0
    v_mul_u32_u24 v2, s70, v1
    v_lshrrev_b32 v2, 16, v2
    v_mul_u32_u24 v3, 20, v2
    v_sub_u32 v3, v1, v3
    v_xor_b32 v3, 2, v3
    v_cmp_lt_u32 vcc, 9, v3
    v_mul_u32_u24 v2, 3840, v2
    v_lshl_add_u32 v2, v3, 4, v2
    v_subrev_u32 v2, 3072, v2
    v_add_u32 v3, 1120, v2
    v_cndmask_b32 v207, v2, v3, vcc
    v_add_u32 v1, 256, v0
    v_mul_u32_u24 v2, s70, v1
    v_lshrrev_b32 v2, 16, v2
    v_mul_u32_u24 v3, 20, v2
    v_sub_u32 v3, v1, v3
    v_xor_b32 v3, 2, v3
    v_cmp_lt_u32 vcc, 9, v3
    v_mul_u32_u24 v2, 3840, v2
    v_lshl_add_u32 v2, v3, 4, v2
    v_subrev_u32 v2, 0, v2
    v_add_u32 v3, 1120, v2
    v_cndmask_b32 v208, v2, v3, vcc
    s_add_u32 m0, s58, 0
    s_nop 0
    buffer_load_dwordx4 v202, s[12:15], s46 offen offset:0 lds
    buffer_load_dwordx4 v203, s[12:15], s46 offen offset:1024 lds
    buffer_load_dwordx4 v206, s[12:15], s46 offen offset:2048 lds
    buffer_load_dwordx4 v207, s[12:15], s46 offen offset:3072 lds
    s_add_u32 m0, s58, 4096
    s_nop 0
    buffer_load_dwordx4 v208, s[12:15], s46 offen offset:0 lds
    s_add_u32 s46, s46, 245760
    s_mul_i32 s70, s42, 10
    v_mov_b32 v3, 1073741824
    v_lshrrev_b32 v4, 2, v0
    v_add_u32 v4, s70, v4
    v_mul_u32_u24 v4, 3840, v4
    v_and_b32 v5, 1, v0
    v_lshl_add_u32 v4, v5, 7, v4
    v_cmp_gt_u32 vcc, 40, v0
    v_bfe_u32 v5, v0, 1, 1
    v_mul_u32_u24 v5, 1280, v5
    v_add_u32 v4, v4, v5
    v_cndmask_b32 v9, v3, v4, vcc
    v_add_u32 v4, s70, v0
    v_cmp_gt_u32 vcc, 10, v0
    v_mul_u32_u24 v4, 3456, v4
    s_nop 0
    v_cndmask_b32 v8, v3, v4, vcc
    buffer_load_dword a211, v9, s[12:15], s50 offen
    s_mov_b32 s4, s32
    s_mov_b32 s5, s33
    s_mov_b32 s6, 2211840
    s_mov_b32 s7, 0x20000
    s_sub_u32 s8, s34, 2048
    s_subb_u32 s9, s35, 0
    s_mov_b32 s10, 2213888
    s_mov_b32 s11, 0x20000
    s_and_b32 s3, s74, 2
    s_lshl_b32 s3, s3, 2
    s_add_u32 s3, s3, s44
    s_add_u32 s49, s49, 128
    s_add_u32 s45, s49, 18432
    s_mov_b32 s20, s36
    s_mov_b32 s21, s37
    s_mov_b32 s22, 19972096
    s_mov_b32 s23, 0x20000
    s_add_u32 s36, s36, 19447808
    s_addc_u32 s37, s37, 0
    s_load_dword s38, s[36:37], 0
    s_load_dwordx2 s[16:17], s[0:1], 16
    s_load_dwordx2 s[30:31], s[0:1], 64
    s_load_dwordx2 s[96:97], s[0:1], 24
    s_load_dwordx2 s[98:99], s[0:1], 56
    v_lshlrev_b32 v209, 4, v0
    v_bfe_u32 v1, v0, 4, 1
    v_bfe_u32 v2, v0, 2, 2
    v_lshl_add_u32 v3, v1, 3, v2
    v_lshrrev_b32 v4, 5, v0
    v_and_b32 v5, 3, v0
    v_lshlrev_b32 v5, 3, v5
    v_bfe_u32 v2, v0, 3, 2
    v_xor_b32 v2, s40, v2
    v_lshl_add_u32 v2, v2, 5, v5
    v_lshl_add_u32 v2, v3, 7, v2
    v_lshl_add_u32 v192, v4, 12, v2
    s_and_b32 s70, s40, 1
    v_lshl_add_u32 v192, s70, 13, v192
    v_xor_b32 v193, 32, v192
    v_xor_b32 v194, 64, v192
    v_xor_b32 v195, 96, v192
    v_xor_b32 v196, 8192, v192
    v_xor_b32 v197, 8192, v193
    v_xor_b32 v198, 8192, v194
    v_xor_b32 v199, 8192, v195
    v_mul_u32_u24 v2, 320, v3
    v_mul_u32_u24 v6, 5120, v4
    v_add3_u32 v2, v2, v6, v5
    v_lshl_add_u32 v6, v1, 5, v2
    v_xor_b32 v1, 1, v1
    v_lshl_add_u32 v2, v1, 5, v2
    v_xor_b32 v1, 1, v1
    s_mul_i32 s71, s70, 10240
    v_add_u32 v210, s71, v6
    v_add_u32 v211, s71, v2
    s_sub_u32 s71, 10240, s71
    v_add_u32 v212, s71, v6
    v_add_u32 v213, s71, v2
    v_xor_b32 v2, s40, v1
    v_lshl_add_u32 v2, v2, 1, v4
    v_and_b32 v5, 15, v0
    v_lshlrev_b32 v6, 4, v5
    v_lshl_add_u32 v152, v2, 9, v6
    v_xor_b32 v153, 2048, v152
    v_lshrrev_b32 v2, 4, v0
    v_bfe_u32 v3, v0, 1, 3
    v_xor_b32 v2, v2, v3
    v_lshlrev_b32 v2, 4, v2
    v_lshl_add_u32 v2, v5, 7, v2
    v_add_u32 v144, s59, v2
    s_lshl_b32 s70, s70, 6
    v_xor_b32 v144, s70, v144
    v_xor_b32 v145, 64, v144
    v_mov_b32 v146, 0x3f803f80
    v_lshrrev_b32 v2, 4, v0
    v_lshlrev_b32 v2, 2, v2
    v_cmp_eq_u32 vcc, v5, v2
    v_lshlrev_b32 v1, 5, v0
    v_add_u32 v1, 143360, v1
    v_lshl_add_u32 v156, s40, 3, v1
    v_lshl_add_u32 v157, s40, 11, v1
    v_cndmask_b32 v148, 0, v146, vcc
    v_cndmask_b32 v149, 0, v146, vcc
    v_cndmask_b32 v150, 0, v146, vcc
    v_cndmask_b32 v151, 0, v146, vcc
    s_waitcnt lgkmcnt(0)
    s_add_u32 s77, s44, 11
    s_lshl_b32 s71, s77, 7
    s_mul_i32 s47, s40, 55296
    s_add_u32 s47, s47, s71
    s_and_b32 s51, s71, 0xffffff80
    s_mul_i32 s62, s42, 110592
    s_lshl_b32 s79, s77, 12
    s_add_u32 s62, s62, s79
    s_add_u32 s62, s62, 2621440
    v_and_b32 v1, 15, v0
    v_lshl_add_u32 v1, s40, 5, v1
    v_lshrrev_b32 v4, 4, v0
    v_mul_u32_u24 v5, 176, v1
    v_add_u32 v5, 104448, v5
    v_lshl_add_u32 v155, v4, 3, v5
    v_mul_u32_u24 v5, 336, v1
    v_mul_u32_u24 v6, 80, v4
    v_add_u32 v5, v5, v6
    v_add_u32 v154, 61440, v5
    v_lshrrev_b32 v1, 2, v0
    v_and_b32 v2, 3, v0
    v_mul_u32_u24 v2, 20, v2
    v_sub_u32 v2, v1, v2
    v_mul_u32_u24 v1, 40, v1
    v_mov_b32 v3, 158720
    v_add_u32 v5, 0, v2
    v_cmp_gt_u32 vcc, 20, v5
    v_add_u32 v6, 136448, v1
    s_nop 0
    v_cndmask_b32 v10, v3, v6, vcc
    v_add_u32 v5, 16, v2
    v_cmp_gt_u32 vcc, 20, v5
    v_add_u32 v6, 137088, v1
    s_nop 0
    v_cndmask_b32 v11, v3, v6, vcc
    v_add_u32 v5, 32, v2
    v_cmp_gt_u32 vcc, 20, v5
    v_add_u32 v6, 137728, v1
    s_nop 0
    v_cndmask_b32 v12, v3, v6, vcc
    v_add_u32 v5, 48, v2
    v_cmp_gt_u32 vcc, 20, v5
    v_add_u32 v6, 138368, v1
    s_nop 0
    v_cndmask_b32 v13, v3, v6, vcc
    v_add_u32 v5, 64, v2
    v_cmp_gt_u32 vcc, 20, v5
    v_add_u32 v6, 139008, v1
    s_nop 0
    v_cndmask_b32 v14, v3, v6, vcc
    v_lshrrev_b32 v4, 5, v0
    v_bfe_u32 v1, v0, 2, 2
    v_lshlrev_b32 v1, 2, v1
    v_lshl_add_u32 v1, v4, 1, v1
    v_and_b32 v2, 1, v0
    v_bfe_u32 v3, v0, 1, 1
    v_lshl_add_u32 v2, v2, 1, v3
    v_bfe_u32 v3, v0, 4, 1
    v_lshl_add_u32 v2, v3, 2, v2
    v_mul_u32_u24 v5, 336, v1
    v_lshl_add_u32 v5, v2, 3, v5
    s_mul_i32 s70, s40, 80
    s_add_u32 s70, s70, 61440
    v_add_u32 v214, s70, v5
    v_and_b32 v2, 3, v0
    v_lshl_add_u32 v2, v3, 2, v2
    s_mul_i32 s70, s40, 40
    v_lshlrev_b32 v5, 3, v2
    v_add_u32 v5, s70, v5
    v_cmp_gt_u32 vcc, 5, v2
    v_mov_b32 v6, 160
    s_nop 0
    v_cndmask_b32 v5, v6, v5, vcc
    v_mul_u32_u24 v6, 176, v1
    v_add_u32 v5, v5, v6
    v_add_u32 v215, 104448, v5
    v_and_b32 v1, 31, v0
    v_lshl_add_u32 v16, s40, 5, v1
    v_mul_u32_u24 v16, 176, v16
    v_add_u32 v16, 104448, v16
    v_mul_u32_u24 v2, 21, v4
    v_add_u32 v2, v2, v1
    v_lshlrev_b32 v2, 4, v2
    v_mov_b32 v3, 1073741824
    v_cmp_gt_u32 vcc, 21, v1
    s_nop 1
    v_cndmask_b32 v17, v3, v2, vcc
    v_cmp_gt_u32 vcc, 21, v0
    s_nop 1
    v_cndmask_b32 v18, v3, v2, vcc
    v_mov_b32 v20, 0x3f80
    v_mov_b32 v21, 0
    s_lshr_b32 s70, s40, 1
    s_lshl_b32 s71, s44, 1
    s_add_u32 s74, s70, s71
    s_lshl_b32 s70, s74, 4
    s_add_u32 s70, s70, s41
    s_waitcnt vmcnt(1)
    s_barrier
    ds_read_b128 a[0:3], v144 offset:0
    ds_read_b128 a[4:7], v144 offset:2048
    ds_read_b128 a[8:11], v145 offset:0
    ds_read_b128 a[12:15], v145 offset:2048
    ds_read_b64_tr_b16 v[160:161], v210 offset:0
    ds_read_b64_tr_b16 v[162:163], v210 offset:1280
    ds_read_b64_tr_b16 v[164:165], v211 offset:0
    ds_read_b64_tr_b16 v[166:167], v211 offset:1280
    ds_read_b64_tr_b16 v[168:169], v210 offset:64
    ds_read_b64_tr_b16 v[170:171], v210 offset:1344
    ds_read_b64_tr_b16 v[172:173], v211 offset:64
    ds_read_b64_tr_b16 v[174:175], v211 offset:1344
    ds_read_b64_tr_b16 v[176:177], v210 offset:128
    ds_read_b64_tr_b16 v[178:179], v210 offset:1408
    ds_read_b64_tr_b16 v[180:181], v211 offset:128
    ds_read_b64_tr_b16 v[182:183], v211 offset:1408
    s_add_u32 m0, s58, 20480
    s_waitcnt lgkmcnt(4)
    v_mfma_f32_16x16x32_bf16 v[64:67], v[160:163], a[0:3], 0
    buffer_load_dwordx4 v202, s[12:15], s46 offen offset:0 lds
    v_mfma_f32_16x16x32_bf16 v[68:71], v[160:163], a[4:7], 0
    ds_read_b64_tr_b16 v[184:185], v210 offset:192
    v_mfma_f32_16x16x32_bf16 a[216:219], v[148:151], v[160:163], 0
    ds_read_b64_tr_b16 v[186:187], v210 offset:1472
    v_mfma_f32_16x16x32_bf16 v[72:75], v[164:167], a[0:3], 0
    buffer_load_dwordx4 v203, s[12:15], s46 offen offset:1024 lds
    v_mfma_f32_16x16x32_bf16 v[76:79], v[164:167], a[4:7], 0
    ds_read_b64_tr_b16 v[188:189], v211 offset:192
    v_mfma_f32_16x16x32_bf16 a[220:223], v[148:151], v[164:167], 0
    ds_read_b64_tr_b16 v[190:191], v211 offset:1472
    v_mfma_f32_16x16x32_bf16 v[80:83], v[168:171], a[0:3], 0
    buffer_load_dwordx4 v206, s[12:15], s46 offen offset:2048 lds
    v_mfma_f32_16x16x32_bf16 v[84:87], v[168:171], a[4:7], 0
    ds_read_b64_tr_b16 v[160:161], v210 offset:256
    v_mfma_f32_16x16x32_bf16 a[224:227], v[148:151], v[168:171], 0
    ds_read_b64_tr_b16 v[162:163], v210 offset:1536
    v_mfma_f32_16x16x32_bf16 v[88:91], v[172:175], a[0:3], 0
    buffer_load_dwordx4 v207, s[12:15], s46 offen offset:3072 lds
    v_mfma_f32_16x16x32_bf16 v[92:95], v[172:175], a[4:7], 0
    ds_read_b64_tr_b16 v[164:165], v211 offset:256
    ds_read_b64_tr_b16 v[166:167], v211 offset:1536
    v_mfma_f32_16x16x32_bf16 a[228:231], v[148:151], v[172:175], 0
    s_add_u32 m0, s58, 24576
    s_waitcnt lgkmcnt(4)
    v_mfma_f32_16x16x32_bf16 v[96:99], v[176:179], a[0:3], 0
    buffer_load_dwordx4 v208, s[12:15], s46 offen offset:0 lds
    ds_read_b64_tr_b16 v[168:169], v212 offset:0
    v_mfma_f32_16x16x32_bf16 v[100:103], v[176:179], a[4:7], 0
    ds_read_b64_tr_b16 v[170:171], v212 offset:1280
    ds_read_b64_tr_b16 v[172:173], v213 offset:0
    v_mfma_f32_16x16x32_bf16 a[232:235], v[148:151], v[176:179], 0
    s_add_u32 s46, s46, 245760
    s_add_u32 m0, s59, 16384
    v_mfma_f32_16x16x32_bf16 v[104:107], v[180:183], a[0:3], 0
    buffer_load_dwordx4 v204, s[24:27], s49 offen offset:0 lds
    v_mfma_f32_16x16x32_bf16 v[108:111], v[180:183], a[4:7], 0
    ds_read_b64_tr_b16 v[174:175], v213 offset:1280
    v_mfma_f32_16x16x32_bf16 a[236:239], v[148:151], v[180:183], 0
    ds_read_b64_tr_b16 v[176:177], v212 offset:64
    v_mfma_f32_16x16x32_bf16 v[112:115], v[184:187], a[0:3], 0
    buffer_load_dwordx4 v205, s[24:27], s49 offen offset:1024 lds
    v_mfma_f32_16x16x32_bf16 v[116:119], v[184:187], a[4:7], 0
    ds_read_b64_tr_b16 v[178:179], v212 offset:1344
    v_mfma_f32_16x16x32_bf16 a[240:243], v[148:151], v[184:187], 0
    ds_read_b64_tr_b16 v[180:181], v213 offset:64
    v_mfma_f32_16x16x32_bf16 v[120:123], v[188:191], a[0:3], 0
    buffer_load_dwordx4 v204, s[24:27], s45 offen offset:2048 lds
    v_mfma_f32_16x16x32_bf16 v[124:127], v[188:191], a[4:7], 0
    ds_read_b64_tr_b16 v[182:183], v213 offset:1344
    v_mfma_f32_16x16x32_bf16 a[244:247], v[148:151], v[188:191], 0
    ds_read_b64_tr_b16 v[184:185], v212 offset:128
    s_waitcnt lgkmcnt(5)
    v_mfma_f32_16x16x32_bf16 v[128:131], v[160:163], a[0:3], 0
    buffer_load_dwordx4 v205, s[24:27], s45 offen offset:3072 lds
    ds_read_b64_tr_b16 v[186:187], v212 offset:1408
    v_mfma_f32_16x16x32_bf16 v[132:135], v[160:163], a[4:7], 0
    ds_read_b64_tr_b16 v[188:189], v213 offset:128
    ds_read_b64_tr_b16 v[190:191], v213 offset:1408
    v_mfma_f32_16x16x32_bf16 a[248:251], v[148:151], v[160:163], 0
    s_add_u32 s49, s49, 128
    s_add_u32 s45, s49, 18432
    s_add_u32 m0, s58, 40960
    v_mfma_f32_16x16x32_bf16 v[136:139], v[164:167], a[0:3], 0
    buffer_load_dwordx4 v202, s[12:15], s46 offen offset:0 lds
    v_mfma_f32_16x16x32_bf16 v[140:143], v[164:167], a[4:7], 0
    ds_read_b64_tr_b16 v[160:161], v212 offset:192
    v_mfma_f32_16x16x32_bf16 a[252:255], v[148:151], v[164:167], 0
    ds_read_b64_tr_b16 v[162:163], v212 offset:1472
    v_mfma_f32_16x16x32_bf16 v[64:67], v[168:171], a[8:11], v[64:67]
    buffer_load_dwordx4 v203, s[12:15], s46 offen offset:1024 lds
    v_mfma_f32_16x16x32_bf16 v[68:71], v[168:171], a[12:15], v[68:71]
    ds_read_b64_tr_b16 v[164:165], v213 offset:192
    ds_read_b64_tr_b16 v[166:167], v213 offset:1472
    v_mfma_f32_16x16x32_bf16 v[72:75], v[172:175], a[8:11], v[72:75]
    buffer_load_dwordx4 v206, s[12:15], s46 offen offset:2048 lds
    v_mfma_f32_16x16x32_bf16 v[76:79], v[172:175], a[12:15], v[76:79]
    ds_read_b64_tr_b16 v[168:169], v212 offset:256
    ds_read_b64_tr_b16 v[170:171], v212 offset:1536
    s_waitcnt lgkmcnt(6)
    v_mfma_f32_16x16x32_bf16 v[80:83], v[176:179], a[8:11], v[80:83]
    buffer_load_dwordx4 v207, s[12:15], s46 offen offset:3072 lds
    ds_read_b64_tr_b16 v[172:173], v213 offset:256
    v_mfma_f32_16x16x32_bf16 v[84:87], v[176:179], a[12:15], v[84:87]
    ds_read_b64_tr_b16 v[174:175], v213 offset:1536
    s_add_u32 m0, s58, 45056
    v_mfma_f32_16x16x32_bf16 v[88:91], v[180:183], a[8:11], v[88:91]
    v_mfma_f32_16x16x32_bf16 v[92:95], v[180:183], a[12:15], v[92:95]
    buffer_load_dwordx4 v208, s[12:15], s46 offen offset:0 lds
    s_add_u32 s46, s46, 245760
    s_mul_i32 s70, s70, 3456
    s_and_b32 s71, s40, 1
    s_mul_i32 s71, s71, 1680
    s_add_u32 s70, s70, s71
    s_add_u32 s65, s70, 17973248
    s_lshl_b32 s74, s74, 3
    s_lshr_b32 s70, s41, 1
    s_add_u32 s74, s74, s70
    s_lshl_b32 s74, s74, 7
    s_and_b32 s70, s41, 1
    s_lshl_b32 s70, s70, 1
    s_and_b32 s71, s40, 1
    s_add_u32 s70, s70, s71
    s_lshl_b32 s70, s70, 2
    s_add_u32 s74, s74, s70
    s_add_u32 s74, s74, 19654656
    s_mul_i32 s58, s40, 5120
    s_mul_i32 s38, s38, 0x9E3779B1
    s_add_u32 s38, s38, 0x7F4A7C15
    v_mov_b32 v28, s38
    v_mov_b32 v29, 1073741824
    v_cmp_eq_u32 vcc, 0, v0
    v_bfe_u32 v30, v209, 1, 8
    v_and_b32 v1, 15, v0
    v_cndmask_b32 v29, v29, v0, vcc
    s_lshl_b32 s70, s40, 10
    s_mul_i32 s69, s44, 3200
    s_add_u32 s69, s69, s70
    s_and_b32 s75, s2, 7
    s_lshl_b32 s75, s75, 1
    s_bfe_u32 s71, s2, 0x10003
    s_add_u32 s75, s75, s71
    s_and_b32 s70, s70, 1024
    s_mul_i32 s100, s75, 1600
    s_add_u32 s100, s100, s70
    v_lshrrev_b32 v2, 5, v209
    v_min_u32 v2, 18, v2
    s_mul_i32 s70, s40, 6
    v_add_u32 v1, s70, v2
    v_min_u32 v1, 21, v1
    v_add_u32 v1, 20, v1
    s_lshl_b32 s70, s40, 3
    s_add_u32 s70, s70, 36
    v_add_u32 v3, s70, v2
    v_cmp_lt_u32 vcc, 5, v2
    s_nop 1
    v_cndmask_b32 v1, v1, v3, vcc
    s_mul_i32 s70, s40, 5
    s_sub_u32 s70, s70, 14
    v_add_u32 v3, s70, v2
    v_cmp_lt_u32 vcc, 13, v2
    s_nop 1
    v_cndmask_b32 v1, v1, v3, vcc
    v_cndmask_b32 v2, 1, 0, vcc
    v_mad_u32_u24 v1, v1, 10, v2
    v_bfe_u32 v2, v209, 4, 1
    s_mul_i32 s70, s2, 257
    s_bfe_u32 s70, s70, 0x30006
    s_mul_i32 s70, s70, 5
    s_lshr_b32 s70, s70, 2
    v_add3_u32 v1, v1, v2, s70
    v_mul_u32_u24 v1, 21846, v1
    v_lshrrev_b32 v1, 16, v1
    v_lshlrev_b32 v1, 4, v1
    v_accvgpr_write_b32 a212, v1
    s_lshl_b32 s1, s2, 2
    s_add_u32 s1, s1, 19448832
    s_cmp_eq_u32 s40, 0
    s_cselect_b32 s1, s1, 1073741824
    s_lshr_b32 s70, s2, 4
    s_lshl_b32 s70, s70, 2
    s_add_u32 s70, s70, s40
    s_lshl_b32 s36, s70, 7
    s_add_u32 s36, s36, 19646464
    s_mul_i32 s76, s70, 40960
    s_mul_i32 s71, s75, 2560
    s_add_u32 s76, s76, s71
    s_add_u32 s76, s76, 9699328
    s_lshr_b32 s28, s70, 1
    s_lshl_b32 s28, s28, 4
    s_add_u32 s28, s28, s75
    s_lshl_b32 s28, s28, 7
    s_and_b32 s70, s40, 1
    s_lshl_b32 s70, s70, 2
    s_add_u32 s70, s70, 19447808
    s_add_u32 s28, s28, s70
    s_add_u32 s28, s28, 133120
    s_lshl_b32 s77, s75, 2
    s_add_u32 s77, s77, s40
    s_lshl_b32 s33, s77, 7
    s_add_u32 s33, s33, 19687424
    v_mfma_f32_16x16x32_bf16 v[96:99], v[184:187], a[8:11], v[96:99]
    v_mfma_f32_16x16x32_bf16 v[100:103], v[184:187], a[12:15], v[100:103]
    s_waitcnt vmcnt(5) lgkmcnt(0)
    s_barrier
    s_add_u32 m0, s59, 32768
    v_mfma_f32_16x16x32_bf16 v[104:107], v[188:191], a[8:11], v[104:107]
    buffer_load_dwordx4 v204, s[24:27], s49 offen offset:0 lds
    ds_read_b128 a[16:19], v144 offset:16384
    v_mfma_f32_16x16x32_bf16 v[108:111], v[188:191], a[12:15], v[108:111]
    ds_read_b64_tr_b16 v[176:177], v210 offset:20480
    ds_read_b64_tr_b16 v[178:179], v210 offset:21760
    ds_read_b64_tr_b16 v[180:181], v211 offset:20480
    v_mfma_f32_16x16x32_bf16 v[112:115], v[160:163], a[8:11], v[112:115]
    buffer_load_dwordx4 v205, s[24:27], s49 offen offset:1024 lds
    ds_read_b128 a[20:23], v144 offset:18432
    v_mfma_f32_16x16x32_bf16 v[116:119], v[160:163], a[12:15], v[116:119]
    ds_read_b64_tr_b16 v[182:183], v211 offset:21760
    ds_read_b64_tr_b16 v[184:185], v210 offset:20544
    v_mfma_f32_16x16x32_bf16 v[120:123], v[164:167], a[8:11], v[120:123]
    buffer_load_dwordx4 v204, s[24:27], s45 offen offset:2048 lds
    ds_read_b128 a[24:27], v145 offset:16384
    v_mfma_f32_16x16x32_bf16 v[124:127], v[164:167], a[12:15], v[124:127]
    ds_read_b64_tr_b16 v[186:187], v210 offset:21824
    ds_read_b64_tr_b16 v[188:189], v211 offset:20544
    v_mfma_f32_16x16x32_bf16 v[128:131], v[168:171], a[8:11], v[128:131]
    buffer_load_dwordx4 v205, s[24:27], s45 offen offset:3072 lds
    ds_read_b128 a[28:31], v145 offset:18432
    ds_read_b64_tr_b16 v[190:191], v211 offset:21824
    v_mfma_f32_16x16x32_bf16 v[132:135], v[168:171], a[12:15], v[132:135]
    ds_read_b64_tr_b16 v[160:161], v210 offset:20608
    s_add_u32 s49, s49, 128
    s_add_u32 s45, s49, 18432
    s_add_u32 m0, s58, 0
    v_mfma_f32_16x16x32_bf16 v[136:139], v[172:175], a[8:11], v[136:139]
    buffer_load_dwordx4 v202, s[12:15], s46 offen offset:0 lds
    ds_read_b64_tr_b16 v[162:163], v210 offset:21888
    v_mfma_f32_16x16x32_bf16 v[140:143], v[172:175], a[12:15], v[140:143]
    ds_read_b64_tr_b16 v[164:165], v211 offset:20608
    ds_read_b64_tr_b16 v[166:167], v211 offset:21888
    s_waitcnt lgkmcnt(4)
    v_mfma_f32_16x16x32_bf16 v[64:67], v[176:179], a[16:19], v[64:67]
    buffer_load_dwordx4 v203, s[12:15], s46 offen offset:1024 lds
    v_mfma_f32_16x16x32_bf16 v[68:71], v[176:179], a[20:23], v[68:71]
    ds_read_b64_tr_b16 v[168:169], v210 offset:20672
    v_mfma_f32_16x16x32_bf16 a[216:219], v[148:151], v[176:179], a[216:219]
    ds_read_b64_tr_b16 v[170:171], v210 offset:21952
    v_mfma_f32_16x16x32_bf16 v[72:75], v[180:183], a[16:19], v[72:75]
    buffer_load_dwordx4 v206, s[12:15], s46 offen offset:2048 lds
    v_mfma_f32_16x16x32_bf16 v[76:79], v[180:183], a[20:23], v[76:79]
    ds_read_b64_tr_b16 v[172:173], v211 offset:20672
    v_mfma_f32_16x16x32_bf16 a[220:223], v[148:151], v[180:183], a[220:223]
    ds_read_b64_tr_b16 v[174:175], v211 offset:21952
    v_mfma_f32_16x16x32_bf16 v[80:83], v[184:187], a[16:19], v[80:83]
    buffer_load_dwordx4 v207, s[12:15], s46 offen offset:3072 lds
    v_mfma_f32_16x16x32_bf16 v[84:87], v[184:187], a[20:23], v[84:87]
    ds_read_b64_tr_b16 v[176:177], v210 offset:20736
    v_mfma_f32_16x16x32_bf16 a[224:227], v[148:151], v[184:187], a[224:227]
    ds_read_b64_tr_b16 v[178:179], v210 offset:22016
    s_add_u32 m0, s58, 4096
    v_mfma_f32_16x16x32_bf16 v[88:91], v[188:191], a[16:19], v[88:91]
    buffer_load_dwordx4 v208, s[12:15], s46 offen offset:0 lds
    v_mfma_f32_16x16x32_bf16 v[92:95], v[188:191], a[20:23], v[92:95]
    ds_read_b64_tr_b16 v[180:181], v211 offset:20736
    ds_read_b64_tr_b16 v[182:183], v211 offset:22016
    v_mfma_f32_16x16x32_bf16 a[228:231], v[148:151], v[188:191], a[228:231]
    s_add_u32 s46, s46, 245760
    s_add_u32 m0, s59, 0
    s_waitcnt lgkmcnt(4)
    v_mfma_f32_16x16x32_bf16 v[96:99], v[160:163], a[16:19], v[96:99]
    buffer_load_dwordx4 v204, s[24:27], s49 offen offset:0 lds
    v_mfma_f32_16x16x32_bf16 v[100:103], v[160:163], a[20:23], v[100:103]
    ds_read_b64_tr_b16 v[184:185], v212 offset:20480
    v_mfma_f32_16x16x32_bf16 a[232:235], v[148:151], v[160:163], a[232:235]
    ds_read_b64_tr_b16 v[186:187], v212 offset:21760
    ds_read_b64_tr_b16 v[188:189], v213 offset:20480
    v_mfma_f32_16x16x32_bf16 v[104:107], v[164:167], a[16:19], v[104:107]
    buffer_load_dwordx4 v205, s[24:27], s49 offen offset:1024 lds
    v_mfma_f32_16x16x32_bf16 v[108:111], v[164:167], a[20:23], v[108:111]
    ds_read_b64_tr_b16 v[190:191], v213 offset:21760
    v_mfma_f32_16x16x32_bf16 a[236:239], v[148:151], v[164:167], a[236:239]
    ds_read_b64_tr_b16 v[160:161], v212 offset:20544
    v_mfma_f32_16x16x32_bf16 v[112:115], v[168:171], a[16:19], v[112:115]
    buffer_load_dwordx4 v204, s[24:27], s45 offen offset:2048 lds
    v_mfma_f32_16x16x32_bf16 v[116:119], v[168:171], a[20:23], v[116:119]
    ds_read_b64_tr_b16 v[162:163], v212 offset:21824
    v_mfma_f32_16x16x32_bf16 a[240:243], v[148:151], v[168:171], a[240:243]
    ds_read_b64_tr_b16 v[164:165], v213 offset:20544
    v_mfma_f32_16x16x32_bf16 v[120:123], v[172:175], a[16:19], v[120:123]
    buffer_load_dwordx4 v205, s[24:27], s45 offen offset:3072 lds
    v_mfma_f32_16x16x32_bf16 v[124:127], v[172:175], a[20:23], v[124:127]
    ds_read_b64_tr_b16 v[166:167], v213 offset:21824
    ds_read_b64_tr_b16 v[168:169], v212 offset:20608
    v_mfma_f32_16x16x32_bf16 a[244:247], v[148:151], v[172:175], a[244:247]
    s_add_u32 s49, s49, 128
    s_add_u32 s45, s49, 18432
    s_waitcnt lgkmcnt(5)
    v_mfma_f32_16x16x32_bf16 v[128:131], v[176:179], a[16:19], v[128:131]
    ds_read_b64_tr_b16 v[170:171], v212 offset:21888
    v_mfma_f32_16x16x32_bf16 v[132:135], v[176:179], a[20:23], v[132:135]
    ds_read_b64_tr_b16 v[172:173], v213 offset:20608
    v_mfma_f32_16x16x32_bf16 a[248:251], v[148:151], v[176:179], a[248:251]
    ds_read_b64_tr_b16 v[174:175], v213 offset:21888
    v_mfma_f32_16x16x32_bf16 v[136:139], v[180:183], a[16:19], v[136:139]
    ds_read_b64_tr_b16 v[176:177], v212 offset:20672
    v_mfma_f32_16x16x32_bf16 v[140:143], v[180:183], a[20:23], v[140:143]
    v_mfma_f32_16x16x32_bf16 a[252:255], v[148:151], v[180:183], a[252:255]
    ds_read_b64_tr_b16 v[178:179], v212 offset:21952
    v_mfma_f32_16x16x32_bf16 v[64:67], v[184:187], a[24:27], v[64:67]
    ds_read_b64_tr_b16 v[180:181], v213 offset:20672
    v_mfma_f32_16x16x32_bf16 v[68:71], v[184:187], a[28:31], v[68:71]
    ds_read_b64_tr_b16 v[182:183], v213 offset:21952
    v_mfma_f32_16x16x32_bf16 v[72:75], v[188:191], a[24:27], v[72:75]
    ds_read_b64_tr_b16 v[184:185], v212 offset:20736
    v_mfma_f32_16x16x32_bf16 v[76:79], v[188:191], a[28:31], v[76:79]
    ds_read_b64_tr_b16 v[186:187], v212 offset:22016
    s_waitcnt lgkmcnt(6)
    v_mfma_f32_16x16x32_bf16 v[80:83], v[160:163], a[24:27], v[80:83]
    ds_read_b64_tr_b16 v[188:189], v213 offset:20736
    v_mfma_f32_16x16x32_bf16 v[84:87], v[160:163], a[28:31], v[84:87]
    ds_read_b64_tr_b16 v[190:191], v213 offset:22016
    v_mfma_f32_16x16x32_bf16 v[88:91], v[164:167], a[24:27], v[88:91]
    v_mfma_f32_16x16x32_bf16 v[92:95], v[164:167], a[28:31], v[92:95]
    s_lshl_b32 s77, s77, 10
    s_add_u32 s77, s77, 18857984
    s_cmp_lt_u32 s40, 3
    s_cselect_b32 s35, 12, 4
    s_lshr_b32 s43, s42, 1
    s_lshl_b32 s43, s43, 4
    s_add_u32 s43, s43, s3
    s_lshl_b32 s43, s43, 7
    s_add_u32 s43, s43, s70
    s_add_u32 s43, s43, 2048
    s_lshl_b32 s67, s42, 8
    s_add_u32 s67, s67, 19671040
    s_add_u32 s48, s47, 221184
    s_add_u32 s51, s47, 442368
    s_add_u32 s52, s47, 663552
    s_add_u32 s55, s47, 884736
    s_add_u32 s56, s47, 1105920
    s_add_u32 s41, s47, 1327104
    s_add_u32 s42, s47, 1548288
    s_add_u32 s44, s47, 1769472
    s_add_u32 s3, s47, 1990656
    s_mul_i32 s68, s2, 257
    s_bfe_u32 s68, s68, 0x30006
    s_mul_i32 s0, s68, 378880
    s_add_u32 s0, s0, 14942208
    s_mul_i32 s75, s58, 6
    s_add_u32 s75, s75, s0
    s_add_u32 s75, s75, 102400
    s_lshl_b32 s101, s58, 3
    s_add_u32 s101, s101, s0
    s_add_u32 s101, s101, 215040
    s_mul_i32 s68, s58, 5
    s_add_u32 s0, s0, s68
    v_lshrrev_b32 v1, 4, v0
    v_mul_u32_u24 v1, 3072, v1
    v_bfe_u32 v2, v0, 2, 2
    v_lshl_add_u32 v1, v2, 7, v1
    v_bfe_u32 v2, v0, 3, 1
    v_bfe_u32 v3, v0, 1, 1
    v_xor_b32 v2, v2, v3
    v_lshl_add_u32 v1, v2, 4, v1
    v_and_b32 v2, 1, v0
    v_lshl_add_u32 v1, v2, 3, v1
    v_lshl_add_u32 v1, s40, 5, v1
    v_add_u32 v32, 110592, v1
    v_xor_b32 v33, 32, v32
    s_cmp_lt_u32 s2, 67
    s_cselect_b32 s96, s96, s98
    s_cselect_b32 s97, s97, s99
    s_mov_b32 s98, 2211840
    s_cselect_b32 s98, 819200, s98
    s_mov_b32 s99, 0x20000
    s_cselect_b32 s29, 0, 67
    s_cselect_b32 s79, 0, 100
    s_cselect_b32 s63, 20, 54
    s_sub_u32 s29, s2, s29
    s_mul_i32 s29, s29, 3
    s_add_u32 s79, s79, s40
    v_add_u32 v1, s29, v0
    v_mul_u32_u24 v2, 6554, v1
    v_lshrrev_b32 v2, 16, v2
    v_mul_u32_u24 v3, 10, v2
    v_sub_u32 v1, v1, v3
    v_cmp_gt_u32 vcc, s63, v2
    v_lshl_add_u32 v3, v1, 2, s40
    v_mul_u32_u24 v3, 52, v3
    v_lshrrev_b32 v3, 8, v3
    v_mul_u32_u24 v3, 365, v3
    v_lshl_add_u32 v3, v1, 2, v3
    v_mad_u32_u24 v3, v2, 5, v3
    v_add_u32 v3, s79, v3
    v_lshlrev_b32 v3, 10, v3
    v_add_u32 v3, 14942208, v3
    v_mov_b32 v4, 1073741824
    v_cndmask_b32 v3, v4, v3, vcc
    v_lshl_add_u32 v2, v2, 2, s40
    v_mul_u32_u24 v2, 10240, v2
    v_lshl_add_u32 v2, v1, 7, v2
    v_readlane_b32 s68, v3, 0
    v_readlane_b32 s63, v2, 0
    v_readlane_b32 s37, v3, 1
    v_readlane_b32 s78, v2, 1
    v_readlane_b32 s54, v3, 2
    v_readlane_b32 s32, v2, 2
    s_lshl_b32 s29, s2, 4
    s_add_u32 s29, s29, 19695616
    s_cmp_eq_u32 s40, 0
    s_cselect_b32 s29, s29, 1073741824
    s_mul_i32 s79, s40, 3072
    s_mov_b32 s39, 20000
    v_mfma_f32_16x16x32_bf16 v[96:99], v[168:171], a[24:27], v[96:99]
    v_mfma_f32_16x16x32_bf16 v[100:103], v[168:171], a[28:31], v[100:103]
    s_waitcnt vmcnt(9) lgkmcnt(0)
    s_barrier
    s_add_u32 m0, s79, 110592
    v_mfma_f32_16x16x32_bf16 v[104:107], v[172:175], a[24:27], v[104:107]
    buffer_load_dwordx4 v204, s[96:99], s63 offen lds
    ds_read_b128 a[32:35], v144 offset:32768
    ds_read_b64_tr_b16 v[160:161], v210 offset:40960
    v_mfma_f32_16x16x32_bf16 v[108:111], v[172:175], a[28:31], v[108:111]
    ds_read_b64_tr_b16 v[162:163], v210 offset:42240
    ds_read_b64_tr_b16 v[164:165], v211 offset:40960
    s_add_u32 m0, s79, 111616
    v_mfma_f32_16x16x32_bf16 v[112:115], v[176:179], a[24:27], v[112:115]
    buffer_load_dwordx4 v204, s[96:99], s78 offen lds
    ds_read_b128 a[36:39], v144 offset:34816
    v_mfma_f32_16x16x32_bf16 v[116:119], v[176:179], a[28:31], v[116:119]
    ds_read_b64_tr_b16 v[166:167], v211 offset:42240
    ds_read_b64_tr_b16 v[168:169], v210 offset:41024
    s_add_u32 m0, s79, 112640
    v_mfma_f32_16x16x32_bf16 v[120:123], v[180:183], a[24:27], v[120:123]
    buffer_load_dwordx4 v204, s[96:99], s32 offen lds
    ds_read_b128 a[40:43], v145 offset:32768
    v_mfma_f32_16x16x32_bf16 v[124:127], v[180:183], a[28:31], v[124:127]
    ds_read_b64_tr_b16 v[170:171], v210 offset:42304
    ds_read_b64_tr_b16 v[172:173], v211 offset:41024
    s_add_u32 m0, s58, 20480
    v_mfma_f32_16x16x32_bf16 v[128:131], v[184:187], a[24:27], v[128:131]
    buffer_load_dwordx4 v202, s[12:15], s46 offen offset:0 lds
    ds_read_b128 a[44:47], v145 offset:34816
    v_mfma_f32_16x16x32_bf16 v[132:135], v[184:187], a[28:31], v[132:135]
    ds_read_b64_tr_b16 v[174:175], v211 offset:42304
    ds_read_b64_tr_b16 v[176:177], v210 offset:41088
    v_mfma_f32_16x16x32_bf16 v[136:139], v[188:191], a[24:27], v[136:139]
    buffer_load_dwordx4 v203, s[12:15], s46 offen offset:1024 lds
    ds_read_b64_tr_b16 v[178:179], v210 offset:42368
    v_mfma_f32_16x16x32_bf16 v[140:143], v[188:191], a[28:31], v[140:143]
    ds_read_b64_tr_b16 v[180:181], v211 offset:41088
    ds_read_b64_tr_b16 v[182:183], v211 offset:42368
    s_waitcnt lgkmcnt(4)
    v_mfma_f32_16x16x32_bf16 v[64:67], v[160:163], a[32:35], v[64:67]
    buffer_load_dwordx4 v206, s[12:15], s46 offen offset:2048 lds
    v_mfma_f32_16x16x32_bf16 v[68:71], v[160:163], a[36:39], v[68:71]
    ds_read_b64_tr_b16 v[184:185], v210 offset:41152
    v_mfma_f32_16x16x32_bf16 a[216:219], v[148:151], v[160:163], a[216:219]
    ds_read_b64_tr_b16 v[186:187], v210 offset:42432
    v_mfma_f32_16x16x32_bf16 v[72:75], v[164:167], a[32:35], v[72:75]
    ds_read_b64_tr_b16 v[188:189], v211 offset:41152
    v_mfma_f32_16x16x32_bf16 v[76:79], v[164:167], a[36:39], v[76:79]
    v_mfma_f32_16x16x32_bf16 a[220:223], v[148:151], v[164:167], a[220:223]
    ds_read_b64_tr_b16 v[190:191], v211 offset:42432
    v_mfma_f32_16x16x32_bf16 v[80:83], v[168:171], a[32:35], v[80:83]
    buffer_load_dwordx4 v207, s[12:15], s46 offen offset:3072 lds
    v_mfma_f32_16x16x32_bf16 v[84:87], v[168:171], a[36:39], v[84:87]
    ds_read_b64_tr_b16 v[160:161], v210 offset:41216
    v_mfma_f32_16x16x32_bf16 a[224:227], v[148:151], v[168:171], a[224:227]
    ds_read_b64_tr_b16 v[162:163], v210 offset:42496
    v_mfma_f32_16x16x32_bf16 v[88:91], v[172:175], a[32:35], v[88:91]
    ds_read_b64_tr_b16 v[164:165], v211 offset:41216
    v_mfma_f32_16x16x32_bf16 v[92:95], v[172:175], a[36:39], v[92:95]
    ds_read_b64_tr_b16 v[166:167], v211 offset:42496
    v_mfma_f32_16x16x32_bf16 a[228:231], v[148:151], v[172:175], a[228:231]
    s_add_u32 m0, s58, 24576
    s_waitcnt lgkmcnt(4)
    v_mfma_f32_16x16x32_bf16 v[96:99], v[176:179], a[32:35], v[96:99]
    buffer_load_dwordx4 v208, s[12:15], s46 offen offset:0 lds
    v_mfma_f32_16x16x32_bf16 v[100:103], v[176:179], a[36:39], v[100:103]
    ds_read_b64_tr_b16 v[168:169], v212 offset:40960
    v_mfma_f32_16x16x32_bf16 a[232:235], v[148:151], v[176:179], a[232:235]
    ds_read_b64_tr_b16 v[170:171], v212 offset:42240
    ds_read_b64_tr_b16 v[172:173], v213 offset:40960
    v_mfma_f32_16x16x32_bf16 v[104:107], v[180:183], a[32:35], v[104:107]
    ds_read_b64_tr_b16 v[174:175], v213 offset:42240
    v_mfma_f32_16x16x32_bf16 v[108:111], v[180:183], a[36:39], v[108:111]
    ds_read_b64_tr_b16 v[176:177], v212 offset:41024
    s_add_u32 s46, s46, 245760
    v_mfma_f32_16x16x32_bf16 a[236:239], v[148:151], v[180:183], a[236:239]
    s_add_u32 m0, s59, 16384
    v_mfma_f32_16x16x32_bf16 v[112:115], v[184:187], a[32:35], v[112:115]
    buffer_load_dwordx4 v204, s[24:27], s49 offen offset:0 lds
    v_mfma_f32_16x16x32_bf16 v[116:119], v[184:187], a[36:39], v[116:119]
    ds_read_b64_tr_b16 v[178:179], v212 offset:42304
    v_mfma_f32_16x16x32_bf16 a[240:243], v[148:151], v[184:187], a[240:243]
    ds_read_b64_tr_b16 v[180:181], v213 offset:41024
    v_mfma_f32_16x16x32_bf16 v[120:123], v[188:191], a[32:35], v[120:123]
    ds_read_b64_tr_b16 v[182:183], v213 offset:42304
    v_mfma_f32_16x16x32_bf16 v[124:127], v[188:191], a[36:39], v[124:127]
    ds_read_b64_tr_b16 v[184:185], v212 offset:41088
    v_mfma_f32_16x16x32_bf16 a[244:247], v[148:151], v[188:191], a[244:247]
    s_waitcnt lgkmcnt(5)
    v_mfma_f32_16x16x32_bf16 v[128:131], v[160:163], a[32:35], v[128:131]
    buffer_load_dwordx4 v205, s[24:27], s49 offen offset:1024 lds
    v_mfma_f32_16x16x32_bf16 v[132:135], v[160:163], a[36:39], v[132:135]
    ds_read_b64_tr_b16 v[186:187], v212 offset:42368
    v_mfma_f32_16x16x32_bf16 a[248:251], v[148:151], v[160:163], a[248:251]
    ds_read_b64_tr_b16 v[188:189], v213 offset:41088
    ds_read_b64_tr_b16 v[190:191], v213 offset:42368
    v_mfma_f32_16x16x32_bf16 v[136:139], v[164:167], a[32:35], v[136:139]
    ds_read_b64_tr_b16 v[160:161], v212 offset:41152
    v_mfma_f32_16x16x32_bf16 v[140:143], v[164:167], a[36:39], v[140:143]
    v_mfma_f32_16x16x32_bf16 a[252:255], v[148:151], v[164:167], a[252:255]
    ds_read_b64_tr_b16 v[162:163], v212 offset:42432
    v_mfma_f32_16x16x32_bf16 v[64:67], v[168:171], a[40:43], v[64:67]
    buffer_load_dwordx4 v204, s[24:27], s45 offen offset:2048 lds
    v_mfma_f32_16x16x32_bf16 v[68:71], v[168:171], a[44:47], v[68:71]
    ds_read_b64_tr_b16 v[164:165], v213 offset:41152
    ds_read_b64_tr_b16 v[166:167], v213 offset:42432
    v_mfma_f32_16x16x32_bf16 v[72:75], v[172:175], a[40:43], v[72:75]
    ds_read_b64_tr_b16 v[168:169], v212 offset:41216
    v_mfma_f32_16x16x32_bf16 v[76:79], v[172:175], a[44:47], v[76:79]
    ds_read_b64_tr_b16 v[170:171], v212 offset:42496
    s_waitcnt lgkmcnt(6)
    v_mfma_f32_16x16x32_bf16 v[80:83], v[176:179], a[40:43], v[80:83]
    buffer_load_dwordx4 v205, s[24:27], s45 offen offset:3072 lds
    v_mfma_f32_16x16x32_bf16 v[84:87], v[176:179], a[44:47], v[84:87]
    ds_read_b64_tr_b16 v[172:173], v213 offset:41216
    ds_read_b64_tr_b16 v[174:175], v213 offset:42496
    v_mfma_f32_16x16x32_bf16 v[88:91], v[180:183], a[40:43], v[88:91]
    s_add_u32 s49, s49, 128
    v_mfma_f32_16x16x32_bf16 v[92:95], v[180:183], a[44:47], v[92:95]
    s_add_u32 s45, s49, 18432
    v_mfma_f32_16x16x32_bf16 v[96:99], v[184:187], a[40:43], v[96:99]
    v_mfma_f32_16x16x32_bf16 v[100:103], v[184:187], a[44:47], v[100:103]
    s_waitcnt vmcnt(12) lgkmcnt(0)
    s_barrier
    s_add_u32 m0, s58, 40960
    v_mfma_f32_16x16x32_bf16 v[104:107], v[188:191], a[40:43], v[104:107]
    buffer_load_dwordx4 v202, s[12:15], s46 offen offset:0 lds
    ds_read_b128 a[48:51], v144 offset:0
    v_mfma_f32_16x16x32_bf16 v[108:111], v[188:191], a[44:47], v[108:111]
    ds_read_b64_tr_b16 v[176:177], v210 offset:0
    ds_read_b64_tr_b16 v[178:179], v210 offset:1280
    ds_read_b64_tr_b16 v[180:181], v211 offset:0
    v_mfma_f32_16x16x32_bf16 v[112:115], v[160:163], a[40:43], v[112:115]
    ds_read_b128 a[52:55], v144 offset:2048
    ds_read_b64_tr_b16 v[182:183], v211 offset:1280
    v_mfma_f32_16x16x32_bf16 v[116:119], v[160:163], a[44:47], v[116:119]
    ds_read_b64_tr_b16 v[184:185], v210 offset:64
    v_mfma_f32_16x16x32_bf16 v[120:123], v[164:167], a[40:43], v[120:123]
    buffer_load_dwordx4 v203, s[12:15], s46 offen offset:1024 lds
    ds_read_b128 a[56:59], v145 offset:0
    v_mfma_f32_16x16x32_bf16 v[124:127], v[164:167], a[44:47], v[124:127]
    ds_read_b64_tr_b16 v[186:187], v210 offset:1344
    ds_read_b64_tr_b16 v[188:189], v211 offset:64
    v_mfma_f32_16x16x32_bf16 v[128:131], v[168:171], a[40:43], v[128:131]
    ds_read_b128 a[60:63], v145 offset:2048
    ds_read_b64_tr_b16 v[190:191], v211 offset:1344
    v_mfma_f32_16x16x32_bf16 v[132:135], v[168:171], a[44:47], v[132:135]
    ds_read_b64_tr_b16 v[160:161], v210 offset:128
    v_mfma_f32_16x16x32_bf16 v[136:139], v[172:175], a[40:43], v[136:139]
    buffer_load_dwordx4 v206, s[12:15], s46 offen offset:2048 lds
    ds_read_b64_tr_b16 v[162:163], v210 offset:1408
    v_mfma_f32_16x16x32_bf16 v[140:143], v[172:175], a[44:47], v[140:143]
    ds_read_b64_tr_b16 v[164:165], v211 offset:128
    ds_read_b64_tr_b16 v[166:167], v211 offset:1408
    s_waitcnt lgkmcnt(4)
    v_mfma_f32_16x16x32_bf16 v[64:67], v[176:179], a[48:51], v[64:67]
    ds_read_b64_tr_b16 v[168:169], v210 offset:192
    v_mfma_f32_16x16x32_bf16 v[68:71], v[176:179], a[52:55], v[68:71]
    v_mfma_f32_16x16x32_bf16 a[216:219], v[148:151], v[176:179], a[216:219]
    ds_read_b64_tr_b16 v[170:171], v210 offset:1472
    v_mfma_f32_16x16x32_bf16 v[72:75], v[180:183], a[48:51], v[72:75]
    buffer_load_dwordx4 v207, s[12:15], s46 offen offset:3072 lds
    v_mfma_f32_16x16x32_bf16 v[76:79], v[180:183], a[52:55], v[76:79]
    ds_read_b64_tr_b16 v[172:173], v211 offset:192
    v_mfma_f32_16x16x32_bf16 a[220:223], v[148:151], v[180:183], a[220:223]
    ds_read_b64_tr_b16 v[174:175], v211 offset:1472
    v_mfma_f32_16x16x32_bf16 v[80:83], v[184:187], a[48:51], v[80:83]
    ds_read_b64_tr_b16 v[176:177], v210 offset:256
    v_mfma_f32_16x16x32_bf16 v[84:87], v[184:187], a[52:55], v[84:87]
    ds_read_b64_tr_b16 v[178:179], v210 offset:1536
    v_mfma_f32_16x16x32_bf16 a[224:227], v[148:151], v[184:187], a[224:227]
    s_add_u32 m0, s58, 45056
    v_mfma_f32_16x16x32_bf16 v[88:91], v[188:191], a[48:51], v[88:91]
    buffer_load_dwordx4 v208, s[12:15], s46 offen offset:0 lds
    v_mfma_f32_16x16x32_bf16 v[92:95], v[188:191], a[52:55], v[92:95]
    ds_read_b64_tr_b16 v[180:181], v211 offset:256
    v_mfma_f32_16x16x32_bf16 a[228:231], v[148:151], v[188:191], a[228:231]
    ds_read_b64_tr_b16 v[182:183], v211 offset:1536
    s_waitcnt lgkmcnt(4)
    v_mfma_f32_16x16x32_bf16 v[96:99], v[160:163], a[48:51], v[96:99]
    ds_read_b64_tr_b16 v[184:185], v212 offset:0
    ds_read_b64_tr_b16 v[186:187], v212 offset:1280
    v_mfma_f32_16x16x32_bf16 v[100:103], v[160:163], a[52:55], v[100:103]
    ds_read_b64_tr_b16 v[188:189], v213 offset:0
    v_mfma_f32_16x16x32_bf16 a[232:235], v[148:151], v[160:163], a[232:235]
    s_add_u32 s46, s46, 245760
    s_add_u32 m0, s59, 32768
    v_mfma_f32_16x16x32_bf16 v[104:107], v[164:167], a[48:51], v[104:107]
    buffer_load_dwordx4 v204, s[24:27], s49 offen offset:0 lds
    v_mfma_f32_16x16x32_bf16 v[108:111], v[164:167], a[52:55], v[108:111]
    ds_read_b64_tr_b16 v[190:191], v213 offset:1280
    v_mfma_f32_16x16x32_bf16 a[236:239], v[148:151], v[164:167], a[236:239]
    ds_read_b64_tr_b16 v[160:161], v212 offset:64
    v_mfma_f32_16x16x32_bf16 v[112:115], v[168:171], a[48:51], v[112:115]
    ds_read_b64_tr_b16 v[162:163], v212 offset:1344
    v_mfma_f32_16x16x32_bf16 v[116:119], v[168:171], a[52:55], v[116:119]
    v_mfma_f32_16x16x32_bf16 a[240:243], v[148:151], v[168:171], a[240:243]
    ds_read_b64_tr_b16 v[164:165], v213 offset:64
    v_mfma_f32_16x16x32_bf16 v[120:123], v[172:175], a[48:51], v[120:123]
    buffer_load_dwordx4 v205, s[24:27], s49 offen offset:1024 lds
    v_mfma_f32_16x16x32_bf16 v[124:127], v[172:175], a[52:55], v[124:127]
    ds_read_b64_tr_b16 v[166:167], v213 offset:1344
    v_mfma_f32_16x16x32_bf16 a[244:247], v[148:151], v[172:175], a[244:247]
    ds_read_b64_tr_b16 v[168:169], v212 offset:128
    s_waitcnt lgkmcnt(5)
    v_mfma_f32_16x16x32_bf16 v[128:131], v[176:179], a[48:51], v[128:131]
    ds_read_b64_tr_b16 v[170:171], v212 offset:1408
    v_mfma_f32_16x16x32_bf16 v[132:135], v[176:179], a[52:55], v[132:135]
    ds_read_b64_tr_b16 v[172:173], v213 offset:128
    v_mfma_f32_16x16x32_bf16 a[248:251], v[148:151], v[176:179], a[248:251]
    ds_read_b64_tr_b16 v[174:175], v213 offset:1408
    v_mfma_f32_16x16x32_bf16 v[136:139], v[180:183], a[48:51], v[136:139]
    buffer_load_dwordx4 v204, s[24:27], s45 offen offset:2048 lds
    v_mfma_f32_16x16x32_bf16 v[140:143], v[180:183], a[52:55], v[140:143]
    ds_read_b64_tr_b16 v[176:177], v212 offset:192
    v_mfma_f32_16x16x32_bf16 a[252:255], v[148:151], v[180:183], a[252:255]
    ds_read_b64_tr_b16 v[178:179], v212 offset:1472
    v_mfma_f32_16x16x32_bf16 v[64:67], v[184:187], a[56:59], v[64:67]
    ds_read_b64_tr_b16 v[180:181], v213 offset:192
    v_mfma_f32_16x16x32_bf16 v[68:71], v[184:187], a[60:63], v[68:71]
    ds_read_b64_tr_b16 v[182:183], v213 offset:1472
    v_mfma_f32_16x16x32_bf16 v[72:75], v[188:191], a[56:59], v[72:75]
    buffer_load_dwordx4 v205, s[24:27], s45 offen offset:3072 lds
    v_mfma_f32_16x16x32_bf16 v[76:79], v[188:191], a[60:63], v[76:79]
    ds_read_b64_tr_b16 v[184:185], v212 offset:256
    ds_read_b64_tr_b16 v[186:187], v212 offset:1536
    s_waitcnt lgkmcnt(6)
    v_mfma_f32_16x16x32_bf16 v[80:83], v[160:163], a[56:59], v[80:83]
    ds_read_b64_tr_b16 v[188:189], v213 offset:256
    ds_read_b64_tr_b16 v[190:191], v213 offset:1536
    s_add_u32 s49, s49, 128
    s_add_u32 s45, s49, 18432
    s_waitcnt vmcnt(18)
    v_mfma_f32_16x16x32_bf16 v[84:87], v[160:163], a[60:63], v[84:87]
    s_mov_b32 s18, 25600
    s_mov_b32 s19, 0x20000
    s_lshl_b32 s64, s40, 10
    s_and_b32 s64, s64, 1024
    s_add_u32 m0, s64, 160768
    v_mfma_f32_16x16x32_bf16 v[88:91], v[164:167], a[56:59], v[88:91]
    buffer_load_dwordx4 v209, s[16:19], s100 offen lds
    v_mfma_f32_16x16x32_bf16 v[92:95], v[164:167], a[60:63], v[92:95]
    v_mfma_f32_16x16x32_bf16 v[96:99], v[168:171], a[56:59], v[96:99]
    v_mfma_f32_16x16x32_bf16 v[100:103], v[168:171], a[60:63], v[100:103]
    s_waitcnt vmcnt(10) lgkmcnt(0)
    s_barrier
    s_lshl_b32 s64, s40, 10
    s_add_u32 m0, s64, 136448
    v_mfma_f32_16x16x32_bf16 v[104:107], v[172:175], a[56:59], v[104:107]
    buffer_load_dwordx4 v209, s[16:19], s69 offen lds
    ds_read_b128 a[64:67], v144 offset:16384
    v_mfma_f32_16x16x32_bf16 v[108:111], v[172:175], a[60:63], v[108:111]
    ds_read_b64_tr_b16 v[160:161], v210 offset:20480
    ds_read_b64_tr_b16 v[162:163], v210 offset:21760
    ds_read_b64_tr_b16 v[164:165], v211 offset:20480
    v_mfma_f32_16x16x32_bf16 v[112:115], v[176:179], a[56:59], v[112:115]
    ds_read_b128 a[68:71], v144 offset:18432
    ds_read_b64_tr_b16 v[166:167], v211 offset:21760
    ds_read_b64_tr_b16 v[168:169], v210 offset:20544
    v_mfma_f32_16x16x32_bf16 v[116:119], v[176:179], a[60:63], v[116:119]
    s_getpc_b64 s[16:17]
KC_pck:
    s_add_u32 s16, s16, KC_tab-KC_pck
    s_addc_u32 s17, s17, 0
    s_movk_i32 s18, 6144
    s_lshl_b32 s64, s40, 10
    s_add_u32 m0, s64, 152576
    v_mfma_f32_16x16x32_bf16 v[120:123], v[180:183], a[56:59], v[120:123]
    buffer_load_dwordx4 v209, s[16:19], s64 offen lds
    ds_read_b128 a[72:75], v145 offset:16384
    v_mfma_f32_16x16x32_bf16 v[124:127], v[180:183], a[60:63], v[124:127]
    ds_read_b64_tr_b16 v[170:171], v210 offset:21824
    ds_read_b64_tr_b16 v[172:173], v211 offset:20544
    v_mfma_f32_16x16x32_bf16 v[128:131], v[184:187], a[56:59], v[128:131]
    ds_read_b128 a[76:79], v145 offset:18432
    ds_read_b64_tr_b16 v[174:175], v211 offset:21824
    ds_read_b64_tr_b16 v[176:177], v210 offset:20608
    v_mfma_f32_16x16x32_bf16 v[132:135], v[184:187], a[60:63], v[132:135]
    s_add_u32 s64, s64, 4096
    s_add_u32 m0, s64, 152576
    v_mfma_f32_16x16x32_bf16 v[136:139], v[188:191], a[56:59], v[136:139]
    buffer_load_dwordx4 v209, s[16:19], s64 offen lds
    ds_read_b64_tr_b16 v[178:179], v210 offset:21888
    v_mfma_f32_16x16x32_bf16 v[140:143], v[188:191], a[60:63], v[140:143]
    ds_read_b64_tr_b16 v[180:181], v211 offset:20608
    ds_read_b64_tr_b16 v[182:183], v211 offset:21888
    s_waitcnt lgkmcnt(4)
    v_mfma_f32_16x16x32_bf16 v[64:67], v[160:163], a[64:67], v[64:67]
    ds_read_b64_tr_b16 v[184:185], v210 offset:20672
    ds_read_b64_tr_b16 v[186:187], v210 offset:21952
    v_mfma_f32_16x16x32_bf16 v[68:71], v[160:163], a[68:71], v[68:71]
    ds_read_b64_tr_b16 v[36:37], v32 offset:0
    ds_read_b64_tr_b16 v[38:39], v33 offset:512
    v_mfma_f32_16x16x32_bf16 a[216:219], v[148:151], v[160:163], a[216:219]
    ds_read_b64_tr_b16 v[40:41], v32 offset:1024
    s_add_u32 m0, s58, 0
    v_mfma_f32_16x16x32_bf16 v[72:75], v[164:167], a[64:67], v[72:75]
    buffer_load_dwordx4 v202, s[12:15], s46 offen offset:0 lds
    ds_read_b64_tr_b16 v[188:189], v211 offset:20672
    v_mfma_f32_16x16x32_bf16 v[76:79], v[164:167], a[68:71], v[76:79]
    ds_read_b64_tr_b16 v[190:191], v211 offset:21952
    ds_read_b64_tr_b16 v[42:43], v33 offset:1536
    v_mfma_f32_16x16x32_bf16 a[220:223], v[148:151], v[164:167], a[220:223]
    ds_read_b64_tr_b16 v[44:45], v32 offset:2048
    ds_read_b64_tr_b16 v[46:47], v33 offset:2560
    v_mfma_f32_16x16x32_bf16 v[80:83], v[168:171], a[64:67], v[80:83]
    ds_read_b64_tr_b16 v[160:161], v210 offset:20736
    ds_read_b64_tr_b16 v[162:163], v210 offset:22016
    v_mfma_f32_16x16x32_bf16 v[84:87], v[168:171], a[68:71], v[84:87]
    s_waitcnt lgkmcnt(8)
    buffer_store_dwordx4 v[36:39], v209, s[20:23], s68 offen sc1
    s_waitcnt lgkmcnt(4)
    v_mfma_f32_16x16x32_bf16 a[224:227], v[148:151], v[168:171], a[224:227]
    buffer_store_dwordx4 v[40:43], v209, s[20:23], s37 offen sc1
    s_waitcnt lgkmcnt(2)
    v_mfma_f32_16x16x32_bf16 v[88:91], v[172:175], a[64:67], v[88:91]
    buffer_load_dwordx4 v203, s[12:15], s46 offen offset:1024 lds
    v_mfma_f32_16x16x32_bf16 v[92:95], v[172:175], a[68:71], v[92:95]
    ds_read_b64_tr_b16 v[164:165], v211 offset:20736
    ds_read_b64_tr_b16 v[166:167], v211 offset:22016
    v_mfma_f32_16x16x32_bf16 a[228:231], v[148:151], v[172:175], a[228:231]
    buffer_store_dwordx4 v[44:47], v209, s[20:23], s54 offen sc1
    v_mfma_f32_16x16x32_bf16 v[96:99], v[176:179], a[64:67], v[96:99]
    ds_read_b64_tr_b16 v[168:169], v212 offset:20480
    v_mfma_f32_16x16x32_bf16 v[100:103], v[176:179], a[68:71], v[100:103]
    ds_read_b64_tr_b16 v[170:171], v212 offset:21760
    v_mfma_f32_16x16x32_bf16 a[232:235], v[148:151], v[176:179], a[232:235]
    ds_read_b64_tr_b16 v[172:173], v213 offset:20480
    v_mfma_f32_16x16x32_bf16 v[104:107], v[180:183], a[64:67], v[104:107]
    buffer_load_dwordx4 v206, s[12:15], s46 offen offset:2048 lds
    v_mfma_f32_16x16x32_bf16 v[108:111], v[180:183], a[68:71], v[108:111]
    ds_read_b64_tr_b16 v[174:175], v213 offset:21760
    v_mfma_f32_16x16x32_bf16 a[236:239], v[148:151], v[180:183], a[236:239]
    ds_read_b64_tr_b16 v[176:177], v212 offset:20544
    v_mfma_f32_16x16x32_bf16 v[112:115], v[184:187], a[64:67], v[112:115]
    ds_read_b64_tr_b16 v[178:179], v212 offset:21824
    v_mfma_f32_16x16x32_bf16 v[116:119], v[184:187], a[68:71], v[116:119]
    v_mfma_f32_16x16x32_bf16 a[240:243], v[148:151], v[184:187], a[240:243]
    ds_read_b64_tr_b16 v[180:181], v213 offset:20544
    v_mfma_f32_16x16x32_bf16 v[120:123], v[188:191], a[64:67], v[120:123]
    buffer_load_dwordx4 v207, s[12:15], s46 offen offset:3072 lds
    v_mfma_f32_16x16x32_bf16 v[124:127], v[188:191], a[68:71], v[124:127]
    ds_read_b64_tr_b16 v[182:183], v213 offset:21824
    v_mfma_f32_16x16x32_bf16 a[244:247], v[148:151], v[188:191], a[244:247]
    ds_read_b64_tr_b16 v[184:185], v212 offset:20608
    s_waitcnt lgkmcnt(5)
    v_mfma_f32_16x16x32_bf16 v[128:131], v[160:163], a[64:67], v[128:131]
    ds_read_b64_tr_b16 v[186:187], v212 offset:21888
    v_mfma_f32_16x16x32_bf16 v[132:135], v[160:163], a[68:71], v[132:135]
    ds_read_b64_tr_b16 v[188:189], v213 offset:20608
    ds_read_b64_tr_b16 v[190:191], v213 offset:21888
    v_mfma_f32_16x16x32_bf16 a[248:251], v[148:151], v[160:163], a[248:251]
    s_add_u32 m0, s58, 4096
    v_mfma_f32_16x16x32_bf16 v[136:139], v[164:167], a[64:67], v[136:139]
    buffer_load_dwordx4 v208, s[12:15], s46 offen offset:0 lds
    v_mfma_f32_16x16x32_bf16 v[140:143], v[164:167], a[68:71], v[140:143]
    ds_read_b64_tr_b16 v[160:161], v212 offset:20672
    v_mfma_f32_16x16x32_bf16 a[252:255], v[148:151], v[164:167], a[252:255]
    ds_read_b64_tr_b16 v[162:163], v212 offset:21952
    v_mfma_f32_16x16x32_bf16 v[64:67], v[168:171], a[72:75], v[64:67]
    ds_read_b64_tr_b16 v[164:165], v213 offset:20672
    ds_read_b64_tr_b16 v[166:167], v213 offset:21952
    v_mfma_f32_16x16x32_bf16 v[68:71], v[168:171], a[76:79], v[68:71]
    s_add_u32 s46, s46, 245760
    s_add_u32 m0, s59, 0
    v_mfma_f32_16x16x32_bf16 v[72:75], v[172:175], a[72:75], v[72:75]
    buffer_load_dwordx4 v204, s[24:27], s49 offen offset:0 lds
    v_mfma_f32_16x16x32_bf16 v[76:79], v[172:175], a[76:79], v[76:79]
    ds_read_b64_tr_b16 v[168:169], v212 offset:20736
    ds_read_b64_tr_b16 v[170:171], v212 offset:22016
    s_waitcnt lgkmcnt(6)
    v_mfma_f32_16x16x32_bf16 v[80:83], v[176:179], a[72:75], v[80:83]
    ds_read_b64_tr_b16 v[172:173], v213 offset:20736
    v_mfma_f32_16x16x32_bf16 v[84:87], v[176:179], a[76:79], v[84:87]
    ds_read_b64_tr_b16 v[174:175], v213 offset:22016
    v_mfma_f32_16x16x32_bf16 v[88:91], v[180:183], a[72:75], v[88:91]
    buffer_load_dwordx4 v205, s[24:27], s49 offen offset:1024 lds
    v_mfma_f32_16x16x32_bf16 v[92:95], v[180:183], a[76:79], v[92:95]
    v_mfma_f32_16x16x32_bf16 v[96:99], v[184:187], a[72:75], v[96:99]
    v_mfma_f32_16x16x32_bf16 v[100:103], v[184:187], a[76:79], v[100:103]
    s_waitcnt vmcnt(14) lgkmcnt(0)
    s_barrier
    v_mfma_f32_16x16x32_bf16 v[104:107], v[188:191], a[72:75], v[104:107]
    buffer_load_dwordx4 v204, s[24:27], s45 offen offset:2048 lds
    ds_read_b128 a[80:83], v144 offset:32768
    v_mfma_f32_16x16x32_bf16 v[108:111], v[188:191], a[76:79], v[108:111]
    ds_read_b64_tr_b16 v[176:177], v210 offset:40960
    ds_read_b64_tr_b16 v[178:179], v210 offset:42240
    ds_read_b64_tr_b16 v[180:181], v211 offset:40960
    v_mfma_f32_16x16x32_bf16 v[112:115], v[160:163], a[72:75], v[112:115]
    ds_read_b128 a[84:87], v144 offset:34816
    ds_read_b64_tr_b16 v[182:183], v211 offset:42240
    v_mfma_f32_16x16x32_bf16 v[116:119], v[160:163], a[76:79], v[116:119]
    ds_read_b64_tr_b16 v[184:185], v210 offset:41024
    v_mfma_f32_16x16x32_bf16 v[120:123], v[164:167], a[72:75], v[120:123]
    buffer_load_dwordx4 v205, s[24:27], s45 offen offset:3072 lds
    ds_read_b128 a[88:91], v145 offset:32768
    v_mfma_f32_16x16x32_bf16 v[124:127], v[164:167], a[76:79], v[124:127]
    ds_read_b64_tr_b16 v[186:187], v210 offset:42304
    ds_read_b64_tr_b16 v[188:189], v211 offset:41024
    v_mfma_f32_16x16x32_bf16 v[128:131], v[168:171], a[72:75], v[128:131]
    ds_read_b128 a[92:95], v145 offset:34816
    ds_read_b64_tr_b16 v[190:191], v211 offset:42304
    ds_read_b64_tr_b16 v[160:161], v210 offset:41088
    v_mfma_f32_16x16x32_bf16 v[132:135], v[168:171], a[76:79], v[132:135]
    s_add_u32 s49, s49, 128
    s_add_u32 s45, s49, 18432
    s_add_u32 m0, s58, 20480
    v_mfma_f32_16x16x32_bf16 v[136:139], v[172:175], a[72:75], v[136:139]
    buffer_load_dwordx4 v202, s[12:15], s46 offen offset:0 lds
    ds_read_b64_tr_b16 v[162:163], v210 offset:42368
    v_mfma_f32_16x16x32_bf16 v[140:143], v[172:175], a[76:79], v[140:143]
    ds_read_b64_tr_b16 v[164:165], v211 offset:41088
    ds_read_b64_tr_b16 v[166:167], v211 offset:42368
    s_waitcnt lgkmcnt(4)
    v_mfma_f32_16x16x32_bf16 v[64:67], v[176:179], a[80:83], v[64:67]
    ds_read_b64_tr_b16 v[168:169], v210 offset:41152
    v_mfma_f32_16x16x32_bf16 v[68:71], v[176:179], a[84:87], v[68:71]
    v_mfma_f32_16x16x32_bf16 a[216:219], v[148:151], v[176:179], a[216:219]
    ds_read_b64_tr_b16 v[170:171], v210 offset:42432
    v_mfma_f32_16x16x32_bf16 v[72:75], v[180:183], a[80:83], v[72:75]
    buffer_load_dwordx4 v203, s[12:15], s46 offen offset:1024 lds
    v_mfma_f32_16x16x32_bf16 v[76:79], v[180:183], a[84:87], v[76:79]
    ds_read_b64_tr_b16 v[172:173], v211 offset:41152
    v_mfma_f32_16x16x32_bf16 a[220:223], v[148:151], v[180:183], a[220:223]
    ds_read_b64_tr_b16 v[174:175], v211 offset:42432
    v_mfma_f32_16x16x32_bf16 v[80:83], v[184:187], a[80:83], v[80:83]
    ds_read_b64_tr_b16 v[176:177], v210 offset:41216
    v_mfma_f32_16x16x32_bf16 v[84:87], v[184:187], a[84:87], v[84:87]
    v_mfma_f32_16x16x32_bf16 a[224:227], v[148:151], v[184:187], a[224:227]
    ds_read_b64_tr_b16 v[178:179], v210 offset:42496
    v_mfma_f32_16x16x32_bf16 v[88:91], v[188:191], a[80:83], v[88:91]
    buffer_load_dwordx4 v206, s[12:15], s46 offen offset:2048 lds
    v_mfma_f32_16x16x32_bf16 v[92:95], v[188:191], a[84:87], v[92:95]
    ds_read_b64_tr_b16 v[180:181], v211 offset:41216
    v_mfma_f32_16x16x32_bf16 a[228:231], v[148:151], v[188:191], a[228:231]
    ds_read_b64_tr_b16 v[182:183], v211 offset:42496
    s_waitcnt lgkmcnt(4)
    v_mfma_f32_16x16x32_bf16 v[96:99], v[160:163], a[80:83], v[96:99]
    ds_read_b64_tr_b16 v[184:185], v212 offset:40960
    v_mfma_f32_16x16x32_bf16 v[100:103], v[160:163], a[84:87], v[100:103]
    ds_read_b64_tr_b16 v[186:187], v212 offset:42240
    v_mfma_f32_16x16x32_bf16 a[232:235], v[148:151], v[160:163], a[232:235]
    ds_read_b64_tr_b16 v[188:189], v213 offset:40960
    v_mfma_f32_16x16x32_bf16 v[104:107], v[164:167], a[80:83], v[104:107]
    buffer_load_dwordx4 v207, s[12:15], s46 offen offset:3072 lds
    v_mfma_f32_16x16x32_bf16 v[108:111], v[164:167], a[84:87], v[108:111]
    ds_read_b64_tr_b16 v[190:191], v213 offset:42240
    v_mfma_f32_16x16x32_bf16 a[236:239], v[148:151], v[164:167], a[236:239]
    ds_read_b64_tr_b16 v[160:161], v212 offset:41024
    v_mfma_f32_16x16x32_bf16 v[112:115], v[168:171], a[80:83], v[112:115]
    ds_read_b64_tr_b16 v[162:163], v212 offset:42304
    v_mfma_f32_16x16x32_bf16 v[116:119], v[168:171], a[84:87], v[116:119]
    ds_read_b64_tr_b16 v[164:165], v213 offset:41024
    v_mfma_f32_16x16x32_bf16 a[240:243], v[148:151], v[168:171], a[240:243]
    s_add_u32 m0, s58, 24576
    v_mfma_f32_16x16x32_bf16 v[120:123], v[172:175], a[80:83], v[120:123]
    buffer_load_dwordx4 v208, s[12:15], s46 offen offset:0 lds
    v_mfma_f32_16x16x32_bf16 v[124:127], v[172:175], a[84:87], v[124:127]
    ds_read_b64_tr_b16 v[166:167], v213 offset:42304
    v_mfma_f32_16x16x32_bf16 a[244:247], v[148:151], v[172:175], a[244:247]
    ds_read_b64_tr_b16 v[168:169], v212 offset:41088
    s_waitcnt lgkmcnt(5)
    v_mfma_f32_16x16x32_bf16 v[128:131], v[176:179], a[80:83], v[128:131]
    ds_read_b64_tr_b16 v[170:171], v212 offset:42368
    ds_read_b64_tr_b16 v[172:173], v213 offset:41088
    v_mfma_f32_16x16x32_bf16 v[132:135], v[176:179], a[84:87], v[132:135]
    ds_read_b64_tr_b16 v[174:175], v213 offset:42368
    v_mfma_f32_16x16x32_bf16 a[248:251], v[148:151], v[176:179], a[248:251]
    s_add_u32 s46, s46, 245760
    s_add_u32 m0, s59, 16384
    v_mfma_f32_16x16x32_bf16 v[136:139], v[180:183], a[80:83], v[136:139]
    buffer_load_dwordx4 v204, s[24:27], s49 offen offset:0 lds
    v_mfma_f32_16x16x32_bf16 v[140:143], v[180:183], a[84:87], v[140:143]
    ds_read_b64_tr_b16 v[176:177], v212 offset:41152
    v_mfma_f32_16x16x32_bf16 a[252:255], v[148:151], v[180:183], a[252:255]
    ds_read_b64_tr_b16 v[178:179], v212 offset:42432
    v_mfma_f32_16x16x32_bf16 v[64:67], v[184:187], a[88:91], v[64:67]
    ds_read_b64_tr_b16 v[180:181], v213 offset:41152
    v_mfma_f32_16x16x32_bf16 v[68:71], v[184:187], a[92:95], v[68:71]
    ds_read_b64_tr_b16 v[182:183], v213 offset:42432
    v_mfma_f32_16x16x32_bf16 v[72:75], v[188:191], a[88:91], v[72:75]
    buffer_load_dwordx4 v205, s[24:27], s49 offen offset:1024 lds
    v_mfma_f32_16x16x32_bf16 v[76:79], v[188:191], a[92:95], v[76:79]
    ds_read_b64_tr_b16 v[184:185], v212 offset:41216
    ds_read_b64_tr_b16 v[186:187], v212 offset:42496
    s_waitcnt lgkmcnt(6)
    v_mfma_f32_16x16x32_bf16 v[80:83], v[160:163], a[88:91], v[80:83]
    ds_read_b64_tr_b16 v[188:189], v213 offset:41216
    v_mfma_f32_16x16x32_bf16 v[84:87], v[160:163], a[92:95], v[84:87]
    ds_read_b64_tr_b16 v[190:191], v213 offset:42496
    s_waitcnt vmcnt(14)
    v_mfma_f32_16x16x32_bf16 v[88:91], v[164:167], a[88:91], v[88:91]
    buffer_load_dwordx4 v204, s[24:27], s45 offen offset:2048 lds
    v_mfma_f32_16x16x32_bf16 v[92:95], v[164:167], a[92:95], v[92:95]
    buffer_load_dwordx2 v[158:159], v30, s[20:23], s67 offen sc1
    v_mfma_f32_16x16x32_bf16 v[96:99], v[168:171], a[88:91], v[96:99]
    v_mfma_f32_16x16x32_bf16 v[100:103], v[168:171], a[92:95], v[100:103]
    s_waitcnt vmcnt(9) lgkmcnt(0)
    s_barrier
    v_mfma_f32_16x16x32_bf16 v[104:107], v[172:175], a[88:91], v[104:107]
    buffer_load_dwordx4 v205, s[24:27], s45 offen offset:3072 lds
    ds_read_b128 a[96:99], v144 offset:0
    ds_read_b64_tr_b16 v[160:161], v210 offset:0
    v_mfma_f32_16x16x32_bf16 v[108:111], v[172:175], a[92:95], v[108:111]
    ds_read_b64_tr_b16 v[162:163], v210 offset:1280
    ds_read_b64_tr_b16 v[164:165], v211 offset:0
    buffer_store_dword v28, v29, s[20:23], s29 offen sc1
    v_mfma_f32_16x16x32_bf16 v[112:115], v[176:179], a[88:91], v[112:115]
    ds_read_b128 a[100:103], v144 offset:2048
    ds_read_b64_tr_b16 v[166:167], v211 offset:1280
    ds_read_b64_tr_b16 v[168:169], v210 offset:64
    v_mfma_f32_16x16x32_bf16 v[116:119], v[176:179], a[92:95], v[116:119]
    s_add_u32 s49, s49, 128
    s_add_u32 s45, s49, 18432
    s_add_u32 m0, s58, 40960
    v_mfma_f32_16x16x32_bf16 v[120:123], v[180:183], a[88:91], v[120:123]
    buffer_load_dwordx4 v202, s[12:15], s46 offen offset:0 lds
    ds_read_b128 a[104:107], v145 offset:0
    v_mfma_f32_16x16x32_bf16 v[124:127], v[180:183], a[92:95], v[124:127]
    ds_read_b64_tr_b16 v[170:171], v210 offset:1344
    ds_read_b64_tr_b16 v[172:173], v211 offset:64
    v_mfma_f32_16x16x32_bf16 v[128:131], v[184:187], a[88:91], v[128:131]
    ds_read_b128 a[108:111], v145 offset:2048
    ds_read_b64_tr_b16 v[174:175], v211 offset:1344
    v_mfma_f32_16x16x32_bf16 v[132:135], v[184:187], a[92:95], v[132:135]
    ds_read_b64_tr_b16 v[176:177], v210 offset:128
    v_mfma_f32_16x16x32_bf16 v[136:139], v[188:191], a[88:91], v[136:139]
    buffer_load_dwordx4 v203, s[12:15], s46 offen offset:1024 lds
    ds_read_b64_tr_b16 v[178:179], v210 offset:1408
    v_mfma_f32_16x16x32_bf16 v[140:143], v[188:191], a[92:95], v[140:143]
    ds_read_b64_tr_b16 v[180:181], v211 offset:128
    ds_read_b64_tr_b16 v[182:183], v211 offset:1408
    s_waitcnt lgkmcnt(4)
    v_mfma_f32_16x16x32_bf16 v[64:67], v[160:163], a[96:99], v[64:67]
    ds_read_b64_tr_b16 v[184:185], v210 offset:192
    ds_read_b64_tr_b16 v[186:187], v210 offset:1472
    v_mfma_f32_16x16x32_bf16 v[68:71], v[160:163], a[100:103], v[68:71]
    ds_read_b64_tr_b16 a[160:161], v10 offset:0
    v_mfma_f32_16x16x32_bf16 a[216:219], v[148:151], v[160:163], a[216:219]
    ds_read_b64_tr_b16 a[162:163], v11 offset:0
    ds_read_b64_tr_b16 a[164:165], v12 offset:0
    v_mfma_f32_16x16x32_bf16 v[72:75], v[164:167], a[96:99], v[72:75]
    buffer_load_dwordx4 v206, s[12:15], s46 offen offset:2048 lds
    v_mfma_f32_16x16x32_bf16 v[76:79], v[164:167], a[100:103], v[76:79]
    ds_read_b64_tr_b16 v[188:189], v211 offset:192
    v_mfma_f32_16x16x32_bf16 a[220:223], v[148:151], v[164:167], a[220:223]
    ds_read_b64_tr_b16 v[190:191], v211 offset:1472
    ds_read_b64_tr_b16 a[166:167], v13 offset:0
    v_mfma_f32_16x16x32_bf16 v[80:83], v[168:171], a[96:99], v[80:83]
    ds_read_b64_tr_b16 v[160:161], v210 offset:256
    ds_read_b64_tr_b16 v[162:163], v210 offset:1536
    v_mfma_f32_16x16x32_bf16 v[84:87], v[168:171], a[100:103], v[84:87]
    ds_read_b64_tr_b16 a[168:169], v14 offset:0
    v_mfma_f32_16x16x32_bf16 a[224:227], v[148:151], v[168:171], a[224:227]
    ds_read_b64_tr_b16 a[170:171], v10 offset:8
    ds_read_b64_tr_b16 a[172:173], v11 offset:8
    v_mfma_f32_16x16x32_bf16 v[88:91], v[172:175], a[96:99], v[88:91]
    buffer_load_dwordx4 v207, s[12:15], s46 offen offset:3072 lds
    v_mfma_f32_16x16x32_bf16 v[92:95], v[172:175], a[100:103], v[92:95]
    ds_read_b64_tr_b16 v[164:165], v211 offset:256
    ds_read_b64_tr_b16 v[166:167], v211 offset:1536
    v_mfma_f32_16x16x32_bf16 a[228:231], v[148:151], v[172:175], a[228:231]
    ds_read_b64_tr_b16 a[174:175], v12 offset:8
    s_waitcnt lgkmcnt(9)
    v_mfma_f32_16x16x32_bf16 v[96:99], v[176:179], a[96:99], v[96:99]
    ds_read_b64_tr_b16 v[168:169], v212 offset:0
    ds_read_b64_tr_b16 v[170:171], v212 offset:1280
    v_mfma_f32_16x16x32_bf16 v[100:103], v[176:179], a[100:103], v[100:103]
    ds_read_b64_tr_b16 v[172:173], v213 offset:0
    v_mfma_f32_16x16x32_bf16 a[232:235], v[148:151], v[176:179], a[232:235]
    ds_read_b64_tr_b16 a[176:177], v13 offset:8
    s_add_u32 m0, s58, 45056
    v_mfma_f32_16x16x32_bf16 v[104:107], v[180:183], a[96:99], v[104:107]
    buffer_load_dwordx4 v208, s[12:15], s46 offen offset:0 lds
    v_mfma_f32_16x16x32_bf16 v[108:111], v[180:183], a[100:103], v[108:111]
    ds_read_b64_tr_b16 v[174:175], v213 offset:1280
    v_mfma_f32_16x16x32_bf16 a[236:239], v[148:151], v[180:183], a[236:239]
    ds_read_b64_tr_b16 v[176:177], v212 offset:64
    ds_read_b64_tr_b16 a[178:179], v14 offset:8
    v_mfma_f32_16x16x32_bf16 v[112:115], v[184:187], a[96:99], v[112:115]
    ds_read_b64_tr_b16 v[178:179], v212 offset:1344
    ds_read_b64_tr_b16 v[180:181], v213 offset:64
    v_mfma_f32_16x16x32_bf16 v[116:119], v[184:187], a[100:103], v[116:119]
    s_add_u32 s46, s46, 245760
    v_mfma_f32_16x16x32_bf16 a[240:243], v[148:151], v[184:187], a[240:243]
    ds_read_b64_tr_b16 a[180:181], v10 offset:16
    s_add_u32 m0, s59, 32768
    v_mfma_f32_16x16x32_bf16 v[120:123], v[188:191], a[96:99], v[120:123]
    buffer_load_dwordx4 v204, s[24:27], s49 offen offset:0 lds
    v_mfma_f32_16x16x32_bf16 v[124:127], v[188:191], a[100:103], v[124:127]
    ds_read_b64_tr_b16 v[182:183], v213 offset:1344
    ds_read_b64_tr_b16 v[184:185], v212 offset:128
    v_mfma_f32_16x16x32_bf16 a[244:247], v[148:151], v[188:191], a[244:247]
    ds_read_b64_tr_b16 a[182:183], v11 offset:16
    s_waitcnt lgkmcnt(8)
    v_mfma_f32_16x16x32_bf16 v[128:131], v[160:163], a[96:99], v[128:131]
    ds_read_b64_tr_b16 v[186:187], v212 offset:1408
    ds_read_b64_tr_b16 v[188:189], v213 offset:128
    v_mfma_f32_16x16x32_bf16 v[132:135], v[160:163], a[100:103], v[132:135]
    ds_read_b64_tr_b16 v[190:191], v213 offset:1408
    v_mfma_f32_16x16x32_bf16 a[248:251], v[148:151], v[160:163], a[248:251]
    ds_read_b64_tr_b16 a[184:185], v12 offset:16
    ds_read_b64_tr_b16 a[186:187], v13 offset:16
    v_mfma_f32_16x16x32_bf16 v[136:139], v[164:167], a[96:99], v[136:139]
    buffer_load_dwordx4 v205, s[24:27], s49 offen offset:1024 lds
    v_mfma_f32_16x16x32_bf16 v[140:143], v[164:167], a[100:103], v[140:143]
    ds_read_b64_tr_b16 v[160:161], v212 offset:192
    v_mfma_f32_16x16x32_bf16 a[252:255], v[148:151], v[164:167], a[252:255]
    ds_read_b64_tr_b16 v[162:163], v212 offset:1472
    ds_read_b64_tr_b16 a[188:189], v14 offset:16
    v_mfma_f32_16x16x32_bf16 v[64:67], v[168:171], a[104:107], v[64:67]
    ds_read_b64_tr_b16 v[164:165], v213 offset:192
    ds_read_b64_tr_b16 v[166:167], v213 offset:1472
    v_mfma_f32_16x16x32_bf16 v[68:71], v[168:171], a[108:111], v[68:71]
    ds_read_b64_tr_b16 a[190:191], v10 offset:24
    v_mfma_f32_16x16x32_bf16 v[72:75], v[172:175], a[104:107], v[72:75]
    buffer_load_dwordx4 v204, s[24:27], s45 offen offset:2048 lds
    v_mfma_f32_16x16x32_bf16 v[76:79], v[172:175], a[108:111], v[76:79]
    ds_read_b64_tr_b16 v[168:169], v212 offset:256
    ds_read_b64_tr_b16 v[170:171], v212 offset:1536
    s_waitcnt lgkmcnt(10)
    v_mfma_f32_16x16x32_bf16 v[80:83], v[176:179], a[104:107], v[80:83]
    ds_read_b64_tr_b16 v[172:173], v213 offset:256
    ds_read_b64_tr_b16 v[174:175], v213 offset:1536
    v_mfma_f32_16x16x32_bf16 v[84:87], v[176:179], a[108:111], v[84:87]
    ds_read_b64_tr_b16 a[192:193], v11 offset:24
    v_mfma_f32_16x16x32_bf16 v[88:91], v[180:183], a[104:107], v[88:91]
    buffer_load_dwordx4 v205, s[24:27], s45 offen offset:3072 lds
    v_mfma_f32_16x16x32_bf16 v[92:95], v[180:183], a[108:111], v[92:95]
    s_add_u32 s49, s49, 128
    s_add_u32 s45, s49, 18432
    v_mfma_f32_16x16x32_bf16 v[96:99], v[184:187], a[104:107], v[96:99]
    v_mfma_f32_16x16x32_bf16 v[100:103], v[184:187], a[108:111], v[100:103]
    s_waitcnt vmcnt(10) lgkmcnt(0)
    s_barrier
    s_add_u32 m0, s58, 0
    v_mfma_f32_16x16x32_bf16 v[104:107], v[188:191], a[104:107], v[104:107]
    buffer_load_dwordx4 v202, s[12:15], s46 offen offset:0 lds
    ds_read_b128 a[112:115], v144 offset:16384
    v_mfma_f32_16x16x32_bf16 v[108:111], v[188:191], a[108:111], v[108:111]
    ds_read_b64_tr_b16 v[176:177], v210 offset:20480
    ds_read_b64_tr_b16 v[178:179], v210 offset:21760
    ds_read_b64_tr_b16 v[180:181], v211 offset:20480
    v_mfma_f32_16x16x32_bf16 v[112:115], v[160:163], a[104:107], v[112:115]
    ds_read_b128 a[116:119], v144 offset:18432
    ds_read_b64_tr_b16 v[182:183], v211 offset:21760
    v_mfma_f32_16x16x32_bf16 v[116:119], v[160:163], a[108:111], v[116:119]
    ds_read_b64_tr_b16 v[184:185], v210 offset:20544
    v_mfma_f32_16x16x32_bf16 v[120:123], v[164:167], a[104:107], v[120:123]
    buffer_load_dwordx4 v203, s[12:15], s46 offen offset:1024 lds
    ds_read_b128 a[120:123], v145 offset:16384
    v_mfma_f32_16x16x32_bf16 v[124:127], v[164:167], a[108:111], v[124:127]
    ds_read_b64_tr_b16 v[186:187], v210 offset:21824
    ds_read_b64_tr_b16 v[188:189], v211 offset:20544
    v_mfma_f32_16x16x32_bf16 v[128:131], v[168:171], a[104:107], v[128:131]
    ds_read_b128 a[124:127], v145 offset:18432
    ds_read_b64_tr_b16 v[190:191], v211 offset:21824
    v_mfma_f32_16x16x32_bf16 v[132:135], v[168:171], a[108:111], v[132:135]
    ds_read_b64_tr_b16 v[160:161], v210 offset:20608
    v_mfma_f32_16x16x32_bf16 v[136:139], v[172:175], a[104:107], v[136:139]
    buffer_load_dwordx4 v206, s[12:15], s46 offen offset:2048 lds
    ds_read_b64_tr_b16 v[162:163], v210 offset:21888
    v_mfma_f32_16x16x32_bf16 v[140:143], v[172:175], a[108:111], v[140:143]
    ds_read_b64_tr_b16 v[164:165], v211 offset:20608
    ds_read_b64_tr_b16 v[166:167], v211 offset:21888
    s_waitcnt lgkmcnt(4)
    v_mfma_f32_16x16x32_bf16 v[64:67], v[176:179], a[112:115], v[64:67]
    ds_read_b64_tr_b16 v[168:169], v210 offset:20672
    ds_read_b64_tr_b16 v[170:171], v210 offset:21952
    v_mfma_f32_16x16x32_bf16 v[68:71], v[176:179], a[116:119], v[68:71]
    ds_read_b64_tr_b16 a[194:195], v12 offset:24
    v_mfma_f32_16x16x32_bf16 a[216:219], v[148:151], v[176:179], a[216:219]
    ds_read_b64_tr_b16 a[196:197], v13 offset:24
    ds_read_b64_tr_b16 a[198:199], v14 offset:24
    v_mfma_f32_16x16x32_bf16 v[72:75], v[180:183], a[112:115], v[72:75]
    buffer_load_dwordx4 v207, s[12:15], s46 offen offset:3072 lds
    v_mfma_f32_16x16x32_bf16 v[76:79], v[180:183], a[116:119], v[76:79]
    ds_read_b64_tr_b16 v[172:173], v211 offset:20672
    v_mfma_f32_16x16x32_bf16 a[220:223], v[148:151], v[180:183], a[220:223]
    ds_read_b64_tr_b16 v[174:175], v211 offset:21952
    ds_read_b64_tr_b16 a[200:201], v10 offset:32
    v_mfma_f32_16x16x32_bf16 v[80:83], v[184:187], a[112:115], v[80:83]
    ds_read_b64_tr_b16 v[176:177], v210 offset:20736
    ds_read_b64_tr_b16 v[178:179], v210 offset:22016
    v_mfma_f32_16x16x32_bf16 v[84:87], v[184:187], a[116:119], v[84:87]
    ds_read_b64_tr_b16 a[202:203], v11 offset:32
    v_mfma_f32_16x16x32_bf16 a[224:227], v[148:151], v[184:187], a[224:227]
    ds_read_b64_tr_b16 a[204:205], v12 offset:32
    s_add_u32 m0, s58, 4096
    v_mfma_f32_16x16x32_bf16 v[88:91], v[188:191], a[112:115], v[88:91]
    buffer_load_dwordx4 v208, s[12:15], s46 offen offset:0 lds
    v_mfma_f32_16x16x32_bf16 v[92:95], v[188:191], a[116:119], v[92:95]
    ds_read_b64_tr_b16 v[180:181], v211 offset:20736
    ds_read_b64_tr_b16 v[182:183], v211 offset:22016
    v_mfma_f32_16x16x32_bf16 a[228:231], v[148:151], v[188:191], a[228:231]
    ds_read_b64_tr_b16 a[206:207], v13 offset:32
    s_waitcnt lgkmcnt(8)
    v_mfma_f32_16x16x32_bf16 v[96:99], v[160:163], a[112:115], v[96:99]
    ds_read_b64_tr_b16 v[184:185], v212 offset:20480
    ds_read_b64_tr_b16 v[186:187], v212 offset:21760
    v_mfma_f32_16x16x32_bf16 v[100:103], v[160:163], a[116:119], v[100:103]
    ds_read_b64_tr_b16 v[188:189], v213 offset:20480
    v_mfma_f32_16x16x32_bf16 a[232:235], v[148:151], v[160:163], a[232:235]
    ds_read_b64_tr_b16 a[208:209], v14 offset:32
    s_add_u32 m0, s59, 0
    v_mfma_f32_16x16x32_bf16 v[104:107], v[164:167], a[112:115], v[104:107]
    buffer_load_dwordx4 v204, s[24:27], s49 offen offset:0 lds
    v_mfma_f32_16x16x32_bf16 v[108:111], v[164:167], a[116:119], v[108:111]
    ds_read_b64_tr_b16 v[190:191], v213 offset:21760
    v_mfma_f32_16x16x32_bf16 a[236:239], v[148:151], v[164:167], a[236:239]
    ds_read_b64_tr_b16 v[160:161], v212 offset:20544
    v_mfma_f32_16x16x32_bf16 v[112:115], v[168:171], a[112:115], v[112:115]
    ds_read_b64_tr_b16 v[162:163], v212 offset:21824
    v_mfma_f32_16x16x32_bf16 v[116:119], v[168:171], a[116:119], v[116:119]
    v_mfma_f32_16x16x32_bf16 a[240:243], v[148:151], v[168:171], a[240:243]
    ds_read_b64_tr_b16 v[164:165], v213 offset:20544
    v_mfma_f32_16x16x32_bf16 v[120:123], v[172:175], a[112:115], v[120:123]
    buffer_load_dwordx4 v205, s[24:27], s49 offen offset:1024 lds
    v_mfma_f32_16x16x32_bf16 v[124:127], v[172:175], a[116:119], v[124:127]
    ds_read_b64_tr_b16 v[166:167], v213 offset:21824
    v_mfma_f32_16x16x32_bf16 a[244:247], v[148:151], v[172:175], a[244:247]
    ds_read_b64_tr_b16 v[168:169], v212 offset:20608
    s_waitcnt lgkmcnt(5)
    v_mfma_f32_16x16x32_bf16 v[128:131], v[176:179], a[112:115], v[128:131]
    ds_read_b64_tr_b16 v[170:171], v212 offset:21888
    v_mfma_f32_16x16x32_bf16 v[132:135], v[176:179], a[116:119], v[132:135]
    ds_read_b64_tr_b16 v[172:173], v213 offset:20608
    v_mfma_f32_16x16x32_bf16 a[248:251], v[148:151], v[176:179], a[248:251]
    ds_read_b64_tr_b16 v[174:175], v213 offset:21888
    v_mfma_f32_16x16x32_bf16 v[136:139], v[180:183], a[112:115], v[136:139]
    buffer_load_dwordx4 v204, s[24:27], s45 offen offset:2048 lds
    v_mfma_f32_16x16x32_bf16 v[140:143], v[180:183], a[116:119], v[140:143]
    ds_read_b64_tr_b16 v[176:177], v212 offset:20672
    v_mfma_f32_16x16x32_bf16 a[252:255], v[148:151], v[180:183], a[252:255]
    ds_read_b64_tr_b16 v[178:179], v212 offset:21952
    v_mfma_f32_16x16x32_bf16 v[64:67], v[184:187], a[120:123], v[64:67]
    ds_read_b64_tr_b16 v[180:181], v213 offset:20672
    v_mfma_f32_16x16x32_bf16 v[68:71], v[184:187], a[124:127], v[68:71]
    ds_read_b64_tr_b16 v[182:183], v213 offset:21952
    v_mfma_f32_16x16x32_bf16 v[72:75], v[188:191], a[120:123], v[72:75]
    buffer_load_dwordx4 v205, s[24:27], s45 offen offset:3072 lds
    v_mfma_f32_16x16x32_bf16 v[76:79], v[188:191], a[124:127], v[76:79]
    ds_read_b64_tr_b16 v[184:185], v212 offset:20736
    ds_read_b64_tr_b16 v[186:187], v212 offset:22016
    s_waitcnt lgkmcnt(6)
    v_mfma_f32_16x16x32_bf16 v[80:83], v[160:163], a[120:123], v[80:83]
    ds_read_b64_tr_b16 v[188:189], v213 offset:20736
    ds_read_b64_tr_b16 v[190:191], v213 offset:22016
    v_mfma_f32_16x16x32_bf16 v[84:87], v[160:163], a[124:127], v[84:87]
    s_and_b32 s64, s2, 6
    s_bfe_u32 s69, s2, 0x10006
    s_add_u32 s64, s64, s69
    s_lshl_b32 s64, s64, 7
    s_add_u32 s64, s64, 1408
    v_mfma_f32_16x16x32_bf16 v[88:91], v[164:167], a[120:123], v[88:91]
    buffer_load_dword a211, v8, s[4:7], s64 offen
    v_mfma_f32_16x16x32_bf16 v[92:95], v[164:167], a[124:127], v[92:95]
    v_mfma_f32_16x16x32_bf16 v[96:99], v[168:171], a[120:123], v[96:99]
    v_mfma_f32_16x16x32_bf16 v[100:103], v[168:171], a[124:127], v[100:103]
    s_waitcnt vmcnt(10) lgkmcnt(0)
    s_barrier
    v_mfma_f32_16x16x32_bf16 v[104:107], v[172:175], a[120:123], v[104:107]
    buffer_load_dword a210, v8, s[8:11], s64 offen offset:2048
    ds_read_b128 a[128:131], v144 offset:32768
    v_mfma_f32_16x16x32_bf16 v[108:111], v[172:175], a[124:127], v[108:111]
    ds_read_b64_tr_b16 v[160:161], v210 offset:40960
    ds_read_b64_tr_b16 v[162:163], v210 offset:42240
    ds_read_b64_tr_b16 v[164:165], v211 offset:40960
    v_mfma_f32_16x16x32_bf16 v[112:115], v[176:179], a[120:123], v[112:115]
    ds_read_b128 a[132:135], v144 offset:34816
    ds_read_b64_tr_b16 v[166:167], v211 offset:42240
    v_mfma_f32_16x16x32_bf16 v[116:119], v[176:179], a[124:127], v[116:119]
    ds_read_b64_tr_b16 v[168:169], v210 offset:41024
    s_add_u32 m0, s66, 20480
    v_mfma_f32_16x16x32_bf16 v[120:123], v[180:183], a[120:123], v[120:123]
    buffer_load_dwordx4 v200, s[4:7], s47 offen offset:0 lds
    ds_read_b128 a[136:139], v145 offset:32768
    v_mfma_f32_16x16x32_bf16 v[124:127], v[180:183], a[124:127], v[124:127]
    ds_read_b64_tr_b16 v[170:171], v210 offset:42304
    ds_read_b64_tr_b16 v[172:173], v211 offset:41024
    v_mfma_f32_16x16x32_bf16 v[128:131], v[184:187], a[120:123], v[128:131]
    ds_read_b128 a[140:143], v145 offset:34816
    ds_read_b64_tr_b16 v[174:175], v211 offset:42304
    v_mfma_f32_16x16x32_bf16 v[132:135], v[184:187], a[124:127], v[132:135]
    ds_read_b64_tr_b16 v[176:177], v210 offset:41088
    v_mfma_f32_16x16x32_bf16 v[136:139], v[188:191], a[120:123], v[136:139]
    buffer_load_dwordx4 v201, s[4:7], s47 offen offset:1024 lds
    ds_read_b64_tr_b16 v[178:179], v210 offset:42368
    v_mfma_f32_16x16x32_bf16 v[140:143], v[188:191], a[124:127], v[140:143]
    ds_read_b64_tr_b16 v[180:181], v211 offset:41088
    ds_read_b64_tr_b16 v[182:183], v211 offset:42368
    s_waitcnt lgkmcnt(4)
    v_mfma_f32_16x16x32_bf16 v[64:67], v[160:163], a[128:131], v[64:67]
    ds_read_b64_tr_b16 v[184:185], v210 offset:41152
    v_mfma_f32_16x16x32_bf16 v[68:71], v[160:163], a[132:135], v[68:71]
    v_mfma_f32_16x16x32_bf16 a[216:219], v[148:151], v[160:163], a[216:219]
    ds_read_b64_tr_b16 v[186:187], v210 offset:42432
    v_mfma_f32_16x16x32_bf16 v[72:75], v[164:167], a[128:131], v[72:75]
    buffer_load_dwordx4 v200, s[8:11], s47 offen offset:2048 lds
    v_mfma_f32_16x16x32_bf16 v[76:79], v[164:167], a[132:135], v[76:79]
    ds_read_b64_tr_b16 v[188:189], v211 offset:41152
    v_mfma_f32_16x16x32_bf16 a[220:223], v[148:151], v[164:167], a[220:223]
    ds_read_b64_tr_b16 v[190:191], v211 offset:42432
    v_mfma_f32_16x16x32_bf16 v[80:83], v[168:171], a[128:131], v[80:83]
    ds_read_b64_tr_b16 v[160:161], v210 offset:41216
    v_mfma_f32_16x16x32_bf16 v[84:87], v[168:171], a[132:135], v[84:87]
    v_mfma_f32_16x16x32_bf16 a[224:227], v[148:151], v[168:171], a[224:227]
    ds_read_b64_tr_b16 v[162:163], v210 offset:42496
    v_mfma_f32_16x16x32_bf16 v[88:91], v[172:175], a[128:131], v[88:91]
    buffer_load_dwordx4 v201, s[8:11], s47 offen offset:3072 lds
    v_mfma_f32_16x16x32_bf16 v[92:95], v[172:175], a[132:135], v[92:95]
    ds_read_b64_tr_b16 v[164:165], v211 offset:41216
    v_mfma_f32_16x16x32_bf16 a[228:231], v[148:151], v[172:175], a[228:231]
    ds_read_b64_tr_b16 v[166:167], v211 offset:42496
    s_waitcnt lgkmcnt(4)
    v_mfma_f32_16x16x32_bf16 v[96:99], v[176:179], a[128:131], v[96:99]
    ds_read_b64_tr_b16 v[168:169], v212 offset:40960
    v_mfma_f32_16x16x32_bf16 v[100:103], v[176:179], a[132:135], v[100:103]
    ds_read_b64_tr_b16 v[170:171], v212 offset:42240
    v_mfma_f32_16x16x32_bf16 a[232:235], v[148:151], v[176:179], a[232:235]
    ds_read_b64_tr_b16 v[172:173], v213 offset:40960
    v_mfma_f32_16x16x32_bf16 v[104:107], v[180:183], a[128:131], v[104:107]
    ds_read_b64_tr_b16 v[174:175], v213 offset:42240
    ds_read_b64_tr_b16 v[176:177], v212 offset:41024
    v_mfma_f32_16x16x32_bf16 v[108:111], v[180:183], a[132:135], v[108:111]
    s_nop 0
P_stk_chk:
    v_cmp_ne_u32 vcc, v159, v28
    s_nop 4
    s_cbranch_vccnz P_stk_slow
P_stk_done:
    v_mov_b32 v159, v158
    v_mfma_f32_16x16x32_bf16 a[236:239], v[148:151], v[180:183], a[236:239]
    v_mov_b32 v249, 0
    v_mov_b32 v250, 0
    v_mfma_f32_16x16x32_bf16 v[112:115], v[184:187], a[128:131], v[112:115]
    ds_read_b64_tr_b16 v[178:179], v212 offset:42304
    ds_read_b64_tr_b16 v[180:181], v213 offset:41024
    v_mfma_f32_16x16x32_bf16 v[116:119], v[184:187], a[132:135], v[116:119]
    v_permlane16_swap_b32 v158, v159
    v_mov_b32 v253, 0
    v_mfma_f32_16x16x32_bf16 a[240:243], v[148:151], v[184:187], a[240:243]
    v_mov_b32 v254, 0
    v_and_b32 v218, 0xffff0000, v158
    v_mfma_f32_16x16x32_bf16 v[120:123], v[188:191], a[128:131], v[120:123]
    ds_read_b64_tr_b16 v[182:183], v213 offset:42304
    ds_read_b64_tr_b16 v[184:185], v212 offset:41088
    v_mfma_f32_16x16x32_bf16 v[124:127], v[188:191], a[132:135], v[124:127]
    v_and_b32 v248, 0xffff, v158
    v_rcp_f32 v219, v218
    v_mfma_f32_16x16x32_bf16 a[244:247], v[148:151], v[188:191], a[244:247]
    v_lshl_or_b32 v248, v158, 16, v248
    s_waitcnt lgkmcnt(5)
    v_mfma_f32_16x16x32_bf16 v[128:131], v[160:163], a[128:131], v[128:131]
    ds_read_b64_tr_b16 v[186:187], v212 offset:42368
    ds_read_b64_tr_b16 v[188:189], v213 offset:41088
    v_mfma_f32_16x16x32_bf16 v[132:135], v[160:163], a[132:135], v[132:135]
    ds_read_b64_tr_b16 v[190:191], v213 offset:42368
    v_mul_f32 v218, v218, v218
    v_mfma_f32_16x16x32_bf16 a[248:251], v[148:151], v[160:163], a[248:251]
    v_mov_b32 v251, v248
    v_mul_f32 v216, 0xc0135761, v219
    v_mfma_f32_16x16x32_bf16 v[136:139], v[164:167], a[128:131], v[136:139]
    ds_read_b64_tr_b16 v[160:161], v212 offset:41152
    ds_read_b64_tr_b16 v[162:163], v212 offset:42432
    v_mfma_f32_16x16x32_bf16 v[140:143], v[164:167], a[132:135], v[140:143]
    v_mul_f32 v217, v219, v219
    v_mul_f32 v217, 0x3d372713, v217
    v_mfma_f32_16x16x32_bf16 a[252:255], v[148:151], v[164:167], a[252:255]
    v_mul_f32 v217, v217, v216
    v_and_b32 v222, 0xffff0000, v159
    v_mfma_f32_16x16x32_bf16 v[64:67], v[168:171], a[136:139], v[64:67]
    ds_read_b64_tr_b16 v[164:165], v213 offset:41152
    ds_read_b64_tr_b16 v[166:167], v213 offset:42432
    v_mfma_f32_16x16x32_bf16 v[68:71], v[168:171], a[140:143], v[68:71]
    v_and_b32 v252, 0xffff, v159
    v_mfma_f32_16x16x32_bf16 v[72:75], v[172:175], a[136:139], v[72:75]
    ds_read_b64_tr_b16 v[168:169], v212 offset:41216
    ds_read_b64_tr_b16 v[170:171], v212 offset:42496
    v_mfma_f32_16x16x32_bf16 v[76:79], v[172:175], a[140:143], v[76:79]
    v_rcp_f32 v223, v222
    s_waitcnt lgkmcnt(6)
    v_mfma_f32_16x16x32_bf16 v[80:83], v[176:179], a[136:139], v[80:83]
    ds_read_b64_tr_b16 v[172:173], v213 offset:41216
    ds_read_b64_tr_b16 v[174:175], v213 offset:42496
    v_mfma_f32_16x16x32_bf16 v[84:87], v[176:179], a[140:143], v[84:87]
    v_lshl_or_b32 v252, v159, 16, v252
    v_mul_f32 v222, v222, v222
    v_mfma_f32_16x16x32_bf16 v[88:91], v[180:183], a[136:139], v[88:91]
    v_mov_b32 v255, v252
    v_mul_f32 v220, 0xc0135761, v223
    v_mfma_f32_16x16x32_bf16 v[92:95], v[180:183], a[140:143], v[92:95]
    v_mul_f32 v221, v223, v223
    v_mul_f32 v221, 0x3d372713, v221
    v_mfma_f32_16x16x32_bf16 v[96:99], v[184:187], a[136:139], v[96:99]
    v_mfma_f32_16x16x32_bf16 v[100:103], v[184:187], a[140:143], v[100:103]
    s_waitcnt vmcnt(6) lgkmcnt(0)
    s_barrier
    s_add_u32 m0, s66, 40960
    v_mfma_f32_16x16x32_bf16 v[104:107], v[188:191], a[136:139], v[104:107]
    buffer_load_dwordx4 v200, s[4:7], s48 offen offset:0 lds
    ds_read_b128 a[144:147], v144 offset:0
    v_mfma_f32_16x16x32_bf16 v[108:111], v[188:191], a[140:143], v[108:111]
    ds_read_b64_tr_b16 v[176:177], v210 offset:0
    ds_read_b64_tr_b16 v[178:179], v210 offset:1280
    ds_read_b64_tr_b16 v[180:181], v211 offset:0
    v_mfma_f32_16x16x32_bf16 v[112:115], v[160:163], a[136:139], v[112:115]
    ds_read_b128 a[148:151], v144 offset:2048
    ds_read_b64_tr_b16 v[182:183], v211 offset:1280
    v_mfma_f32_16x16x32_bf16 v[116:119], v[160:163], a[140:143], v[116:119]
    ds_read_b64_tr_b16 v[184:185], v210 offset:64
    v_mul_f32 v221, v221, v220
    v_mfma_f32_16x16x32_bf16 v[120:123], v[164:167], a[136:139], v[120:123]
    buffer_load_dwordx4 v201, s[4:7], s48 offen offset:1024 lds
    ds_read_b128 a[152:155], v145 offset:0
    v_mfma_f32_16x16x32_bf16 v[124:127], v[164:167], a[140:143], v[124:127]
    ds_read_b64_tr_b16 v[186:187], v210 offset:1344
    ds_read_b64_tr_b16 v[188:189], v211 offset:64
    v_mfma_f32_16x16x32_bf16 v[128:131], v[168:171], a[136:139], v[128:131]
    ds_read_b128 a[156:159], v145 offset:2048
    ds_read_b64_tr_b16 v[190:191], v211 offset:1344
    v_mfma_f32_16x16x32_bf16 v[132:135], v[168:171], a[140:143], v[132:135]
    ds_read_b64_tr_b16 v[160:161], v210 offset:128
    v_mfma_f32_16x16x32_bf16 v[136:139], v[172:175], a[136:139], v[136:139]
    buffer_load_dwordx4 v200, s[8:11], s48 offen offset:2048 lds
    ds_read_b64_tr_b16 v[162:163], v210 offset:1408
    v_mfma_f32_16x16x32_bf16 v[140:143], v[172:175], a[140:143], v[140:143]
    ds_read_b64_tr_b16 v[164:165], v211 offset:128
    ds_read_b64_tr_b16 v[166:167], v211 offset:1408
    s_waitcnt lgkmcnt(4)
    v_mfma_f32_16x16x32_bf16 v[64:67], v[176:179], a[144:147], v[64:67]
    ds_read_b64_tr_b16 v[168:169], v210 offset:192
    ds_read_b64_tr_b16 v[170:171], v210 offset:1472
    v_mfma_f32_16x16x32_bf16 v[68:71], v[176:179], a[148:151], v[68:71]
    s_mov_b32 s37, 19695616
    v_mfma_f32_16x16x32_bf16 a[216:219], v[148:151], v[176:179], a[216:219]
    v_mov_b32 v145, s38
    v_mov_b32 v144, 1073741824
    v_mfma_f32_16x16x32_bf16 v[72:75], v[180:183], a[144:147], v[72:75]
    buffer_load_dwordx4 v201, s[8:11], s48 offen offset:3072 lds
    v_mfma_f32_16x16x32_bf16 v[76:79], v[180:183], a[148:151], v[76:79]
    ds_read_b64_tr_b16 v[172:173], v211 offset:192
    v_mfma_f32_16x16x32_bf16 a[220:223], v[148:151], v[180:183], a[220:223]
    ds_read_b64_tr_b16 v[174:175], v211 offset:1472
    v_cmp_eq_u32 vcc, 0, v209
    v_mfma_f32_16x16x32_bf16 v[80:83], v[184:187], a[144:147], v[80:83]
    ds_read_b64_tr_b16 v[176:177], v210 offset:256
    ds_read_b64_tr_b16 v[178:179], v210 offset:1536
    v_mfma_f32_16x16x32_bf16 v[84:87], v[184:187], a[148:151], v[84:87]
    v_add_u32 v159, 4096, v209
    v_mfma_f32_16x16x32_bf16 a[224:227], v[148:151], v[184:187], a[224:227]
    v_accvgpr_read_b32 v158, a212
    v_cndmask_b32 v144, v144, v209, vcc
    v_mfma_f32_16x16x32_bf16 v[88:91], v[188:191], a[144:147], v[88:91]
    ds_read_b64_tr_b16 v[180:181], v211 offset:256
    v_mfma_f32_16x16x32_bf16 v[92:95], v[188:191], a[148:151], v[92:95]
    ds_read_b64_tr_b16 v[182:183], v211 offset:1536
    v_mfma_f32_16x16x32_bf16 a[228:231], v[148:151], v[188:191], a[228:231]
    buffer_store_dword v145, v144, s[20:23], s1 offen sc1
    s_waitcnt lgkmcnt(4)
    v_mfma_f32_16x16x32_bf16 v[96:99], v[160:163], a[144:147], v[96:99]
    ds_read_b64_tr_b16 v[184:185], v212 offset:0
    v_mfma_f32_16x16x32_bf16 v[100:103], v[160:163], a[148:151], v[100:103]
    ds_read_b64_tr_b16 v[186:187], v212 offset:1280
    v_mfma_f32_16x16x32_bf16 a[232:235], v[148:151], v[160:163], a[232:235]
    ds_read_b64_tr_b16 v[188:189], v213 offset:0
    v_mfma_f32_16x16x32_bf16 v[104:107], v[164:167], a[144:147], v[104:107]
    ds_read_b64_tr_b16 v[190:191], v213 offset:1280
    v_mfma_f32_16x16x32_bf16 v[108:111], v[164:167], a[148:151], v[108:111]
    v_mfma_f32_16x16x32_bf16 a[236:239], v[148:151], v[164:167], a[236:239]
    ds_read_b64_tr_b16 v[160:161], v212 offset:64
    v_mfma_f32_16x16x32_bf16 v[112:115], v[168:171], a[144:147], v[112:115]
    ds_read_b64_tr_b16 v[162:163], v212 offset:1344
    v_mfma_f32_16x16x32_bf16 v[116:119], v[168:171], a[148:151], v[116:119]
    v_mfma_f32_16x16x32_bf16 a[240:243], v[148:151], v[168:171], a[240:243]
    ds_read_b64_tr_b16 v[164:165], v213 offset:64
    v_mfma_f32_16x16x32_bf16 v[120:123], v[172:175], a[144:147], v[120:123]
    ds_read_b64_tr_b16 v[166:167], v213 offset:1344
    v_mfma_f32_16x16x32_bf16 v[124:127], v[172:175], a[148:151], v[124:127]
    ds_read_b64_tr_b16 v[168:169], v212 offset:128
    v_mfma_f32_16x16x32_bf16 a[244:247], v[148:151], v[172:175], a[244:247]
    s_waitcnt lgkmcnt(5)
    v_mfma_f32_16x16x32_bf16 v[128:131], v[176:179], a[144:147], v[128:131]
    ds_read_b64_tr_b16 v[170:171], v212 offset:1408
    v_mfma_f32_16x16x32_bf16 v[132:135], v[176:179], a[148:151], v[132:135]
    ds_read_b64_tr_b16 v[172:173], v213 offset:128
    v_mfma_f32_16x16x32_bf16 a[248:251], v[148:151], v[176:179], a[248:251]
    ds_read_b64_tr_b16 v[174:175], v213 offset:1408
    v_mfma_f32_16x16x32_bf16 v[136:139], v[180:183], a[144:147], v[136:139]
    ds_read_b64_tr_b16 v[176:177], v212 offset:192
    v_mfma_f32_16x16x32_bf16 v[140:143], v[180:183], a[148:151], v[140:143]
    v_mfma_f32_16x16x32_bf16 a[252:255], v[148:151], v[180:183], a[252:255]
    ds_read_b64_tr_b16 v[178:179], v212 offset:1472
    v_mfma_f32_16x16x32_bf16 v[64:67], v[184:187], a[152:155], v[64:67]
    ds_read_b64_tr_b16 v[180:181], v213 offset:192
    v_mfma_f32_16x16x32_bf16 v[68:71], v[184:187], a[156:159], v[68:71]
    ds_read_b64_tr_b16 v[182:183], v213 offset:1472
    v_mfma_f32_16x16x32_bf16 v[72:75], v[188:191], a[152:155], v[72:75]
    ds_read_b64_tr_b16 v[184:185], v212 offset:256
    ds_read_b64_tr_b16 v[186:187], v212 offset:1536
    v_accvgpr_read_b32 v224, a216
    v_accvgpr_read_b32 v225, a220
    v_accvgpr_read_b32 v226, a224
    v_mfma_f32_16x16x32_bf16 v[76:79], v[188:191], a[156:159], v[76:79]
    v_accvgpr_read_b32 v227, a228
    v_accvgpr_read_b32 v228, a232
    v_accvgpr_read_b32 v229, a236
    v_accvgpr_read_b32 v230, a240
    v_accvgpr_read_b32 v231, a244
    s_waitcnt lgkmcnt(6)
    v_mfma_f32_16x16x32_bf16 v[80:83], v[160:163], a[152:155], v[80:83]
    ds_read_b64_tr_b16 v[188:189], v213 offset:256
    ds_read_b64_tr_b16 v[190:191], v213 offset:1536
    v_accvgpr_read_b32 v232, a248
    v_accvgpr_read_b32 v233, a252
    v_mul_u32_u24 v202, 5, v209
    s_and_b32 s72, s40, 1
    v_mfma_f32_16x16x32_bf16 v[84:87], v[160:163], a[156:159], v[84:87]
    v_add_u32 v202, 131200, v202
    v_lshl_add_u32 v203, s72, 2, v202
    v_and_b32 v234, 0xffff0000, v224
    v_sub_f32 v224, v224, v234
    v_cvt_pk_bf16_f32 v224, v234, v224
    v_mfma_f32_16x16x32_bf16 v[88:91], v[164:167], a[152:155], v[88:91]
    ds_write_b32 v203, v224 offset:0
    v_and_b32 v235, 0xffff0000, v225
    v_sub_f32 v225, v225, v235
    v_cvt_pk_bf16_f32 v225, v235, v225
    ds_write_b32 v203, v225 offset:8
    v_mfma_f32_16x16x32_bf16 v[92:95], v[164:167], a[156:159], v[92:95]
    v_and_b32 v234, 0xffff0000, v226
    v_sub_f32 v226, v226, v234
    v_cvt_pk_bf16_f32 v226, v234, v226
    ds_write_b32 v203, v226 offset:16
    v_mfma_f32_16x16x32_bf16 v[96:99], v[168:171], a[152:155], v[96:99]
    v_mfma_f32_16x16x32_bf16 v[100:103], v[168:171], a[156:159], v[100:103]
    s_waitcnt vmcnt(5) lgkmcnt(0)
    s_barrier
    s_add_u32 m0, s66, 0
    v_mfma_f32_16x16x32_bf16 v[104:107], v[172:175], a[152:155], v[104:107]
    buffer_load_dwordx4 v200, s[4:7], s51 offen offset:0 lds
    ds_read_b64_tr_b16 v[160:161], v192 offset:20480
    ds_read_b64_tr_b16 v[162:163], v192 offset:20992
    ds_read_b64_tr_b16 v[164:165], v193 offset:20480
    v_and_b32 v235, 0xffff0000, v227
    v_mfma_f32_16x16x32_bf16 v[108:111], v[172:175], a[156:159], v[108:111]
    v_sub_f32 v227, v227, v235
    v_cvt_pk_bf16_f32 v227, v235, v227
    ds_write_b32 v203, v227 offset:24
    v_and_b32 v234, 0xffff0000, v228
    v_mfma_f32_16x16x32_bf16 v[112:115], v[176:179], a[152:155], v[112:115]
    buffer_load_dwordx4 v201, s[4:7], s51 offen offset:1024 lds
    ds_read_b64_tr_b16 v[166:167], v193 offset:20992
    ds_read_b64_tr_b16 v[168:169], v194 offset:20480
    v_sub_f32 v228, v228, v234
    v_cvt_pk_bf16_f32 v228, v234, v228
    v_mfma_f32_16x16x32_bf16 v[116:119], v[176:179], a[156:159], v[116:119]
    ds_write_b32 v203, v228 offset:32
    v_and_b32 v235, 0xffff0000, v229
    v_sub_f32 v229, v229, v235
    v_cvt_pk_bf16_f32 v229, v235, v229
    v_mfma_f32_16x16x32_bf16 v[120:123], v[180:183], a[152:155], v[120:123]
    buffer_load_dwordx4 v200, s[8:11], s51 offen offset:2048 lds
    ds_read_b64_tr_b16 v[170:171], v194 offset:20992
    ds_read_b64_tr_b16 v[172:173], v195 offset:20480
    ds_write_b32 v203, v229 offset:40
    v_mfma_f32_16x16x32_bf16 v[124:127], v[180:183], a[156:159], v[124:127]
    v_and_b32 v234, 0xffff0000, v230
    v_sub_f32 v230, v230, v234
    v_cvt_pk_bf16_f32 v230, v234, v230
    ds_write_b32 v203, v230 offset:48
    v_mfma_f32_16x16x32_bf16 v[128:131], v[184:187], a[152:155], v[128:131]
    buffer_load_dwordx4 v201, s[8:11], s51 offen offset:3072 lds
    ds_read_b64_tr_b16 v[174:175], v195 offset:20992
    ds_read_b64_tr_b16 v[176:177], v192 offset:22528
    ds_read_b64_tr_b16 v[178:179], v192 offset:23040
    v_mfma_f32_16x16x32_bf16 v[132:135], v[184:187], a[156:159], v[132:135]
    v_and_b32 v235, 0xffff0000, v231
    v_sub_f32 v231, v231, v235
    v_cvt_pk_bf16_f32 v231, v235, v231
    buffer_load_dword v146, v158, s[20:23], s37 offen sc1
    v_mfma_f32_16x16x32_bf16 v[136:139], v[188:191], a[152:155], v[136:139]
    v_mfma_f32_16x16x32_bf16 v[140:143], v[188:191], a[156:159], v[140:143]
    ds_read_b64_tr_b16 v[180:181], v193 offset:22528
    ds_read_b64_tr_b16 v[182:183], v193 offset:23040
    ds_write_b32 v203, v231 offset:56
    v_and_b32 v234, 0xffff0000, v232
    v_sub_f32 v232, v232, v234
    v_cvt_pk_bf16_f32 v232, v234, v232
    ds_write_b32 v203, v232 offset:64
    v_and_b32 v235, 0xffff0000, v233
    v_sub_f32 v233, v233, v235
    v_cvt_pk_bf16_f32 v233, v235, v233
    ds_write_b32 v203, v233 offset:72
    s_waitcnt lgkmcnt(0)
    s_barrier
    ds_read_b128 v[224:227], v202 offset:0
    ds_read_b128 v[228:231], v202 offset:16
    ds_read_b128 v[232:235], v202 offset:32
    ds_read_b128 v[236:239], v202 offset:48
    ds_read_b128 v[240:243], v202 offset:64
    v_mov_b32 v244, v248
    v_mov_b32 v245, v248
    v_mov_b32 v246, v252
    v_mov_b32 v247, v252
    v_mul_f32 v22, 0x3fb8aa3b, v219
    v_mul_f32 v23, 0x3fb8aa3b, v223
    ds_write_b64 v16, v[20:21] offset:160
    s_waitcnt lgkmcnt(1)
    v_mfma_f32_16x16x16_bf16 v[64:67], v[224:225], v[244:245], v[64:67]
    v_mfma_f32_16x16x16_bf16 v[68:71], v[224:225], v[246:247], v[68:71]
    v_mfma_f32_16x16x16_bf16 v[72:75], v[226:227], v[244:245], v[72:75]
    v_mfma_f32_16x16x16_bf16 v[76:79], v[226:227], v[246:247], v[76:79]
    v_mfma_f32_16x16x16_bf16 v[80:83], v[228:229], v[244:245], v[80:83]
    v_mfma_f32_16x16x16_bf16 v[84:87], v[228:229], v[246:247], v[84:87]
    v_mfma_f32_16x16x16_bf16 v[88:91], v[230:231], v[244:245], v[88:91]
    v_mfma_f32_16x16x16_bf16 v[92:95], v[230:231], v[246:247], v[92:95]
    v_mfma_f32_16x16x16_bf16 v[96:99], v[232:233], v[244:245], v[96:99]
    v_mfma_f32_16x16x16_bf16 v[100:103], v[232:233], v[246:247], v[100:103]
    v_mfma_f32_16x16x16_bf16 v[104:107], v[234:235], v[244:245], v[104:107]
    v_mfma_f32_16x16x16_bf16 v[108:111], v[234:235], v[246:247], v[108:111]
    v_mfma_f32_16x16x16_bf16 v[112:115], v[236:237], v[244:245], v[112:115]
    v_mfma_f32_16x16x16_bf16 v[116:119], v[236:237], v[246:247], v[116:119]
    v_mfma_f32_16x16x16_bf16 v[120:123], v[238:239], v[244:245], v[120:123]
    v_mfma_f32_16x16x16_bf16 v[124:127], v[238:239], v[246:247], v[124:127]
    v_mfma_f32_16x16x16_bf16 v[128:131], v[240:241], v[244:245], v[128:131]
    v_mfma_f32_16x16x16_bf16 v[132:135], v[240:241], v[246:247], v[132:135]
    v_mfma_f32_16x16x16_bf16 v[136:139], v[242:243], v[244:245], v[136:139]
    v_mfma_f32_16x16x16_bf16 v[140:143], v[242:243], v[246:247], v[140:143]
    v_pk_mul_f32 v[64:65], v[64:65], v[22:23] op_sel:[0,0] op_sel_hi:[1,0]
    v_pk_mul_f32 v[66:67], v[66:67], v[22:23] op_sel:[0,0] op_sel_hi:[1,0]
    v_pk_mul_f32 v[72:73], v[72:73], v[22:23] op_sel:[0,0] op_sel_hi:[1,0]
    v_pk_mul_f32 v[74:75], v[74:75], v[22:23] op_sel:[0,0] op_sel_hi:[1,0]
    v_pk_mul_f32 v[80:81], v[80:81], v[22:23] op_sel:[0,0] op_sel_hi:[1,0]
    v_pk_mul_f32 v[82:83], v[82:83], v[22:23] op_sel:[0,0] op_sel_hi:[1,0]
    v_pk_mul_f32 v[88:89], v[88:89], v[22:23] op_sel:[0,0] op_sel_hi:[1,0]
    v_pk_mul_f32 v[90:91], v[90:91], v[22:23] op_sel:[0,0] op_sel_hi:[1,0]
    v_pk_mul_f32 v[96:97], v[96:97], v[22:23] op_sel:[0,0] op_sel_hi:[1,0]
    v_pk_mul_f32 v[98:99], v[98:99], v[22:23] op_sel:[0,0] op_sel_hi:[1,0]
    v_cvt_pk_bf16_f32 v224, v64, v65
    v_cvt_pk_bf16_f32 v225, v66, v67
    v_cvt_pk_bf16_f32 v226, v72, v73
    v_cvt_pk_bf16_f32 v227, v74, v75
    v_cvt_pk_bf16_f32 v228, v80, v81
    v_cvt_pk_bf16_f32 v229, v82, v83
    v_cvt_pk_bf16_f32 v230, v88, v89
    v_cvt_pk_bf16_f32 v231, v90, v91
    v_cvt_pk_bf16_f32 v232, v96, v97
    v_cvt_pk_bf16_f32 v233, v98, v99
    v_pk_mul_f32 v[68:69], v[68:69], v[22:23] op_sel:[0,1] op_sel_hi:[1,1]
    v_pk_mul_f32 v[70:71], v[70:71], v[22:23] op_sel:[0,1] op_sel_hi:[1,1]
    v_pk_mul_f32 v[76:77], v[76:77], v[22:23] op_sel:[0,1] op_sel_hi:[1,1]
    v_pk_mul_f32 v[78:79], v[78:79], v[22:23] op_sel:[0,1] op_sel_hi:[1,1]
    v_pk_mul_f32 v[84:85], v[84:85], v[22:23] op_sel:[0,1] op_sel_hi:[1,1]
    v_pk_mul_f32 v[86:87], v[86:87], v[22:23] op_sel:[0,1] op_sel_hi:[1,1]
    v_pk_mul_f32 v[92:93], v[92:93], v[22:23] op_sel:[0,1] op_sel_hi:[1,1]
    v_pk_mul_f32 v[94:95], v[94:95], v[22:23] op_sel:[0,1] op_sel_hi:[1,1]
    v_pk_mul_f32 v[100:101], v[100:101], v[22:23] op_sel:[0,1] op_sel_hi:[1,1]
    v_pk_mul_f32 v[102:103], v[102:103], v[22:23] op_sel:[0,1] op_sel_hi:[1,1]
    v_cvt_pk_bf16_f32 v234, v68, v69
    v_cvt_pk_bf16_f32 v235, v70, v71
    v_cvt_pk_bf16_f32 v236, v76, v77
    v_cvt_pk_bf16_f32 v237, v78, v79
    v_cvt_pk_bf16_f32 v238, v84, v85
    v_cvt_pk_bf16_f32 v239, v86, v87
    v_cvt_pk_bf16_f32 v240, v92, v93
    v_cvt_pk_bf16_f32 v241, v94, v95
    v_cvt_pk_bf16_f32 v242, v100, v101
    v_cvt_pk_bf16_f32 v243, v102, v103
    v_mfma_f32_16x16x32_bf16 v[64:67], a[160:163], v[224:227], 0
    v_mul_f32 v104, v219, v104
    v_mul_f32 v105, v219, v105
    v_mfma_f32_16x16x32_bf16 v[68:71], a[170:173], v[224:227], 0
    v_mul_f32 v106, v219, v106
    v_mul_f32 v107, v219, v107
    v_mfma_f32_16x16x32_bf16 v[72:75], a[180:183], v[224:227], 0
    v_cvt_pk_bf16_f32 v104, v104, v105
    v_cvt_pk_bf16_f32 v105, v106, v107
    v_mfma_f32_16x16x32_bf16 v[76:79], a[190:193], v[224:227], 0
    ds_write_b64 v155, v[104:105] offset:0
    v_mul_f32 v112, v219, v112
    v_mfma_f32_16x16x32_bf16 v[80:83], a[200:203], v[224:227], 0
    v_mul_f32 v113, v219, v113
    v_mul_f32 v114, v219, v114
    v_mfma_f32_16x16x32_bf16 v[64:67], a[164:167], v[228:231], v[64:67]
    v_mul_f32 v115, v219, v115
    v_cvt_pk_bf16_f32 v112, v112, v113
    v_mfma_f32_16x16x32_bf16 v[68:71], a[174:177], v[228:231], v[68:71]
    v_cvt_pk_bf16_f32 v113, v114, v115
    ds_write_b64 v155, v[112:113] offset:32
    v_mfma_f32_16x16x32_bf16 v[72:75], a[184:187], v[228:231], v[72:75]
    v_mul_f32 v120, v219, v120
    v_mul_f32 v121, v219, v121
    v_mfma_f32_16x16x32_bf16 v[76:79], a[194:197], v[228:231], v[76:79]
    v_mul_f32 v122, v219, v122
    v_mul_f32 v123, v219, v123
    v_mfma_f32_16x16x32_bf16 v[80:83], a[204:207], v[228:231], v[80:83]
    v_cvt_pk_bf16_f32 v120, v120, v121
    v_cvt_pk_bf16_f32 v121, v122, v123
    v_mfma_f32_16x16x16_bf16 v[64:67], a[168:169], v[232:233], v[64:67]
    ds_write_b64 v155, v[120:121] offset:64
    v_mul_f32 v128, v219, v128
    v_mfma_f32_16x16x16_bf16 v[68:71], a[178:179], v[232:233], v[68:71]
    v_mul_f32 v129, v219, v129
    v_mul_f32 v130, v219, v130
    v_mfma_f32_16x16x16_bf16 v[72:75], a[188:189], v[232:233], v[72:75]
    v_mul_f32 v131, v219, v131
    v_cvt_pk_bf16_f32 v128, v128, v129
    v_mfma_f32_16x16x16_bf16 v[76:79], a[198:199], v[232:233], v[76:79]
    v_cvt_pk_bf16_f32 v129, v130, v131
    ds_write_b64 v155, v[128:129] offset:96
    v_mfma_f32_16x16x16_bf16 v[80:83], a[208:209], v[232:233], v[80:83]
    v_mul_f32 v136, v219, v136
    v_mul_f32 v137, v219, v137
    v_mfma_f32_16x16x32_bf16 v[84:87], a[160:163], v[234:237], 0
    v_mul_f32 v138, v219, v138
    v_mul_f32 v139, v219, v139
    v_mfma_f32_16x16x32_bf16 v[88:91], a[170:173], v[234:237], 0
    v_cvt_pk_bf16_f32 v136, v136, v137
    v_cvt_pk_bf16_f32 v137, v138, v139
    v_mfma_f32_16x16x32_bf16 v[92:95], a[180:183], v[234:237], 0
    ds_write_b64 v155, v[136:137] offset:128
    v_mul_f32 v108, v223, v108
    v_mfma_f32_16x16x32_bf16 v[96:99], a[190:193], v[234:237], 0
    v_mul_f32 v109, v223, v109
    v_mul_f32 v110, v223, v110
    v_mfma_f32_16x16x32_bf16 v[100:103], a[200:203], v[234:237], 0
    v_mul_f32 v111, v223, v111
    v_cvt_pk_bf16_f32 v108, v108, v109
    v_mfma_f32_16x16x32_bf16 v[84:87], a[164:167], v[238:241], v[84:87]
    v_cvt_pk_bf16_f32 v109, v110, v111
    ds_write_b64 v155, v[108:109] offset:2816
    v_mfma_f32_16x16x32_bf16 v[88:91], a[174:177], v[238:241], v[88:91]
    v_mul_f32 v116, v223, v116
    v_mul_f32 v117, v223, v117
    v_mfma_f32_16x16x32_bf16 v[92:95], a[184:187], v[238:241], v[92:95]
    v_mul_f32 v118, v223, v118
    v_mul_f32 v119, v223, v119
    v_mfma_f32_16x16x32_bf16 v[96:99], a[194:197], v[238:241], v[96:99]
    v_cvt_pk_bf16_f32 v116, v116, v117
    v_cvt_pk_bf16_f32 v117, v118, v119
    v_mfma_f32_16x16x32_bf16 v[100:103], a[204:207], v[238:241], v[100:103]
    ds_write_b64 v155, v[116:117] offset:2848
    v_mul_f32 v124, v223, v124
    v_mfma_f32_16x16x16_bf16 v[84:87], a[168:169], v[242:243], v[84:87]
    v_mul_f32 v125, v223, v125
    v_mul_f32 v126, v223, v126
    v_mfma_f32_16x16x16_bf16 v[88:91], a[178:179], v[242:243], v[88:91]
    v_mul_f32 v127, v223, v127
    v_cvt_pk_bf16_f32 v124, v124, v125
    v_mfma_f32_16x16x16_bf16 v[92:95], a[188:189], v[242:243], v[92:95]
    v_cvt_pk_bf16_f32 v125, v126, v127
    ds_write_b64 v155, v[124:125] offset:2880
    v_mfma_f32_16x16x16_bf16 v[96:99], a[198:199], v[242:243], v[96:99]
    v_mul_f32 v132, v223, v132
    v_mul_f32 v133, v223, v133
    v_mfma_f32_16x16x16_bf16 v[100:103], a[208:209], v[242:243], v[100:103]
    v_mul_f32 v134, v223, v134
    v_mul_f32 v135, v223, v135
    v_cvt_pk_bf16_f32 v132, v132, v133
    v_cvt_pk_bf16_f32 v133, v134, v135
    ds_write_b64 v155, v[132:133] offset:2912
    v_mul_f32 v140, v223, v140
    v_mul_f32 v141, v223, v141
    v_mul_f32 v142, v223, v142
    v_mul_f32 v143, v223, v143
    v_cvt_pk_bf16_f32 v140, v140, v141
    v_cvt_pk_bf16_f32 v141, v142, v143
    ds_write_b64 v155, v[140:141] offset:2944
    s_waitcnt vmcnt(0)
    v_cmp_ne_u32 vcc, v146, v145
    s_nop 3
    s_cmp_eq_u64 vcc, 0
    s_cselect_b32 s101, s101, 1073741824
    s_cselect_b32 s75, s75, 1073741824
    s_cselect_b32 s0, s0, 1073741824
    v_max3_f32 v52, v64, v65, v66
    s_add_u32 s100, s75, 0
    buffer_load_dwordx4 a[160:163], v209, s[20:23], s100 offen offset:0 sc1
    v_min3_f32 v53, v64, v65, v66
    v_max3_f32 v52, v52, v67, v68
    v_min3_f32 v53, v53, v67, v68
    v_max3_f32 v52, v52, v69, v70
    v_min3_f32 v53, v53, v69, v70
    v_max3_f32 v52, v52, v71, v72
    v_min3_f32 v53, v53, v71, v72
    v_max3_f32 v52, v52, v73, v74
    v_min3_f32 v53, v53, v73, v74
    v_max3_f32 v52, v52, v75, v76
    v_min3_f32 v53, v53, v75, v76
    v_max3_f32 v52, v52, v77, v78
    v_min3_f32 v53, v53, v77, v78
    v_max3_f32 v52, v52, v79, v80
    buffer_load_dwordx4 a[164:167], v209, s[20:23], s100 offen offset:1024 sc1
    v_min3_f32 v53, v53, v79, v80
    v_max3_f32 v52, v52, v81, v82
    v_min3_f32 v53, v53, v81, v82
    v_max_f32 v52, v52, v83
    v_min_f32 v53, v53, v83
    v_pk_add_f32 v[32:33], v[64:65], v[52:53] op_sel_hi:[1,0] neg_lo:[0,1] neg_hi:[0,1]
    v_pk_add_f32 v[64:65], v[52:53], v[64:65] op_sel:[1,0] neg_lo:[0,1] neg_hi:[0,1]
    v_exp_f32 v32, v32
    v_exp_f32 v33, v33
    v_exp_f32 v64, v64
    v_exp_f32 v65, v65
    v_pk_add_f32 v[34:35], v[66:67], v[52:53] op_sel_hi:[1,0] neg_lo:[0,1] neg_hi:[0,1]
    v_pk_add_f32 v[66:67], v[52:53], v[66:67] op_sel:[1,0] neg_lo:[0,1] neg_hi:[0,1]
    v_exp_f32 v34, v34
    buffer_load_dwordx4 a[168:171], v209, s[20:23], s100 offen offset:2048 sc1
    v_exp_f32 v35, v35
    v_exp_f32 v66, v66
    v_exp_f32 v67, v67
    v_pk_add_f32 v[36:37], v[68:69], v[52:53] op_sel_hi:[1,0] neg_lo:[0,1] neg_hi:[0,1]
    v_pk_add_f32 v[68:69], v[52:53], v[68:69] op_sel:[1,0] neg_lo:[0,1] neg_hi:[0,1]
    v_exp_f32 v36, v36
    v_exp_f32 v37, v37
    v_exp_f32 v68, v68
    v_exp_f32 v69, v69
    v_pk_add_f32 v[54:55], v[32:33], v[34:35]
    v_pk_add_f32 v[56:57], v[64:65], v[66:67]
    v_pk_add_f32 v[38:39], v[70:71], v[52:53] op_sel_hi:[1,0] neg_lo:[0,1] neg_hi:[0,1]
    v_pk_add_f32 v[70:71], v[52:53], v[70:71] op_sel:[1,0] neg_lo:[0,1] neg_hi:[0,1]
    v_exp_f32 v38, v38
    buffer_load_dwordx4 a[172:175], v209, s[20:23], s100 offen offset:3072 sc1
    v_exp_f32 v39, v39
    v_exp_f32 v70, v70
    v_exp_f32 v71, v71
    v_pk_add_f32 v[54:55], v[54:55], v[36:37]
    v_pk_add_f32 v[56:57], v[56:57], v[68:69]
    v_pk_add_f32 v[40:41], v[72:73], v[52:53] op_sel_hi:[1,0] neg_lo:[0,1] neg_hi:[0,1]
    v_pk_add_f32 v[72:73], v[52:53], v[72:73] op_sel:[1,0] neg_lo:[0,1] neg_hi:[0,1]
    v_exp_f32 v40, v40
    v_exp_f32 v41, v41
    v_exp_f32 v72, v72
    v_exp_f32 v73, v73
    v_pk_add_f32 v[54:55], v[54:55], v[38:39]
    v_pk_add_f32 v[56:57], v[56:57], v[70:71]
    v_pk_add_f32 v[42:43], v[74:75], v[52:53] op_sel_hi:[1,0] neg_lo:[0,1] neg_hi:[0,1]
    buffer_load_dwordx4 a[176:179], v159, s[20:23], s100 offen offset:0 sc1
    v_pk_add_f32 v[74:75], v[52:53], v[74:75] op_sel:[1,0] neg_lo:[0,1] neg_hi:[0,1]
    v_exp_f32 v42, v42
    v_exp_f32 v43, v43
    v_exp_f32 v74, v74
    v_exp_f32 v75, v75
    v_pk_add_f32 v[54:55], v[54:55], v[40:41]
    v_pk_add_f32 v[56:57], v[56:57], v[72:73]
    v_pk_add_f32 v[44:45], v[76:77], v[52:53] op_sel_hi:[1,0] neg_lo:[0,1] neg_hi:[0,1]
    v_pk_add_f32 v[76:77], v[52:53], v[76:77] op_sel:[1,0] neg_lo:[0,1] neg_hi:[0,1]
    v_exp_f32 v44, v44
    v_exp_f32 v45, v45
    v_exp_f32 v76, v76
    v_exp_f32 v77, v77
    v_pk_add_f32 v[54:55], v[54:55], v[42:43]
    s_add_u32 s100, s75, 5120
    buffer_load_dwordx4 a[180:183], v209, s[20:23], s100 offen offset:0 sc1
    v_pk_add_f32 v[56:57], v[56:57], v[74:75]
    v_pk_add_f32 v[46:47], v[78:79], v[52:53] op_sel_hi:[1,0] neg_lo:[0,1] neg_hi:[0,1]
    v_pk_add_f32 v[78:79], v[52:53], v[78:79] op_sel:[1,0] neg_lo:[0,1] neg_hi:[0,1]
    v_exp_f32 v46, v46
    v_exp_f32 v47, v47
    v_exp_f32 v78, v78
    v_exp_f32 v79, v79
    v_pk_add_f32 v[54:55], v[54:55], v[44:45]
    v_pk_add_f32 v[56:57], v[56:57], v[76:77]
    v_pk_add_f32 v[48:49], v[80:81], v[52:53] op_sel_hi:[1,0] neg_lo:[0,1] neg_hi:[0,1]
    v_pk_add_f32 v[80:81], v[52:53], v[80:81] op_sel:[1,0] neg_lo:[0,1] neg_hi:[0,1]
    v_exp_f32 v48, v48
    v_exp_f32 v49, v49
    v_exp_f32 v80, v80
    buffer_load_dwordx4 a[184:187], v209, s[20:23], s100 offen offset:1024 sc1
    v_exp_f32 v81, v81
    v_pk_add_f32 v[54:55], v[54:55], v[46:47]
    v_pk_add_f32 v[56:57], v[56:57], v[78:79]
    v_pk_add_f32 v[50:51], v[82:83], v[52:53] op_sel_hi:[1,0] neg_lo:[0,1] neg_hi:[0,1]
    v_pk_add_f32 v[82:83], v[52:53], v[82:83] op_sel:[1,0] neg_lo:[0,1] neg_hi:[0,1]
    v_exp_f32 v50, v50
    v_exp_f32 v51, v51
    v_exp_f32 v82, v82
    v_exp_f32 v83, v83
    v_pk_add_f32 v[54:55], v[54:55], v[48:49]
    v_pk_add_f32 v[56:57], v[56:57], v[80:81]
    v_pk_add_f32 v[54:55], v[54:55], v[50:51]
    v_pk_add_f32 v[56:57], v[56:57], v[82:83]
    v_add_f32 v54, v54, v55
    buffer_load_dwordx4 a[188:191], v209, s[20:23], s100 offen offset:2048 sc1
    v_add_f32 v56, v56, v57
    v_rcp_f32 v54, v54
    v_rcp_f32 v56, v56
    v_pk_mul_f32 v[32:33], v[32:33], v[54:55] op_sel_hi:[1,0]
    v_pk_mul_f32 v[34:35], v[34:35], v[54:55] op_sel_hi:[1,0]
    v_pk_mul_f32 v[36:37], v[36:37], v[54:55] op_sel_hi:[1,0]
    v_pk_mul_f32 v[38:39], v[38:39], v[54:55] op_sel_hi:[1,0]
    v_pk_mul_f32 v[40:41], v[40:41], v[54:55] op_sel_hi:[1,0]
    v_pk_mul_f32 v[42:43], v[42:43], v[54:55] op_sel_hi:[1,0]
    v_pk_mul_f32 v[44:45], v[44:45], v[54:55] op_sel_hi:[1,0]
    v_pk_mul_f32 v[46:47], v[46:47], v[54:55] op_sel_hi:[1,0]
    v_pk_mul_f32 v[48:49], v[48:49], v[54:55] op_sel_hi:[1,0]
    v_pk_mul_f32 v[50:51], v[50:51], v[54:55] op_sel_hi:[1,0]
    v_pk_mul_f32 v[64:65], v[64:65], v[56:57] op_sel_hi:[1,0]
    buffer_load_dwordx4 a[192:195], v209, s[20:23], s100 offen offset:3072 sc1
    v_pk_mul_f32 v[66:67], v[66:67], v[56:57] op_sel_hi:[1,0]
    v_pk_mul_f32 v[68:69], v[68:69], v[56:57] op_sel_hi:[1,0]
    v_pk_mul_f32 v[70:71], v[70:71], v[56:57] op_sel_hi:[1,0]
    v_pk_mul_f32 v[72:73], v[72:73], v[56:57] op_sel_hi:[1,0]
    v_pk_mul_f32 v[74:75], v[74:75], v[56:57] op_sel_hi:[1,0]
    v_pk_mul_f32 v[76:77], v[76:77], v[56:57] op_sel_hi:[1,0]
    v_pk_mul_f32 v[78:79], v[78:79], v[56:57] op_sel_hi:[1,0]
    v_pk_mul_f32 v[80:81], v[80:81], v[56:57] op_sel_hi:[1,0]
    v_pk_mul_f32 v[82:83], v[82:83], v[56:57] op_sel_hi:[1,0]
    v_cvt_pk_bf16_f32 v224, v32, v33
    v_cvt_pk_bf16_f32 v225, v34, v35
    v_cvt_pk_bf16_f32 v226, v36, v37
    v_cvt_pk_bf16_f32 v227, v38, v39
    ds_write_b128 v154, v[224:227] offset:0
    v_cvt_pk_bf16_f32 v228, v40, v41
    buffer_load_dwordx4 a[196:199], v159, s[20:23], s100 offen offset:0 sc1
    v_cvt_pk_bf16_f32 v229, v42, v43
    v_cvt_pk_bf16_f32 v230, v44, v45
    v_cvt_pk_bf16_f32 v231, v46, v47
    ds_write_b128 v154, v[228:231] offset:16
    v_cvt_pk_bf16_f32 v232, v48, v49
    v_cvt_pk_bf16_f32 v233, v50, v51
    v_cvt_pk_bf16_f32 v234, v64, v65
    v_cvt_pk_bf16_f32 v235, v66, v67
    ds_write_b128 v154, v[232:235] offset:32
    v_cvt_pk_bf16_f32 v236, v68, v69
    v_cvt_pk_bf16_f32 v237, v70, v71
    v_cvt_pk_bf16_f32 v238, v72, v73
    v_cvt_pk_bf16_f32 v239, v74, v75
    ds_write_b128 v154, v[236:239] offset:48
    v_cvt_pk_bf16_f32 v240, v76, v77
    v_cvt_pk_bf16_f32 v241, v78, v79
    v_cvt_pk_bf16_f32 v242, v80, v81
    s_add_u32 s100, s75, 10240
    buffer_load_dwordx4 a[200:203], v209, s[20:23], s100 offen offset:0 sc1
    v_cvt_pk_bf16_f32 v243, v82, v83
    ds_write_b128 v154, v[240:243] offset:64
    v_max3_f32 v52, v84, v85, v86
    buffer_load_dwordx4 a[204:207], v209, s[20:23], s100 offen offset:1024 sc1
    v_min3_f32 v53, v84, v85, v86
    v_max3_f32 v52, v52, v87, v88
    v_min3_f32 v53, v53, v87, v88
    v_max3_f32 v52, v52, v89, v90
    v_min3_f32 v53, v53, v89, v90
    v_max3_f32 v52, v52, v91, v92
    v_min3_f32 v53, v53, v91, v92
    v_max3_f32 v52, v52, v93, v94
    v_min3_f32 v53, v53, v93, v94
    v_max3_f32 v52, v52, v95, v96
    v_min3_f32 v53, v53, v95, v96
    v_max3_f32 v52, v52, v97, v98
    v_min3_f32 v53, v53, v97, v98
    v_max3_f32 v52, v52, v99, v100
    buffer_load_dwordx4 a[208:211], v209, s[20:23], s100 offen offset:2048 sc1
    v_min3_f32 v53, v53, v99, v100
    v_max3_f32 v52, v52, v101, v102
    v_min3_f32 v53, v53, v101, v102
    v_max_f32 v52, v52, v103
    v_min_f32 v53, v53, v103
    v_pk_add_f32 v[32:33], v[84:85], v[52:53] op_sel_hi:[1,0] neg_lo:[0,1] neg_hi:[0,1]
    v_pk_add_f32 v[84:85], v[52:53], v[84:85] op_sel:[1,0] neg_lo:[0,1] neg_hi:[0,1]
    v_exp_f32 v32, v32
    v_exp_f32 v33, v33
    v_exp_f32 v84, v84
    v_exp_f32 v85, v85
    v_pk_add_f32 v[34:35], v[86:87], v[52:53] op_sel_hi:[1,0] neg_lo:[0,1] neg_hi:[0,1]
    v_pk_add_f32 v[86:87], v[52:53], v[86:87] op_sel:[1,0] neg_lo:[0,1] neg_hi:[0,1]
    v_exp_f32 v34, v34
    buffer_load_dwordx4 a[212:215], v209, s[20:23], s100 offen offset:3072 sc1
    v_exp_f32 v35, v35
    v_exp_f32 v86, v86
    v_exp_f32 v87, v87
    v_pk_add_f32 v[36:37], v[88:89], v[52:53] op_sel_hi:[1,0] neg_lo:[0,1] neg_hi:[0,1]
    v_pk_add_f32 v[88:89], v[52:53], v[88:89] op_sel:[1,0] neg_lo:[0,1] neg_hi:[0,1]
    v_exp_f32 v36, v36
    v_exp_f32 v37, v37
    v_exp_f32 v88, v88
    v_exp_f32 v89, v89
    v_pk_add_f32 v[54:55], v[32:33], v[34:35]
    v_pk_add_f32 v[56:57], v[84:85], v[86:87]
    v_pk_add_f32 v[38:39], v[90:91], v[52:53] op_sel_hi:[1,0] neg_lo:[0,1] neg_hi:[0,1]
    v_pk_add_f32 v[90:91], v[52:53], v[90:91] op_sel:[1,0] neg_lo:[0,1] neg_hi:[0,1]
    v_exp_f32 v38, v38
    buffer_load_dwordx4 a[216:219], v159, s[20:23], s100 offen offset:0 sc1
    v_exp_f32 v39, v39
    v_exp_f32 v90, v90
    v_exp_f32 v91, v91
    v_pk_add_f32 v[54:55], v[54:55], v[36:37]
    v_pk_add_f32 v[56:57], v[56:57], v[88:89]
    v_pk_add_f32 v[40:41], v[92:93], v[52:53] op_sel_hi:[1,0] neg_lo:[0,1] neg_hi:[0,1]
    v_pk_add_f32 v[92:93], v[52:53], v[92:93] op_sel:[1,0] neg_lo:[0,1] neg_hi:[0,1]
    v_exp_f32 v40, v40
    v_exp_f32 v41, v41
    v_exp_f32 v92, v92
    v_exp_f32 v93, v93
    v_pk_add_f32 v[54:55], v[54:55], v[38:39]
    v_pk_add_f32 v[56:57], v[56:57], v[90:91]
    v_pk_add_f32 v[42:43], v[94:95], v[52:53] op_sel_hi:[1,0] neg_lo:[0,1] neg_hi:[0,1]
    s_add_u32 s100, s101, 25600
    buffer_load_dwordx4 a[220:223], v209, s[20:23], s100 offen offset:0 sc1
    v_pk_add_f32 v[94:95], v[52:53], v[94:95] op_sel:[1,0] neg_lo:[0,1] neg_hi:[0,1]
    v_exp_f32 v42, v42
    v_exp_f32 v43, v43
    v_exp_f32 v94, v94
    v_exp_f32 v95, v95
    v_pk_add_f32 v[54:55], v[54:55], v[40:41]
    v_pk_add_f32 v[56:57], v[56:57], v[92:93]
    v_pk_add_f32 v[44:45], v[96:97], v[52:53] op_sel_hi:[1,0] neg_lo:[0,1] neg_hi:[0,1]
    v_pk_add_f32 v[96:97], v[52:53], v[96:97] op_sel:[1,0] neg_lo:[0,1] neg_hi:[0,1]
    v_exp_f32 v44, v44
    v_exp_f32 v45, v45
    v_exp_f32 v96, v96
    v_exp_f32 v97, v97
    v_pk_add_f32 v[54:55], v[54:55], v[42:43]
    buffer_load_dwordx4 a[224:227], v209, s[20:23], s100 offen offset:1024 sc1
    v_pk_add_f32 v[56:57], v[56:57], v[94:95]
    v_pk_add_f32 v[46:47], v[98:99], v[52:53] op_sel_hi:[1,0] neg_lo:[0,1] neg_hi:[0,1]
    v_pk_add_f32 v[98:99], v[52:53], v[98:99] op_sel:[1,0] neg_lo:[0,1] neg_hi:[0,1]
    v_exp_f32 v46, v46
    v_exp_f32 v47, v47
    v_exp_f32 v98, v98
    v_exp_f32 v99, v99
    v_pk_add_f32 v[54:55], v[54:55], v[44:45]
    v_pk_add_f32 v[56:57], v[56:57], v[96:97]
    v_pk_add_f32 v[48:49], v[100:101], v[52:53] op_sel_hi:[1,0] neg_lo:[0,1] neg_hi:[0,1]
    v_pk_add_f32 v[100:101], v[52:53], v[100:101] op_sel:[1,0] neg_lo:[0,1] neg_hi:[0,1]
    v_exp_f32 v48, v48
    v_exp_f32 v49, v49
    v_exp_f32 v100, v100
    buffer_load_dwordx4 a[228:231], v209, s[20:23], s100 offen offset:2048 sc1
    v_exp_f32 v101, v101
    v_pk_add_f32 v[54:55], v[54:55], v[46:47]
    v_pk_add_f32 v[56:57], v[56:57], v[98:99]
    v_pk_add_f32 v[50:51], v[102:103], v[52:53] op_sel_hi:[1,0] neg_lo:[0,1] neg_hi:[0,1]
    v_pk_add_f32 v[102:103], v[52:53], v[102:103] op_sel:[1,0] neg_lo:[0,1] neg_hi:[0,1]
    v_exp_f32 v50, v50
    v_exp_f32 v51, v51
    v_exp_f32 v102, v102
    v_exp_f32 v103, v103
    v_pk_add_f32 v[54:55], v[54:55], v[48:49]
    v_pk_add_f32 v[56:57], v[56:57], v[100:101]
    v_pk_add_f32 v[54:55], v[54:55], v[50:51]
    v_pk_add_f32 v[56:57], v[56:57], v[102:103]
    v_add_f32 v54, v54, v55
    buffer_load_dwordx4 a[232:235], v209, s[20:23], s100 offen offset:3072 sc1
    v_add_f32 v56, v56, v57
    v_rcp_f32 v54, v54
    v_rcp_f32 v56, v56
    v_pk_mul_f32 v[32:33], v[32:33], v[54:55] op_sel_hi:[1,0]
    v_pk_mul_f32 v[34:35], v[34:35], v[54:55] op_sel_hi:[1,0]
    v_pk_mul_f32 v[36:37], v[36:37], v[54:55] op_sel_hi:[1,0]
    v_pk_mul_f32 v[38:39], v[38:39], v[54:55] op_sel_hi:[1,0]
    v_pk_mul_f32 v[40:41], v[40:41], v[54:55] op_sel_hi:[1,0]
    v_pk_mul_f32 v[42:43], v[42:43], v[54:55] op_sel_hi:[1,0]
    v_pk_mul_f32 v[44:45], v[44:45], v[54:55] op_sel_hi:[1,0]
    v_pk_mul_f32 v[46:47], v[46:47], v[54:55] op_sel_hi:[1,0]
    v_pk_mul_f32 v[48:49], v[48:49], v[54:55] op_sel_hi:[1,0]
    v_pk_mul_f32 v[50:51], v[50:51], v[54:55] op_sel_hi:[1,0]
    v_pk_mul_f32 v[84:85], v[84:85], v[56:57] op_sel_hi:[1,0]
    buffer_load_dwordx4 a[236:239], v159, s[20:23], s100 offen offset:0 sc1
    v_pk_mul_f32 v[86:87], v[86:87], v[56:57] op_sel_hi:[1,0]
    v_pk_mul_f32 v[88:89], v[88:89], v[56:57] op_sel_hi:[1,0]
    v_pk_mul_f32 v[90:91], v[90:91], v[56:57] op_sel_hi:[1,0]
    v_pk_mul_f32 v[92:93], v[92:93], v[56:57] op_sel_hi:[1,0]
    v_pk_mul_f32 v[94:95], v[94:95], v[56:57] op_sel_hi:[1,0]
    v_pk_mul_f32 v[96:97], v[96:97], v[56:57] op_sel_hi:[1,0]
    v_pk_mul_f32 v[98:99], v[98:99], v[56:57] op_sel_hi:[1,0]
    v_pk_mul_f32 v[100:101], v[100:101], v[56:57] op_sel_hi:[1,0]
    v_pk_mul_f32 v[102:103], v[102:103], v[56:57] op_sel_hi:[1,0]
    v_cvt_pk_bf16_f32 v224, v32, v33
    v_cvt_pk_bf16_f32 v225, v34, v35
    v_cvt_pk_bf16_f32 v226, v36, v37
    v_cvt_pk_bf16_f32 v227, v38, v39
    ds_write_b128 v154, v[224:227] offset:5376
    v_cvt_pk_bf16_f32 v228, v40, v41
    v_cvt_pk_bf16_f32 v229, v42, v43
    v_cvt_pk_bf16_f32 v230, v44, v45
    v_cvt_pk_bf16_f32 v231, v46, v47
    ds_write_b128 v154, v[228:231] offset:5392
    v_cvt_pk_bf16_f32 v232, v48, v49
    v_cvt_pk_bf16_f32 v233, v50, v51
    v_cvt_pk_bf16_f32 v234, v84, v85
    v_cvt_pk_bf16_f32 v235, v86, v87
    ds_write_b128 v154, v[232:235] offset:5408
    v_cvt_pk_bf16_f32 v236, v88, v89
    v_cvt_pk_bf16_f32 v237, v90, v91
    v_cvt_pk_bf16_f32 v238, v92, v93
    v_cvt_pk_bf16_f32 v239, v94, v95
    ds_write_b128 v154, v[236:239] offset:5424
    v_cvt_pk_bf16_f32 v240, v96, v97
    v_cvt_pk_bf16_f32 v241, v98, v99
    v_cvt_pk_bf16_f32 v242, v100, v101
    v_cvt_pk_bf16_f32 v243, v102, v103
    ds_write_b128 v154, v[240:243] offset:5440
    s_waitcnt lgkmcnt(0)
    s_barrier
    ds_read_b64_tr_b16 v[104:105], v215 offset:0
    ds_read_b64_tr_b16 v[106:107], v215 offset:176
    ds_read_b64_tr_b16 v[96:97], v214 offset:0
    ds_read_b64_tr_b16 v[98:99], v214 offset:336
    ds_read_b64_tr_b16 v[100:101], v214 offset:64
    ds_read_b64_tr_b16 v[102:103], v214 offset:400
    ds_read_b64_tr_b16 v[116:117], v215 offset:2816
    ds_read_b64_tr_b16 v[118:119], v215 offset:2992
    ds_read_b64_tr_b16 v[108:109], v214 offset:5376
    ds_read_b64_tr_b16 v[110:111], v214 offset:5712
    ds_read_b64_tr_b16 v[112:113], v214 offset:5440
    ds_read_b64_tr_b16 v[114:115], v214 offset:5776
    v_mov_b32 v210, v17
    v_mov_b32 v211, v18
    s_waitcnt lgkmcnt(6)
    v_mfma_f32_32x32x16_bf16 v[64:79], v[96:99], v[104:107], 0
    ds_read_b64_tr_b16 v[128:129], v215 offset:5632
    ds_read_b64_tr_b16 v[130:131], v215 offset:5808
    ds_read_b64_tr_b16 v[120:121], v214 offset:10752
    v_mfma_f32_32x32x16_bf16 v[80:95], v[100:103], v[104:107], 0
    ds_read_b64_tr_b16 v[122:123], v214 offset:11088
    ds_read_b64_tr_b16 v[124:125], v214 offset:10816
    ds_read_b64_tr_b16 v[126:127], v214 offset:11152
    s_waitcnt lgkmcnt(6)
    v_mfma_f32_32x32x16_bf16 v[64:79], v[108:111], v[116:119], v[64:79]
    ds_read_b64_tr_b16 v[104:105], v215 offset:8448
    ds_read_b64_tr_b16 v[106:107], v215 offset:8624
    ds_read_b64_tr_b16 v[96:97], v214 offset:16128
    v_mfma_f32_32x32x16_bf16 v[80:95], v[112:115], v[116:119], v[80:95]
    ds_read_b64_tr_b16 v[98:99], v214 offset:16464
    ds_read_b64_tr_b16 v[100:101], v214 offset:16192
    ds_read_b64_tr_b16 v[102:103], v214 offset:16528
    s_waitcnt lgkmcnt(6)
    v_mfma_f32_32x32x16_bf16 v[64:79], v[120:123], v[128:131], v[64:79]
    ds_read_b64_tr_b16 v[116:117], v215 offset:11264
    ds_read_b64_tr_b16 v[118:119], v215 offset:11440
    ds_read_b64_tr_b16 v[108:109], v214 offset:21504
    v_mfma_f32_32x32x16_bf16 v[80:95], v[124:127], v[128:131], v[80:95]
    ds_read_b64_tr_b16 v[110:111], v214 offset:21840
    ds_read_b64_tr_b16 v[112:113], v214 offset:21568
    ds_read_b64_tr_b16 v[114:115], v214 offset:21904
    s_waitcnt lgkmcnt(6)
    v_mfma_f32_32x32x16_bf16 v[64:79], v[96:99], v[104:107], v[64:79]
    ds_read_b64_tr_b16 v[128:129], v215 offset:14080
    ds_read_b64_tr_b16 v[130:131], v215 offset:14256
    ds_read_b64_tr_b16 v[120:121], v214 offset:26880
    v_mfma_f32_32x32x16_bf16 v[80:95], v[100:103], v[104:107], v[80:95]
    ds_read_b64_tr_b16 v[122:123], v214 offset:27216
    ds_read_b64_tr_b16 v[124:125], v214 offset:26944
    ds_read_b64_tr_b16 v[126:127], v214 offset:27280
    s_waitcnt lgkmcnt(6)
    v_mfma_f32_32x32x16_bf16 v[64:79], v[108:111], v[116:119], v[64:79]
    ds_read_b64_tr_b16 v[104:105], v215 offset:16896
    ds_read_b64_tr_b16 v[106:107], v215 offset:17072
    ds_read_b64_tr_b16 v[96:97], v214 offset:32256
    v_mfma_f32_32x32x16_bf16 v[80:95], v[112:115], v[116:119], v[80:95]
    ds_read_b64_tr_b16 v[98:99], v214 offset:32592
    ds_read_b64_tr_b16 v[100:101], v214 offset:32320
    ds_read_b64_tr_b16 v[102:103], v214 offset:32656
    s_waitcnt lgkmcnt(6)
    v_mfma_f32_32x32x16_bf16 v[64:79], v[120:123], v[128:131], v[64:79]
    ds_read_b64_tr_b16 v[116:117], v215 offset:19712
    ds_read_b64_tr_b16 v[118:119], v215 offset:19888
    ds_read_b64_tr_b16 v[108:109], v214 offset:37632
    v_mfma_f32_32x32x16_bf16 v[80:95], v[124:127], v[128:131], v[80:95]
    ds_read_b64_tr_b16 v[110:111], v214 offset:37968
    ds_read_b64_tr_b16 v[112:113], v214 offset:37696
    ds_read_b64_tr_b16 v[114:115], v214 offset:38032
    s_waitcnt lgkmcnt(6)
    v_mfma_f32_32x32x16_bf16 v[64:79], v[96:99], v[104:107], v[64:79]
    v_mfma_f32_32x32x16_bf16 v[80:95], v[100:103], v[104:107], v[80:95]
    s_waitcnt lgkmcnt(0)
    v_mfma_f32_32x32x16_bf16 v[64:79], v[108:111], v[116:119], v[64:79]
    v_mfma_f32_32x32x16_bf16 v[80:95], v[112:115], v[116:119], v[80:95]
    s_barrier
    s_add_u32 m0, s66, 65536
    v_mfma_f32_16x16x32_bf16 v[0:3], v[160:163], a[0:3], 0
    buffer_load_dwordx4 v200, s[4:7], s52 offen offset:0 lds
    v_mfma_f32_16x16x32_bf16 v[4:7], v[160:163], a[4:7], 0
    ds_read_b64_tr_b16 v[184:185], v194 offset:22528
    v_mfma_f32_16x16x32_bf16 a[248:251], v[148:151], v[160:163], 0
    ds_read_b64_tr_b16 v[186:187], v194 offset:23040
    v_mfma_f32_16x16x32_bf16 v[8:11], v[164:167], a[0:3], 0
    buffer_load_dwordx4 v201, s[4:7], s52 offen offset:1024 lds
    v_mfma_f32_16x16x32_bf16 v[12:15], v[164:167], a[4:7], 0
    ds_read_b64_tr_b16 v[188:189], v195 offset:22528
    ds_read_b64_tr_b16 v[190:191], v195 offset:23040
    v_mfma_f32_16x16x32_bf16 v[16:19], v[168:171], a[0:3], 0
    buffer_load_dwordx4 v200, s[8:11], s52 offen offset:2048 lds
    ds_read_b64_tr_b16 v[160:161], v196 offset:20480
    ds_read_b64_tr_b16 v[162:163], v196 offset:20992
    ds_read_b64_tr_b16 v[164:165], v197 offset:20480
    v_cvt_pk_bf16_f32 v132, v64, v65
    v_mfma_f32_16x16x32_bf16 v[20:23], v[168:171], a[4:7], 0
    v_cvt_pk_bf16_f32 v133, v66, v67
    v_cvt_pk_bf16_f32 v134, v68, v69
    v_cvt_pk_bf16_f32 v135, v70, v71
    buffer_store_dwordx4 v[132:135], v210, s[20:23], s65 offen offset:0 sc1
    v_mfma_f32_16x16x32_bf16 v[24:27], v[172:175], a[0:3], 0
    buffer_load_dwordx4 v201, s[8:11], s52 offen offset:3072 lds
    ds_read_b64_tr_b16 v[166:167], v197 offset:20992
    ds_read_b64_tr_b16 v[168:169], v198 offset:20480
    v_cvt_pk_bf16_f32 v136, v72, v73
    v_cvt_pk_bf16_f32 v137, v74, v75
    v_mfma_f32_16x16x32_bf16 v[28:31], v[172:175], a[4:7], 0
    v_cvt_pk_bf16_f32 v138, v76, v77
    v_cvt_pk_bf16_f32 v139, v78, v79
    buffer_store_dwordx4 v[136:139], v210, s[20:23], s65 offen offset:672 sc1
    s_add_u32 m0, s66, 81920
    s_waitcnt lgkmcnt(5)
    v_mfma_f32_16x16x32_bf16 v[32:35], v[176:179], a[0:3], 0
    buffer_load_dwordx4 v200, s[4:7], s55 offen offset:0 lds
    ds_read_b64_tr_b16 v[170:171], v198 offset:20992
    ds_read_b64_tr_b16 v[172:173], v199 offset:20480
    v_mfma_f32_16x16x32_bf16 v[36:39], v[176:179], a[4:7], 0
    v_cvt_pk_bf16_f32 v140, v80, v81
    v_cvt_pk_bf16_f32 v141, v82, v83
    v_cvt_pk_bf16_f32 v142, v84, v85
    v_cvt_pk_bf16_f32 v143, v86, v87
    v_mfma_f32_16x16x32_bf16 a[252:255], v[148:151], v[176:179], 0
    buffer_store_dwordx4 v[140:143], v211, s[20:23], s65 offen offset:1344 sc1
    v_add_u32 v64, 65536, v192
    v_add_u32 v65, 65536, v193
    v_add_u32 v66, 65536, v194
    v_mfma_f32_16x16x32_bf16 v[40:43], v[180:183], a[0:3], 0
    buffer_load_dwordx4 v201, s[4:7], s55 offen offset:1024 lds
    ds_read_b64_tr_b16 v[174:175], v199 offset:20992
    ds_read_b64_tr_b16 v[176:177], v196 offset:22528
    ds_read_b64_tr_b16 v[178:179], v196 offset:23040
    v_mfma_f32_16x16x32_bf16 v[44:47], v[180:183], a[4:7], 0
    v_add_u32 v67, 65536, v195
    v_add_u32 v68, 65536, v196
    v_add_u32 v69, 65536, v197
    v_add_u32 v70, 65536, v198
    v_add_u32 v71, 65536, v199
    v_mfma_f32_16x16x32_bf16 v[48:51], v[184:187], a[0:3], 0
    buffer_load_dwordx4 v200, s[8:11], s55 offen offset:2048 lds
    v_mfma_f32_16x16x32_bf16 v[52:55], v[184:187], a[4:7], 0
    ds_read_b64_tr_b16 v[180:181], v197 offset:22528
    ds_read_b64_tr_b16 v[182:183], v197 offset:23040
    v_mfma_f32_16x16x32_bf16 v[56:59], v[188:191], a[0:3], 0
    buffer_load_dwordx4 v201, s[8:11], s55 offen offset:3072 lds
    ds_read_b64_tr_b16 v[184:185], v198 offset:22528
    v_mfma_f32_16x16x32_bf16 v[60:63], v[188:191], a[4:7], 0
    ds_read_b64_tr_b16 v[186:187], v198 offset:23040
    s_add_u32 s45, s101, 30720
    s_add_u32 m0, s58, 102400
    s_waitcnt lgkmcnt(6)
    v_mfma_f32_16x16x32_bf16 v[0:3], v[160:163], a[8:11], v[0:3]
    buffer_load_dwordx4 v209, s[20:23], s45 offen offset:0 sc1 lds
    v_mfma_f32_16x16x32_bf16 v[4:7], v[160:163], a[12:15], v[4:7]
    ds_read_b64_tr_b16 v[188:189], v199 offset:22528
    v_mfma_f32_16x16x32_bf16 a[248:251], v[148:151], v[160:163], a[248:251]
    ds_read_b64_tr_b16 v[190:191], v199 offset:23040
    v_mfma_f32_16x16x32_bf16 v[8:11], v[164:167], a[8:11], v[8:11]
    buffer_load_dwordx4 v209, s[20:23], s45 offen offset:1024 sc1 lds
    v_mfma_f32_16x16x32_bf16 v[12:15], v[164:167], a[12:15], v[12:15]
    v_mfma_f32_16x16x32_bf16 v[16:19], v[168:171], a[8:11], v[16:19]
    v_mfma_f32_16x16x32_bf16 v[20:23], v[168:171], a[12:15], v[20:23]
    s_waitcnt lgkmcnt(0)
    s_barrier
    v_mfma_f32_16x16x32_bf16 v[24:27], v[172:175], a[8:11], v[24:27]
    buffer_load_dwordx4 v209, s[20:23], s45 offen offset:2048 sc1 lds
    ds_read_b64_tr_b16 v[160:161], v192 offset:40960
    v_mfma_f32_16x16x32_bf16 v[28:31], v[172:175], a[12:15], v[28:31]
    ds_read_b64_tr_b16 v[162:163], v192 offset:41472
    ds_read_b64_tr_b16 v[164:165], v193 offset:40960
    v_mfma_f32_16x16x32_bf16 v[32:35], v[176:179], a[8:11], v[32:35]
    buffer_load_dwordx4 v209, s[20:23], s45 offen offset:3072 sc1 lds
    v_mfma_f32_16x16x32_bf16 v[36:39], v[176:179], a[12:15], v[36:39]
    ds_read_b64_tr_b16 v[166:167], v193 offset:41472
    v_mfma_f32_16x16x32_bf16 a[252:255], v[148:151], v[176:179], a[252:255]
    ds_read_b64_tr_b16 v[168:169], v194 offset:40960
    s_add_u32 m0, s58, 106496
    v_mfma_f32_16x16x32_bf16 v[40:43], v[180:183], a[8:11], v[40:43]
    buffer_load_dwordx4 v159, s[20:23], s45 offen offset:0 sc1 lds
    ds_read_b64_tr_b16 v[170:171], v194 offset:41472
    v_mfma_f32_16x16x32_bf16 v[44:47], v[180:183], a[12:15], v[44:47]
    ds_read_b64_tr_b16 v[172:173], v195 offset:40960
    s_add_u32 m0, s66, 20480
    v_mfma_f32_16x16x32_bf16 v[48:51], v[184:187], a[8:11], v[48:51]
    buffer_load_dwordx4 v200, s[4:7], s56 offen offset:0 lds
    ds_read_b64_tr_b16 v[174:175], v195 offset:41472
    v_mfma_f32_16x16x32_bf16 v[52:55], v[184:187], a[12:15], v[52:55]
    ds_read_b64_tr_b16 v[176:177], v192 offset:43008
    ds_read_b64_tr_b16 v[178:179], v192 offset:43520
    s_add_u32 s100, s75, 15360
    v_mfma_f32_16x16x32_bf16 v[56:59], v[188:191], a[8:11], v[56:59]
    buffer_load_dwordx4 a[0:3], v209, s[20:23], s100 offen offset:0 sc1
    v_mfma_f32_16x16x32_bf16 v[60:63], v[188:191], a[12:15], v[60:63]
    ds_read_b64_tr_b16 v[180:181], v193 offset:43008
    ds_read_b64_tr_b16 v[182:183], v193 offset:43520
    s_waitcnt lgkmcnt(4)
    v_mfma_f32_16x16x32_bf16 v[0:3], v[160:163], a[16:19], v[0:3]
    buffer_load_dwordx4 v201, s[4:7], s56 offen offset:1024 lds
    v_mfma_f32_16x16x32_bf16 v[4:7], v[160:163], a[20:23], v[4:7]
    ds_read_b64_tr_b16 v[184:185], v194 offset:43008
    ds_read_b64_tr_b16 v[186:187], v194 offset:43520
    v_mfma_f32_16x16x32_bf16 a[248:251], v[148:151], v[160:163], a[248:251]
    s_getpc_b64 s[12:13]
KR_pck:
    s_sub_u32 s12, s12, KR_pck-K1_pf
    s_subb_u32 s13, s13, 0
    s_mov_b32 s14, CODE_END-K1_pf
    v_mfma_f32_16x16x32_bf16 v[8:11], v[164:167], a[16:19], v[8:11]
    ds_read_b64_tr_b16 v[188:189], v195 offset:43008
    ds_read_b64_tr_b16 v[190:191], v195 offset:43520
    v_mfma_f32_16x16x32_bf16 v[12:15], v[164:167], a[20:23], v[12:15]
    s_mov_b32 s15, 0x20000
    v_mfma_f32_16x16x32_bf16 v[16:19], v[168:171], a[16:19], v[16:19]
    buffer_load_dwordx4 v200, s[8:11], s56 offen offset:2048 lds
    ds_read_b64_tr_b16 v[160:161], v196 offset:40960
    v_mfma_f32_16x16x32_bf16 v[20:23], v[168:171], a[20:23], v[20:23]
    ds_read_b64_tr_b16 v[162:163], v196 offset:41472
    ds_read_b64_tr_b16 v[164:165], v197 offset:40960
    v_mfma_f32_16x16x32_bf16 v[24:27], v[172:175], a[16:19], v[24:27]
    buffer_load_dwordx4 a[4:7], v209, s[20:23], s100 offen offset:1024 sc1
    v_mfma_f32_16x16x32_bf16 v[28:31], v[172:175], a[20:23], v[28:31]
    ds_read_b64_tr_b16 v[166:167], v197 offset:41472
    ds_read_b64_tr_b16 v[168:169], v198 offset:40960
    s_waitcnt lgkmcnt(5)
    v_mfma_f32_16x16x32_bf16 v[32:35], v[176:179], a[16:19], v[32:35]
    buffer_load_dwordx4 v201, s[8:11], s56 offen offset:3072 lds
    ds_read_b64_tr_b16 v[170:171], v198 offset:41472
    v_mfma_f32_16x16x32_bf16 v[36:39], v[176:179], a[20:23], v[36:39]
    ds_read_b64_tr_b16 v[172:173], v199 offset:40960
    s_lshr_b32 s16, s2, 3
    v_mfma_f32_16x16x32_bf16 a[252:255], v[148:151], v[176:179], a[252:255]
    s_lshl_b32 s16, s16, 2
    s_waitcnt vmcnt(14)
    buffer_store_dword v145, v144, s[20:23], s74 offen sc1
    v_mfma_f32_16x16x32_bf16 v[40:43], v[180:183], a[16:19], v[40:43]
    ds_read_b64_tr_b16 v[174:175], v199 offset:41472
    ds_read_b64_tr_b16 v[176:177], v196 offset:43008
    ds_read_b64_tr_b16 v[178:179], v196 offset:43520
    v_mfma_f32_16x16x32_bf16 v[44:47], v[180:183], a[20:23], v[44:47]
    s_add_u32 s45, s101, 35840
    s_add_u32 m0, s58, 122880
    v_mfma_f32_16x16x32_bf16 v[48:51], v[184:187], a[16:19], v[48:51]
    buffer_load_dwordx4 v209, s[20:23], s45 offen offset:0 sc1 lds
    v_mfma_f32_16x16x32_bf16 v[52:55], v[184:187], a[20:23], v[52:55]
    ds_read_b64_tr_b16 v[180:181], v197 offset:43008
    ds_read_b64_tr_b16 v[182:183], v197 offset:43520
    v_mfma_f32_16x16x32_bf16 v[56:59], v[188:191], a[16:19], v[56:59]
    buffer_load_dwordx4 a[8:11], v209, s[20:23], s100 offen offset:2048 sc1
    v_mfma_f32_16x16x32_bf16 v[60:63], v[188:191], a[20:23], v[60:63]
    ds_read_b64_tr_b16 v[184:185], v198 offset:43008
    ds_read_b64_tr_b16 v[186:187], v198 offset:43520
    s_waitcnt lgkmcnt(6)
    v_mfma_f32_16x16x32_bf16 v[0:3], v[160:163], a[24:27], v[0:3]
    buffer_load_dwordx4 v209, s[20:23], s45 offen offset:1024 sc1 lds
    v_mfma_f32_16x16x32_bf16 v[4:7], v[160:163], a[28:31], v[4:7]
    ds_read_b64_tr_b16 v[188:189], v199 offset:43008
    ds_read_b64_tr_b16 v[190:191], v199 offset:43520
    v_mfma_f32_16x16x32_bf16 a[248:251], v[148:151], v[160:163], a[248:251]
    s_add_u32 s16, s16, s40
    s_lshl_b32 s16, s16, 10
    v_mfma_f32_16x16x32_bf16 v[8:11], v[164:167], a[24:27], v[8:11]
    v_mfma_f32_16x16x32_bf16 v[12:15], v[164:167], a[28:31], v[12:15]
    buffer_load_dwordx4 a[244:247], v209, s[12:15], s16 offen
    s_and_b32 s70, s2, 7
    s_lshl_b32 s70, s70, 1
    s_bfe_u32 s71, s2, 0x10003
    s_add_u32 s70, s70, s71
    s_lshl_b32 s79, s70, 10
    s_add_u32 s79, s79, 19654656
    s_bfe_u32 s29, s2, 0x30004
    s_lshl_b32 s29, s29, 1
    s_add_u32 s29, s29, s40
    s_cmp_lt_u32 s40, 2
    s_cselect_b32 s29, s29, 15
    s_mul_i32 s63, s70, 55296
    s_lshl_b32 s32, s29, 8
    s_add_u32 s63, s63, s32
    s_add_u32 s63, s63, 17973248
    s_lshl_b32 s78, s70, 12
    s_add_u32 s78, s78, s32
    s_add_u32 s78, s78, 18857984
    s_cmp_lt_u32 s29, 14
    s_cselect_b32 s63, s63, 1073741824
    s_cselect_b32 s78, s78, 1073741824
    s_cselect_b32 s32, 0, 1073741824
    s_and_b32 s34, s29, 3
    s_lshl_b32 s34, s34, 2
    s_add_u32 s32, s32, s34
    s_lshr_b32 s29, s29, 2
    s_lshl_b32 s34, s70, 2
    s_add_u32 s29, s29, s34
    s_lshl_b32 s29, s29, 7
    s_add_u32 s29, s29, s32
    s_add_u32 s29, s29, 19687424
    v_and_b32 v100, 16, v209
    v_mov_b32 v101, 0x3f80
    v_lshlrev_b32 v101, v100, v101
    v_bfe_u32 v100, v209, 5, 2
    v_cmp_eq_u32 vcc, 0, v100
    s_nop 1
    v_cndmask_b32 v102, 0, v101, vcc
    v_accvgpr_write_b32 a240, v102
    v_cmp_eq_u32 vcc, 1, v100
    s_nop 1
    v_cndmask_b32 v102, 0, v101, vcc
    v_accvgpr_write_b32 a241, v102
    v_cmp_eq_u32 vcc, 2, v100
    s_nop 1
    v_cndmask_b32 v102, 0, v101, vcc
    v_accvgpr_write_b32 a242, v102
    v_cmp_eq_u32 vcc, 3, v100
    s_nop 1
    v_cndmask_b32 v102, 0, v101, vcc
    v_accvgpr_write_b32 a243, v102
    v_lshrrev_b32 v100, 8, v209
    v_and_b32 v101, 1, v100
    v_mul_u32_u24 v100, 3456, v100
    v_and_b32 v102, 0xf0, v209
    v_add_u32 v154, v100, v102
    v_lshl_add_u32 v210, v101, 3, v102
    v_mfma_f32_16x16x32_bf16 v[16:19], v[168:171], a[24:27], v[16:19]
    v_mfma_f32_16x16x32_bf16 v[20:23], v[168:171], a[28:31], v[20:23]
    s_waitcnt lgkmcnt(0)
    s_barrier
    v_mfma_f32_16x16x32_bf16 v[24:27], v[172:175], a[24:27], v[24:27]
    buffer_load_dwordx4 v209, s[20:23], s45 offen offset:2048 sc1 lds
    ds_read_b64_tr_b16 v[160:161], v192 offset:0
    v_mfma_f32_16x16x32_bf16 v[28:31], v[172:175], a[28:31], v[28:31]
    ds_read_b64_tr_b16 v[162:163], v192 offset:512
    ds_read_b64_tr_b16 v[164:165], v193 offset:0
    v_mfma_f32_16x16x32_bf16 v[32:35], v[176:179], a[24:27], v[32:35]
    buffer_load_dwordx4 a[12:15], v209, s[20:23], s100 offen offset:3072 sc1
    v_mfma_f32_16x16x32_bf16 v[36:39], v[176:179], a[28:31], v[36:39]
    ds_read_b64_tr_b16 v[166:167], v193 offset:512
    v_mfma_f32_16x16x32_bf16 a[252:255], v[148:151], v[176:179], a[252:255]
    ds_read_b64_tr_b16 v[168:169], v194 offset:0
    v_mfma_f32_16x16x32_bf16 v[40:43], v[180:183], a[24:27], v[40:43]
    buffer_load_dwordx4 v209, s[20:23], s45 offen offset:3072 sc1 lds
    v_mfma_f32_16x16x32_bf16 v[44:47], v[180:183], a[28:31], v[44:47]
    ds_read_b64_tr_b16 v[170:171], v194 offset:512
    ds_read_b64_tr_b16 v[172:173], v195 offset:0
    v_mfma_f32_16x16x32_bf16 v[48:51], v[184:187], a[24:27], v[48:51]
    ds_read_b64_tr_b16 v[174:175], v195 offset:512
    ds_read_b64_tr_b16 v[176:177], v192 offset:2048
    v_mfma_f32_16x16x32_bf16 v[52:55], v[184:187], a[28:31], v[52:55]
    ds_read_b64_tr_b16 v[178:179], v192 offset:2560
    s_add_u32 m0, s58, 126976
    v_mfma_f32_16x16x32_bf16 v[56:59], v[188:191], a[24:27], v[56:59]
    buffer_load_dwordx4 v159, s[20:23], s45 offen offset:0 sc1 lds
    v_mfma_f32_16x16x32_bf16 v[60:63], v[188:191], a[28:31], v[60:63]
    ds_read_b64_tr_b16 v[180:181], v193 offset:2048
    ds_read_b64_tr_b16 v[182:183], v193 offset:2560
    s_waitcnt lgkmcnt(4)
    v_mfma_f32_16x16x32_bf16 v[0:3], v[160:163], a[32:35], v[0:3]
    buffer_load_dwordx4 a[16:19], v159, s[20:23], s100 offen offset:0 sc1
    v_mfma_f32_16x16x32_bf16 v[4:7], v[160:163], a[36:39], v[4:7]
    ds_read_b64_tr_b16 v[184:185], v194 offset:2048
    v_mfma_f32_16x16x32_bf16 a[248:251], v[148:151], v[160:163], a[248:251]
    ds_read_b64_tr_b16 v[186:187], v194 offset:2560
    s_add_u32 m0, s66, 40960
    v_mfma_f32_16x16x32_bf16 v[8:11], v[164:167], a[32:35], v[8:11]
    buffer_load_dwordx4 v200, s[4:7], s41 offen offset:0 lds
    v_mfma_f32_16x16x32_bf16 v[12:15], v[164:167], a[36:39], v[12:15]
    ds_read_b64_tr_b16 v[188:189], v195 offset:2048
    ds_read_b64_tr_b16 v[190:191], v195 offset:2560
    v_mfma_f32_16x16x32_bf16 v[16:19], v[168:171], a[32:35], v[16:19]
    ds_read_b64_tr_b16 v[160:161], v196 offset:0
    ds_read_b64_tr_b16 v[162:163], v196 offset:512
    v_mfma_f32_16x16x32_bf16 v[20:23], v[168:171], a[36:39], v[20:23]
    ds_read_b64_tr_b16 v[164:165], v197 offset:0
    v_mfma_f32_16x16x32_bf16 v[24:27], v[172:175], a[32:35], v[24:27]
    buffer_load_dwordx4 v201, s[4:7], s41 offen offset:1024 lds
    ds_read_b64_tr_b16 v[166:167], v197 offset:512
    ds_read_b64_tr_b16 v[168:169], v198 offset:0
    v_mfma_f32_16x16x32_bf16 v[28:31], v[172:175], a[36:39], v[28:31]
    s_add_u32 s100, s75, 20480
    s_cmp_lt_u32 s40, 3
    s_cselect_b32 s100, s100, 1073741824
    s_waitcnt lgkmcnt(5)
    v_mfma_f32_16x16x32_bf16 v[32:35], v[176:179], a[32:35], v[32:35]
    buffer_load_dwordx4 a[20:23], v209, s[20:23], s100 offen offset:0 sc1
    v_mfma_f32_16x16x32_bf16 v[36:39], v[176:179], a[36:39], v[36:39]
    ds_read_b64_tr_b16 v[170:171], v198 offset:512
    v_mfma_f32_16x16x32_bf16 a[252:255], v[148:151], v[176:179], a[252:255]
    ds_read_b64_tr_b16 v[172:173], v199 offset:0
    v_mfma_f32_16x16x32_bf16 v[40:43], v[180:183], a[32:35], v[40:43]
    buffer_load_dwordx4 v200, s[8:11], s41 offen offset:2048 lds
    ds_read_b64_tr_b16 v[174:175], v199 offset:512
    v_mfma_f32_16x16x32_bf16 v[44:47], v[180:183], a[36:39], v[44:47]
    ds_read_b64_tr_b16 v[176:177], v196 offset:2048
    ds_read_b64_tr_b16 v[178:179], v196 offset:2560
    v_mfma_f32_16x16x32_bf16 v[48:51], v[184:187], a[32:35], v[48:51]
    ds_read_b64_tr_b16 v[180:181], v197 offset:2048
    v_mfma_f32_16x16x32_bf16 v[52:55], v[184:187], a[36:39], v[52:55]
    ds_read_b64_tr_b16 v[182:183], v197 offset:2560
    v_mfma_f32_16x16x32_bf16 v[56:59], v[188:191], a[32:35], v[56:59]
    buffer_load_dwordx4 v201, s[8:11], s41 offen offset:3072 lds
    v_mfma_f32_16x16x32_bf16 v[60:63], v[188:191], a[36:39], v[60:63]
    ds_read_b64_tr_b16 v[184:185], v198 offset:2048
    ds_read_b64_tr_b16 v[186:187], v198 offset:2560
    s_waitcnt lgkmcnt(6)
    v_mfma_f32_16x16x32_bf16 v[0:3], v[160:163], a[40:43], v[0:3]
    buffer_load_dwordx4 a[24:27], v209, s[20:23], s100 offen offset:1024 sc1
    v_mfma_f32_16x16x32_bf16 v[4:7], v[160:163], a[44:47], v[4:7]
    ds_read_b64_tr_b16 v[188:189], v199 offset:2048
    v_mfma_f32_16x16x32_bf16 a[248:251], v[148:151], v[160:163], a[248:251]
    ds_read_b64_tr_b16 v[190:191], v199 offset:2560
    v_mfma_f32_16x16x32_bf16 v[8:11], v[164:167], a[40:43], v[8:11]
    v_mfma_f32_16x16x32_bf16 v[12:15], v[164:167], a[44:47], v[12:15]
    v_mfma_f32_16x16x32_bf16 v[16:19], v[168:171], a[40:43], v[16:19]
    v_mfma_f32_16x16x32_bf16 v[20:23], v[168:171], a[44:47], v[20:23]
    s_waitcnt lgkmcnt(0)
    s_barrier
    v_mfma_f32_16x16x32_bf16 v[24:27], v[172:175], a[40:43], v[24:27]
    buffer_load_dwordx4 a[28:31], v209, s[20:23], s100 offen offset:2048 sc1
    ds_read_b64_tr_b16 v[160:161], v64 offset:0
    v_mfma_f32_16x16x32_bf16 v[28:31], v[172:175], a[44:47], v[28:31]
    ds_read_b64_tr_b16 v[162:163], v64 offset:512
    ds_read_b64_tr_b16 v[164:165], v65 offset:0
    v_mfma_f32_16x16x32_bf16 v[32:35], v[176:179], a[40:43], v[32:35]
    ds_read_b64_tr_b16 v[166:167], v65 offset:512
    v_mfma_f32_16x16x32_bf16 v[36:39], v[176:179], a[44:47], v[36:39]
    v_mfma_f32_16x16x32_bf16 a[252:255], v[148:151], v[176:179], a[252:255]
    ds_read_b64_tr_b16 v[168:169], v66 offset:0
    v_mfma_f32_16x16x32_bf16 v[40:43], v[180:183], a[40:43], v[40:43]
    ds_read_b64_tr_b16 v[170:171], v66 offset:512
    v_mfma_f32_16x16x32_bf16 v[44:47], v[180:183], a[44:47], v[44:47]
    ds_read_b64_tr_b16 v[172:173], v67 offset:0
    v_mfma_f32_16x16x32_bf16 v[48:51], v[184:187], a[40:43], v[48:51]
    buffer_load_dwordx4 a[32:35], v209, s[20:23], s100 offen offset:3072 sc1
    ds_read_b64_tr_b16 v[174:175], v67 offset:512
    v_mfma_f32_16x16x32_bf16 v[52:55], v[184:187], a[44:47], v[52:55]
    ds_read_b64_tr_b16 v[176:177], v64 offset:2048
    ds_read_b64_tr_b16 v[178:179], v64 offset:2560
    v_mfma_f32_16x16x32_bf16 v[56:59], v[188:191], a[40:43], v[56:59]
    ds_read_b64_tr_b16 v[180:181], v65 offset:2048
    v_mfma_f32_16x16x32_bf16 v[60:63], v[188:191], a[44:47], v[60:63]
    ds_read_b64_tr_b16 v[182:183], v65 offset:2560
    s_waitcnt lgkmcnt(4)
    v_mfma_f32_16x16x32_bf16 v[0:3], v[160:163], a[48:51], v[0:3]
    ds_read_b64_tr_b16 v[184:185], v66 offset:2048
    v_mfma_f32_16x16x32_bf16 v[4:7], v[160:163], a[52:55], v[4:7]
    v_mfma_f32_16x16x32_bf16 a[248:251], v[148:151], v[160:163], a[248:251]
    ds_read_b64_tr_b16 v[186:187], v66 offset:2560
    v_mfma_f32_16x16x32_bf16 v[8:11], v[164:167], a[48:51], v[8:11]
    buffer_load_dwordx4 a[36:39], v159, s[20:23], s100 offen offset:0 sc1
    v_mfma_f32_16x16x32_bf16 v[12:15], v[164:167], a[52:55], v[12:15]
    ds_read_b64_tr_b16 v[188:189], v67 offset:2048
    ds_read_b64_tr_b16 v[190:191], v67 offset:2560
    v_mfma_f32_16x16x32_bf16 v[16:19], v[168:171], a[48:51], v[16:19]
    ds_read_b64_tr_b16 v[160:161], v68 offset:0
    ds_read_b64_tr_b16 v[162:163], v68 offset:512
    v_mfma_f32_16x16x32_bf16 v[20:23], v[168:171], a[52:55], v[20:23]
    ds_read_b64_tr_b16 v[164:165], v69 offset:0
    v_mfma_f32_16x16x32_bf16 v[24:27], v[172:175], a[48:51], v[24:27]
    ds_read_b64_tr_b16 v[166:167], v69 offset:512
    ds_read_b64_tr_b16 v[168:169], v70 offset:0
    v_mfma_f32_16x16x32_bf16 v[28:31], v[172:175], a[52:55], v[28:31]
    s_add_u32 s100, s75, 25600
    s_cmp_lt_u32 s40, 3
    s_cselect_b32 s100, s100, 1073741824
    s_waitcnt lgkmcnt(5)
    v_mfma_f32_16x16x32_bf16 v[32:35], v[176:179], a[48:51], v[32:35]
    buffer_load_dwordx4 a[40:43], v209, s[20:23], s100 offen offset:0 sc1
    v_mfma_f32_16x16x32_bf16 v[36:39], v[176:179], a[52:55], v[36:39]
    ds_read_b64_tr_b16 v[170:171], v70 offset:512
    v_mfma_f32_16x16x32_bf16 a[252:255], v[148:151], v[176:179], a[252:255]
    ds_read_b64_tr_b16 v[172:173], v71 offset:0
    v_mfma_f32_16x16x32_bf16 v[40:43], v[180:183], a[48:51], v[40:43]
    ds_read_b64_tr_b16 v[174:175], v71 offset:512
    ds_read_b64_tr_b16 v[176:177], v68 offset:2048
    v_mfma_f32_16x16x32_bf16 v[44:47], v[180:183], a[52:55], v[44:47]
    ds_read_b64_tr_b16 v[178:179], v68 offset:2560
    v_mfma_f32_16x16x32_bf16 v[48:51], v[184:187], a[48:51], v[48:51]
    ds_read_b64_tr_b16 v[180:181], v69 offset:2048
    v_mfma_f32_16x16x32_bf16 v[52:55], v[184:187], a[52:55], v[52:55]
    ds_read_b64_tr_b16 v[182:183], v69 offset:2560
    v_mfma_f32_16x16x32_bf16 v[56:59], v[188:191], a[48:51], v[56:59]
    buffer_load_dwordx4 a[44:47], v209, s[20:23], s100 offen offset:1024 sc1
    v_mfma_f32_16x16x32_bf16 v[60:63], v[188:191], a[52:55], v[60:63]
    ds_read_b64_tr_b16 v[184:185], v70 offset:2048
    ds_read_b64_tr_b16 v[186:187], v70 offset:2560
    s_waitcnt lgkmcnt(6)
    v_mfma_f32_16x16x32_bf16 v[0:3], v[160:163], a[56:59], v[0:3]
    ds_read_b64_tr_b16 v[188:189], v71 offset:2048
    ds_read_b64_tr_b16 v[190:191], v71 offset:2560
    v_mfma_f32_16x16x32_bf16 v[4:7], v[160:163], a[60:63], v[4:7]
    v_bfe_u32 v158, v209, 6, 3
    v_mfma_f32_16x16x32_bf16 a[248:251], v[148:151], v[160:163], a[248:251]
    v_lshlrev_b32 v158, 7, v158
    v_bfe_u32 v147, v209, 4, 2
    v_mfma_f32_16x16x32_bf16 v[8:11], v[164:167], a[56:59], v[8:11]
    v_lshl_add_u32 v158, v147, 2, v158
    v_mfma_f32_16x16x32_bf16 v[12:15], v[164:167], a[60:63], v[12:15]
    buffer_load_dword v146, v158, s[20:23], s79 offen sc1
    v_mfma_f32_16x16x32_bf16 v[16:19], v[168:171], a[56:59], v[16:19]
    v_mfma_f32_16x16x32_bf16 v[20:23], v[168:171], a[60:63], v[20:23]
    s_waitcnt vmcnt(33) lgkmcnt(0)
    s_barrier
    s_add_u32 m0, s66, 65536
    v_mfma_f32_16x16x32_bf16 v[24:27], v[172:175], a[56:59], v[24:27]
    buffer_load_dwordx4 v200, s[4:7], s42 offen offset:0 lds
    ds_read_b64_tr_b16 v[160:161], v64 offset:16384
    v_mfma_f32_16x16x32_bf16 v[28:31], v[172:175], a[60:63], v[28:31]
    ds_read_b64_tr_b16 v[162:163], v64 offset:16896
    ds_read_b64_tr_b16 v[164:165], v65 offset:16384
    v_mfma_f32_16x16x32_bf16 v[32:35], v[176:179], a[56:59], v[32:35]
    buffer_load_dwordx4 a[48:51], v209, s[20:23], s100 offen offset:2048 sc1
    v_mfma_f32_16x16x32_bf16 v[36:39], v[176:179], a[60:63], v[36:39]
    ds_read_b64_tr_b16 v[166:167], v65 offset:16896
    v_mfma_f32_16x16x32_bf16 a[252:255], v[148:151], v[176:179], a[252:255]
    ds_read_b64_tr_b16 v[168:169], v66 offset:16384
    v_mfma_f32_16x16x32_bf16 v[40:43], v[180:183], a[56:59], v[40:43]
    buffer_load_dwordx4 v201, s[4:7], s42 offen offset:1024 lds
    v_mfma_f32_16x16x32_bf16 v[44:47], v[180:183], a[60:63], v[44:47]
    ds_read_b64_tr_b16 v[170:171], v66 offset:16896
    ds_read_b64_tr_b16 v[172:173], v67 offset:16384
    v_mfma_f32_16x16x32_bf16 v[48:51], v[184:187], a[56:59], v[48:51]
    ds_read_b64_tr_b16 v[174:175], v67 offset:16896
    ds_read_b64_tr_b16 v[176:177], v64 offset:18432
    v_mfma_f32_16x16x32_bf16 v[52:55], v[184:187], a[60:63], v[52:55]
    ds_read_b64_tr_b16 v[178:179], v64 offset:18944
    v_mfma_f32_16x16x32_bf16 v[56:59], v[188:191], a[56:59], v[56:59]
    buffer_load_dwordx4 v200, s[8:11], s42 offen offset:2048 lds
    v_mfma_f32_16x16x32_bf16 v[60:63], v[188:191], a[60:63], v[60:63]
    ds_read_b64_tr_b16 v[180:181], v65 offset:18432
    ds_read_b64_tr_b16 v[182:183], v65 offset:18944
    s_waitcnt lgkmcnt(4)
    v_mfma_f32_16x16x32_bf16 v[0:3], v[160:163], a[64:67], v[0:3]
    buffer_load_dwordx4 a[52:55], v209, s[20:23], s100 offen offset:3072 sc1
    v_mfma_f32_16x16x32_bf16 v[4:7], v[160:163], a[68:71], v[4:7]
    ds_read_b64_tr_b16 v[184:185], v66 offset:18432
    ds_read_b64_tr_b16 v[186:187], v66 offset:18944
    s_cmp_eq_u32 s2, 0
    s_cselect_b32 s1, s1, 1073741824
    v_mfma_f32_16x16x32_bf16 a[248:251], v[148:151], v[160:163], a[248:251]
    buffer_load_dwordx4 v[136:139], v209, s[20:23], s1 offen sc1
    v_mfma_f32_16x16x32_bf16 v[8:11], v[164:167], a[64:67], v[8:11]
    buffer_load_dwordx4 v201, s[8:11], s42 offen offset:3072 lds
    v_mfma_f32_16x16x32_bf16 v[12:15], v[164:167], a[68:71], v[12:15]
    ds_read_b64_tr_b16 v[188:189], v67 offset:18432
    ds_read_b64_tr_b16 v[190:191], v67 offset:18944
    v_mfma_f32_16x16x32_bf16 v[16:19], v[168:171], a[64:67], v[16:19]
    ds_read_b64_tr_b16 v[160:161], v68 offset:16384
    ds_read_b64_tr_b16 v[162:163], v68 offset:16896
    v_mfma_f32_16x16x32_bf16 v[20:23], v[168:171], a[68:71], v[20:23]
    ds_read_b64_tr_b16 v[164:165], v69 offset:16384
    s_add_u32 m0, s66, 0
    v_mfma_f32_16x16x32_bf16 v[24:27], v[172:175], a[64:67], v[24:27]
    buffer_load_dwordx4 v200, s[4:7], s44 offen offset:0 lds
    v_mfma_f32_16x16x32_bf16 v[28:31], v[172:175], a[68:71], v[28:31]
    ds_read_b64_tr_b16 v[166:167], v69 offset:16896
    ds_read_b64_tr_b16 v[168:169], v70 offset:16384
    s_waitcnt lgkmcnt(5)
    v_mfma_f32_16x16x32_bf16 v[32:35], v[176:179], a[64:67], v[32:35]
    buffer_load_dwordx4 a[56:59], v159, s[20:23], s100 offen offset:0 sc1
    v_mfma_f32_16x16x32_bf16 v[36:39], v[176:179], a[68:71], v[36:39]
    ds_read_b64_tr_b16 v[170:171], v70 offset:16896
    v_mfma_f32_16x16x32_bf16 a[252:255], v[148:151], v[176:179], a[252:255]
    ds_read_b64_tr_b16 v[172:173], v71 offset:16384
    v_mfma_f32_16x16x32_bf16 v[40:43], v[180:183], a[64:67], v[40:43]
    buffer_load_dwordx4 v201, s[4:7], s44 offen offset:1024 lds
    ds_read_b64_tr_b16 v[174:175], v71 offset:16896
    v_mfma_f32_16x16x32_bf16 v[44:47], v[180:183], a[68:71], v[44:47]
    ds_read_b64_tr_b16 v[176:177], v68 offset:18432
    ds_read_b64_tr_b16 v[178:179], v68 offset:18944
    v_mfma_f32_16x16x32_bf16 v[48:51], v[184:187], a[64:67], v[48:51]
    ds_read_b64_tr_b16 v[180:181], v69 offset:18432
    v_mfma_f32_16x16x32_bf16 v[52:55], v[184:187], a[68:71], v[52:55]
    ds_read_b64_tr_b16 v[182:183], v69 offset:18944
    v_mfma_f32_16x16x32_bf16 v[56:59], v[188:191], a[64:67], v[56:59]
    buffer_load_dwordx4 v200, s[8:11], s44 offen offset:2048 lds
    ds_read_b64_tr_b16 v[184:185], v70 offset:18432
    v_mfma_f32_16x16x32_bf16 v[60:63], v[188:191], a[68:71], v[60:63]
    ds_read_b64_tr_b16 v[186:187], v70 offset:18944
    s_add_u32 s100, s101, 0
    s_waitcnt lgkmcnt(6)
    v_mfma_f32_16x16x32_bf16 v[0:3], v[160:163], a[72:75], v[0:3]
    buffer_load_dwordx4 a[60:63], v209, s[20:23], s100 offen offset:0 sc1
    v_mfma_f32_16x16x32_bf16 v[4:7], v[160:163], a[76:79], v[4:7]
    ds_read_b64_tr_b16 v[188:189], v71 offset:18432
    v_mfma_f32_16x16x32_bf16 a[248:251], v[148:151], v[160:163], a[248:251]
    ds_read_b64_tr_b16 v[190:191], v71 offset:18944
    v_mfma_f32_16x16x32_bf16 v[8:11], v[164:167], a[72:75], v[8:11]
    buffer_load_dwordx4 v201, s[8:11], s44 offen offset:3072 lds
    v_mfma_f32_16x16x32_bf16 v[12:15], v[164:167], a[76:79], v[12:15]
    v_mfma_f32_16x16x32_bf16 v[16:19], v[168:171], a[72:75], v[16:19]
    v_mfma_f32_16x16x32_bf16 v[20:23], v[168:171], a[76:79], v[20:23]
    s_waitcnt vmcnt(35) lgkmcnt(0)
    s_barrier
    v_mfma_f32_16x16x32_bf16 v[24:27], v[172:175], a[72:75], v[24:27]
    buffer_load_dwordx4 a[64:67], v209, s[20:23], s100 offen offset:1024 sc1
    ds_read_b64_tr_b16 v[160:161], v192 offset:20480
    v_mfma_f32_16x16x32_bf16 v[28:31], v[172:175], a[76:79], v[28:31]
    ds_read_b64_tr_b16 v[162:163], v192 offset:20992
    ds_read_b64_tr_b16 v[164:165], v193 offset:20480
    v_mfma_f32_16x16x32_bf16 v[32:35], v[176:179], a[72:75], v[32:35]
    ds_read_b64_tr_b16 v[166:167], v193 offset:20992
    v_mfma_f32_16x16x32_bf16 v[36:39], v[176:179], a[76:79], v[36:39]
    v_mfma_f32_16x16x32_bf16 a[252:255], v[148:151], v[176:179], a[252:255]
    ds_read_b64_tr_b16 v[168:169], v194 offset:20480
    v_mfma_f32_16x16x32_bf16 v[40:43], v[180:183], a[72:75], v[40:43]
    ds_read_b64_tr_b16 v[170:171], v194 offset:20992
    v_mfma_f32_16x16x32_bf16 v[44:47], v[180:183], a[76:79], v[44:47]
    ds_read_b64_tr_b16 v[172:173], v195 offset:20480
    v_mfma_f32_16x16x32_bf16 v[48:51], v[184:187], a[72:75], v[48:51]
    buffer_load_dwordx4 a[68:71], v209, s[20:23], s100 offen offset:2048 sc1
    ds_read_b64_tr_b16 v[174:175], v195 offset:20992
    v_mfma_f32_16x16x32_bf16 v[52:55], v[184:187], a[76:79], v[52:55]
    ds_read_b64_tr_b16 v[176:177], v192 offset:22528
    ds_read_b64_tr_b16 v[178:179], v192 offset:23040
    v_mfma_f32_16x16x32_bf16 v[56:59], v[188:191], a[72:75], v[56:59]
    ds_read_b64_tr_b16 v[180:181], v193 offset:22528
    v_mfma_f32_16x16x32_bf16 v[60:63], v[188:191], a[76:79], v[60:63]
    ds_read_b64_tr_b16 v[182:183], v193 offset:23040
    s_waitcnt lgkmcnt(4)
    v_mfma_f32_16x16x32_bf16 v[0:3], v[160:163], a[80:83], v[0:3]
    ds_read_b64_tr_b16 v[184:185], v194 offset:22528
    ds_read_b64_tr_b16 v[186:187], v194 offset:23040
    v_mfma_f32_16x16x32_bf16 v[4:7], v[160:163], a[84:87], v[4:7]
    s_waitcnt vmcnt(15)
    s_nop 0
P_kvk_chk:
    v_cmp_ne_u32 vcc, v146, v145
    s_nop 4
    s_cbranch_vccnz P_kvk_slow
P_kvk_done:
    s_add_u32 s54, s63, 0
    v_mfma_f32_16x16x32_bf16 a[248:251], v[148:151], v[160:163], a[248:251]
    buffer_load_dwordx4 v[72:75], v154, s[20:23], s54 offen sc1
    v_mfma_f32_16x16x32_bf16 v[8:11], v[164:167], a[80:83], v[8:11]
    buffer_load_dwordx4 a[72:75], v209, s[20:23], s100 offen offset:3072 sc1
    ds_read_b64_tr_b16 v[188:189], v195 offset:22528
    v_mfma_f32_16x16x32_bf16 v[12:15], v[164:167], a[84:87], v[12:15]
    ds_read_b64_tr_b16 v[190:191], v195 offset:23040
    s_add_u32 s54, s63, 13824
    v_mfma_f32_16x16x32_bf16 v[16:19], v[168:171], a[80:83], v[16:19]
    ds_read_b64_tr_b16 v[160:161], v196 offset:20480
    ds_read_b64_tr_b16 v[162:163], v196 offset:20992
    v_mfma_f32_16x16x32_bf16 v[20:23], v[168:171], a[84:87], v[20:23]
    ds_read_b64_tr_b16 v[164:165], v197 offset:20480
    buffer_load_dwordx4 v[76:79], v154, s[20:23], s54 offen sc1
    v_mfma_f32_16x16x32_bf16 v[24:27], v[172:175], a[80:83], v[24:27]
    ds_read_b64_tr_b16 v[166:167], v197 offset:20992
    ds_read_b64_tr_b16 v[168:169], v198 offset:20480
    v_mfma_f32_16x16x32_bf16 v[28:31], v[172:175], a[84:87], v[28:31]
    s_add_u32 s54, s63, 27648
    s_waitcnt lgkmcnt(5)
    v_mfma_f32_16x16x32_bf16 v[32:35], v[176:179], a[80:83], v[32:35]
    buffer_load_dwordx4 a[76:79], v159, s[20:23], s100 offen offset:0 sc1
    v_mfma_f32_16x16x32_bf16 v[36:39], v[176:179], a[84:87], v[36:39]
    ds_read_b64_tr_b16 v[170:171], v198 offset:20992
    ds_read_b64_tr_b16 v[172:173], v199 offset:20480
    v_mfma_f32_16x16x32_bf16 a[252:255], v[148:151], v[176:179], a[252:255]
    buffer_load_dwordx4 v[204:207], v154, s[20:23], s54 offen sc1
    s_add_u32 s54, s63, 41472
    v_mfma_f32_16x16x32_bf16 v[40:43], v[180:183], a[80:83], v[40:43]
    ds_read_b64_tr_b16 v[174:175], v199 offset:20992
    ds_read_b64_tr_b16 v[176:177], v196 offset:22528
    v_mfma_f32_16x16x32_bf16 v[44:47], v[180:183], a[84:87], v[44:47]
    ds_read_b64_tr_b16 v[178:179], v196 offset:23040
    buffer_load_dwordx4 v[212:215], v154, s[20:23], s54 offen sc1
    v_mfma_f32_16x16x32_bf16 v[48:51], v[184:187], a[80:83], v[48:51]
    ds_read_b64_tr_b16 v[180:181], v197 offset:22528
    v_mfma_f32_16x16x32_bf16 v[52:55], v[184:187], a[84:87], v[52:55]
    ds_read_b64_tr_b16 v[182:183], v197 offset:23040
    v_mfma_f32_16x16x32_bf16 v[56:59], v[188:191], a[80:83], v[56:59]
    ds_read_b64_tr_b16 v[184:185], v198 offset:22528
    ds_read_b64_tr_b16 v[186:187], v198 offset:23040
    v_mfma_f32_16x16x32_bf16 v[60:63], v[188:191], a[84:87], v[60:63]
    s_add_u32 s100, s101, 5120
    s_waitcnt lgkmcnt(6)
    v_mfma_f32_16x16x32_bf16 v[0:3], v[160:163], a[88:91], v[0:3]
    buffer_load_dwordx4 a[80:83], v209, s[20:23], s100 offen offset:0 sc1
    v_mfma_f32_16x16x32_bf16 v[4:7], v[160:163], a[92:95], v[4:7]
    ds_read_b64_tr_b16 v[188:189], v199 offset:22528
    v_mfma_f32_16x16x32_bf16 a[248:251], v[148:151], v[160:163], a[248:251]
    ds_read_b64_tr_b16 v[190:191], v199 offset:23040
    v_lshrrev_b32 v155, 2, v209
    v_mfma_f32_16x16x32_bf16 v[8:11], v[164:167], a[88:91], v[8:11]
    v_min_u32 v155, 16, v155
    v_mfma_f32_16x16x32_bf16 v[12:15], v[164:167], a[92:95], v[12:15]
    buffer_load_dword v147, v155, s[20:23], s36 offen sc1
    v_mfma_f32_16x16x32_bf16 v[16:19], v[168:171], a[88:91], v[16:19]
    v_mfma_f32_16x16x32_bf16 v[20:23], v[168:171], a[92:95], v[20:23]
    s_waitcnt lgkmcnt(0)
    s_barrier
    s_add_u32 m0, s66, 20480
    v_mfma_f32_16x16x32_bf16 v[24:27], v[172:175], a[88:91], v[24:27]
    buffer_load_dwordx4 v200, s[4:7], s3 offen offset:0 lds
    ds_read_b64_tr_b16 v[160:161], v192 offset:40960
    v_mfma_f32_16x16x32_bf16 v[28:31], v[172:175], a[92:95], v[28:31]
    ds_read_b64_tr_b16 v[162:163], v192 offset:41472
    ds_read_b64_tr_b16 v[164:165], v193 offset:40960
    v_mfma_f32_16x16x32_bf16 v[32:35], v[176:179], a[88:91], v[32:35]
    buffer_load_dwordx4 a[84:87], v209, s[20:23], s100 offen offset:1024 sc1
    v_mfma_f32_16x16x32_bf16 v[36:39], v[176:179], a[92:95], v[36:39]
    ds_read_b64_tr_b16 v[166:167], v193 offset:41472
    v_mfma_f32_16x16x32_bf16 a[252:255], v[148:151], v[176:179], a[252:255]
    ds_read_b64_tr_b16 v[168:169], v194 offset:40960
    v_mfma_f32_16x16x32_bf16 v[40:43], v[180:183], a[88:91], v[40:43]
    buffer_load_dwordx4 v201, s[4:7], s3 offen offset:1024 lds
    v_mfma_f32_16x16x32_bf16 v[44:47], v[180:183], a[92:95], v[44:47]
    ds_read_b64_tr_b16 v[170:171], v194 offset:41472
    ds_read_b64_tr_b16 v[172:173], v195 offset:40960
    v_mfma_f32_16x16x32_bf16 v[48:51], v[184:187], a[88:91], v[48:51]
    ds_read_b64_tr_b16 v[174:175], v195 offset:41472
    ds_read_b64_tr_b16 v[176:177], v192 offset:43008
    v_mfma_f32_16x16x32_bf16 v[52:55], v[184:187], a[92:95], v[52:55]
    ds_read_b64_tr_b16 v[178:179], v192 offset:43520
    v_mfma_f32_16x16x32_bf16 v[56:59], v[188:191], a[88:91], v[56:59]
    buffer_load_dwordx4 v200, s[8:11], s3 offen offset:2048 lds
    v_mfma_f32_16x16x32_bf16 v[60:63], v[188:191], a[92:95], v[60:63]
    ds_read_b64_tr_b16 v[180:181], v193 offset:43008
    ds_read_b64_tr_b16 v[182:183], v193 offset:43520
    s_waitcnt lgkmcnt(4)
    v_mfma_f32_16x16x32_bf16 v[0:3], v[160:163], a[96:99], v[0:3]
    buffer_load_dwordx4 a[88:91], v209, s[20:23], s100 offen offset:2048 sc1
    v_mfma_f32_16x16x32_bf16 v[4:7], v[160:163], a[100:103], v[4:7]
    ds_read_b64_tr_b16 v[184:185], v194 offset:43008
    v_mfma_f32_16x16x32_bf16 a[248:251], v[148:151], v[160:163], a[248:251]
    ds_read_b64_tr_b16 v[186:187], v194 offset:43520
    v_mfma_f32_16x16x32_bf16 v[8:11], v[164:167], a[96:99], v[8:11]
    buffer_load_dwordx4 v201, s[8:11], s3 offen offset:3072 lds
    v_mfma_f32_16x16x32_bf16 v[12:15], v[164:167], a[100:103], v[12:15]
    ds_read_b64_tr_b16 v[188:189], v195 offset:43008
    ds_read_b64_tr_b16 v[190:191], v195 offset:43520
    v_mfma_f32_16x16x32_bf16 v[16:19], v[168:171], a[96:99], v[16:19]
    ds_read_b64_tr_b16 v[160:161], v196 offset:40960
    ds_read_b64_tr_b16 v[162:163], v196 offset:41472
    v_mfma_f32_16x16x32_bf16 v[20:23], v[168:171], a[100:103], v[20:23]
    ds_read_b64_tr_b16 v[164:165], v197 offset:40960
    s_add_u32 s45, s0, 0
    s_add_u32 m0, s58, 81920
    v_mfma_f32_16x16x32_bf16 v[24:27], v[172:175], a[96:99], v[24:27]
    buffer_load_dwordx4 v209, s[20:23], s45 offen offset:0 sc1 lds
    v_mfma_f32_16x16x32_bf16 v[28:31], v[172:175], a[100:103], v[28:31]
    ds_read_b64_tr_b16 v[166:167], v197 offset:41472
    ds_read_b64_tr_b16 v[168:169], v198 offset:40960
    s_waitcnt lgkmcnt(5)
    v_mfma_f32_16x16x32_bf16 v[32:35], v[176:179], a[96:99], v[32:35]
    buffer_load_dwordx4 a[92:95], v209, s[20:23], s100 offen offset:3072 sc1
    v_mfma_f32_16x16x32_bf16 v[36:39], v[176:179], a[100:103], v[36:39]
    ds_read_b64_tr_b16 v[170:171], v198 offset:41472
    ds_read_b64_tr_b16 v[172:173], v199 offset:40960
    v_mfma_f32_16x16x32_bf16 a[252:255], v[148:151], v[176:179], a[252:255]
    s_waitcnt vmcnt(25)
    v_xor_b32 v136, v136, v145
    v_xor_b32 v137, v137, v145
    v_mfma_f32_16x16x32_bf16 v[40:43], v[180:183], a[96:99], v[40:43]
    buffer_load_dwordx4 v209, s[20:23], s45 offen offset:1024 sc1 lds
    ds_read_b64_tr_b16 v[174:175], v199 offset:41472
    v_mfma_f32_16x16x32_bf16 v[44:47], v[180:183], a[100:103], v[44:47]
    ds_read_b64_tr_b16 v[176:177], v196 offset:43008
    ds_read_b64_tr_b16 v[178:179], v196 offset:43520
    v_mfma_f32_16x16x32_bf16 v[48:51], v[184:187], a[96:99], v[48:51]
    ds_read_b64_tr_b16 v[180:181], v197 offset:43008
    ds_read_b64_tr_b16 v[182:183], v197 offset:43520
    v_mfma_f32_16x16x32_bf16 v[52:55], v[184:187], a[100:103], v[52:55]
    v_xor_b32 v138, v138, v145
    v_xor_b32 v139, v139, v145
    v_mfma_f32_16x16x32_bf16 v[56:59], v[188:191], a[96:99], v[56:59]
    buffer_load_dwordx4 v209, s[20:23], s45 offen offset:2048 sc1 lds
    v_mfma_f32_16x16x32_bf16 v[60:63], v[188:191], a[100:103], v[60:63]
    ds_read_b64_tr_b16 v[184:185], v198 offset:43008
    ds_read_b64_tr_b16 v[186:187], v198 offset:43520
    s_waitcnt lgkmcnt(6)
    v_mfma_f32_16x16x32_bf16 v[0:3], v[160:163], a[104:107], v[0:3]
    buffer_load_dwordx4 a[96:99], v159, s[20:23], s100 offen offset:0 sc1
    v_mfma_f32_16x16x32_bf16 v[4:7], v[160:163], a[108:111], v[4:7]
    ds_read_b64_tr_b16 v[188:189], v199 offset:43008
    ds_read_b64_tr_b16 v[190:191], v199 offset:43520
    v_mfma_f32_16x16x32_bf16 a[248:251], v[148:151], v[160:163], a[248:251]
    v_or3_b32 v136, v136, v137, v138
    v_or_b32 v136, v136, v139
    s_waitcnt vmcnt(13)
    v_mfma_f32_16x16x32_bf16 v[244:247], a[240:243], v[72:75], 0
    v_mfma_f32_16x16x32_bf16 v[244:247], a[240:243], v[76:79], v[244:247]
    v_mfma_f32_16x16x32_bf16 v[244:247], a[240:243], v[204:207], v[244:247]
    v_mfma_f32_16x16x32_bf16 v[244:247], a[240:243], v[212:215], v[244:247]
    v_mfma_f32_16x16x32_bf16 v[8:11], v[164:167], a[104:107], v[8:11]
    buffer_load_dwordx4 v209, s[20:23], s45 offen offset:3072 sc1 lds
    v_cmp_ne_u32 vcc, 0, v136
    s_sub_u32 s50, s1, 1024
    s_nop 2
    s_cmp_eq_u64 vcc, 0
    s_cselect_b32 s50, s50, 1073741824
    s_cselect_b32 s1, 1073741824, s1
    v_mfma_f32_16x16x32_bf16 v[12:15], v[164:167], a[108:111], v[12:15]
    buffer_store_dword v145, v144, s[20:23], s50 offen sc1
    v_mfma_f32_16x16x32_bf16 v[16:19], v[168:171], a[104:107], v[16:19]
    v_mfma_f32_16x16x32_bf16 v[20:23], v[168:171], a[108:111], v[20:23]
    s_waitcnt lgkmcnt(0)
    s_barrier
    s_add_u32 m0, s58, 86016
    v_mfma_f32_16x16x32_bf16 v[24:27], v[172:175], a[104:107], v[24:27]
    buffer_load_dwordx4 v159, s[20:23], s45 offen offset:0 sc1 lds
    ds_read_b64_tr_b16 v[160:161], v64 offset:0
    v_mfma_f32_16x16x32_bf16 v[28:31], v[172:175], a[108:111], v[28:31]
    ds_read_b64_tr_b16 v[162:163], v64 offset:512
    ds_read_b64_tr_b16 v[164:165], v65 offset:0
    s_add_u32 s100, s101, 10240
    v_mfma_f32_16x16x32_bf16 v[32:35], v[176:179], a[104:107], v[32:35]
    buffer_load_dwordx4 a[100:103], v209, s[20:23], s100 offen offset:0 sc1
    v_mfma_f32_16x16x32_bf16 v[36:39], v[176:179], a[108:111], v[36:39]
    ds_read_b64_tr_b16 v[166:167], v65 offset:512
    ds_read_b64_tr_b16 v[168:169], v66 offset:0
    v_mfma_f32_16x16x32_bf16 a[252:255], v[148:151], v[176:179], a[252:255]
    v_cvt_pk_bf16_f32 v244, v244, v245
    v_cvt_pk_bf16_f32 v245, v246, v247
    v_mfma_f32_16x16x32_bf16 v[40:43], v[180:183], a[104:107], v[40:43]
    ds_read_b64_tr_b16 v[170:171], v66 offset:512
    ds_read_b64_tr_b16 v[172:173], v67 offset:0
    v_mfma_f32_16x16x32_bf16 v[44:47], v[180:183], a[108:111], v[44:47]
    buffer_store_dwordx2 v[244:245], v210, s[20:23], s78 offen sc1
    v_mfma_f32_16x16x32_bf16 v[48:51], v[184:187], a[104:107], v[48:51]
    ds_read_b64_tr_b16 v[174:175], v67 offset:512
    ds_read_b64_tr_b16 v[176:177], v64 offset:2048
    v_mfma_f32_16x16x32_bf16 v[52:55], v[184:187], a[108:111], v[52:55]
    ds_read_b64_tr_b16 v[178:179], v64 offset:2560
    v_mfma_f32_16x16x32_bf16 v[56:59], v[188:191], a[104:107], v[56:59]
    ds_read_b64_tr_b16 v[180:181], v65 offset:2048
    v_mfma_f32_16x16x32_bf16 v[60:63], v[188:191], a[108:111], v[60:63]
    ds_read_b64_tr_b16 v[182:183], v65 offset:2560
    s_waitcnt lgkmcnt(4)
    v_mfma_f32_16x16x32_bf16 v[0:3], v[160:163], a[112:115], v[0:3]
    buffer_load_dwordx4 a[104:107], v209, s[20:23], s100 offen offset:1024 sc1
    v_mfma_f32_16x16x32_bf16 v[4:7], v[160:163], a[116:119], v[4:7]
    ds_read_b64_tr_b16 v[184:185], v66 offset:2048
    ds_read_b64_tr_b16 v[186:187], v66 offset:2560
    v_mfma_f32_16x16x32_bf16 a[248:251], v[148:151], v[160:163], a[248:251]
    v_add_u32 v202, 152576, v209
    ds_read_b128 v[96:99], v202 offset:0
    v_mfma_f32_16x16x32_bf16 v[8:11], v[164:167], a[112:115], v[8:11]
    ds_read_b64_tr_b16 v[188:189], v67 offset:2048
    ds_read_b64_tr_b16 v[190:191], v67 offset:2560
    v_mfma_f32_16x16x32_bf16 v[12:15], v[164:167], a[116:119], v[12:15]
    ds_read_b128 v[100:103], v202 offset:1024
    ds_read_b128 v[104:107], v202 offset:2048
    v_mfma_f32_16x16x32_bf16 v[16:19], v[168:171], a[112:115], v[16:19]
    ds_read_b64_tr_b16 v[160:161], v68 offset:0
    ds_read_b64_tr_b16 v[162:163], v68 offset:512
    v_mfma_f32_16x16x32_bf16 v[20:23], v[168:171], a[116:119], v[20:23]
    ds_read_b64_tr_b16 v[164:165], v69 offset:0
    v_and_b32 v208, 0x1f0, v209
    s_waitcnt vmcnt(17)
    v_mfma_f32_16x16x32_bf16 v[24:27], v[172:175], a[112:115], v[24:27]
    buffer_load_dwordx4 a[108:111], v209, s[20:23], s100 offen offset:2048 sc1
    v_mfma_f32_16x16x32_bf16 v[28:31], v[172:175], a[116:119], v[28:31]
    ds_read_b64_tr_b16 v[166:167], v69 offset:512
    ds_read_b64_tr_b16 v[168:169], v70 offset:0
    s_waitcnt lgkmcnt(7)
    v_mfma_f32_16x16x32_bf16 v[32:35], v[176:179], a[112:115], v[32:35]
    ds_read_b64_tr_b16 v[170:171], v70 offset:512
    ds_read_b64_tr_b16 v[172:173], v71 offset:0
    v_mfma_f32_16x16x32_bf16 v[36:39], v[176:179], a[116:119], v[36:39]
    s_nop 0
P_qk_chk:
    v_cmp_ne_u32 vcc, v147, v145
    s_nop 4
    s_cbranch_vccnz P_qk_slow
P_qk_done:
    buffer_load_dwordx4 v[72:75], v209, s[20:23], s76 offen offset:0 sc1
    v_mfma_f32_16x16x32_bf16 a[252:255], v[148:151], v[176:179], a[252:255]
    buffer_load_dwordx4 v[76:79], v209, s[20:23], s76 offen offset:1024 sc1
    v_mfma_f32_16x16x32_bf16 v[40:43], v[180:183], a[112:115], v[40:43]
    ds_read_b64_tr_b16 v[174:175], v71 offset:512
    ds_read_b64_tr_b16 v[176:177], v68 offset:2048
    v_mfma_f32_16x16x32_bf16 v[44:47], v[180:183], a[116:119], v[44:47]
    ds_read_b64_tr_b16 v[178:179], v68 offset:2560
    buffer_load_dwordx4 v[204:207], v208, s[20:23], s76 offen offset:2048 sc1
    v_mfma_f32_16x16x32_bf16 v[48:51], v[184:187], a[112:115], v[48:51]
    ds_read_b64_tr_b16 v[180:181], v69 offset:2048
    ds_read_b64_tr_b16 v[182:183], v69 offset:2560
    s_waitcnt lgkmcnt(12)
    v_mfma_f32_16x16x32_bf16 v[52:55], v[184:187], a[116:119], v[52:55]
    ds_read_b64_tr_b16 v[112:113], v96
    ds_read_b64_tr_b16 v[114:115], v97
    v_mfma_f32_16x16x32_bf16 v[56:59], v[188:191], a[112:115], v[56:59]
    ds_read_b64_tr_b16 v[184:185], v70 offset:2048
    ds_read_b64_tr_b16 v[186:187], v70 offset:2560
    v_mfma_f32_16x16x32_bf16 v[60:63], v[188:191], a[116:119], v[60:63]
    ds_read_b64_tr_b16 v[116:117], v98
    ds_read_b64_tr_b16 v[118:119], v99
    s_waitcnt lgkmcnt(10)
    v_mfma_f32_16x16x32_bf16 v[0:3], v[160:163], a[120:123], v[0:3]
    buffer_load_dwordx4 a[112:115], v209, s[20:23], s100 offen offset:3072 sc1
    v_mfma_f32_16x16x32_bf16 v[4:7], v[160:163], a[124:127], v[4:7]
    ds_read_b64_tr_b16 v[188:189], v71 offset:2048
    ds_read_b64_tr_b16 v[190:191], v71 offset:2560
    v_mfma_f32_16x16x32_bf16 a[248:251], v[148:151], v[160:163], a[248:251]
    ds_read_b64_tr_b16 v[120:121], v100
    ds_read_b64_tr_b16 v[122:123], v101
    v_mfma_f32_16x16x32_bf16 v[8:11], v[164:167], a[120:123], v[8:11]
    ds_read_b64_tr_b16 v[124:125], v102
    ds_read_b64_tr_b16 v[126:127], v103
    v_mfma_f32_16x16x32_bf16 v[12:15], v[164:167], a[124:127], v[12:15]
    ds_read_b64_tr_b16 v[128:129], v104
    ds_read_b64_tr_b16 v[130:131], v105
    v_mfma_f32_16x16x32_bf16 v[16:19], v[168:171], a[120:123], v[16:19]
    v_mfma_f32_16x16x32_bf16 v[20:23], v[168:171], a[124:127], v[20:23]
    s_waitcnt vmcnt(16) lgkmcnt(0)
    s_barrier
    s_add_u32 s45, s0, 5120
    s_add_u32 m0, s58, 61440
    v_mfma_f32_16x16x32_bf16 v[24:27], v[172:175], a[120:123], v[24:27]
    buffer_load_dwordx4 v209, s[20:23], s45 offen offset:0 sc1 lds
    v_mfma_f32_16x16x32_bf16 v[28:31], v[172:175], a[124:127], v[28:31]
    ds_read_b64_tr_b16 v[160:161], v192 offset:0
    ds_read_b64_tr_b16 v[162:163], v192 offset:512
    v_mfma_f32_16x16x32_bf16 v[32:35], v[176:179], a[120:123], v[32:35]
    buffer_load_dwordx4 a[116:119], v159, s[20:23], s100 offen offset:0 sc1
    v_mfma_f32_16x16x32_bf16 v[36:39], v[176:179], a[124:127], v[36:39]
    ds_read_b64_tr_b16 v[164:165], v192 offset:2048
    ds_read_b64_tr_b16 v[166:167], v192 offset:2560
    v_mfma_f32_16x16x32_bf16 a[252:255], v[148:151], v[176:179], a[252:255]
    ds_read_b64_tr_b16 v[132:133], v106
    ds_read_b64_tr_b16 v[134:135], v107
    v_mfma_f32_16x16x32_bf16 v[40:43], v[180:183], a[120:123], v[40:43]
    buffer_load_dwordx4 v209, s[20:23], s45 offen offset:1024 sc1 lds
    ds_read_b64_tr_b16 v[168:169], v196 offset:0
    v_mfma_f32_16x16x32_bf16 v[44:47], v[180:183], a[124:127], v[44:47]
    ds_read_b64_tr_b16 v[170:171], v196 offset:512
    s_waitcnt vmcnt(9)
    buffer_store_dword v145, v144, s[20:23], s29 offen sc1
    v_mfma_f32_16x16x32_bf16 v[48:51], v[184:187], a[120:123], v[48:51]
    ds_read_b64_tr_b16 v[172:173], v196 offset:2048
    v_mfma_f32_16x16x32_bf16 v[52:55], v[184:187], a[124:127], v[52:55]
    ds_read_b64_tr_b16 v[174:175], v196 offset:2560
    v_mfma_f32_16x16x32_bf16 v[56:59], v[188:191], a[120:123], v[56:59]
    buffer_load_dwordx4 v209, s[20:23], s45 offen offset:2048 sc1 lds
    ds_read_b64_tr_b16 v[176:177], v192 offset:20480
    v_mfma_f32_16x16x32_bf16 v[60:63], v[188:191], a[124:127], v[60:63]
    ds_read_b64_tr_b16 v[178:179], v192 offset:20992
    s_add_u32 s100, s101, 15360
    s_waitcnt lgkmcnt(2)
    v_mfma_f32_16x16x32_bf16 v[0:3], v[160:163], a[128:131], v[0:3]
    buffer_load_dwordx4 a[120:123], v209, s[20:23], s100 offen offset:0 sc1
    ds_read_b64_tr_b16 v[180:181], v192 offset:22528
    v_mfma_f32_16x16x32_bf16 v[4:7], v[160:163], a[132:135], v[4:7]
    ds_read_b64_tr_b16 v[182:183], v192 offset:23040
    s_and_b32 s54, s2, 6
    v_mfma_f32_16x16x32_bf16 a[248:251], v[148:151], v[160:163], a[248:251]
    s_lshl_b32 s54, s54, 2
    s_bfe_u32 s70, s2, 0x30003
    s_add_u32 s54, s54, s70
    v_mfma_f32_16x16x32_bf16 v[32:35], v[164:167], a[128:131], v[32:35]
    buffer_load_dwordx4 v209, s[20:23], s45 offen offset:3072 sc1 lds
    ds_read_b64_tr_b16 v[184:185], v196 offset:20480
    v_mfma_f32_16x16x32_bf16 v[36:39], v[164:167], a[132:135], v[36:39]
    ds_read_b64_tr_b16 v[186:187], v196 offset:20992
    s_mul_i32 s55, s2, 257
    v_mfma_f32_16x16x32_bf16 a[252:255], v[148:151], v[164:167], a[252:255]
    s_bfe_u32 s55, s55, 0x30006
    s_mul_i32 s70, s40, 3
    v_mfma_f32_16x16x32_bf16 v[0:3], v[168:171], a[136:139], v[0:3]
    ds_read_b64_tr_b16 v[188:189], v196 offset:22528
    ds_read_b64_tr_b16 v[190:191], v196 offset:23040
    v_mfma_f32_16x16x32_bf16 v[4:7], v[168:171], a[140:143], v[4:7]
    s_min_u32 s70, s70, 5
    s_lshl_b32 s51, s54, 4
    s_add_u32 s51, s51, s70
    v_mfma_f32_16x16x32_bf16 a[248:251], v[148:151], v[168:171], a[248:251]
    s_lshl_b32 s51, s51, 7
    s_add_u32 m0, s58, 65536
    v_mfma_f32_16x16x32_bf16 v[32:35], v[172:175], a[136:139], v[32:35]
    buffer_load_dwordx4 v159, s[20:23], s45 offen offset:0 sc1 lds
    ds_read_b64_tr_b16 v[160:161], v193 offset:0
    v_mfma_f32_16x16x32_bf16 v[36:39], v[172:175], a[140:143], v[36:39]
    ds_read_b64_tr_b16 v[162:163], v193 offset:512
    s_add_u32 s51, s51, 19450880
    v_mfma_f32_16x16x32_bf16 a[252:255], v[148:151], v[172:175], a[252:255]
    s_add_u32 s57, s76, 2621440
    s_add_u32 s47, s43, 65536
    s_waitcnt lgkmcnt(2)
    v_mfma_f32_16x16x32_bf16 v[0:3], v[176:179], a[144:147], v[0:3]
    buffer_load_dwordx4 a[124:127], v209, s[20:23], s100 offen offset:1024 sc1
    ds_read_b64_tr_b16 v[164:165], v194 offset:0
    v_mfma_f32_16x16x32_bf16 v[4:7], v[176:179], a[148:151], v[4:7]
    ds_read_b64_tr_b16 v[166:167], v194 offset:512
    s_mul_i32 s76, s54, 221184
    v_mfma_f32_16x16x32_bf16 a[248:251], v[148:151], v[176:179], a[248:251]
    s_add_u32 s45, s0, 10240
    s_add_u32 m0, s58, 40960
    v_mfma_f32_16x16x32_bf16 v[32:35], v[180:183], a[144:147], v[32:35]
    buffer_load_dwordx4 v209, s[20:23], s45 offen offset:0 sc1 lds
    ds_read_b64_tr_b16 v[168:169], v195 offset:0
    v_mfma_f32_16x16x32_bf16 v[36:39], v[180:183], a[148:151], v[36:39]
    ds_read_b64_tr_b16 v[170:171], v195 offset:512
    s_add_u32 s76, s76, 2621440
    v_mfma_f32_16x16x32_bf16 a[252:255], v[148:151], v[180:183], a[252:255]
    s_mul_i32 s70, s40, 12288
    s_add_u32 s53, s76, s70
    v_mfma_f32_16x16x32_bf16 v[0:3], v[184:187], a[152:155], v[0:3]
    ds_read_b64_tr_b16 v[172:173], v193 offset:2048
    ds_read_b64_tr_b16 v[174:175], v193 offset:2560
    v_mfma_f32_16x16x32_bf16 v[4:7], v[184:187], a[156:159], v[4:7]
    s_lshl_b32 s70, s40, 14
    s_add_u32 s76, s76, s70
    s_add_u32 s76, s76, 45056
    v_mfma_f32_16x16x32_bf16 a[248:251], v[148:151], v[184:187], a[248:251]
    ds_read_b128 v[212:215], v202 offset:3072
    ds_read_b128 v[140:143], v202 offset:4096
    v_mfma_f32_16x16x32_bf16 v[32:35], v[188:191], a[152:155], v[32:35]
    buffer_load_dwordx4 v209, s[20:23], s45 offen offset:1024 sc1 lds
    ds_read_b64_tr_b16 v[176:177], v194 offset:2048
    v_mfma_f32_16x16x32_bf16 v[36:39], v[188:191], a[156:159], v[36:39]
    ds_read_b64_tr_b16 v[178:179], v194 offset:2560
    s_lshr_b32 s71, s40, 1
    v_mfma_f32_16x16x32_bf16 a[252:255], v[148:151], v[188:191], a[252:255]
    s_and_b32 s70, s40, 1
    s_lshl_b32 s70, s70, 8
    s_waitcnt lgkmcnt(4)
    v_mfma_f32_16x16x32_bf16 v[8:11], v[160:163], a[128:131], v[8:11]
    ds_read_b64_tr_b16 v[180:181], v195 offset:2048
    ds_read_b64_tr_b16 v[182:183], v195 offset:2560
    v_mfma_f32_16x16x32_bf16 v[12:15], v[160:163], a[132:135], v[12:15]
    s_mul_i32 s72, s71, 110592
    s_sub_u32 s73, 110592, s72
    s_add_u32 s72, s72, s70
    v_mfma_f32_16x16x32_bf16 v[16:19], v[164:167], a[128:131], v[16:19]
    buffer_load_dwordx4 v209, s[20:23], s45 offen offset:2048 sc1 lds
    ds_read_b64_tr_b16 v[184:185], v197 offset:0
    v_mfma_f32_16x16x32_bf16 v[20:23], v[164:167], a[132:135], v[20:23]
    ds_read_b64_tr_b16 v[186:187], v197 offset:512
    v_accvgpr_read_b32 v240, a248
    v_accvgpr_read_b32 v241, a252
    v_mfma_f32_16x16x32_bf16 v[24:27], v[168:171], a[128:131], v[24:27]
    ds_read_b64_tr_b16 v[188:189], v198 offset:0
    ds_read_b64_tr_b16 v[190:191], v198 offset:512
    v_xor_b32 v244, 8, v156
    v_mfma_f32_16x16x32_bf16 v[28:31], v[168:171], a[132:135], v[28:31]
    v_xor_b32 v245, 16, v156
    v_xor_b32 v246, 24, v156
    v_and_b32 v242, 0xffff0000, v240
    v_mfma_f32_16x16x32_bf16 v[40:43], v[172:175], a[128:131], v[40:43]
    buffer_load_dwordx4 v209, s[20:23], s45 offen offset:3072 sc1 lds
    ds_read_b64_tr_b16 v[160:161], v199 offset:0
    v_mfma_f32_16x16x32_bf16 v[44:47], v[172:175], a[132:135], v[44:47]
    ds_read_b64_tr_b16 v[162:163], v199 offset:512
    v_sub_f32 v240, v240, v242
    s_waitcnt lgkmcnt(2)
    v_mfma_f32_16x16x32_bf16 v[48:51], v[176:179], a[128:131], v[48:51]
    ds_read_b64_tr_b16 v[164:165], v197 offset:2048
    ds_read_b64_tr_b16 v[166:167], v197 offset:2560
    v_cvt_pk_bf16_f32 v240, v242, v240
    v_mfma_f32_16x16x32_bf16 v[52:55], v[176:179], a[132:135], v[52:55]
    v_and_b32 v243, 0xffff0000, v241
    s_add_u32 m0, s58, 45056
    v_mfma_f32_16x16x32_bf16 v[56:59], v[180:183], a[128:131], v[56:59]
    buffer_load_dwordx4 v159, s[20:23], s45 offen offset:0 sc1 lds
    ds_read_b64_tr_b16 v[168:169], v198 offset:2048
    v_mfma_f32_16x16x32_bf16 v[60:63], v[180:183], a[132:135], v[60:63]
    ds_read_b64_tr_b16 v[170:171], v198 offset:2560
    v_sub_f32 v241, v241, v243
    v_cvt_pk_bf16_f32 v241, v243, v241
    v_mfma_f32_16x16x32_bf16 v[8:11], v[184:187], a[136:139], v[8:11]
    buffer_load_dwordx4 a[128:131], v209, s[20:23], s100 offen offset:2048 sc1
    ds_read_b64_tr_b16 v[172:173], v199 offset:2048
    v_mfma_f32_16x16x32_bf16 v[12:15], v[184:187], a[140:143], v[12:15]
    ds_read_b64_tr_b16 v[174:175], v199 offset:2560
    ds_write_b64 v156, v[240:241] offset:0
    v_mfma_f32_16x16x32_bf16 v[16:19], v[188:191], a[136:139], v[16:19]
    ds_read_b64_tr_b16 v[176:177], v193 offset:20480
    ds_read_b64_tr_b16 v[178:179], v193 offset:20992
    v_mfma_f32_16x16x32_bf16 v[20:23], v[188:191], a[140:143], v[20:23]
    ds_write_b64 v244, v[240:241] offset:2048
    ds_write_b64 v245, v[240:241] offset:4096
    s_waitcnt lgkmcnt(5)
    v_mfma_f32_16x16x32_bf16 v[24:27], v[160:163], a[136:139], v[24:27]
    ds_read_b64_tr_b16 v[180:181], v194 offset:20480
    ds_read_b64_tr_b16 v[182:183], v194 offset:20992
    v_mfma_f32_16x16x32_bf16 v[28:31], v[160:163], a[140:143], v[28:31]
    ds_write_b64 v246, v[240:241] offset:6144
    s_add_u32 s73, s73, s70
    s_lshl_b32 s52, s54, 1
    v_mfma_f32_16x16x32_bf16 v[40:43], v[164:167], a[136:139], v[40:43]
    buffer_load_dwordx4 a[132:135], v209, s[20:23], s100 offen offset:3072 sc1
    ds_read_b64_tr_b16 v[184:185], v195 offset:20480
    v_mfma_f32_16x16x32_bf16 v[44:47], v[164:167], a[140:143], v[44:47]
    ds_read_b64_tr_b16 v[186:187], v195 offset:20992
    s_add_u32 s52, s52, s71
    s_mul_i32 s52, s52, 40960
    v_mfma_f32_16x16x32_bf16 v[48:51], v[168:171], a[136:139], v[48:51]
    ds_read_b64_tr_b16 v[188:189], v193 offset:22528
    ds_read_b64_tr_b16 v[190:191], v193 offset:23040
    s_add_u32 s52, s52, s70
    v_mfma_f32_16x16x32_bf16 v[52:55], v[168:171], a[140:143], v[52:55]
    s_add_u32 s52, s52, 12320768
    s_lshl_b32 s48, s54, 11
    s_lshl_b32 s71, s71, 2
    v_mfma_f32_16x16x32_bf16 v[56:59], v[172:175], a[136:139], v[56:59]
    v_mfma_f32_16x16x32_bf16 v[60:63], v[172:175], a[140:143], v[60:63]
    s_waitcnt lgkmcnt(4)
    s_barrier
    ds_read_b64_tr_b16 v[160:161], v194 offset:22528
    ds_read_b64_tr_b16 v[162:163], v194 offset:23040
    s_waitcnt lgkmcnt(2)
    v_mfma_f32_16x16x32_bf16 v[8:11], v[176:179], a[144:147], v[8:11]
    buffer_load_dwordx4 a[136:139], v159, s[20:23], s100 offen offset:0 sc1
    ds_read_b64_tr_b16 v[164:165], v195 offset:22528
    ds_read_b64_tr_b16 v[166:167], v195 offset:23040
    v_mfma_f32_16x16x32_bf16 v[12:15], v[176:179], a[148:151], v[12:15]
    ds_read_b128 v[240:243], v157 offset:0
    ds_read_b128 v[244:247], v157 offset:16
    v_bfe_u32 v155, v209, 2, 4
    v_mfma_f32_16x16x32_bf16 v[16:19], v[180:183], a[144:147], v[16:19]
    ds_read_b64_tr_b16 v[168:169], v197 offset:20480
    ds_read_b64_tr_b16 v[170:171], v197 offset:20992
    s_add_u32 s49, s48, s71
    v_mfma_f32_16x16x32_bf16 v[20:23], v[180:183], a[148:151], v[20:23]
    s_add_u32 s49, s49, 19580928
    s_lshl_b32 s71, s40, 9
    s_add_u32 s48, s48, s71
    v_min_u32 v155, s35, v155
    v_mfma_f32_16x16x32_bf16 v[24:27], v[184:187], a[144:147], v[24:27]
    ds_read_b64_tr_b16 v[172:173], v198 offset:20480
    ds_read_b64_tr_b16 v[174:175], v198 offset:20992
    v_mfma_f32_16x16x32_bf16 v[28:31], v[184:187], a[148:151], v[28:31]
    s_add_u32 s48, s48, 19515392
    s_waitcnt vmcnt(18)
    v_mfma_f32_32x32x16_bf16 v[80:95], v[112:115], v[72:75], 0
    v_mfma_f32_32x32x16_bf16 v[80:95], v[120:123], v[76:79], v[80:95]
    v_mfma_f32_32x32x16_bf16 v[80:95], v[128:131], v[204:207], v[80:95]
    v_mfma_f32_32x32x16_bf16 v[96:111], v[116:119], v[72:75], 0
    v_mfma_f32_16x16x32_bf16 v[40:43], v[188:191], a[144:147], v[40:43]
    ds_read_b64_tr_b16 v[176:177], v199 offset:20480
    ds_read_b64_tr_b16 v[178:179], v199 offset:20992
    s_waitcnt lgkmcnt(6)
    v_mfma_f32_16x16x16_bf16 v[8:11], v[242:243], v[248:249], v[8:11]
    v_mfma_f32_16x16x16_bf16 v[12:15], v[242:243], v[252:253], v[12:15]
    v_mfma_f32_16x16x16_bf16 v[0:3], v[240:241], v[248:249], v[0:3]
    v_add_u32 v148, s72, v140
    v_mfma_f32_16x16x32_bf16 v[44:47], v[188:191], a[148:151], v[44:47]
    v_add_u32 v150, s73, v140
    v_xor_b32 v149, 256, v148
    v_xor_b32 v151, 256, v150
    v_bfe_u32 v156, v209, 5, 2
    v_mfma_f32_32x32x16_bf16 v[96:111], v[124:127], v[76:79], v[96:111]
    v_mfma_f32_32x32x16_bf16 v[96:111], v[132:135], v[204:207], v[96:111]
    s_waitcnt lgkmcnt(2)
    v_mfma_f32_16x16x32_bf16 v[48:51], v[160:163], a[144:147], v[48:51]
    ds_read_b64_tr_b16 v[180:181], v197 offset:22528
    ds_read_b64_tr_b16 v[182:183], v197 offset:23040
    v_mfma_f32_16x16x16_bf16 v[16:19], v[244:245], v[248:249], v[16:19]
    v_mfma_f32_16x16x16_bf16 v[20:23], v[244:245], v[252:253], v[20:23]
    v_mfma_f32_16x16x16_bf16 v[32:35], v[240:241], v[250:251], v[32:35]
    v_bfe_u32 v157, v209, 2, 3
    v_min_u32 v158, 2, v156
    v_mfma_f32_16x16x32_bf16 v[52:55], v[160:163], a[148:151], v[52:55]
    v_lshl_add_u32 v158, v158, 7, v157
    v_lshl_add_u32 v156, v156, 7, v157
    v_and_b32 v157, 0xf0, v209
    v_lshlrev_b32 v157, 3, v157
    v_mfma_f32_16x16x32_bf16 v[56:59], v[164:167], a[144:147], v[56:59]
    ds_read_b64_tr_b16 v[184:185], v198 offset:22528
    v_mfma_f32_16x16x32_bf16 v[60:63], v[164:167], a[148:151], v[60:63]
    ds_read_b64_tr_b16 v[186:187], v198 offset:23040
    v_mfma_f32_16x16x16_bf16 v[24:27], v[246:247], v[248:249], v[24:27]
    v_mfma_f32_16x16x16_bf16 v[28:31], v[246:247], v[252:253], v[28:31]
    v_mfma_f32_16x16x16_bf16 v[4:7], v[240:241], v[252:253], v[4:7]
    v_mfma_f32_16x16x32_bf16 v[8:11], v[168:171], a[152:155], v[8:11]
    ds_read_b64_tr_b16 v[188:189], v199 offset:22528
    v_mfma_f32_16x16x32_bf16 v[12:15], v[168:171], a[156:159], v[12:15]
    ds_read_b64_tr_b16 v[190:191], v199 offset:23040
    v_mfma_f32_16x16x16_bf16 v[40:43], v[242:243], v[250:251], v[40:43]
    v_mfma_f32_16x16x16_bf16 v[44:47], v[242:243], v[254:255], v[44:47]
    v_mfma_f32_16x16x16_bf16 v[36:39], v[240:241], v[254:255], v[36:39]
    v_mfma_f32_16x16x32_bf16 v[16:19], v[172:175], a[152:155], v[16:19]
    v_mfma_f32_16x16x16_bf16 v[48:51], v[244:245], v[250:251], v[48:51]
    v_mfma_f32_16x16x16_bf16 v[52:55], v[244:245], v[254:255], v[52:55]
    v_mfma_f32_16x16x32_bf16 v[20:23], v[172:175], a[156:159], v[20:23]
    s_waitcnt lgkmcnt(0)
    v_mfma_f32_16x16x32_bf16 v[24:27], v[176:179], a[152:155], v[24:27]
    v_mfma_f32_16x16x16_bf16 v[56:59], v[246:247], v[250:251], v[56:59]
    v_mfma_f32_16x16x16_bf16 v[60:63], v[246:247], v[254:255], v[60:63]
    v_mfma_f32_16x16x32_bf16 v[28:31], v[176:179], a[156:159], v[28:31]
    v_mfma_f32_16x16x32_bf16 v[40:43], v[180:183], a[152:155], v[40:43]
    v_mfma_f32_16x16x32_bf16 v[44:47], v[180:183], a[156:159], v[44:47]
    v_mfma_f32_16x16x32_bf16 v[48:51], v[184:187], a[152:155], v[48:51]
    v_mfma_f32_16x16x32_bf16 v[52:55], v[184:187], a[156:159], v[52:55]
    v_mfma_f32_16x16x32_bf16 v[56:59], v[188:191], a[152:155], v[56:59]
    v_mfma_f32_16x16x32_bf16 v[60:63], v[188:191], a[156:159], v[60:63]
KP_join:
    s_nop 0
    s_nop 0
    s_waitcnt lgkmcnt(0)
    s_barrier
    s_nop 3
    buffer_load_dword v146, v158, s[20:23], s51 offen sc1
    buffer_load_dword v147, v155, s[20:23], s33 offen sc1
    v_pk_mul_f32 v[224:225], v[0:1], v[0:1]
    v_pk_mul_f32 v[226:227], v[2:3], v[2:3]
    v_pk_fma_f32 v[224:225], v[224:225], v[216:217], v[216:217] op_sel:[0,1,0] op_sel_hi:[1,1,0]
    v_pk_fma_f32 v[226:227], v[226:227], v[216:217], v[216:217] op_sel:[0,1,0] op_sel_hi:[1,1,0]
    v_pk_mul_f32 v[224:225], v[224:225], v[0:1]
    v_pk_mul_f32 v[226:227], v[226:227], v[2:3]
    v_exp_f32 v224, v224
    v_exp_f32 v225, v225
    v_exp_f32 v226, v226
    v_exp_f32 v227, v227
    s_add_u32 s100, s101, 20480
    buffer_load_dwordx4 a[140:143], v209, s[20:23], s100 offen offset:0 sc1
    v_pk_mul_f32 v[32:33], v[0:1], v[32:33]
    v_pk_mul_f32 v[34:35], v[2:3], v[34:35]
    v_pk_fma_f32 v[224:225], v[224:225], v[218:219], v[218:219] op_sel_hi:[1,0,0]
    v_pk_fma_f32 v[226:227], v[226:227], v[218:219], v[218:219] op_sel_hi:[1,0,0]
    v_rcp_f32 v224, v224
    v_rcp_f32 v225, v225
    v_rcp_f32 v226, v226
    v_rcp_f32 v227, v227
    v_pk_mul_f32 v[32:33], v[32:33], v[224:225]
    v_pk_mul_f32 v[34:35], v[34:35], v[226:227]
    v_cvt_pk_bf16_f32 v232, v32, v33
    v_cvt_pk_bf16_f32 v233, v34, v35
    buffer_load_dwordx4 a[144:147], v209, s[20:23], s100 offen offset:1024 sc1
    v_pk_mul_f32 v[228:229], v[8:9], v[8:9]
    v_pk_mul_f32 v[230:231], v[10:11], v[10:11]
    v_pk_fma_f32 v[228:229], v[228:229], v[216:217], v[216:217] op_sel:[0,1,0] op_sel_hi:[1,1,0]
    v_pk_fma_f32 v[230:231], v[230:231], v[216:217], v[216:217] op_sel:[0,1,0] op_sel_hi:[1,1,0]
    v_pk_mul_f32 v[228:229], v[228:229], v[8:9]
    v_pk_mul_f32 v[230:231], v[230:231], v[10:11]
    v_exp_f32 v228, v228
    v_exp_f32 v229, v229
    v_exp_f32 v230, v230
    v_exp_f32 v231, v231
    v_pk_mul_f32 v[40:41], v[8:9], v[40:41]
    v_pk_mul_f32 v[42:43], v[10:11], v[42:43]
    buffer_load_dwordx4 a[148:151], v209, s[20:23], s100 offen offset:2048 sc1
    v_pk_fma_f32 v[228:229], v[228:229], v[218:219], v[218:219] op_sel_hi:[1,0,0]
    v_pk_fma_f32 v[230:231], v[230:231], v[218:219], v[218:219] op_sel_hi:[1,0,0]
    v_rcp_f32 v228, v228
    v_rcp_f32 v229, v229
    v_rcp_f32 v230, v230
    v_rcp_f32 v231, v231
    v_pk_mul_f32 v[40:41], v[40:41], v[228:229]
    v_pk_mul_f32 v[42:43], v[42:43], v[230:231]
    v_cvt_pk_bf16_f32 v234, v40, v41
    v_cvt_pk_bf16_f32 v235, v42, v43
    v_pk_mul_f32 v[224:225], v[4:5], v[4:5]
    v_pk_mul_f32 v[226:227], v[6:7], v[6:7]
    buffer_load_dwordx4 a[152:155], v209, s[20:23], s100 offen offset:3072 sc1
    v_permlane16_swap_b32 v232, v234
    v_permlane16_swap_b32 v233, v235
    buffer_store_dwordx4 v[232:235], v152, s[20:23], s62 offen offset:0 sc1
    v_pk_fma_f32 v[224:225], v[224:225], v[220:221], v[220:221] op_sel:[0,1,0] op_sel_hi:[1,1,0]
    v_pk_fma_f32 v[226:227], v[226:227], v[220:221], v[220:221] op_sel:[0,1,0] op_sel_hi:[1,1,0]
    v_pk_mul_f32 v[224:225], v[224:225], v[4:5]
    v_pk_mul_f32 v[226:227], v[226:227], v[6:7]
    v_exp_f32 v224, v224
    v_exp_f32 v225, v225
    v_exp_f32 v226, v226
    v_exp_f32 v227, v227
    v_pk_mul_f32 v[36:37], v[4:5], v[36:37]
    v_pk_mul_f32 v[38:39], v[6:7], v[38:39]
    v_pk_fma_f32 v[224:225], v[224:225], v[222:223], v[222:223] op_sel_hi:[1,0,0]
    v_pk_fma_f32 v[226:227], v[226:227], v[222:223], v[222:223] op_sel_hi:[1,0,0]
    v_rcp_f32 v224, v224
    v_rcp_f32 v225, v225
    v_rcp_f32 v226, v226
    buffer_load_dwordx4 a[156:159], v159, s[20:23], s100 offen offset:0 sc1
    v_rcp_f32 v227, v227
    v_pk_mul_f32 v[36:37], v[36:37], v[224:225]
    v_pk_mul_f32 v[38:39], v[38:39], v[226:227]
    v_cvt_pk_bf16_f32 v236, v36, v37
    v_cvt_pk_bf16_f32 v237, v38, v39
    v_pk_mul_f32 v[228:229], v[12:13], v[12:13]
    s_waitcnt vmcnt(7)
    v_cmp_ne_u32 vcc, v146, v145
    s_nop 3
    s_cmp_eq_u64 vcc, 0
    s_cselect_b32 s53, s53, 1073741824
    v_pk_mul_f32 v[230:231], v[14:15], v[14:15]
    v_pk_fma_f32 v[228:229], v[228:229], v[220:221], v[220:221] op_sel:[0,1,0] op_sel_hi:[1,1,0]
    v_pk_fma_f32 v[230:231], v[230:231], v[220:221], v[220:221] op_sel:[0,1,0] op_sel_hi:[1,1,0]
    v_pk_mul_f32 v[228:229], v[228:229], v[12:13]
    v_pk_mul_f32 v[230:231], v[230:231], v[14:15]
    v_exp_f32 v228, v228
    s_add_u32 s59, s53, 0
    buffer_load_dwordx4 v[160:163], v148, s[20:23], s59 offen sc1
    v_exp_f32 v229, v229
    v_exp_f32 v230, v230
    v_exp_f32 v231, v231
    v_pk_mul_f32 v[44:45], v[12:13], v[44:45]
    s_waitcnt vmcnt(7)
    s_nop 0
P_k2_chk:
    v_cmp_ne_u32 vcc, v147, v145
    s_nop 4
    s_cbranch_vccnz P_k2_slow
P_k2_done:
    s_mov_b32 s56, m0
    s_lshl_b32 s50, s40, 10
    s_add_u32 m0, s50, 151552
    s_nop 0
    buffer_load_dwordx4 v209, s[20:23], s77 offen sc1 lds
    s_mov_b32 m0, s56
    v_pk_mul_f32 v[46:47], v[14:15], v[46:47]
    v_pk_fma_f32 v[228:229], v[228:229], v[222:223], v[222:223] op_sel_hi:[1,0,0]
    v_pk_fma_f32 v[230:231], v[230:231], v[222:223], v[222:223] op_sel_hi:[1,0,0]
    v_rcp_f32 v228, v228
    v_rcp_f32 v229, v229
    v_rcp_f32 v230, v230
    v_rcp_f32 v231, v231
    v_pk_mul_f32 v[44:45], v[44:45], v[228:229]
    v_pk_mul_f32 v[46:47], v[46:47], v[230:231]
    v_cvt_pk_bf16_f32 v238, v44, v45
    buffer_load_dwordx4 v[164:167], v149, s[20:23], s59 offen sc1
    v_cvt_pk_bf16_f32 v239, v46, v47
    v_pk_mul_f32 v[224:225], v[16:17], v[16:17]
    v_pk_mul_f32 v[226:227], v[18:19], v[18:19]
    v_permlane16_swap_b32 v236, v238
    v_permlane16_swap_b32 v237, v239
    buffer_store_dwordx4 v[236:239], v152, s[20:23], s62 offen offset:256 sc1
    v_pk_fma_f32 v[224:225], v[224:225], v[216:217], v[216:217] op_sel:[0,1,0] op_sel_hi:[1,1,0]
    v_pk_fma_f32 v[226:227], v[226:227], v[216:217], v[216:217] op_sel:[0,1,0] op_sel_hi:[1,1,0]
    v_pk_mul_f32 v[224:225], v[224:225], v[16:17]
    v_pk_mul_f32 v[226:227], v[226:227], v[18:19]
    v_exp_f32 v224, v224
    v_exp_f32 v225, v225
    v_exp_f32 v226, v226
    v_exp_f32 v227, v227
    v_pk_mul_f32 v[48:49], v[16:17], v[48:49]
    v_pk_mul_f32 v[50:51], v[18:19], v[50:51]
    v_pk_fma_f32 v[224:225], v[224:225], v[218:219], v[218:219] op_sel_hi:[1,0,0]
    v_pk_fma_f32 v[226:227], v[226:227], v[218:219], v[218:219] op_sel_hi:[1,0,0]
    v_rcp_f32 v224, v224
    buffer_load_dwordx4 v[168:171], v150, s[20:23], s59 offen sc1
    v_rcp_f32 v225, v225
    v_rcp_f32 v226, v226
    v_rcp_f32 v227, v227
    v_pk_mul_f32 v[48:49], v[48:49], v[224:225]
    v_pk_mul_f32 v[50:51], v[50:51], v[226:227]
    v_cvt_pk_bf16_f32 v232, v48, v49
    v_cvt_pk_bf16_f32 v233, v50, v51
    v_pk_mul_f32 v[228:229], v[24:25], v[24:25]
    v_pk_mul_f32 v[230:231], v[26:27], v[26:27]
    v_pk_fma_f32 v[228:229], v[228:229], v[216:217], v[216:217] op_sel:[0,1,0] op_sel_hi:[1,1,0]
    v_pk_fma_f32 v[230:231], v[230:231], v[216:217], v[216:217] op_sel:[0,1,0] op_sel_hi:[1,1,0]
    v_pk_mul_f32 v[228:229], v[228:229], v[24:25]
    v_pk_mul_f32 v[230:231], v[230:231], v[26:27]
    buffer_load_dwordx4 v[172:175], v151, s[20:23], s59 offen sc1
    v_exp_f32 v228, v228
    v_exp_f32 v229, v229
    v_exp_f32 v230, v230
    v_exp_f32 v231, v231
    v_pk_mul_f32 v[56:57], v[24:25], v[56:57]
    v_pk_mul_f32 v[58:59], v[26:27], v[58:59]
    v_pk_fma_f32 v[228:229], v[228:229], v[218:219], v[218:219] op_sel_hi:[1,0,0]
    v_pk_fma_f32 v[230:231], v[230:231], v[218:219], v[218:219] op_sel_hi:[1,0,0]
    v_rcp_f32 v228, v228
    v_rcp_f32 v229, v229
    v_rcp_f32 v230, v230
    s_add_u32 s59, s53, 2048
    buffer_load_dwordx4 v[176:179], v148, s[20:23], s59 offen sc1
    v_rcp_f32 v231, v231
    v_pk_mul_f32 v[56:57], v[56:57], v[228:229]
    v_pk_mul_f32 v[58:59], v[58:59], v[230:231]
    v_cvt_pk_bf16_f32 v234, v56, v57
    v_cvt_pk_bf16_f32 v235, v58, v59
    v_pk_mul_f32 v[224:225], v[20:21], v[20:21]
    v_pk_mul_f32 v[226:227], v[22:23], v[22:23]
    v_permlane16_swap_b32 v232, v234
    v_permlane16_swap_b32 v233, v235
    buffer_store_dwordx4 v[232:235], v153, s[20:23], s62 offen offset:0 sc1
    v_pk_fma_f32 v[224:225], v[224:225], v[220:221], v[220:221] op_sel:[0,1,0] op_sel_hi:[1,1,0]
    v_pk_fma_f32 v[226:227], v[226:227], v[220:221], v[220:221] op_sel:[0,1,0] op_sel_hi:[1,1,0]
    v_pk_mul_f32 v[224:225], v[224:225], v[20:21]
    v_pk_mul_f32 v[226:227], v[226:227], v[22:23]
    v_exp_f32 v224, v224
    v_exp_f32 v225, v225
    v_exp_f32 v226, v226
    v_exp_f32 v227, v227
    buffer_load_dwordx4 v[180:183], v149, s[20:23], s59 offen sc1
    v_pk_mul_f32 v[52:53], v[20:21], v[52:53]
    v_pk_mul_f32 v[54:55], v[22:23], v[54:55]
    v_pk_fma_f32 v[224:225], v[224:225], v[222:223], v[222:223] op_sel_hi:[1,0,0]
    v_pk_fma_f32 v[226:227], v[226:227], v[222:223], v[222:223] op_sel_hi:[1,0,0]
    v_rcp_f32 v224, v224
    v_rcp_f32 v225, v225
    v_rcp_f32 v226, v226
    v_rcp_f32 v227, v227
    v_pk_mul_f32 v[52:53], v[52:53], v[224:225]
    v_pk_mul_f32 v[54:55], v[54:55], v[226:227]
    v_cvt_pk_bf16_f32 v236, v52, v53
    v_cvt_pk_bf16_f32 v237, v54, v55
    buffer_load_dwordx4 v[184:187], v150, s[20:23], s59 offen sc1
    v_pk_mul_f32 v[228:229], v[28:29], v[28:29]
    v_pk_mul_f32 v[230:231], v[30:31], v[30:31]
    v_pk_fma_f32 v[228:229], v[228:229], v[220:221], v[220:221] op_sel:[0,1,0] op_sel_hi:[1,1,0]
    v_pk_fma_f32 v[230:231], v[230:231], v[220:221], v[220:221] op_sel:[0,1,0] op_sel_hi:[1,1,0]
    v_pk_mul_f32 v[228:229], v[228:229], v[28:29]
    v_pk_mul_f32 v[230:231], v[230:231], v[30:31]
    v_exp_f32 v228, v228
    v_exp_f32 v229, v229
    v_exp_f32 v230, v230
    v_exp_f32 v231, v231
    v_pk_mul_f32 v[60:61], v[28:29], v[60:61]
    v_pk_mul_f32 v[62:63], v[30:31], v[62:63]
    buffer_load_dwordx4 v[188:191], v151, s[20:23], s59 offen sc1
    v_pk_fma_f32 v[228:229], v[228:229], v[222:223], v[222:223] op_sel_hi:[1,0,0]
    v_pk_fma_f32 v[230:231], v[230:231], v[222:223], v[222:223] op_sel_hi:[1,0,0]
    v_rcp_f32 v228, v228
    v_rcp_f32 v229, v229
    v_rcp_f32 v230, v230
    v_rcp_f32 v231, v231
    v_pk_mul_f32 v[60:61], v[60:61], v[228:229]
    v_pk_mul_f32 v[62:63], v[62:63], v[230:231]
    v_cvt_pk_bf16_f32 v238, v60, v61
    v_cvt_pk_bf16_f32 v239, v62, v63
    s_nop 0
    v_permlane16_swap_b32 v236, v238
    v_permlane16_swap_b32 v237, v239
    s_add_u32 s59, s53, 4096
    buffer_load_dwordx4 v[192:195], v148, s[20:23], s59 offen sc1
    buffer_store_dwordx4 v[236:239], v153, s[20:23], s62 offen offset:256 sc1
    v_mov_b32 v220, v140
    v_mov_b32 v221, v141
    v_mov_b32 v222, v142
    v_mov_b32 v223, v143
    buffer_load_dwordx4 v[196:199], v149, s[20:23], s59 offen sc1
    buffer_load_dwordx4 v[200:203], v150, s[20:23], s59 offen sc1
    buffer_load_dwordx4 v[204:207], v151, s[20:23], s59 offen sc1
    s_cmp_ge_u32 s101, 1073741824
    s_cbranch_scc1 FB_w
FB_w_done:
    s_cmp_ge_u32 s53, 1073741824
    s_cbranch_scc1 FB_he
FB_he_done:
    v_max3_f32 v52, v80, v81, v82
    v_min3_f32 v53, v80, v81, v82
    v_max3_f32 v52, v52, v83, v84
    v_min3_f32 v53, v53, v83, v84
    v_max3_f32 v52, v52, v85, v86
    v_min3_f32 v53, v53, v85, v86
    v_max3_f32 v52, v52, v87, v88
    v_min3_f32 v53, v53, v87, v88
    v_max3_f32 v52, v52, v89, v90
    v_min3_f32 v53, v53, v89, v90
    v_max3_f32 v52, v52, v91, v92
    v_min3_f32 v53, v53, v91, v92
    v_max3_f32 v52, v52, v93, v94
    v_min3_f32 v53, v53, v93, v94
    v_max3_f32 v52, v52, v95, v96
    v_min3_f32 v53, v53, v95, v96
    s_add_u32 s59, s53, 6144
    buffer_load_dwordx4 v[224:227], v148, s[20:23], s59 offen sc1
    v_max3_f32 v52, v52, v97, v98
    v_min3_f32 v53, v53, v97, v98
    v_max_f32 v52, v52, v99
    v_min_f32 v53, v53, v99
    v_pk_add_f32 v[32:33], v[80:81], v[52:53] op_sel_hi:[1,0] neg_lo:[0,1] neg_hi:[0,1]
    v_pk_add_f32 v[80:81], v[52:53], v[80:81] op_sel:[1,0] neg_lo:[0,1] neg_hi:[0,1]
    v_exp_f32 v32, v32
    v_exp_f32 v33, v33
    v_exp_f32 v80, v80
    v_exp_f32 v81, v81
    v_pk_add_f32 v[34:35], v[82:83], v[52:53] op_sel_hi:[1,0] neg_lo:[0,1] neg_hi:[0,1]
    v_pk_add_f32 v[82:83], v[52:53], v[82:83] op_sel:[1,0] neg_lo:[0,1] neg_hi:[0,1]
    v_exp_f32 v34, v34
    v_exp_f32 v35, v35
    buffer_load_dwordx4 v[228:231], v149, s[20:23], s59 offen sc1
    v_exp_f32 v82, v82
    v_exp_f32 v83, v83
    v_pk_add_f32 v[36:37], v[84:85], v[52:53] op_sel_hi:[1,0] neg_lo:[0,1] neg_hi:[0,1]
    v_pk_add_f32 v[84:85], v[52:53], v[84:85] op_sel:[1,0] neg_lo:[0,1] neg_hi:[0,1]
    v_exp_f32 v36, v36
    v_exp_f32 v37, v37
    v_exp_f32 v84, v84
    v_exp_f32 v85, v85
    v_pk_add_f32 v[54:55], v[32:33], v[34:35]
    v_pk_add_f32 v[56:57], v[80:81], v[82:83]
    v_pk_add_f32 v[38:39], v[86:87], v[52:53] op_sel_hi:[1,0] neg_lo:[0,1] neg_hi:[0,1]
    v_pk_add_f32 v[86:87], v[52:53], v[86:87] op_sel:[1,0] neg_lo:[0,1] neg_hi:[0,1]
    v_exp_f32 v38, v38
    buffer_load_dwordx4 v[232:235], v150, s[20:23], s59 offen sc1
    v_exp_f32 v39, v39
    v_exp_f32 v86, v86
    v_exp_f32 v87, v87
    v_pk_add_f32 v[54:55], v[54:55], v[36:37]
    v_pk_add_f32 v[56:57], v[56:57], v[84:85]
    v_pk_add_f32 v[40:41], v[88:89], v[52:53] op_sel_hi:[1,0] neg_lo:[0,1] neg_hi:[0,1]
    v_pk_add_f32 v[88:89], v[52:53], v[88:89] op_sel:[1,0] neg_lo:[0,1] neg_hi:[0,1]
    v_exp_f32 v40, v40
    v_exp_f32 v41, v41
    v_exp_f32 v88, v88
    v_exp_f32 v89, v89
    v_pk_add_f32 v[54:55], v[54:55], v[38:39]
    buffer_load_dwordx4 v[236:239], v151, s[20:23], s59 offen sc1
    v_pk_add_f32 v[56:57], v[56:57], v[86:87]
    v_pk_add_f32 v[42:43], v[90:91], v[52:53] op_sel_hi:[1,0] neg_lo:[0,1] neg_hi:[0,1]
    v_pk_add_f32 v[90:91], v[52:53], v[90:91] op_sel:[1,0] neg_lo:[0,1] neg_hi:[0,1]
    v_exp_f32 v42, v42
    v_exp_f32 v43, v43
    s_waitcnt vmcnt(18)
    s_barrier
    ds_read_b128 v[104:107], v212 offset:0
    ds_read_b128 v[108:111], v213 offset:0
    ds_read_b128 v[112:115], v212 offset:336
    ds_read_b128 v[116:119], v213 offset:336
    s_add_u32 s59, s53, 8192
    s_cmp_lt_u32 s40, 3
    s_cselect_b32 s59, s59, 1073741824
    buffer_load_dwordx4 v[240:243], v148, s[20:23], s59 offen sc1
    ds_read_b128 v[120:123], v212 offset:672
    ds_read_b128 v[124:127], v213 offset:672
    ds_read_b128 v[128:131], v212 offset:1008
    ds_read_b128 v[132:135], v213 offset:1008
    ds_read_b128 v[136:139], v212 offset:1344
    ds_read_b128 v[140:143], v213 offset:1344
    v_exp_f32 v90, v90
    v_exp_f32 v91, v91
    v_pk_add_f32 v[54:55], v[54:55], v[40:41]
    v_pk_add_f32 v[56:57], v[56:57], v[88:89]
    v_pk_add_f32 v[44:45], v[92:93], v[52:53] op_sel_hi:[1,0] neg_lo:[0,1] neg_hi:[0,1]
    v_pk_add_f32 v[92:93], v[52:53], v[92:93] op_sel:[1,0] neg_lo:[0,1] neg_hi:[0,1]
    v_exp_f32 v44, v44
    v_exp_f32 v45, v45
    buffer_load_dwordx4 v[244:247], v149, s[20:23], s59 offen sc1
    v_exp_f32 v92, v92
    v_exp_f32 v93, v93
    v_pk_add_f32 v[54:55], v[54:55], v[42:43]
    v_pk_add_f32 v[56:57], v[56:57], v[90:91]
    v_pk_add_f32 v[46:47], v[94:95], v[52:53] op_sel_hi:[1,0] neg_lo:[0,1] neg_hi:[0,1]
    v_pk_add_f32 v[94:95], v[52:53], v[94:95] op_sel:[1,0] neg_lo:[0,1] neg_hi:[0,1]
    v_exp_f32 v46, v46
    v_exp_f32 v47, v47
    v_exp_f32 v94, v94
    v_exp_f32 v95, v95
    v_pk_add_f32 v[54:55], v[54:55], v[44:45]
    v_pk_add_f32 v[56:57], v[56:57], v[92:93]
    v_pk_add_f32 v[48:49], v[96:97], v[52:53] op_sel_hi:[1,0] neg_lo:[0,1] neg_hi:[0,1]
    buffer_load_dwordx4 v[248:251], v150, s[20:23], s59 offen sc1
    v_pk_add_f32 v[96:97], v[52:53], v[96:97] op_sel:[1,0] neg_lo:[0,1] neg_hi:[0,1]
    v_exp_f32 v48, v48
    v_exp_f32 v49, v49
    v_exp_f32 v96, v96
    v_exp_f32 v97, v97
    v_pk_add_f32 v[54:55], v[54:55], v[46:47]
    v_pk_add_f32 v[56:57], v[56:57], v[94:95]
    v_pk_add_f32 v[50:51], v[98:99], v[52:53] op_sel_hi:[1,0] neg_lo:[0,1] neg_hi:[0,1]
    v_pk_add_f32 v[98:99], v[52:53], v[98:99] op_sel:[1,0] neg_lo:[0,1] neg_hi:[0,1]
    v_exp_f32 v50, v50
    v_exp_f32 v51, v51
    v_exp_f32 v98, v98
    buffer_load_dwordx4 v[252:255], v151, s[20:23], s59 offen sc1
    v_exp_f32 v99, v99
    v_pk_add_f32 v[54:55], v[54:55], v[48:49]
    v_pk_add_f32 v[56:57], v[56:57], v[96:97]
    v_pk_add_f32 v[54:55], v[54:55], v[50:51]
    v_pk_add_f32 v[56:57], v[56:57], v[98:99]
    v_add_f32 v54, v54, v55
    v_add_f32 v56, v56, v57
    v_rcp_f32 v54, v54
    v_rcp_f32 v56, v56
    v_pk_mul_f32 v[32:33], v[32:33], v[54:55] op_sel_hi:[1,0]
    v_pk_mul_f32 v[34:35], v[34:35], v[54:55] op_sel_hi:[1,0]
    v_pk_mul_f32 v[36:37], v[36:37], v[54:55] op_sel_hi:[1,0]
    v_pk_mul_f32 v[38:39], v[38:39], v[54:55] op_sel_hi:[1,0]
    v_pk_mul_f32 v[40:41], v[40:41], v[54:55] op_sel_hi:[1,0]
    v_pk_mul_f32 v[42:43], v[42:43], v[54:55] op_sel_hi:[1,0]
    s_add_u32 s45, s0, 15360
    s_add_u32 m0, s58, 20480
    s_nop 0
    buffer_load_dwordx4 v209, s[20:23], s45 offen offset:0 sc1 lds
    v_pk_mul_f32 v[44:45], v[44:45], v[54:55] op_sel_hi:[1,0]
    v_pk_mul_f32 v[46:47], v[46:47], v[54:55] op_sel_hi:[1,0]
    v_pk_mul_f32 v[48:49], v[48:49], v[54:55] op_sel_hi:[1,0]
    v_pk_mul_f32 v[50:51], v[50:51], v[54:55] op_sel_hi:[1,0]
    v_pk_mul_f32 v[80:81], v[80:81], v[56:57] op_sel_hi:[1,0]
    v_pk_mul_f32 v[82:83], v[82:83], v[56:57] op_sel_hi:[1,0]
    v_pk_mul_f32 v[84:85], v[84:85], v[56:57] op_sel_hi:[1,0]
    v_pk_mul_f32 v[86:87], v[86:87], v[56:57] op_sel_hi:[1,0]
    v_pk_mul_f32 v[88:89], v[88:89], v[56:57] op_sel_hi:[1,0]
    v_pk_mul_f32 v[90:91], v[90:91], v[56:57] op_sel_hi:[1,0]
    v_pk_mul_f32 v[92:93], v[92:93], v[56:57] op_sel_hi:[1,0]
    v_pk_mul_f32 v[94:95], v[94:95], v[56:57] op_sel_hi:[1,0]
    s_waitcnt vmcnt(12)
    buffer_store_dword v145, v144, s[20:23], s47 offen sc1
    v_pk_mul_f32 v[96:97], v[96:97], v[56:57] op_sel_hi:[1,0]
    v_pk_mul_f32 v[98:99], v[98:99], v[56:57] op_sel_hi:[1,0]
    v_cvt_pk_bf16_f32 v60, v32, v33
    v_cvt_pk_bf16_f32 v61, v34, v35
    v_cvt_pk_bf16_f32 v62, v36, v37
    v_cvt_pk_bf16_f32 v63, v38, v39
    v_cvt_pk_bf16_f32 v64, v40, v41
    v_cvt_pk_bf16_f32 v65, v42, v43
    v_cvt_pk_bf16_f32 v66, v44, v45
    v_cvt_pk_bf16_f32 v67, v46, v47
    buffer_load_dwordx4 v209, s[20:23], s45 offen offset:1024 sc1 lds
    v_cvt_pk_bf16_f32 v68, v48, v49
    v_cvt_pk_bf16_f32 v69, v50, v51
    v_cvt_pk_bf16_f32 v70, v80, v81
    v_cvt_pk_bf16_f32 v71, v82, v83
    v_cvt_pk_bf16_f32 v72, v84, v85
    v_cvt_pk_bf16_f32 v73, v86, v87
    v_cvt_pk_bf16_f32 v74, v88, v89
    v_cvt_pk_bf16_f32 v75, v90, v91
    v_cvt_pk_bf16_f32 v76, v92, v93
    v_cvt_pk_bf16_f32 v77, v94, v95
    v_cvt_pk_bf16_f32 v78, v96, v97
    v_cvt_pk_bf16_f32 v79, v98, v99
    s_waitcnt lgkmcnt(0)
    v_mfma_f32_32x32x16_bf16 v[0:15], v[104:107], v[60:63], 0
    v_add_u32 v153, 10240, v220
    v_add_u32 v154, 20480, v220
    v_add_u32 v155, 30720, v220
    v_add_u32 v212, 152576, v209
    buffer_load_dwordx4 v209, s[20:23], s45 offen offset:2048 sc1 lds
    v_mfma_f32_32x32x16_bf16 v[16:31], v[108:111], v[60:63], 0
    ds_read_b128 v[216:219], v212 offset:5120
    s_add_u32 s70, s58, 102400
    v_add_u32 v210, s70, v209
    v_add_u32 v211, 65536, v209
    v_mfma_f32_32x32x16_bf16 v[0:15], v[112:115], v[64:67], v[0:15]
    s_mov_b32 s4, s30
    s_mov_b32 s5, s31
    s_mov_b32 s6, 2621440
    s_xor_b32 s74, s40, 1
    v_mfma_f32_32x32x16_bf16 v[16:31], v[116:119], v[64:67], v[16:31]
    s_mul_i32 s74, s74, 15360
    s_add_u32 s74, s74, 102400
    v_add_u32 v152, s74, v209
    s_xor_b32 s74, s40, 2
    v_mfma_f32_32x32x16_bf16 v[0:15], v[120:123], v[68:71], v[0:15]
    s_mul_i32 s74, s74, 15360
    s_add_u32 s74, s74, 107520
    v_add_u32 v212, s74, v209
    s_xor_b32 s74, s40, 3
    v_mfma_f32_32x32x16_bf16 v[16:31], v[124:127], v[68:71], v[16:31]
    s_mul_i32 s74, s74, 15360
    s_add_u32 s74, s74, 112640
    buffer_load_dwordx4 v209, s[20:23], s45 offen offset:3072 sc1 lds
    v_add_u32 v213, s74, v209
    s_lshl_b32 s46, s54, 2
    v_mfma_f32_32x32x16_bf16 v[0:15], v[128:131], v[72:75], v[0:15]
    s_add_u32 s46, s46, s40
    s_mul_i32 s46, s46, 20480
    s_mul_i32 s74, s55, 160
    s_add_u32 s46, s46, s74
    v_mfma_f32_32x32x16_bf16 v[16:31], v[132:135], v[72:75], v[16:31]
    s_mul_i32 s74, s40, 15360
    v_add_u32 v208, s74, v209
    v_add_u32 v208, 102400, v208
    s_waitcnt lgkmcnt(0)
    v_mfma_f32_32x32x16_bf16 v[0:15], v[136:139], v[76:79], v[0:15]
    v_add_u32 v216, s74, v216
    v_add_u32 v217, s74, v217
    v_add_u32 v218, s74, v218
    v_add_u32 v219, s74, v219
    v_mfma_f32_32x32x16_bf16 v[16:31], v[140:143], v[76:79], v[16:31]
    s_nop 11
    v_add_f32 v20, 0x358637bd, v20
    v_rcp_f32 v20, v20
    s_nop 0
    v_pk_mul_f32 v[0:1], v[0:1], v[20:21] op_sel_hi:[1,0]
    v_pk_mul_f32 v[2:3], v[2:3], v[20:21] op_sel_hi:[1,0]
    s_add_u32 s59, s53, 10240
    s_cmp_lt_u32 s40, 3
    s_cselect_b32 s59, s59, 1073741824
    buffer_load_dwordx4 v[128:131], v148, s[20:23], s59 offen sc1
    v_pk_mul_f32 v[4:5], v[4:5], v[20:21] op_sel_hi:[1,0]
    v_pk_mul_f32 v[6:7], v[6:7], v[20:21] op_sel_hi:[1,0]
    v_pk_mul_f32 v[8:9], v[8:9], v[20:21] op_sel_hi:[1,0]
    v_pk_mul_f32 v[10:11], v[10:11], v[20:21] op_sel_hi:[1,0]
    v_pk_mul_f32 v[12:13], v[12:13], v[20:21] op_sel_hi:[1,0]
    v_pk_mul_f32 v[14:15], v[14:15], v[20:21] op_sel_hi:[1,0]
    v_pk_mul_f32 v[16:17], v[16:17], v[20:21] op_sel_hi:[1,0]
    v_pk_mul_f32 v[18:19], v[18:19], v[20:21] op_sel_hi:[1,0]
    v_cvt_pk_bf16_f32 v84, v0, v1
    v_cvt_pk_bf16_f32 v85, v2, v3
    v_cvt_pk_bf16_f32 v86, v4, v5
    v_cvt_pk_bf16_f32 v87, v6, v7
    v_cvt_pk_bf16_f32 v88, v8, v9
    v_cvt_pk_bf16_f32 v89, v10, v11
    v_cvt_pk_bf16_f32 v90, v12, v13
    v_cvt_pk_bf16_f32 v91, v14, v15
    buffer_load_dwordx4 v[132:135], v149, s[20:23], s59 offen sc1
    v_cvt_pk_bf16_f32 v92, v16, v17
    v_cvt_pk_bf16_f32 v93, v18, v19
    buffer_store_dwordx4 v[84:87], v214, s[20:23], s57 offen sc1
    buffer_store_dwordx4 v[88:91], v214, s[20:23], s57 offen offset:512 sc1
    buffer_store_dwordx2 v[92:93], v215, s[20:23], s57 offen offset:1024 sc1
    v_mfma_f32_16x16x32_bf16 v[0:3], a[160:163], v[160:163], 0
    s_add_u32 m0, s58, 24576
    s_nop 0
    buffer_load_dwordx4 v159, s[20:23], s45 offen offset:0 sc1 lds
    v_mfma_f32_16x16x32_bf16 v[4:7], a[164:167], v[160:163], 0
    v_mfma_f32_16x16x32_bf16 v[8:11], a[168:171], v[160:163], 0
    v_mfma_f32_16x16x32_bf16 v[12:15], a[172:175], v[160:163], 0
    v_mfma_f32_16x16x32_bf16 v[16:19], a[176:179], v[160:163], 0
    s_add_u32 s45, s0, 20480
    s_add_u32 m0, s58, 0
    s_nop 0
    buffer_load_dwordx4 v209, s[20:23], s45 offen offset:0 sc1 lds
    v_mfma_f32_16x16x32_bf16 v[20:23], a[160:163], v[164:167], 0
    v_mfma_f32_16x16x32_bf16 v[24:27], a[164:167], v[164:167], 0
    v_mfma_f32_16x16x32_bf16 v[28:31], a[168:171], v[164:167], 0
    buffer_load_dwordx4 v209, s[20:23], s45 offen offset:1024 sc1 lds
    v_mfma_f32_16x16x32_bf16 v[32:35], a[172:175], v[164:167], 0
    v_mfma_f32_16x16x32_bf16 v[36:39], a[176:179], v[164:167], 0
    v_mfma_f32_16x16x32_bf16 v[40:43], a[160:163], v[168:171], 0
    buffer_load_dwordx4 v209, s[20:23], s45 offen offset:2048 sc1 lds
    v_mfma_f32_16x16x32_bf16 v[44:47], a[164:167], v[168:171], 0
    v_mfma_f32_16x16x32_bf16 v[48:51], a[168:171], v[168:171], 0
    v_mfma_f32_16x16x32_bf16 v[52:55], a[172:175], v[168:171], 0
    v_mfma_f32_16x16x32_bf16 v[56:59], a[176:179], v[168:171], 0
    buffer_load_dwordx4 v209, s[20:23], s45 offen offset:3072 sc1 lds
    v_mfma_f32_16x16x32_bf16 v[60:63], a[160:163], v[172:175], 0
    v_mfma_f32_16x16x32_bf16 v[64:67], a[164:167], v[172:175], 0
    v_mfma_f32_16x16x32_bf16 v[68:71], a[168:171], v[172:175], 0
    s_add_u32 m0, s58, 4096
    s_nop 0
    buffer_load_dwordx4 v159, s[20:23], s45 offen offset:0 sc1 lds
    v_mfma_f32_16x16x32_bf16 v[72:75], a[172:175], v[172:175], 0
    v_mfma_f32_16x16x32_bf16 v[76:79], a[176:179], v[172:175], 0
    v_mfma_f32_16x16x32_bf16 v[0:3], a[180:183], v[176:179], v[0:3]
    buffer_load_dwordx4 v[136:139], v150, s[20:23], s59 offen sc1
    ds_read_b128 a[160:163], v210 offset:0
    v_mfma_f32_16x16x32_bf16 v[4:7], a[184:187], v[176:179], v[4:7]
    v_mfma_f32_16x16x32_bf16 v[8:11], a[188:191], v[176:179], v[8:11]
    v_mfma_f32_16x16x32_bf16 v[12:15], a[192:195], v[176:179], v[12:15]
    v_mfma_f32_16x16x32_bf16 v[16:19], a[196:199], v[176:179], v[16:19]
    buffer_load_dwordx4 v[140:143], v151, s[20:23], s59 offen sc1
    ds_read_b128 a[164:167], v210 offset:1024
    v_mfma_f32_16x16x32_bf16 v[20:23], a[180:183], v[180:183], v[20:23]
    v_mfma_f32_16x16x32_bf16 v[24:27], a[184:187], v[180:183], v[24:27]
    v_mfma_f32_16x16x32_bf16 v[28:31], a[188:191], v[180:183], v[28:31]
    v_mfma_f32_16x16x32_bf16 v[32:35], a[192:195], v[180:183], v[32:35]
    ds_read_b128 a[168:171], v210 offset:2048
    v_mfma_f32_16x16x32_bf16 v[36:39], a[196:199], v[180:183], v[36:39]
    v_mfma_f32_16x16x32_bf16 v[40:43], a[180:183], v[184:187], v[40:43]
    v_mfma_f32_16x16x32_bf16 v[44:47], a[184:187], v[184:187], v[44:47]
    v_mfma_f32_16x16x32_bf16 v[48:51], a[188:191], v[184:187], v[48:51]
    ds_read_b128 a[172:175], v210 offset:3072
    v_mfma_f32_16x16x32_bf16 v[52:55], a[192:195], v[184:187], v[52:55]
    v_mfma_f32_16x16x32_bf16 v[56:59], a[196:199], v[184:187], v[56:59]
    v_mfma_f32_16x16x32_bf16 v[60:63], a[180:183], v[188:191], v[60:63]
    v_mfma_f32_16x16x32_bf16 v[64:67], a[184:187], v[188:191], v[64:67]
    ds_read_b128 a[176:179], v210 offset:4096
    v_mfma_f32_16x16x32_bf16 v[68:71], a[188:191], v[188:191], v[68:71]
    v_mfma_f32_16x16x32_bf16 v[72:75], a[192:195], v[188:191], v[72:75]
    v_mfma_f32_16x16x32_bf16 v[76:79], a[196:199], v[188:191], v[76:79]
    s_waitcnt vmcnt(2)
    s_barrier
    v_mfma_f32_16x16x32_bf16 v[0:3], a[200:203], v[192:195], v[0:3]
    buffer_load_dword v146, v156, s[20:23], s48 offen sc1
    v_mfma_f32_16x16x32_bf16 v[4:7], a[204:207], v[192:195], v[4:7]
    v_mfma_f32_16x16x32_bf16 v[8:11], a[208:211], v[192:195], v[8:11]
    v_mfma_f32_16x16x32_bf16 v[12:15], a[212:215], v[192:195], v[12:15]
    ds_read_b128 a[180:183], v210 offset:20480
    v_mfma_f32_16x16x32_bf16 v[16:19], a[216:219], v[192:195], v[16:19]
    v_mfma_f32_16x16x32_bf16 v[20:23], a[200:203], v[196:199], v[20:23]
    v_mfma_f32_16x16x32_bf16 v[24:27], a[204:207], v[196:199], v[24:27]
    ds_read_b128 a[184:187], v210 offset:21504
    v_mfma_f32_16x16x32_bf16 v[28:31], a[208:211], v[196:199], v[28:31]
    v_mfma_f32_16x16x32_bf16 v[32:35], a[212:215], v[196:199], v[32:35]
    v_mfma_f32_16x16x32_bf16 v[36:39], a[216:219], v[196:199], v[36:39]
    ds_read_b128 a[188:191], v210 offset:22528
    v_mfma_f32_16x16x32_bf16 v[40:43], a[200:203], v[200:203], v[40:43]
    v_mfma_f32_16x16x32_bf16 v[44:47], a[204:207], v[200:203], v[44:47]
    ds_read_b128 a[192:195], v210 offset:23552
    v_mfma_f32_16x16x32_bf16 v[48:51], a[208:211], v[200:203], v[48:51]
    v_mfma_f32_16x16x32_bf16 v[52:55], a[212:215], v[200:203], v[52:55]
    v_mfma_f32_16x16x32_bf16 v[56:59], a[216:219], v[200:203], v[56:59]
    ds_read_b128 a[196:199], v210 offset:24576
    v_mfma_f32_16x16x32_bf16 v[60:63], a[200:203], v[204:207], v[60:63]
    v_mfma_f32_16x16x32_bf16 v[64:67], a[204:207], v[204:207], v[64:67]
    v_mfma_f32_16x16x32_bf16 v[68:71], a[208:211], v[204:207], v[68:71]
    buffer_store_dword v145, v144, s[20:23], s28 offen sc1
    v_mfma_f32_16x16x32_bf16 v[72:75], a[212:215], v[204:207], v[72:75]
    v_mfma_f32_16x16x32_bf16 v[76:79], a[216:219], v[204:207], v[76:79]
    v_mfma_f32_16x16x32_bf16 v[0:3], a[0:3], v[224:227], v[0:3]
    ds_read_b128 a[200:203], v211 offset:16384
    v_mfma_f32_16x16x32_bf16 v[4:7], a[4:7], v[224:227], v[4:7]
    v_mfma_f32_16x16x32_bf16 v[8:11], a[8:11], v[224:227], v[8:11]
    v_mfma_f32_16x16x32_bf16 v[12:15], a[12:15], v[224:227], v[12:15]
    v_mfma_f32_16x16x32_bf16 v[16:19], a[16:19], v[224:227], v[16:19]
    ds_read_b128 a[204:207], v211 offset:17408
    v_mfma_f32_16x16x32_bf16 v[20:23], a[0:3], v[228:231], v[20:23]
    v_mfma_f32_16x16x32_bf16 v[24:27], a[4:7], v[228:231], v[24:27]
    v_mfma_f32_16x16x32_bf16 v[28:31], a[8:11], v[228:231], v[28:31]
    v_mfma_f32_16x16x32_bf16 v[32:35], a[12:15], v[228:231], v[32:35]
    ds_read_b128 a[208:211], v211 offset:18432
    v_mfma_f32_16x16x32_bf16 v[36:39], a[16:19], v[228:231], v[36:39]
    v_mfma_f32_16x16x32_bf16 v[40:43], a[0:3], v[232:235], v[40:43]
    v_mfma_f32_16x16x32_bf16 v[44:47], a[4:7], v[232:235], v[44:47]
    v_mfma_f32_16x16x32_bf16 v[48:51], a[8:11], v[232:235], v[48:51]
    ds_read_b128 a[212:215], v211 offset:19456
    v_mfma_f32_16x16x32_bf16 v[52:55], a[12:15], v[232:235], v[52:55]
    v_mfma_f32_16x16x32_bf16 v[56:59], a[16:19], v[232:235], v[56:59]
    v_mfma_f32_16x16x32_bf16 v[60:63], a[0:3], v[236:239], v[60:63]
    v_mfma_f32_16x16x32_bf16 v[64:67], a[4:7], v[236:239], v[64:67]
    ds_read_b128 a[216:219], v211 offset:20480
    v_mfma_f32_16x16x32_bf16 v[68:71], a[8:11], v[236:239], v[68:71]
    v_mfma_f32_16x16x32_bf16 v[72:75], a[12:15], v[236:239], v[72:75]
    v_mfma_f32_16x16x32_bf16 v[76:79], a[16:19], v[236:239], v[76:79]
    s_waitcnt vmcnt(1)
    s_nop 0
P_hl_chk:
    v_cmp_ne_u32 vcc, v146, v145
    s_nop 4
    s_cbranch_vccnz P_hl_slow
P_hl_done:
    v_mfma_f32_16x16x32_bf16 v[0:3], a[20:23], v[240:243], v[0:3]
    s_add_u32 s59, s76, 0
    buffer_load_dwordx4 v[112:115], v148, s[20:23], s59 offen sc1
    ds_read_b128 a[0:3], v211 offset:21504
    v_mfma_f32_16x16x32_bf16 v[4:7], a[24:27], v[240:243], v[4:7]
    v_mfma_f32_16x16x32_bf16 v[8:11], a[28:31], v[240:243], v[8:11]
    v_mfma_f32_16x16x32_bf16 v[12:15], a[32:35], v[240:243], v[12:15]
    v_mfma_f32_16x16x32_bf16 v[16:19], a[36:39], v[240:243], v[16:19]
    buffer_load_dwordx4 v[116:119], v149, s[20:23], s59 offen sc1
    ds_read_b128 a[4:7], v211 offset:22528
    v_mfma_f32_16x16x32_bf16 v[20:23], a[20:23], v[244:247], v[20:23]
    v_mfma_f32_16x16x32_bf16 v[24:27], a[24:27], v[244:247], v[24:27]
    v_mfma_f32_16x16x32_bf16 v[28:31], a[28:31], v[244:247], v[28:31]
    buffer_load_dwordx4 v[120:123], v150, s[20:23], s59 offen sc1
    v_mfma_f32_16x16x32_bf16 v[32:35], a[32:35], v[244:247], v[32:35]
    ds_read_b128 a[8:11], v211 offset:23552
    v_mfma_f32_16x16x32_bf16 v[36:39], a[36:39], v[244:247], v[36:39]
    v_mfma_f32_16x16x32_bf16 v[40:43], a[20:23], v[248:251], v[40:43]
    buffer_load_dwordx4 v[124:127], v151, s[20:23], s59 offen sc1
    v_mfma_f32_16x16x32_bf16 v[44:47], a[24:27], v[248:251], v[44:47]
    v_mfma_f32_16x16x32_bf16 v[48:51], a[28:31], v[248:251], v[48:51]
    ds_read_b128 a[12:15], v211 offset:24576
    v_mfma_f32_16x16x32_bf16 v[52:55], a[32:35], v[248:251], v[52:55]
    v_mfma_f32_16x16x32_bf16 v[56:59], a[36:39], v[248:251], v[56:59]
    s_add_u32 s59, s76, 2048
    buffer_load_dwordx4 v[96:99], v148, s[20:23], s59 offen sc1
    v_mfma_f32_16x16x32_bf16 v[60:63], a[20:23], v[252:255], v[60:63]
    v_mfma_f32_16x16x32_bf16 v[64:67], a[24:27], v[252:255], v[64:67]
    ds_read_b128 a[16:19], v211 offset:25600
    v_mfma_f32_16x16x32_bf16 v[68:71], a[28:31], v[252:255], v[68:71]
    buffer_load_dwordx4 v[100:103], v149, s[20:23], s59 offen sc1
    v_mfma_f32_16x16x32_bf16 v[72:75], a[32:35], v[252:255], v[72:75]
    v_mfma_f32_16x16x32_bf16 v[76:79], a[36:39], v[252:255], v[76:79]
    v_mfma_f32_16x16x32_bf16 v[0:3], a[40:43], v[128:131], v[0:3]
    buffer_load_dwordx4 v[104:107], v150, s[20:23], s59 offen sc1
    ds_read_b128 a[20:23], v211 offset:26624
    v_mfma_f32_16x16x32_bf16 v[4:7], a[44:47], v[128:131], v[4:7]
    v_mfma_f32_16x16x32_bf16 v[8:11], a[48:51], v[128:131], v[8:11]
    v_mfma_f32_16x16x32_bf16 v[12:15], a[52:55], v[128:131], v[12:15]
    v_mfma_f32_16x16x32_bf16 v[16:19], a[56:59], v[128:131], v[16:19]
    buffer_load_dwordx4 v[108:111], v151, s[20:23], s59 offen sc1
    ds_read_b128 a[24:27], v211 offset:27648
    v_mfma_f32_16x16x32_bf16 v[20:23], a[40:43], v[132:135], v[20:23]
    v_mfma_f32_16x16x32_bf16 v[24:27], a[44:47], v[132:135], v[24:27]
    v_mfma_f32_16x16x32_bf16 v[28:31], a[48:51], v[132:135], v[28:31]
    s_add_u32 s59, s76, 4096
    buffer_load_dwordx4 v[80:83], v148, s[20:23], s59 offen sc1
    v_mfma_f32_16x16x32_bf16 v[32:35], a[52:55], v[132:135], v[32:35]
    ds_read_b128 a[28:31], v211 offset:28672
    v_mfma_f32_16x16x32_bf16 v[36:39], a[56:59], v[132:135], v[36:39]
    v_mfma_f32_16x16x32_bf16 v[40:43], a[40:43], v[136:139], v[40:43]
    buffer_load_dwordx4 v[84:87], v149, s[20:23], s59 offen sc1
    v_mfma_f32_16x16x32_bf16 v[44:47], a[44:47], v[136:139], v[44:47]
    v_mfma_f32_16x16x32_bf16 v[48:51], a[48:51], v[136:139], v[48:51]
    ds_read_b128 a[32:35], v211 offset:29696
    v_mfma_f32_16x16x32_bf16 v[52:55], a[52:55], v[136:139], v[52:55]
    v_mfma_f32_16x16x32_bf16 v[56:59], a[56:59], v[136:139], v[56:59]
    buffer_load_dwordx4 v[88:91], v150, s[20:23], s59 offen sc1
    v_mfma_f32_16x16x32_bf16 v[60:63], a[40:43], v[140:143], v[60:63]
    v_mfma_f32_16x16x32_bf16 v[64:67], a[44:47], v[140:143], v[64:67]
    ds_read_b128 a[36:39], v211 offset:30720
    v_mfma_f32_16x16x32_bf16 v[68:71], a[48:51], v[140:143], v[68:71]
    buffer_load_dwordx4 v[92:95], v151, s[20:23], s59 offen sc1
    v_mfma_f32_16x16x32_bf16 v[72:75], a[52:55], v[140:143], v[72:75]
    v_mfma_f32_16x16x32_bf16 v[76:79], a[56:59], v[140:143], v[76:79]
    s_waitcnt vmcnt(8)
    v_mfma_f32_16x16x32_bf16 v[0:3], a[60:63], v[112:115], v[0:3]
    s_add_u32 s59, s76, 6144
    buffer_load_dwordx4 v[160:163], v148, s[20:23], s59 offen sc1
    ds_read_b128 a[40:43], v211 offset:31744
    v_mfma_f32_16x16x32_bf16 v[4:7], a[64:67], v[112:115], v[4:7]
    v_mfma_f32_16x16x32_bf16 v[8:11], a[68:71], v[112:115], v[8:11]
    v_mfma_f32_16x16x32_bf16 v[12:15], a[72:75], v[112:115], v[12:15]
    v_mfma_f32_16x16x32_bf16 v[16:19], a[76:79], v[112:115], v[16:19]
    buffer_load_dwordx4 v[164:167], v149, s[20:23], s59 offen sc1
    ds_read_b128 a[44:47], v211 offset:32768
    v_mfma_f32_16x16x32_bf16 v[20:23], a[60:63], v[116:119], v[20:23]
    v_mfma_f32_16x16x32_bf16 v[24:27], a[64:67], v[116:119], v[24:27]
    v_mfma_f32_16x16x32_bf16 v[28:31], a[68:71], v[116:119], v[28:31]
    buffer_load_dwordx4 v[168:171], v150, s[20:23], s59 offen sc1
    v_mfma_f32_16x16x32_bf16 v[32:35], a[72:75], v[116:119], v[32:35]
    ds_read_b128 a[48:51], v211 offset:33792
    v_mfma_f32_16x16x32_bf16 v[36:39], a[76:79], v[116:119], v[36:39]
    v_mfma_f32_16x16x32_bf16 v[40:43], a[60:63], v[120:123], v[40:43]
    buffer_load_dwordx4 v[172:175], v151, s[20:23], s59 offen sc1
    v_mfma_f32_16x16x32_bf16 v[44:47], a[64:67], v[120:123], v[44:47]
    v_mfma_f32_16x16x32_bf16 v[48:51], a[68:71], v[120:123], v[48:51]
    ds_read_b128 a[52:55], v211 offset:34816
    v_mfma_f32_16x16x32_bf16 v[52:55], a[72:75], v[120:123], v[52:55]
    v_mfma_f32_16x16x32_bf16 v[56:59], a[76:79], v[120:123], v[56:59]
    s_add_u32 s59, s76, 8192
    buffer_load_dwordx4 v[176:179], v148, s[20:23], s59 offen sc1
    v_mfma_f32_16x16x32_bf16 v[60:63], a[60:63], v[124:127], v[60:63]
    v_mfma_f32_16x16x32_bf16 v[64:67], a[64:67], v[124:127], v[64:67]
    ds_read_b128 a[56:59], v211 offset:35840
    v_mfma_f32_16x16x32_bf16 v[68:71], a[68:71], v[124:127], v[68:71]
    buffer_load_dwordx4 v[180:183], v149, s[20:23], s59 offen sc1
    v_mfma_f32_16x16x32_bf16 v[72:75], a[72:75], v[124:127], v[72:75]
    v_mfma_f32_16x16x32_bf16 v[76:79], a[76:79], v[124:127], v[76:79]
    s_waitcnt vmcnt(10)
    v_mfma_f32_16x16x32_bf16 v[0:3], a[80:83], v[96:99], v[0:3]
    buffer_load_dwordx4 v[184:187], v150, s[20:23], s59 offen sc1
    buffer_load_dword v147, v157, s[20:23], s49 offen sc1
    v_mfma_f32_16x16x32_bf16 v[4:7], a[84:87], v[96:99], v[4:7]
    v_mfma_f32_16x16x32_bf16 v[8:11], a[88:91], v[96:99], v[8:11]
    v_mfma_f32_16x16x32_bf16 v[12:15], a[92:95], v[96:99], v[12:15]
    v_mfma_f32_16x16x32_bf16 v[16:19], a[96:99], v[96:99], v[16:19]
    buffer_load_dwordx4 v[188:191], v151, s[20:23], s59 offen sc1
    ds_read_b128 a[60:63], v209 offset:61440
    v_mfma_f32_16x16x32_bf16 v[20:23], a[80:83], v[100:103], v[20:23]
    v_mfma_f32_16x16x32_bf16 v[24:27], a[84:87], v[100:103], v[24:27]
    v_mfma_f32_16x16x32_bf16 v[28:31], a[88:91], v[100:103], v[28:31]
    s_add_u32 s59, s76, 10240
    buffer_load_dwordx4 v[192:195], v148, s[20:23], s59 offen sc1
    ds_read_b128 a[64:67], v209 offset:62464
    v_mfma_f32_16x16x32_bf16 v[32:35], a[92:95], v[100:103], v[32:35]
    v_mfma_f32_16x16x32_bf16 v[36:39], a[96:99], v[100:103], v[36:39]
    v_mfma_f32_16x16x32_bf16 v[40:43], a[80:83], v[104:107], v[40:43]
    buffer_load_dwordx4 v[196:199], v149, s[20:23], s59 offen sc1
    ds_read_b128 a[68:71], v209 offset:63488
    v_mfma_f32_16x16x32_bf16 v[44:47], a[84:87], v[104:107], v[44:47]
    v_mfma_f32_16x16x32_bf16 v[48:51], a[88:91], v[104:107], v[48:51]
    v_mfma_f32_16x16x32_bf16 v[52:55], a[92:95], v[104:107], v[52:55]
    ds_read_b128 a[72:75], v209 offset:64512
    v_mfma_f32_16x16x32_bf16 v[56:59], a[96:99], v[104:107], v[56:59]
    buffer_load_dwordx4 v[200:203], v150, s[20:23], s59 offen sc1
    v_mfma_f32_16x16x32_bf16 v[60:63], a[80:83], v[108:111], v[60:63]
    v_mfma_f32_16x16x32_bf16 v[64:67], a[84:87], v[108:111], v[64:67]
    ds_read_b128 a[76:79], v211 offset:0
    v_mfma_f32_16x16x32_bf16 v[68:71], a[88:91], v[108:111], v[68:71]
    buffer_load_dwordx4 v[204:207], v151, s[20:23], s59 offen sc1
    v_mfma_f32_16x16x32_bf16 v[72:75], a[92:95], v[108:111], v[72:75]
    v_mfma_f32_16x16x32_bf16 v[76:79], a[96:99], v[108:111], v[76:79]
    s_waitcnt vmcnt(13)
    v_mfma_f32_16x16x32_bf16 v[0:3], a[100:103], v[80:83], v[0:3]
    s_add_u32 s59, s76, 12288
    buffer_load_dwordx4 v[224:227], v148, s[20:23], s59 offen sc1
    ds_read_b128 a[80:83], v211 offset:1024
    v_mfma_f32_16x16x32_bf16 v[4:7], a[104:107], v[80:83], v[4:7]
    v_mfma_f32_16x16x32_bf16 v[8:11], a[108:111], v[80:83], v[8:11]
    v_mfma_f32_16x16x32_bf16 v[12:15], a[112:115], v[80:83], v[12:15]
    v_mfma_f32_16x16x32_bf16 v[16:19], a[116:119], v[80:83], v[16:19]
    buffer_load_dwordx4 v[228:231], v149, s[20:23], s59 offen sc1
    ds_read_b128 a[84:87], v211 offset:2048
    v_mfma_f32_16x16x32_bf16 v[20:23], a[100:103], v[84:87], v[20:23]
    v_mfma_f32_16x16x32_bf16 v[24:27], a[104:107], v[84:87], v[24:27]
    v_mfma_f32_16x16x32_bf16 v[28:31], a[108:111], v[84:87], v[28:31]
    buffer_load_dwordx4 v[232:235], v150, s[20:23], s59 offen sc1
    v_mfma_f32_16x16x32_bf16 v[32:35], a[112:115], v[84:87], v[32:35]
    ds_read_b128 a[88:91], v211 offset:3072
    v_mfma_f32_16x16x32_bf16 v[36:39], a[116:119], v[84:87], v[36:39]
    v_mfma_f32_16x16x32_bf16 v[40:43], a[100:103], v[88:91], v[40:43]
    buffer_load_dwordx4 v[236:239], v151, s[20:23], s59 offen sc1
    v_mfma_f32_16x16x32_bf16 v[44:47], a[104:107], v[88:91], v[44:47]
    v_mfma_f32_16x16x32_bf16 v[48:51], a[108:111], v[88:91], v[48:51]
    ds_read_b128 a[92:95], v211 offset:4096
    v_mfma_f32_16x16x32_bf16 v[52:55], a[112:115], v[88:91], v[52:55]
    v_mfma_f32_16x16x32_bf16 v[56:59], a[116:119], v[88:91], v[56:59]
    s_add_u32 s59, s76, 14336
    buffer_load_dwordx4 v[240:243], v148, s[20:23], s59 offen sc1
    v_mfma_f32_16x16x32_bf16 v[60:63], a[100:103], v[92:95], v[60:63]
    v_mfma_f32_16x16x32_bf16 v[64:67], a[104:107], v[92:95], v[64:67]
    ds_read_b128 a[96:99], v211 offset:5120
    v_mfma_f32_16x16x32_bf16 v[68:71], a[108:111], v[92:95], v[68:71]
    buffer_load_dwordx4 v[244:247], v149, s[20:23], s59 offen sc1
    v_mfma_f32_16x16x32_bf16 v[72:75], a[112:115], v[92:95], v[72:75]
    v_mfma_f32_16x16x32_bf16 v[76:79], a[116:119], v[92:95], v[76:79]
    s_waitcnt vmcnt(15)
    v_mfma_f32_16x16x32_bf16 v[0:3], a[120:123], v[160:163], v[0:3]
    buffer_load_dwordx4 v[248:251], v150, s[20:23], s59 offen sc1
    ds_read_b128 a[100:103], v211 offset:6144
    v_mfma_f32_16x16x32_bf16 v[4:7], a[124:127], v[160:163], v[4:7]
    v_mfma_f32_16x16x32_bf16 v[8:11], a[128:131], v[160:163], v[8:11]
    v_mfma_f32_16x16x32_bf16 v[12:15], a[132:135], v[160:163], v[12:15]
    v_mfma_f32_16x16x32_bf16 v[16:19], a[136:139], v[160:163], v[16:19]
    buffer_load_dwordx4 v[252:255], v151, s[20:23], s59 offen sc1
    ds_read_b128 a[104:107], v211 offset:7168
    v_mfma_f32_16x16x32_bf16 v[20:23], a[120:123], v[164:167], v[20:23]
    v_mfma_f32_16x16x32_bf16 v[24:27], a[124:127], v[164:167], v[24:27]
    v_mfma_f32_16x16x32_bf16 v[28:31], a[128:131], v[164:167], v[28:31]
    v_mfma_f32_16x16x32_bf16 v[32:35], a[132:135], v[164:167], v[32:35]
    ds_read_b128 a[108:111], v211 offset:8192
    v_mfma_f32_16x16x32_bf16 v[36:39], a[136:139], v[164:167], v[36:39]
    v_mfma_f32_16x16x32_bf16 v[40:43], a[120:123], v[168:171], v[40:43]
    v_mfma_f32_16x16x32_bf16 v[44:47], a[124:127], v[168:171], v[44:47]
    v_mfma_f32_16x16x32_bf16 v[48:51], a[128:131], v[168:171], v[48:51]
    ds_read_b128 a[112:115], v211 offset:9216
    v_mfma_f32_16x16x32_bf16 v[52:55], a[132:135], v[168:171], v[52:55]
    v_mfma_f32_16x16x32_bf16 v[56:59], a[136:139], v[168:171], v[56:59]
    v_mfma_f32_16x16x32_bf16 v[60:63], a[120:123], v[172:175], v[60:63]
    v_mfma_f32_16x16x32_bf16 v[64:67], a[124:127], v[172:175], v[64:67]
    ds_read_b128 a[116:119], v211 offset:10240
    v_mfma_f32_16x16x32_bf16 v[68:71], a[128:131], v[172:175], v[68:71]
    v_mfma_f32_16x16x32_bf16 v[72:75], a[132:135], v[172:175], v[72:75]
    v_mfma_f32_16x16x32_bf16 v[76:79], a[136:139], v[172:175], v[76:79]
    s_waitcnt vmcnt(13)
    s_nop 0
P_o_chk:
    v_cmp_ne_u32 vcc, v147, v145
    s_nop 4
    s_cbranch_vccnz P_o_slow
P_o_done:
    s_waitcnt vmcnt(12)
    v_mfma_f32_16x16x32_bf16 v[0:3], a[140:143], v[176:179], v[0:3]
    s_add_u32 s56, s52, 0
    buffer_load_dwordx4 v[128:131], v220, s[20:23], s56 offen sc1
    ds_read_b128 a[120:123], v211 offset:11264
    v_mfma_f32_16x16x32_bf16 v[4:7], a[144:147], v[176:179], v[4:7]
    v_mfma_f32_16x16x32_bf16 v[8:11], a[148:151], v[176:179], v[8:11]
    v_mfma_f32_16x16x32_bf16 v[12:15], a[152:155], v[176:179], v[12:15]
    v_mfma_f32_16x16x32_bf16 v[16:19], a[156:159], v[176:179], v[16:19]
    buffer_load_dwordx4 v[132:135], v153, s[20:23], s56 offen sc1
    ds_read_b128 a[124:127], v211 offset:12288
    v_mfma_f32_16x16x32_bf16 v[20:23], a[140:143], v[180:183], v[20:23]
    v_mfma_f32_16x16x32_bf16 v[24:27], a[144:147], v[180:183], v[24:27]
    v_mfma_f32_16x16x32_bf16 v[28:31], a[148:151], v[180:183], v[28:31]
    buffer_load_dwordx4 v[136:139], v154, s[20:23], s56 offen sc1
    v_mfma_f32_16x16x32_bf16 v[32:35], a[152:155], v[180:183], v[32:35]
    ds_read_b128 a[128:131], v211 offset:13312
    v_mfma_f32_16x16x32_bf16 v[36:39], a[156:159], v[180:183], v[36:39]
    v_mfma_f32_16x16x32_bf16 v[40:43], a[140:143], v[184:187], v[40:43]
    buffer_load_dwordx4 v[140:143], v155, s[20:23], s56 offen sc1
    v_mfma_f32_16x16x32_bf16 v[44:47], a[144:147], v[184:187], v[44:47]
    v_mfma_f32_16x16x32_bf16 v[48:51], a[148:151], v[184:187], v[48:51]
    ds_read_b128 a[132:135], v211 offset:14336
    v_mfma_f32_16x16x32_bf16 v[52:55], a[152:155], v[184:187], v[52:55]
    v_mfma_f32_16x16x32_bf16 v[56:59], a[156:159], v[184:187], v[56:59]
    s_add_u32 s56, s52, 2048
    buffer_load_dwordx4 v[112:115], v220, s[20:23], s56 offen sc1
    v_mfma_f32_16x16x32_bf16 v[60:63], a[140:143], v[188:191], v[60:63]
    v_mfma_f32_16x16x32_bf16 v[64:67], a[144:147], v[188:191], v[64:67]
    ds_read_b128 a[136:139], v211 offset:15360
    v_mfma_f32_16x16x32_bf16 v[68:71], a[148:151], v[188:191], v[68:71]
    buffer_load_dwordx4 v[116:119], v153, s[20:23], s56 offen sc1
    v_mfma_f32_16x16x32_bf16 v[72:75], a[152:155], v[188:191], v[72:75]
    v_mfma_f32_16x16x32_bf16 v[76:79], a[156:159], v[188:191], v[76:79]
    s_waitcnt lgkmcnt(15)
    s_barrier
    s_waitcnt vmcnt(14)
    v_mfma_f32_16x16x32_bf16 v[0:3], a[220:223], v[192:195], v[0:3]
    buffer_load_dwordx4 v[176:179], v221, s[24:27], s46 offen
    ds_read_b128 a[140:143], v209 offset:40960
    v_mfma_f32_16x16x32_bf16 v[4:7], a[224:227], v[192:195], v[4:7]
    v_mfma_f32_16x16x32_bf16 v[8:11], a[228:231], v[192:195], v[8:11]
    v_mfma_f32_16x16x32_bf16 v[12:15], a[232:235], v[192:195], v[12:15]
    v_mfma_f32_16x16x32_bf16 v[16:19], a[236:239], v[192:195], v[16:19]
    buffer_load_dwordx4 v[180:183], v222, s[24:27], s46 offen
    ds_read_b128 a[144:147], v209 offset:41984
    v_mfma_f32_16x16x32_bf16 v[20:23], a[220:223], v[196:199], v[20:23]
    v_mfma_f32_16x16x32_bf16 v[24:27], a[224:227], v[196:199], v[24:27]
    v_mfma_f32_16x16x32_bf16 v[28:31], a[228:231], v[196:199], v[28:31]
    buffer_load_dwordx4 v[184:187], v223, s[24:27], s46 offen
    v_mfma_f32_16x16x32_bf16 v[32:35], a[232:235], v[196:199], v[32:35]
    ds_read_b128 a[148:151], v209 offset:43008
    v_mfma_f32_16x16x32_bf16 v[36:39], a[236:239], v[196:199], v[36:39]
    v_mfma_f32_16x16x32_bf16 v[40:43], a[220:223], v[200:203], v[40:43]
    buffer_load_dwordx4 v[120:123], v154, s[20:23], s56 offen sc1
    v_mfma_f32_16x16x32_bf16 v[44:47], a[224:227], v[200:203], v[44:47]
    v_mfma_f32_16x16x32_bf16 v[48:51], a[228:231], v[200:203], v[48:51]
    ds_read_b128 a[152:155], v209 offset:44032
    v_mfma_f32_16x16x32_bf16 v[52:55], a[232:235], v[200:203], v[52:55]
    v_mfma_f32_16x16x32_bf16 v[56:59], a[236:239], v[200:203], v[56:59]
    buffer_load_dwordx4 v[124:127], v155, s[20:23], s56 offen sc1
    v_mfma_f32_16x16x32_bf16 v[60:63], a[220:223], v[204:207], v[60:63]
    v_mfma_f32_16x16x32_bf16 v[64:67], a[224:227], v[204:207], v[64:67]
    ds_read_b128 a[156:159], v209 offset:45056
    v_mfma_f32_16x16x32_bf16 v[68:71], a[228:231], v[204:207], v[68:71]
    s_add_u32 s56, s52, 4096
    buffer_load_dwordx4 v[96:99], v220, s[20:23], s56 offen sc1
    v_mfma_f32_16x16x32_bf16 v[72:75], a[232:235], v[204:207], v[72:75]
    v_mfma_f32_16x16x32_bf16 v[76:79], a[236:239], v[204:207], v[76:79]
    s_waitcnt vmcnt(16)
    v_mfma_f32_16x16x32_bf16 v[0:3], a[160:163], v[224:227], v[0:3]
    buffer_load_dwordx4 v[100:103], v153, s[20:23], s56 offen sc1
    ds_read_b128 a[220:223], v209 offset:46080
    v_mfma_f32_16x16x32_bf16 v[4:7], a[164:167], v[224:227], v[4:7]
    v_mfma_f32_16x16x32_bf16 v[8:11], a[168:171], v[224:227], v[8:11]
    v_mfma_f32_16x16x32_bf16 v[12:15], a[172:175], v[224:227], v[12:15]
    v_mfma_f32_16x16x32_bf16 v[16:19], a[176:179], v[224:227], v[16:19]
    buffer_load_dwordx4 v[104:107], v154, s[20:23], s56 offen sc1
    ds_read_b128 a[224:227], v209 offset:47104
    v_mfma_f32_16x16x32_bf16 v[20:23], a[160:163], v[228:231], v[20:23]
    v_mfma_f32_16x16x32_bf16 v[24:27], a[164:167], v[228:231], v[24:27]
    v_mfma_f32_16x16x32_bf16 v[28:31], a[168:171], v[228:231], v[28:31]
    buffer_load_dwordx4 v[108:111], v155, s[20:23], s56 offen sc1
    v_mfma_f32_16x16x32_bf16 v[32:35], a[172:175], v[228:231], v[32:35]
    ds_read_b128 a[228:231], v209 offset:48128
    v_mfma_f32_16x16x32_bf16 v[36:39], a[176:179], v[228:231], v[36:39]
    v_mfma_f32_16x16x32_bf16 v[40:43], a[160:163], v[232:235], v[40:43]
    s_add_u32 s56, s52, 6144
    buffer_load_dwordx4 v[80:83], v220, s[20:23], s56 offen sc1
    v_mfma_f32_16x16x32_bf16 v[44:47], a[164:167], v[232:235], v[44:47]
    v_mfma_f32_16x16x32_bf16 v[48:51], a[168:171], v[232:235], v[48:51]
    ds_read_b128 a[232:235], v209 offset:49152
    v_mfma_f32_16x16x32_bf16 v[52:55], a[172:175], v[232:235], v[52:55]
    v_mfma_f32_16x16x32_bf16 v[56:59], a[176:179], v[232:235], v[56:59]
    buffer_load_dwordx4 v[84:87], v153, s[20:23], s56 offen sc1
    v_mfma_f32_16x16x32_bf16 v[60:63], a[160:163], v[236:239], v[60:63]
    v_mfma_f32_16x16x32_bf16 v[64:67], a[164:167], v[236:239], v[64:67]
    ds_read_b128 a[236:239], v209 offset:50176
    v_mfma_f32_16x16x32_bf16 v[68:71], a[168:171], v[236:239], v[68:71]
    buffer_load_dwordx4 v[88:91], v154, s[20:23], s56 offen sc1
    v_mfma_f32_16x16x32_bf16 v[72:75], a[172:175], v[236:239], v[72:75]
    v_mfma_f32_16x16x32_bf16 v[76:79], a[176:179], v[236:239], v[76:79]
    s_waitcnt vmcnt(18)
    v_mfma_f32_16x16x32_bf16 v[0:3], a[180:183], v[240:243], v[0:3]
    buffer_load_dwordx4 v[92:95], v155, s[20:23], s56 offen sc1
    ds_read_b128 a[160:163], v209 offset:51200
    v_mfma_f32_16x16x32_bf16 v[4:7], a[184:187], v[240:243], v[4:7]
    v_mfma_f32_16x16x32_bf16 v[8:11], a[188:191], v[240:243], v[8:11]
    v_mfma_f32_16x16x32_bf16 v[12:15], a[192:195], v[240:243], v[12:15]
    v_mfma_f32_16x16x32_bf16 v[16:19], a[196:199], v[240:243], v[16:19]
    s_add_u32 s56, s52, 8192
    buffer_load_dwordx4 v[160:163], v220, s[20:23], s56 offen sc1
    ds_read_b128 a[164:167], v209 offset:52224
    v_mfma_f32_16x16x32_bf16 v[20:23], a[180:183], v[244:247], v[20:23]
    v_mfma_f32_16x16x32_bf16 v[24:27], a[184:187], v[244:247], v[24:27]
    v_mfma_f32_16x16x32_bf16 v[28:31], a[188:191], v[244:247], v[28:31]
    buffer_load_dwordx4 v[164:167], v153, s[20:23], s56 offen sc1
    v_mfma_f32_16x16x32_bf16 v[32:35], a[192:195], v[244:247], v[32:35]
    ds_read_b128 a[168:171], v209 offset:53248
    v_mfma_f32_16x16x32_bf16 v[36:39], a[196:199], v[244:247], v[36:39]
    v_mfma_f32_16x16x32_bf16 v[40:43], a[180:183], v[248:251], v[40:43]
    buffer_load_dwordx4 v[168:171], v154, s[20:23], s56 offen sc1
    v_mfma_f32_16x16x32_bf16 v[44:47], a[184:187], v[248:251], v[44:47]
    v_mfma_f32_16x16x32_bf16 v[48:51], a[188:191], v[248:251], v[48:51]
    ds_read_b128 a[172:175], v209 offset:54272
    v_mfma_f32_16x16x32_bf16 v[52:55], a[192:195], v[248:251], v[52:55]
    v_mfma_f32_16x16x32_bf16 v[56:59], a[196:199], v[248:251], v[56:59]
    buffer_load_dwordx4 v[172:175], v155, s[20:23], s56 offen sc1
    v_mfma_f32_16x16x32_bf16 v[60:63], a[180:183], v[252:255], v[60:63]
    v_mfma_f32_16x16x32_bf16 v[64:67], a[184:187], v[252:255], v[64:67]
    ds_read_b128 a[176:179], v209 offset:55296
    v_mfma_f32_16x16x32_bf16 v[68:71], a[188:191], v[252:255], v[68:71]
    v_mfma_f32_16x16x32_bf16 v[72:75], a[192:195], v[252:255], v[72:75]
    v_mfma_f32_16x16x32_bf16 v[76:79], a[196:199], v[252:255], v[76:79]
    s_waitcnt vmcnt(19)
    v_mfma_f32_16x16x32_bf16 v[224:227], a[200:203], v[128:131], 0
    v_mfma_f32_16x16x32_bf16 v[228:231], a[204:207], v[128:131], 0
    v_mfma_f32_16x16x32_bf16 v[232:235], a[208:211], v[128:131], 0
    v_mfma_f32_16x16x32_bf16 v[236:239], a[212:215], v[128:131], 0
    ds_write_b128 v152, v[20:23] offset:0
    v_mov_b32 v252, 0xffff0000
    v_mov_b32 v253, 0xbfb8aa3b
    s_waitcnt vmcnt(14)
    v_mfma_f32_16x16x32_bf16 v[240:243], a[216:219], v[128:131], 0
    v_mfma_f32_16x16x32_bf16 v[224:227], a[0:3], v[132:135], v[224:227]
    ds_write_b128 v152, v[24:27] offset:1024
    v_lshlrev_b32 v192, 16, v176
    v_and_b32 v193, v252, v176
    v_mfma_f32_16x16x32_bf16 v[228:231], a[4:7], v[132:135], v[228:231]
    v_mfma_f32_16x16x32_bf16 v[232:235], a[8:11], v[132:135], v[232:235]
    ds_write_b128 v152, v[28:31] offset:2048
    v_lshlrev_b32 v194, 16, v177
    v_and_b32 v195, v252, v177
    v_mfma_f32_16x16x32_bf16 v[236:239], a[12:15], v[132:135], v[236:239]
    v_mfma_f32_16x16x32_bf16 v[240:243], a[16:19], v[132:135], v[240:243]
    ds_write_b128 v152, v[32:35] offset:3072
    v_lshlrev_b32 v196, 16, v178
    v_and_b32 v197, v252, v178
    v_mfma_f32_16x16x32_bf16 v[224:227], a[20:23], v[136:139], v[224:227]
    v_mfma_f32_16x16x32_bf16 v[228:231], a[24:27], v[136:139], v[228:231]
    ds_write_b128 v152, v[36:39] offset:4096
    v_lshlrev_b32 v198, 16, v179
    v_and_b32 v199, v252, v179
    v_mfma_f32_16x16x32_bf16 v[232:235], a[28:31], v[136:139], v[232:235]
    v_mfma_f32_16x16x32_bf16 v[236:239], a[32:35], v[136:139], v[236:239]
    ds_write_b128 v212, v[40:43] offset:0
    v_lshlrev_b32 v200, 16, v180
    v_and_b32 v201, v252, v180
    v_mfma_f32_16x16x32_bf16 v[240:243], a[36:39], v[136:139], v[240:243]
    v_mfma_f32_16x16x32_bf16 v[224:227], a[40:43], v[140:143], v[224:227]
    ds_write_b128 v212, v[44:47] offset:1024
    v_lshlrev_b32 v202, 16, v181
    v_and_b32 v203, v252, v181
    v_mfma_f32_16x16x32_bf16 v[228:231], a[44:47], v[140:143], v[228:231]
    v_mfma_f32_16x16x32_bf16 v[232:235], a[48:51], v[140:143], v[232:235]
    ds_write_b128 v212, v[48:51] offset:2048
    v_mfma_f32_16x16x32_bf16 v[236:239], a[52:55], v[140:143], v[236:239]
    v_mfma_f32_16x16x32_bf16 v[240:243], a[56:59], v[140:143], v[240:243]
    s_waitcnt vmcnt(12)
    v_mfma_f32_16x16x32_bf16 v[224:227], a[60:63], v[112:115], v[224:227]
    ds_write_b128 v212, v[52:55] offset:3072
    v_lshlrev_b32 v204, 16, v182
    v_and_b32 v205, v252, v182
    v_mfma_f32_16x16x32_bf16 v[228:231], a[64:67], v[112:115], v[228:231]
    v_mfma_f32_16x16x32_bf16 v[232:235], a[68:71], v[112:115], v[232:235]
    v_mfma_f32_16x16x32_bf16 v[236:239], a[72:75], v[112:115], v[236:239]
    ds_write_b128 v212, v[56:59] offset:4096
    v_lshlrev_b32 v206, 16, v183
    v_and_b32 v207, v252, v183
    v_mfma_f32_16x16x32_bf16 v[240:243], a[76:79], v[112:115], v[240:243]
    s_waitcnt lgkmcnt(15)
    v_mfma_f32_16x16x32_bf16 v[224:227], a[80:83], v[116:119], v[224:227]
    ds_write_b128 v213, v[60:63] offset:0
    v_lshlrev_b32 v244, 16, v184
    v_and_b32 v245, v252, v184
    v_mfma_f32_16x16x32_bf16 v[228:231], a[84:87], v[116:119], v[228:231]
    v_mfma_f32_16x16x32_bf16 v[232:235], a[88:91], v[116:119], v[232:235]
    ds_write_b128 v213, v[64:67] offset:1024
    v_lshlrev_b32 v246, 16, v185
    v_and_b32 v247, v252, v185
    v_mfma_f32_16x16x32_bf16 v[236:239], a[92:95], v[116:119], v[236:239]
    v_mfma_f32_16x16x32_bf16 v[240:243], a[96:99], v[116:119], v[240:243]
    ds_write_b128 v213, v[68:71] offset:2048
    v_lshlrev_b32 v248, 16, v186
    v_and_b32 v249, v252, v186
    v_mfma_f32_16x16x32_bf16 v[224:227], a[100:103], v[120:123], v[224:227]
    ds_read_b128 a[200:203], v209 offset:56320
    v_mfma_f32_16x16x32_bf16 v[228:231], a[104:107], v[120:123], v[228:231]
    ds_write_b128 v213, v[72:75] offset:3072
    v_lshlrev_b32 v250, 16, v187
    v_and_b32 v251, v252, v187
    v_mfma_f32_16x16x32_bf16 v[232:235], a[108:111], v[120:123], v[232:235]
    ds_read_b128 a[204:207], v209 offset:57344
    v_mfma_f32_16x16x32_bf16 v[236:239], a[112:115], v[120:123], v[236:239]
    ds_read_b128 a[208:211], v209 offset:58368
    ds_write_b128 v213, v[76:79] offset:4096
    v_mfma_f32_16x16x32_bf16 v[240:243], a[116:119], v[120:123], v[240:243]
    ds_read_b128 a[212:215], v209 offset:59392
    v_mfma_f32_16x16x32_bf16 v[224:227], a[120:123], v[124:127], v[224:227]
    ds_read_b128 a[216:219], v209 offset:60416
    v_mfma_f32_16x16x32_bf16 v[228:231], a[124:127], v[124:127], v[228:231]
    v_mfma_f32_16x16x32_bf16 v[232:235], a[128:131], v[124:127], v[232:235]
    ds_read_b128 a[0:3], v209 offset:20480
    v_mfma_f32_16x16x32_bf16 v[236:239], a[132:135], v[124:127], v[236:239]
    ds_read_b128 a[4:7], v209 offset:21504
    v_mfma_f32_16x16x32_bf16 v[240:243], a[136:139], v[124:127], v[240:243]
    ds_read_b128 a[8:11], v209 offset:22528
    s_waitcnt lgkmcnt(5)
    s_barrier
    s_waitcnt vmcnt(8)
    v_mfma_f32_16x16x32_bf16 v[224:227], a[140:143], v[96:99], v[224:227]
    ds_read_b128 a[12:15], v209 offset:23552
    ds_read_b128 v[20:23], v208 offset:0
    v_mfma_f32_16x16x32_bf16 v[228:231], a[144:147], v[96:99], v[228:231]
    ds_read_b128 a[16:19], v209 offset:24576
    ds_read_b128 v[24:27], v208 offset:5120
    ds_read_b128 v[28:31], v208 offset:10240
    v_mfma_f32_16x16x32_bf16 v[232:235], a[148:151], v[96:99], v[232:235]
    ds_read_b128 v[32:35], v208 offset:1024
    ds_read_b128 v[36:39], v208 offset:6144
    ds_read_b128 v[40:43], v208 offset:11264
    v_mfma_f32_16x16x32_bf16 v[236:239], a[152:155], v[96:99], v[236:239]
    ds_read_b128 a[20:23], v209 offset:25600
    ds_read_b128 v[44:47], v208 offset:2048
    ds_read_b128 v[48:51], v208 offset:7168
    v_mfma_f32_16x16x32_bf16 v[240:243], a[156:159], v[96:99], v[240:243]
    ds_read_b128 a[24:27], v209 offset:26624
    ds_read_b128 v[52:55], v208 offset:12288
    s_waitcnt lgkmcnt(8)
    ds_read_b128 v[56:59], v208 offset:3072
    v_mfma_f32_16x16x32_bf16 v[224:227], a[220:223], v[100:103], v[224:227]
    ds_read_b128 a[28:31], v209 offset:27648
    v_add_f32 v20, v20, v24
    v_add_f32 v21, v21, v25
    v_add_f32 v22, v22, v26
    v_mfma_f32_16x16x32_bf16 v[228:231], a[224:227], v[100:103], v[228:231]
    ds_read_b128 a[32:35], v209 offset:28672
    v_add_f32 v23, v23, v27
    v_add_f32 v0, v0, v28
    v_mfma_f32_16x16x32_bf16 v[232:235], a[228:231], v[100:103], v[232:235]
    v_add_f32 v1, v1, v29
    v_add_f32 v2, v2, v30
    v_add_f32 v3, v3, v31
    v_mfma_f32_16x16x32_bf16 v[236:239], a[232:235], v[100:103], v[236:239]
    ds_read_b128 a[36:39], v209 offset:29696
    ds_read_b128 v[60:63], v208 offset:8192
    v_add_f32 v0, v0, v20
    v_add_f32 v1, v1, v21
    v_mfma_f32_16x16x32_bf16 v[240:243], a[236:239], v[100:103], v[240:243]
    ds_read_b128 a[40:43], v209 offset:30720
    v_add_f32 v2, v2, v22
    v_add_f32 v3, v3, v23
    v_mfma_f32_16x16x32_bf16 v[224:227], a[160:163], v[104:107], v[224:227]
    ds_read_b128 a[44:47], v209 offset:31744
    v_mul_f32 v20, v253, v0
    v_mul_f32 v21, v253, v1
    v_mul_f32 v22, v253, v2
    v_mfma_f32_16x16x32_bf16 v[228:231], a[164:167], v[104:107], v[228:231]
    ds_read_b128 a[48:51], v209 offset:32768
    v_mul_f32 v23, v253, v3
    ds_read_b128 v[64:67], v208 offset:13312
    v_mfma_f32_16x16x32_bf16 v[232:235], a[168:171], v[104:107], v[232:235]
    ds_read_b128 a[52:55], v209 offset:33792
    v_exp_f32 v20, v20
    v_exp_f32 v21, v21
    v_exp_f32 v22, v22
    v_mfma_f32_16x16x32_bf16 v[236:239], a[172:175], v[104:107], v[236:239]
    v_exp_f32 v23, v23
    v_add_f32 v20, 1.0, v20
    v_add_f32 v21, 1.0, v21
    v_mfma_f32_16x16x32_bf16 v[240:243], a[176:179], v[104:107], v[240:243]
    ds_read_b128 a[56:59], v209 offset:34816
    v_add_f32 v22, 1.0, v22
    v_add_f32 v23, 1.0, v23
    v_mfma_f32_16x16x32_bf16 v[224:227], a[200:203], v[108:111], v[224:227]
    ds_read_b128 a[60:63], v209 offset:35840
    ds_read_b128 v[68:71], v208 offset:4096
    v_rcp_f32 v20, v20
    v_rcp_f32 v21, v21
    v_mfma_f32_16x16x32_bf16 v[228:231], a[204:207], v[108:111], v[228:231]
    ds_read_b128 a[64:67], v209 offset:36864
    v_rcp_f32 v22, v22
    v_rcp_f32 v23, v23
    v_mul_f32 v0, v0, v20
    v_mfma_f32_16x16x32_bf16 v[232:235], a[208:211], v[108:111], v[232:235]
    ds_read_b128 a[68:71], v209 offset:37888
    v_mul_f32 v1, v1, v21
    v_mul_f32 v2, v2, v22
    v_mfma_f32_16x16x32_bf16 v[236:239], a[212:215], v[108:111], v[236:239]
    v_mul_f32 v3, v3, v23
    ds_read_b128 v[72:75], v208 offset:9216
    s_waitcnt lgkmcnt(15)
    v_mfma_f32_16x16x32_bf16 v[240:243], a[216:219], v[108:111], v[240:243]
    ds_read_b128 a[72:75], v209 offset:38912
    v_add_f32 v32, v32, v36
    v_add_f32 v33, v33, v37
    s_waitcnt vmcnt(4)
    v_mfma_f32_16x16x32_bf16 v[224:227], a[0:3], v[80:83], v[224:227]
    ds_read_b128 a[76:79], v209 offset:39936
    v_add_f32 v34, v34, v38
    v_mfma_f32_16x16x32_bf16 v[228:231], a[4:7], v[80:83], v[228:231]
    ds_read_b128 a[80:83], v209 offset:0
    v_add_f32 v35, v35, v39
    v_add_f32 v4, v4, v40
    v_mfma_f32_16x16x32_bf16 v[232:235], a[8:11], v[80:83], v[232:235]
    ds_read_b128 a[84:87], v209 offset:1024
    v_add_f32 v5, v5, v41
    v_add_f32 v6, v6, v42
    ds_read_b128 v[76:79], v208 offset:14336
    v_mfma_f32_16x16x32_bf16 v[236:239], a[12:15], v[80:83], v[236:239]
    ds_read_b128 a[88:91], v209 offset:2048
    v_add_f32 v7, v7, v43
    v_add_f32 v4, v4, v32
    v_mfma_f32_16x16x32_bf16 v[240:243], a[16:19], v[80:83], v[240:243]
    v_add_f32 v5, v5, v33
    v_add_f32 v6, v6, v34
    v_add_f32 v7, v7, v35
    s_waitcnt lgkmcnt(15)
    v_mfma_f32_16x16x32_bf16 v[224:227], a[20:23], v[84:87], v[224:227]
    ds_read_b128 a[92:95], v209 offset:3072
    v_mul_f32 v32, v253, v4
    v_mul_f32 v33, v253, v5
    v_mul_f32 v34, v253, v6
    v_mfma_f32_16x16x32_bf16 v[228:231], a[24:27], v[84:87], v[228:231]
    ds_read_b128 a[96:99], v209 offset:4096
    v_mul_f32 v35, v253, v7
    v_exp_f32 v32, v32
    v_mfma_f32_16x16x32_bf16 v[232:235], a[28:31], v[84:87], v[232:235]
    ds_read_b128 a[100:103], v209 offset:5120
    v_exp_f32 v33, v33
    v_exp_f32 v34, v34
    v_exp_f32 v35, v35
    v_mfma_f32_16x16x32_bf16 v[236:239], a[32:35], v[84:87], v[236:239]
    ds_read_b128 a[104:107], v209 offset:6144
    v_add_f32 v32, 1.0, v32
    v_add_f32 v33, 1.0, v33
    v_add_f32 v34, 1.0, v34
    v_mfma_f32_16x16x32_bf16 v[240:243], a[36:39], v[84:87], v[240:243]
    v_add_f32 v35, 1.0, v35
    v_rcp_f32 v32, v32
    s_waitcnt lgkmcnt(15)
    v_mfma_f32_16x16x32_bf16 v[224:227], a[40:43], v[88:91], v[224:227]
    ds_read_b128 a[108:111], v209 offset:7168
    v_rcp_f32 v33, v33
    v_rcp_f32 v34, v34
    v_rcp_f32 v35, v35
    v_mfma_f32_16x16x32_bf16 v[228:231], a[44:47], v[88:91], v[228:231]
    ds_read_b128 a[112:115], v209 offset:8192
    v_mul_f32 v4, v4, v32
    v_mul_f32 v5, v5, v33
    v_mfma_f32_16x16x32_bf16 v[232:235], a[48:51], v[88:91], v[232:235]
    ds_read_b128 a[116:119], v209 offset:9216
    v_mul_f32 v6, v6, v34
    v_mul_f32 v7, v7, v35
    v_mfma_f32_16x16x32_bf16 v[236:239], a[52:55], v[88:91], v[236:239]
    ds_read_b128 a[120:123], v209 offset:10240
    v_add_f32 v44, v44, v48
    v_add_f32 v45, v45, v49
    v_add_f32 v46, v46, v50
    v_mfma_f32_16x16x32_bf16 v[240:243], a[56:59], v[88:91], v[240:243]
    ds_read_b128 a[124:127], v209 offset:11264
    v_add_f32 v47, v47, v51
    v_add_f32 v8, v8, v52
    s_waitcnt lgkmcnt(13)
    v_mfma_f32_16x16x32_bf16 v[224:227], a[60:63], v[92:95], v[224:227]
    v_add_f32 v9, v9, v53
    v_add_f32 v10, v10, v54
    v_add_f32 v11, v11, v55
    v_mfma_f32_16x16x32_bf16 v[228:231], a[64:67], v[92:95], v[228:231]
    ds_read_b128 a[128:131], v209 offset:12288
    v_add_f32 v8, v8, v44
    v_add_f32 v9, v9, v45
    v_add_f32 v10, v10, v46
    v_mfma_f32_16x16x32_bf16 v[232:235], a[68:71], v[92:95], v[232:235]
    ds_read_b128 a[132:135], v209 offset:13312
    v_add_f32 v11, v11, v47
    v_mul_f32 v44, v253, v8
    v_mfma_f32_16x16x32_bf16 v[236:239], a[72:75], v[92:95], v[236:239]
    ds_read_b128 a[136:139], v209 offset:14336
    v_mul_f32 v45, v253, v9
    v_mul_f32 v46, v253, v10
    v_mul_f32 v47, v253, v11
    v_mfma_f32_16x16x32_bf16 v[240:243], a[76:79], v[92:95], v[240:243]
    ds_read_b128 a[140:143], v209 offset:15360
    v_exp_f32 v44, v44
    v_exp_f32 v45, v45
    s_waitcnt vmcnt(0)
    s_waitcnt lgkmcnt(11)
    v_mfma_f32_16x16x32_bf16 v[224:227], a[80:83], v[160:163], v[224:227]
    v_exp_f32 v46, v46
    v_mfma_f32_16x16x32_bf16 v[228:231], a[84:87], v[160:163], v[228:231]
    ds_read_b128 a[144:147], v209 offset:16384
    v_exp_f32 v47, v47
    v_add_f32 v44, 1.0, v44
    v_mfma_f32_16x16x32_bf16 v[232:235], a[88:91], v[160:163], v[232:235]
    ds_read_b128 a[148:151], v209 offset:17408
    v_add_f32 v45, 1.0, v45
    v_add_f32 v46, 1.0, v46
    v_add_f32 v47, 1.0, v47
    v_mfma_f32_16x16x32_bf16 v[236:239], a[92:95], v[160:163], v[236:239]
    ds_read_b128 a[152:155], v209 offset:18432
    v_rcp_f32 v44, v44
    v_rcp_f32 v45, v45
    v_mfma_f32_16x16x32_bf16 v[240:243], a[96:99], v[160:163], v[240:243]
    ds_read_b128 a[156:159], v209 offset:19456
    v_rcp_f32 v46, v46
    v_rcp_f32 v47, v47
    v_mul_f32 v8, v8, v44
    s_waitcnt lgkmcnt(10)
    v_mfma_f32_16x16x32_bf16 v[224:227], a[100:103], v[164:167], v[224:227]
    v_mul_f32 v9, v9, v45
    v_mul_f32 v10, v10, v46
    v_mul_f32 v11, v11, v47
    v_mfma_f32_16x16x32_bf16 v[228:231], a[104:107], v[164:167], v[228:231]
    v_add_f32 v56, v56, v60
    v_mfma_f32_16x16x32_bf16 v[232:235], a[108:111], v[164:167], v[232:235]
    v_add_f32 v57, v57, v61
    v_add_f32 v58, v58, v62
    v_add_f32 v59, v59, v63
    v_mfma_f32_16x16x32_bf16 v[236:239], a[112:115], v[164:167], v[236:239]
    v_add_f32 v12, v12, v64
    v_add_f32 v13, v13, v65
    v_add_f32 v14, v14, v66
    v_mfma_f32_16x16x32_bf16 v[240:243], a[116:119], v[164:167], v[240:243]
    v_add_f32 v15, v15, v67
    v_add_f32 v12, v12, v56
    s_waitcnt lgkmcnt(5)
    v_mfma_f32_16x16x32_bf16 v[224:227], a[120:123], v[168:171], v[224:227]
    v_add_f32 v13, v13, v57
    v_add_f32 v14, v14, v58
    v_add_f32 v15, v15, v59
    v_mfma_f32_16x16x32_bf16 v[228:231], a[124:127], v[168:171], v[228:231]
    v_mul_f32 v56, v253, v12
    v_mul_f32 v57, v253, v13
    v_mfma_f32_16x16x32_bf16 v[232:235], a[128:131], v[168:171], v[232:235]
    v_mul_f32 v58, v253, v14
    v_mul_f32 v59, v253, v15
    v_exp_f32 v56, v56
    v_mfma_f32_16x16x32_bf16 v[236:239], a[132:135], v[168:171], v[236:239]
    v_exp_f32 v57, v57
    v_exp_f32 v58, v58
    v_exp_f32 v59, v59
    v_mfma_f32_16x16x32_bf16 v[240:243], a[136:139], v[168:171], v[240:243]
    v_add_f32 v56, 1.0, v56
    v_add_f32 v57, 1.0, v57
    s_waitcnt lgkmcnt(0)
    v_mfma_f32_16x16x32_bf16 v[224:227], a[140:143], v[172:175], v[224:227]
    v_add_f32 v58, 1.0, v58
    v_add_f32 v59, 1.0, v59
    v_rcp_f32 v56, v56
    v_mfma_f32_16x16x32_bf16 v[228:231], a[144:147], v[172:175], v[228:231]
    v_rcp_f32 v57, v57
    v_rcp_f32 v58, v58
    v_rcp_f32 v59, v59
    v_mfma_f32_16x16x32_bf16 v[232:235], a[148:151], v[172:175], v[232:235]
    v_mul_f32 v12, v12, v56
    v_mul_f32 v13, v13, v57
    v_mfma_f32_16x16x32_bf16 v[236:239], a[152:155], v[172:175], v[236:239]
    v_mul_f32 v14, v14, v58
    v_mul_f32 v15, v15, v59
    v_mfma_f32_16x16x32_bf16 v[240:243], a[156:159], v[172:175], v[240:243]
    v_add_f32 v68, v68, v72
    v_add_f32 v69, v69, v73
    v_add_f32 v70, v70, v74
    v_add_f32 v71, v71, v75
    v_add_f32 v16, v16, v76
    v_add_f32 v17, v17, v77
    v_add_f32 v18, v18, v78
    v_add_f32 v19, v19, v79
    v_add_f32 v16, v16, v68
    v_add_f32 v17, v17, v69
    v_add_f32 v18, v18, v70
    v_add_f32 v19, v19, v71
    v_mul_f32 v68, v253, v16
    v_mul_f32 v69, v253, v17
    v_mul_f32 v70, v253, v18
    v_mul_f32 v71, v253, v19
    v_exp_f32 v68, v68
    v_exp_f32 v69, v69
    v_exp_f32 v70, v70
    v_exp_f32 v71, v71
    v_add_f32 v68, 1.0, v68
    v_add_f32 v69, 1.0, v69
    v_add_f32 v70, 1.0, v70
    v_add_f32 v71, 1.0, v71
    v_rcp_f32 v68, v68
    v_rcp_f32 v69, v69
    v_rcp_f32 v70, v70
    v_rcp_f32 v71, v71
    v_mul_f32 v16, v16, v68
    v_mul_f32 v17, v17, v69
    v_mul_f32 v18, v18, v70
    v_mul_f32 v19, v19, v71
    v_pk_mul_f32 v[0:1], v[0:1], v[224:225]
    v_pk_mul_f32 v[2:3], v[2:3], v[226:227]
    v_cvt_pk_bf16_f32 v0, v0, v1
    v_cvt_pk_bf16_f32 v1, v2, v3
    ds_write_b64 v219, v[0:1] offset:0
    v_pk_mul_f32 v[4:5], v[4:5], v[228:229]
    v_pk_mul_f32 v[6:7], v[6:7], v[230:231]
    v_cvt_pk_bf16_f32 v4, v4, v5
    v_cvt_pk_bf16_f32 v5, v6, v7
    ds_write_b64 v219, v[4:5] offset:32
    v_pk_mul_f32 v[8:9], v[8:9], v[232:233]
    v_pk_mul_f32 v[10:11], v[10:11], v[234:235]
    v_cvt_pk_bf16_f32 v8, v8, v9
    v_cvt_pk_bf16_f32 v9, v10, v11
    ds_write_b64 v219, v[8:9] offset:64
    v_pk_mul_f32 v[12:13], v[12:13], v[236:237]
    v_pk_mul_f32 v[14:15], v[14:15], v[238:239]
    v_cvt_pk_bf16_f32 v12, v12, v13
    v_cvt_pk_bf16_f32 v13, v14, v15
    ds_write_b64 v219, v[12:13] offset:96
    v_pk_mul_f32 v[16:17], v[16:17], v[240:241]
    v_pk_mul_f32 v[18:19], v[18:19], v[242:243]
    v_cvt_pk_bf16_f32 v16, v16, v17
    v_cvt_pk_bf16_f32 v17, v18, v19
    ds_write_b64 v219, v[16:17] offset:128
    s_waitcnt lgkmcnt(0)
    ds_read_b128 v[20:23], v216
    ds_read_b128 v[24:27], v217
    ds_read_b128 v[28:31], v218
    s_waitcnt lgkmcnt(2)
    v_lshlrev_b32 v40, 16, v20
    v_and_b32 v41, v252, v20
    v_lshlrev_b32 v42, 16, v21
    v_and_b32 v43, v252, v21
    v_lshlrev_b32 v44, 16, v22
    v_and_b32 v45, v252, v22
    v_lshlrev_b32 v46, 16, v23
    v_and_b32 v47, v252, v23
    v_pk_add_f32 v[40:41], v[40:41], v[192:193]
    v_pk_add_f32 v[42:43], v[42:43], v[194:195]
    v_pk_add_f32 v[44:45], v[44:45], v[196:197]
    v_pk_add_f32 v[46:47], v[46:47], v[198:199]
    v_cvt_pk_bf16_f32 v20, v40, v41
    v_cvt_pk_bf16_f32 v21, v42, v43
    v_cvt_pk_bf16_f32 v22, v44, v45
    v_cvt_pk_bf16_f32 v23, v46, v47
    buffer_store_dwordx4 v[20:23], v221, s[4:7], s46 offen
    s_waitcnt lgkmcnt(1)
    v_lshlrev_b32 v40, 16, v24
    v_and_b32 v41, v252, v24
    v_lshlrev_b32 v42, 16, v25
    v_and_b32 v43, v252, v25
    v_lshlrev_b32 v44, 16, v26
    v_and_b32 v45, v252, v26
    v_lshlrev_b32 v46, 16, v27
    v_and_b32 v47, v252, v27
    v_pk_add_f32 v[40:41], v[40:41], v[200:201]
    v_pk_add_f32 v[42:43], v[42:43], v[202:203]
    v_pk_add_f32 v[44:45], v[44:45], v[204:205]
    v_pk_add_f32 v[46:47], v[46:47], v[206:207]
    v_cvt_pk_bf16_f32 v24, v40, v41
    v_cvt_pk_bf16_f32 v25, v42, v43
    v_cvt_pk_bf16_f32 v26, v44, v45
    v_cvt_pk_bf16_f32 v27, v46, v47
    buffer_store_dwordx4 v[24:27], v222, s[4:7], s46 offen
    s_waitcnt lgkmcnt(0)
    v_lshlrev_b32 v40, 16, v28
    v_and_b32 v41, v252, v28
    v_lshlrev_b32 v42, 16, v29
    v_and_b32 v43, v252, v29
    v_lshlrev_b32 v44, 16, v30
    v_and_b32 v45, v252, v30
    v_lshlrev_b32 v46, 16, v31
    v_and_b32 v47, v252, v31
    v_pk_add_f32 v[40:41], v[40:41], v[244:245]
    v_pk_add_f32 v[42:43], v[42:43], v[246:247]
    v_pk_add_f32 v[44:45], v[44:45], v[248:249]
    v_pk_add_f32 v[46:47], v[46:47], v[250:251]
    v_cvt_pk_bf16_f32 v28, v40, v41
    v_cvt_pk_bf16_f32 v29, v42, v43
    v_cvt_pk_bf16_f32 v30, v44, v45
    v_cvt_pk_bf16_f32 v31, v46, v47
    buffer_store_dwordx4 v[28:31], v223, s[4:7], s46 offen
    s_cmp_lg_u32 s1, 19448832
    s_cbranch_scc1 KP_end
    s_mov_b32 s70, 19448832
    v_mov_b32 v17, s38
KP_ep:
    buffer_load_dwordx4 v[64:67], v209, s[20:23], s70 offen offset:0 sc1
    s_waitcnt vmcnt(0)
    v_mov_b32 v16, 0
    v_xor_b32 v64, v64, v17
    v_or_b32 v16, v16, v64
    v_xor_b32 v65, v65, v17
    v_or_b32 v16, v16, v65
    v_xor_b32 v66, v66, v17
    v_or_b32 v16, v16, v66
    v_xor_b32 v67, v67, v17
    v_or_b32 v16, v16, v67
    v_cmp_ne_u32 vcc, 0, v16
    s_nop 4
    s_cbranch_vccz KP_ep2
    s_cmp_eq_u32 s39, 0
    s_cbranch_scc1 KP_end
    s_sub_u32 s39, s39, 1
    s_sleep 1
    s_branch KP_ep
KP_ep2:
    s_mov_b32 s70, 19447808
    v_mov_b32 v16, 0
    buffer_store_dword v17, v16, s[20:23], s70 offen sc1
KP_end:
    s_endpgm
P_qg_slow:
    s_cmp_eq_u32 s39, 0
    s_cbranch_scc1 P_qg_done
    s_sub_u32 s39, s39, 1
    s_sleep 4
    buffer_load_dword v147, v155, s[20:23], s36 offen sc1
    s_waitcnt vmcnt(0)
    s_branch P_qg_chk
P_stg_slow:
    s_cmp_eq_u32 s39, 0
    s_cbranch_scc1 P_stg_done
    s_sub_u32 s39, s39, 1
    s_sleep 4
    buffer_load_dwordx2 v[158:159], v82, s[20:23], s67 offen sc1
    s_waitcnt vmcnt(0)
    s_branch P_stg_chk
P_qq_slow:
    s_cmp_eq_u32 s39, 0
    s_cbranch_scc1 P_qq_done
    s_sub_u32 s39, s39, 1
    s_sleep 4
    buffer_load_dword v147, v155, s[20:23], s36 offen sc1
    s_waitcnt vmcnt(0)
    s_branch P_qq_chk
P_stq_slow:
    s_cmp_eq_u32 s39, 0
    s_cbranch_scc1 P_stq_done
    s_sub_u32 s39, s39, 1
    s_sleep 4
    buffer_load_dwordx2 v[158:159], v82, s[20:23], s67 offen sc1
    s_waitcnt vmcnt(0)
    s_branch P_stq_chk
P_qk_slow:
    s_cmp_eq_u32 s39, 0
    s_cbranch_scc1 P_qk_done
    s_sub_u32 s39, s39, 1
    s_sleep 4
    buffer_load_dword v147, v155, s[20:23], s36 offen sc1
    s_waitcnt vmcnt(0)
    s_branch P_qk_chk
P_stk_slow:
    s_cmp_eq_u32 s39, 0
    s_cbranch_scc1 P_stk_done
    s_sub_u32 s39, s39, 1
    s_sleep 4
    buffer_load_dwordx2 v[158:159], v30, s[20:23], s67 offen sc1
    s_waitcnt vmcnt(0)
    s_branch P_stk_chk
P_kvk_slow:
    s_cmp_eq_u32 s39, 0
    s_cbranch_scc1 P_kvk_done
    s_sub_u32 s39, s39, 1
    s_sleep 4
    buffer_load_dword v146, v158, s[20:23], s79 offen sc1
    s_waitcnt vmcnt(0)
    s_branch P_kvk_chk
P_k2_slow:
    s_cmp_eq_u32 s39, 0
    s_cbranch_scc1 P_k2_done
    s_sub_u32 s39, s39, 1
    s_sleep 4
    buffer_load_dword v147, v155, s[20:23], s33 offen sc1
    s_waitcnt vmcnt(0)
    s_branch P_k2_chk
FB_w:
    s_waitcnt vmcnt(0)
    buffer_store_dword v145, v144, s[20:23], s47 offen sc1
    v_lshrrev_b32 v58, 5, v209
    v_min_u32 v58, 18, v58
    s_mul_i32 s70, s40, 6
    v_add_u32 v56, s70, v58
    v_min_u32 v56, 21, v56
    v_add_u32 v56, 20, v56
    s_lshl_b32 s70, s40, 3
    s_add_u32 s70, s70, 36
    v_add_u32 v59, s70, v58
    v_cmp_lt_u32 vcc, 5, v58
    s_nop 1
    v_cndmask_b32 v56, v56, v59, vcc
    s_mul_i32 s70, s40, 5
    s_sub_u32 s70, s70, 14
    v_add_u32 v59, s70, v58
    v_cmp_lt_u32 vcc, 13, v58
    s_nop 1
    v_cndmask_b32 v56, v56, v59, vcc
    v_cndmask_b32 v58, 1, 0, vcc
    v_mad_u32_u24 v56, v56, 10, v58
    v_bfe_u32 v58, v209, 4, 1
    s_mul_i32 s70, s2, 257
    s_bfe_u32 s70, s70, 0x30006
    s_mul_i32 s70, s70, 5
    s_lshr_b32 s70, s70, 2
    v_add3_u32 v56, v56, v58, s70
    v_mul_u32_u24 v56, 21846, v56
    v_lshrrev_b32 v56, 16, v56
    v_lshlrev_b32 v56, 4, v56
FB_w_l:
    buffer_load_dword v57, v56, s[20:23], s37 offen sc1
    s_waitcnt vmcnt(0)
    v_cmp_ne_u32 vcc, v57, v145
    s_nop 4
    s_cbranch_vccz FB_w_go
    s_cmp_eq_u32 s39, 0
    s_cbranch_scc1 FB_w_go
    s_sub_u32 s39, s39, 1
    s_sleep 4
    s_branch FB_w_l
FB_w_go:
    s_mov_b32 s70, s55
    s_mul_i32 s0, s70, 378880
    s_add_u32 s0, s0, 14942208
    s_mul_i32 s75, s58, 6
    s_add_u32 s75, s75, s0
    s_add_u32 s75, s75, 102400
    s_lshl_b32 s101, s58, 3
    s_add_u32 s101, s101, s0
    s_add_u32 s101, s101, 215040
    s_mul_i32 s70, s58, 5
    s_add_u32 s0, s0, s70
    s_add_u32 s100, s75, 0
    buffer_load_dwordx4 a[160:163], v209, s[20:23], s100 offen offset:0 sc1
    buffer_load_dwordx4 a[164:167], v209, s[20:23], s100 offen offset:1024 sc1
    buffer_load_dwordx4 a[168:171], v209, s[20:23], s100 offen offset:2048 sc1
    buffer_load_dwordx4 a[172:175], v209, s[20:23], s100 offen offset:3072 sc1
    buffer_load_dwordx4 a[176:179], v159, s[20:23], s100 offen offset:0 sc1
    s_add_u32 s100, s75, 5120
    buffer_load_dwordx4 a[180:183], v209, s[20:23], s100 offen offset:0 sc1
    buffer_load_dwordx4 a[184:187], v209, s[20:23], s100 offen offset:1024 sc1
    buffer_load_dwordx4 a[188:191], v209, s[20:23], s100 offen offset:2048 sc1
    buffer_load_dwordx4 a[192:195], v209, s[20:23], s100 offen offset:3072 sc1
    buffer_load_dwordx4 a[196:199], v159, s[20:23], s100 offen offset:0 sc1
    s_add_u32 s100, s75, 10240
    buffer_load_dwordx4 a[200:203], v209, s[20:23], s100 offen offset:0 sc1
    buffer_load_dwordx4 a[204:207], v209, s[20:23], s100 offen offset:1024 sc1
    buffer_load_dwordx4 a[208:211], v209, s[20:23], s100 offen offset:2048 sc1
    buffer_load_dwordx4 a[212:215], v209, s[20:23], s100 offen offset:3072 sc1
    buffer_load_dwordx4 a[216:219], v159, s[20:23], s100 offen offset:0 sc1
    s_add_u32 s100, s75, 15360
    buffer_load_dwordx4 a[0:3], v209, s[20:23], s100 offen offset:0 sc1
    buffer_load_dwordx4 a[4:7], v209, s[20:23], s100 offen offset:1024 sc1
    buffer_load_dwordx4 a[8:11], v209, s[20:23], s100 offen offset:2048 sc1
    buffer_load_dwordx4 a[12:15], v209, s[20:23], s100 offen offset:3072 sc1
    buffer_load_dwordx4 a[16:19], v159, s[20:23], s100 offen offset:0 sc1
    s_add_u32 s100, s75, 20480
    s_cmp_lt_u32 s40, 3
    s_cselect_b32 s100, s100, 1073741824
    buffer_load_dwordx4 a[20:23], v209, s[20:23], s100 offen offset:0 sc1
    buffer_load_dwordx4 a[24:27], v209, s[20:23], s100 offen offset:1024 sc1
    buffer_load_dwordx4 a[28:31], v209, s[20:23], s100 offen offset:2048 sc1
    buffer_load_dwordx4 a[32:35], v209, s[20:23], s100 offen offset:3072 sc1
    buffer_load_dwordx4 a[36:39], v159, s[20:23], s100 offen offset:0 sc1
    s_add_u32 s100, s75, 25600
    s_cmp_lt_u32 s40, 3
    s_cselect_b32 s100, s100, 1073741824
    buffer_load_dwordx4 a[40:43], v209, s[20:23], s100 offen offset:0 sc1
    buffer_load_dwordx4 a[44:47], v209, s[20:23], s100 offen offset:1024 sc1
    buffer_load_dwordx4 a[48:51], v209, s[20:23], s100 offen offset:2048 sc1
    buffer_load_dwordx4 a[52:55], v209, s[20:23], s100 offen offset:3072 sc1
    buffer_load_dwordx4 a[56:59], v159, s[20:23], s100 offen offset:0 sc1
    s_add_u32 s100, s101, 0
    buffer_load_dwordx4 a[60:63], v209, s[20:23], s100 offen offset:0 sc1
    buffer_load_dwordx4 a[64:67], v209, s[20:23], s100 offen offset:1024 sc1
    buffer_load_dwordx4 a[68:71], v209, s[20:23], s100 offen offset:2048 sc1
    buffer_load_dwordx4 a[72:75], v209, s[20:23], s100 offen offset:3072 sc1
    buffer_load_dwordx4 a[76:79], v159, s[20:23], s100 offen offset:0 sc1
    s_add_u32 s100, s101, 5120
    buffer_load_dwordx4 a[80:83], v209, s[20:23], s100 offen offset:0 sc1
    buffer_load_dwordx4 a[84:87], v209, s[20:23], s100 offen offset:1024 sc1
    buffer_load_dwordx4 a[88:91], v209, s[20:23], s100 offen offset:2048 sc1
    buffer_load_dwordx4 a[92:95], v209, s[20:23], s100 offen offset:3072 sc1
    buffer_load_dwordx4 a[96:99], v159, s[20:23], s100 offen offset:0 sc1
    s_add_u32 s100, s101, 10240
    buffer_load_dwordx4 a[100:103], v209, s[20:23], s100 offen offset:0 sc1
    buffer_load_dwordx4 a[104:107], v209, s[20:23], s100 offen offset:1024 sc1
    buffer_load_dwordx4 a[108:111], v209, s[20:23], s100 offen offset:2048 sc1
    buffer_load_dwordx4 a[112:115], v209, s[20:23], s100 offen offset:3072 sc1
    buffer_load_dwordx4 a[116:119], v159, s[20:23], s100 offen offset:0 sc1
    s_add_u32 s100, s101, 15360
    buffer_load_dwordx4 a[120:123], v209, s[20:23], s100 offen offset:0 sc1
    buffer_load_dwordx4 a[124:127], v209, s[20:23], s100 offen offset:1024 sc1
    buffer_load_dwordx4 a[128:131], v209, s[20:23], s100 offen offset:2048 sc1
    buffer_load_dwordx4 a[132:135], v209, s[20:23], s100 offen offset:3072 sc1
    buffer_load_dwordx4 a[136:139], v159, s[20:23], s100 offen offset:0 sc1
    s_add_u32 s100, s101, 20480
    buffer_load_dwordx4 a[140:143], v209, s[20:23], s100 offen offset:0 sc1
    buffer_load_dwordx4 a[144:147], v209, s[20:23], s100 offen offset:1024 sc1
    buffer_load_dwordx4 a[148:151], v209, s[20:23], s100 offen offset:2048 sc1
    buffer_load_dwordx4 a[152:155], v209, s[20:23], s100 offen offset:3072 sc1
    buffer_load_dwordx4 a[156:159], v159, s[20:23], s100 offen offset:0 sc1
    s_add_u32 s100, s101, 25600
    buffer_load_dwordx4 a[220:223], v209, s[20:23], s100 offen offset:0 sc1
    buffer_load_dwordx4 a[224:227], v209, s[20:23], s100 offen offset:1024 sc1
    buffer_load_dwordx4 a[228:231], v209, s[20:23], s100 offen offset:2048 sc1
    buffer_load_dwordx4 a[232:235], v209, s[20:23], s100 offen offset:3072 sc1
    buffer_load_dwordx4 a[236:239], v159, s[20:23], s100 offen offset:0 sc1
    s_add_u32 s45, s101, 30720
    s_add_u32 m0, s58, 102400
    s_nop 0
    buffer_load_dwordx4 v209, s[20:23], s45 offen offset:0 sc1 lds
    buffer_load_dwordx4 v209, s[20:23], s45 offen offset:1024 sc1 lds
    buffer_load_dwordx4 v209, s[20:23], s45 offen offset:2048 sc1 lds
    buffer_load_dwordx4 v209, s[20:23], s45 offen offset:3072 sc1 lds
    s_add_u32 m0, s58, 106496
    s_nop 0
    buffer_load_dwordx4 v159, s[20:23], s45 offen offset:0 sc1 lds
    s_add_u32 s45, s101, 35840
    s_add_u32 m0, s58, 122880
    s_nop 0
    buffer_load_dwordx4 v209, s[20:23], s45 offen offset:0 sc1 lds
    buffer_load_dwordx4 v209, s[20:23], s45 offen offset:1024 sc1 lds
    buffer_load_dwordx4 v209, s[20:23], s45 offen offset:2048 sc1 lds
    buffer_load_dwordx4 v209, s[20:23], s45 offen offset:3072 sc1 lds
    s_add_u32 m0, s58, 126976
    s_nop 0
    buffer_load_dwordx4 v159, s[20:23], s45 offen offset:0 sc1 lds
    s_add_u32 s45, s0, 0
    s_add_u32 m0, s58, 81920
    s_nop 0
    buffer_load_dwordx4 v209, s[20:23], s45 offen offset:0 sc1 lds
    buffer_load_dwordx4 v209, s[20:23], s45 offen offset:1024 sc1 lds
    buffer_load_dwordx4 v209, s[20:23], s45 offen offset:2048 sc1 lds
    buffer_load_dwordx4 v209, s[20:23], s45 offen offset:3072 sc1 lds
    s_add_u32 m0, s58, 86016
    s_nop 0
    buffer_load_dwordx4 v159, s[20:23], s45 offen offset:0 sc1 lds
    s_add_u32 s45, s0, 5120
    s_add_u32 m0, s58, 61440
    s_nop 0
    buffer_load_dwordx4 v209, s[20:23], s45 offen offset:0 sc1 lds
    buffer_load_dwordx4 v209, s[20:23], s45 offen offset:1024 sc1 lds
    buffer_load_dwordx4 v209, s[20:23], s45 offen offset:2048 sc1 lds
    buffer_load_dwordx4 v209, s[20:23], s45 offen offset:3072 sc1 lds
    s_add_u32 m0, s58, 65536
    s_nop 0
    buffer_load_dwordx4 v159, s[20:23], s45 offen offset:0 sc1 lds
    s_add_u32 s45, s0, 10240
    s_add_u32 m0, s58, 40960
    s_nop 0
    buffer_load_dwordx4 v209, s[20:23], s45 offen offset:0 sc1 lds
    buffer_load_dwordx4 v209, s[20:23], s45 offen offset:1024 sc1 lds
    buffer_load_dwordx4 v209, s[20:23], s45 offen offset:2048 sc1 lds
    buffer_load_dwordx4 v209, s[20:23], s45 offen offset:3072 sc1 lds
    s_add_u32 m0, s58, 45056
    s_nop 0
    buffer_load_dwordx4 v159, s[20:23], s45 offen offset:0 sc1 lds
    s_waitcnt vmcnt(0)
    s_branch FB_w_done
FB_he:
    s_waitcnt vmcnt(0)
    buffer_store_dword v145, v144, s[20:23], s47 offen sc1
FB_he_l:
    buffer_load_dword v146, v158, s[20:23], s51 offen sc1
    s_waitcnt vmcnt(0)
    v_cmp_ne_u32 vcc, v146, v145
    s_nop 4
    s_cbranch_vccz FB_he_go
    s_cmp_eq_u32 s39, 0
    s_cbranch_scc1 FB_he_go
    s_sub_u32 s39, s39, 1
    s_sleep 4
    s_branch FB_he_l
FB_he_go:
    s_mul_i32 s53, s54, 221184
    s_add_u32 s53, s53, 2621440
    s_mul_i32 s70, s40, 12288
    s_add_u32 s53, s53, s70
    s_add_u32 s59, s53, 0
    buffer_load_dwordx4 v[160:163], v148, s[20:23], s59 offen sc1
    buffer_load_dwordx4 v[164:167], v149, s[20:23], s59 offen sc1
    buffer_load_dwordx4 v[168:171], v150, s[20:23], s59 offen sc1
    buffer_load_dwordx4 v[172:175], v151, s[20:23], s59 offen sc1
    s_add_u32 s59, s53, 2048
    buffer_load_dwordx4 v[176:179], v148, s[20:23], s59 offen sc1
    buffer_load_dwordx4 v[180:183], v149, s[20:23], s59 offen sc1
    buffer_load_dwordx4 v[184:187], v150, s[20:23], s59 offen sc1
    buffer_load_dwordx4 v[188:191], v151, s[20:23], s59 offen sc1
    s_add_u32 s59, s53, 4096
    buffer_load_dwordx4 v[192:195], v148, s[20:23], s59 offen sc1
    buffer_load_dwordx4 v[196:199], v149, s[20:23], s59 offen sc1
    buffer_load_dwordx4 v[200:203], v150, s[20:23], s59 offen sc1
    buffer_load_dwordx4 v[204:207], v151, s[20:23], s59 offen sc1
    s_waitcnt vmcnt(0)
    s_branch FB_he_done
P_hl_slow:
    s_cmp_eq_u32 s39, 0
    s_cbranch_scc1 P_hl_done
    s_sub_u32 s39, s39, 1
    s_sleep 4
    buffer_load_dword v146, v156, s[20:23], s48 offen sc1
    s_waitcnt vmcnt(0)
    s_branch P_hl_chk
P_o_slow:
    s_cmp_eq_u32 s39, 0
    s_cbranch_scc1 P_o_done
    s_sub_u32 s39, s39, 1
    s_sleep 4
    buffer_load_dword v147, v157, s[20:23], s49 offen sc1
    s_waitcnt vmcnt(0)
    s_branch P_o_chk
.p2align 6
.type KC_tab,@object
KC_tab:
  .long 160768, 160928, 160800, 160960
  .long 158720, 158720, 158720, 158720
  .long 160776, 160936, 158720, 158720
  .long 158720, 158720, 158720, 158720
  .long 160808, 160968, 160840, 161000
  .long 158720, 158720, 158720, 158720
  .long 160816, 160976, 158720, 158720
  .long 158720, 158720, 158720, 158720
  .long 160848, 161008, 160880, 161040
  .long 158720, 158720, 158720, 158720
  .long 160856, 161016, 158720, 158720
  .long 158720, 158720, 158720, 158720
  .long 160888, 161048, 160920, 161080
  .long 158720, 158720, 158720, 158720
  .long 160896, 161056, 158720, 158720
  .long 158720, 158720, 158720, 158720
  .long 160784, 160944, 158720, 158720
  .long 158720, 158720, 158720, 158720
  .long 160792, 160952, 158720, 158720
  .long 158720, 158720, 158720, 158720
  .long 160824, 160984, 158720, 158720
  .long 158720, 158720, 158720, 158720
  .long 160832, 160992, 158720, 158720
  .long 158720, 158720, 158720, 158720
  .long 160864, 161024, 158720, 158720
  .long 158720, 158720, 158720, 158720
  .long 160872, 161032, 158720, 158720
  .long 158720, 158720, 158720, 158720
  .long 160904, 161064, 158720, 158720
  .long 158720, 158720, 158720, 158720
  .long 160912, 161072, 158720, 158720
  .long 158720, 158720, 158720, 158720
  .long 161088, 161248, 161120, 161280
  .long 158720, 158720, 158720, 158720
  .long 161096, 161256, 158720, 158720
  .long 158720, 158720, 158720, 158720
  .long 161128, 161288, 161160, 161320
  .long 158720, 158720, 158720, 158720
  .long 161136, 161296, 158720, 158720
  .long 158720, 158720, 158720, 158720
  .long 161168, 161328, 161200, 161360
  .long 158720, 158720, 158720, 158720
  .long 161176, 161336, 158720, 158720
  .long 158720, 158720, 158720, 158720
  .long 161208, 161368, 161240, 161400
  .long 158720, 158720, 158720, 158720
  .long 161216, 161376, 158720, 158720
  .long 158720, 158720, 158720, 158720
  .long 161104, 161264, 158720, 158720
  .long 158720, 158720, 158720, 158720
  .long 161112, 161272, 158720, 158720
  .long 158720, 158720, 158720, 158720
  .long 161144, 161304, 158720, 158720
  .long 158720, 158720, 158720, 158720
  .long 161152, 161312, 158720, 158720
  .long 158720, 158720, 158720, 158720
  .long 161184, 161344, 158720, 158720
  .long 158720, 158720, 158720, 158720
  .long 161192, 161352, 158720, 158720
  .long 158720, 158720, 158720, 158720
  .long 161224, 161384, 158720, 158720
  .long 158720, 158720, 158720, 158720
  .long 161232, 161392, 158720, 158720
  .long 158720, 158720, 158720, 158720
  .long 161408, 158720, 161440, 158720
  .long 158720, 161568, 158720, 161600
  .long 161416, 158720, 158720, 158720
  .long 158720, 161576, 158720, 158720
  .long 161448, 158720, 161480, 158720
  .long 158720, 161608, 158720, 161640
  .long 161456, 158720, 158720, 158720
  .long 158720, 161616, 158720, 158720
  .long 161488, 158720, 161520, 158720
  .long 158720, 161648, 158720, 161680
  .long 161496, 158720, 158720, 158720
  .long 158720, 161656, 158720, 158720
  .long 161528, 158720, 161560, 158720
  .long 158720, 161688, 158720, 161720
  .long 161536, 158720, 158720, 158720
  .long 158720, 161696, 158720, 158720
  .long 161424, 158720, 158720, 158720
  .long 158720, 161584, 158720, 158720
  .long 161432, 158720, 158720, 158720
  .long 158720, 161592, 158720, 158720
  .long 161464, 158720, 158720, 158720
  .long 158720, 161624, 158720, 158720
  .long 161472, 158720, 158720, 158720
  .long 158720, 161632, 158720, 158720
  .long 161504, 158720, 158720, 158720
  .long 158720, 161664, 158720, 158720
  .long 161512, 158720, 158720, 158720
  .long 158720, 161672, 158720, 158720
  .long 161544, 158720, 158720, 158720
  .long 158720, 161704, 158720, 158720
  .long 161552, 158720, 158720, 158720
  .long 158720, 161712, 158720, 158720
  .long 158720, 158720, 158720, 158720
  .long 161728, 161888, 161760, 161920
  .long 158720, 158720, 158720, 158720
  .long 161736, 161896, 158720, 158720
  .long 158720, 158720, 158720, 158720
  .long 161768, 161928, 161800, 161960
  .long 158720, 158720, 158720, 158720
  .long 161776, 161936, 158720, 158720
  .long 158720, 158720, 158720, 158720
  .long 161808, 161968, 161840, 162000
  .long 158720, 158720, 158720, 158720
  .long 161816, 161976, 158720, 158720
  .long 158720, 158720, 158720, 158720
  .long 161848, 162008, 161880, 162040
  .long 158720, 158720, 158720, 158720
  .long 161856, 162016, 158720, 158720
  .long 158720, 158720, 158720, 158720
  .long 161744, 161904, 158720, 158720
  .long 158720, 158720, 158720, 158720
  .long 161752, 161912, 158720, 158720
  .long 158720, 158720, 158720, 158720
  .long 161784, 161944, 158720, 158720
  .long 158720, 158720, 158720, 158720
  .long 161792, 161952, 158720, 158720
  .long 158720, 158720, 158720, 158720
  .long 161824, 161984, 158720, 158720
  .long 158720, 158720, 158720, 158720
  .long 161832, 161992, 158720, 158720
  .long 158720, 158720, 158720, 158720
  .long 161864, 162024, 158720, 158720
  .long 158720, 158720, 158720, 158720
  .long 161872, 162032, 158720, 158720
  .long 158720, 158720, 158720, 158720
  .long 162048, 162208, 162080, 162240
  .long 158720, 158720, 158720, 158720
  .long 162056, 162216, 158720, 158720
  .long 158720, 158720, 158720, 158720
  .long 162088, 162248, 162120, 162280
  .long 158720, 158720, 158720, 158720
  .long 162096, 162256, 158720, 158720
  .long 158720, 158720, 158720, 158720
  .long 162128, 162288, 162160, 162320
  .long 158720, 158720, 158720, 158720
  .long 162136, 162296, 158720, 158720
  .long 158720, 158720, 158720, 158720
  .long 162168, 162328, 162200, 162360
  .long 158720, 158720, 158720, 158720
  .long 162176, 162336, 158720, 158720
  .long 158720, 158720, 158720, 158720
  .long 162064, 162224, 158720, 158720
  .long 158720, 158720, 158720, 158720
  .long 162072, 162232, 158720, 158720
  .long 158720, 158720, 158720, 158720
  .long 162104, 162264, 158720, 158720
  .long 158720, 158720, 158720, 158720
  .long 162112, 162272, 158720, 158720
  .long 158720, 158720, 158720, 158720
  .long 162144, 162304, 158720, 158720
  .long 158720, 158720, 158720, 158720
  .long 162152, 162312, 158720, 158720
  .long 158720, 158720, 158720, 158720
  .long 162184, 162344, 158720, 158720
  .long 158720, 158720, 158720, 158720
  .long 162192, 162352, 158720, 158720
  .long 158720, 158720, 158720, 158720
  .long 158720, 158720, 158720, 158720
  .long 158720, 158720, 158720, 158720
  .long 158720, 158720, 158720, 158720
  .long 158720, 158720, 158720, 158720
  .long 158720, 158720, 158720, 158720
  .long 158720, 158720, 158720, 158720
  .long 158720, 158720, 158720, 158720
  .long 158720, 158720, 158720, 158720
  .long 158720, 158720, 158720, 158720
  .long 158720, 158720, 158720, 158720
  .long 158720, 158720, 158720, 158720
  .long 158720, 158720, 158720, 158720
  .long 158720, 158720, 158720, 158720
  .long 158720, 158720, 158720, 158720
  .long 158720, 158720, 158720, 158720
  .long 158720, 158720, 158720, 158720
  .long 158720, 158720, 158720, 158720
  .long 158720, 158720, 158720, 158720
  .long 158720, 158720, 158720, 158720
  .long 158720, 158720, 158720, 158720
  .long 158720, 158720, 158720, 158720
  .long 158720, 158720, 158720, 158720
  .long 158720, 158720, 158720, 158720
  .long 158720, 158720, 158720, 158720
  .long 158720, 158720, 158720, 158720
  .long 158720, 158720, 158720, 158720
  .long 158720, 158720, 158720, 158720
  .long 158720, 158720, 158720, 158720
  .long 158720, 158720, 158720, 158720
  .long 158720, 158720, 158720, 158720
  .long 158720, 158720, 158720, 158720
  .long 151552, 151808, 0, 0
  .long 151568, 151824, 16, 16
  .long 151584, 151840, 32, 32
  .long 151600, 151856, 48, 48
  .long 158720, 158720, 64, 64
  .long 158720, 158720, 80, 80
  .long 158720, 158720, 96, 96
  .long 158720, 158720, 112, 112
  .long 151616, 151872, 128, 128
  .long 151632, 151872, 144, 144
  .long 151648, 151872, 160, 160
  .long 151664, 151872, 176, 176
  .long 158720, 158720, 192, 192
  .long 158720, 158720, 208, 208
  .long 158720, 158720, 224, 224
  .long 158720, 158720, 240, 240
  .long 151680, 151872, 256, 256
  .long 151696, 151872, 272, 272
  .long 151712, 151872, 288, 288
  .long 151728, 151872, 304, 304
  .long 158720, 158720, 320, 320
  .long 158720, 158720, 336, 336
  .long 158720, 158720, 352, 352
  .long 158720, 158720, 368, 368
  .long 151744, 151872, 384, 384
  .long 151760, 151872, 400, 400
  .long 151776, 151872, 416, 416
  .long 151792, 151872, 432, 432
  .long 158720, 158720, 448, 448
  .long 158720, 158720, 464, 464
  .long 158720, 158720, 480, 480
  .long 158720, 158720, 496, 496
  .long 158720, 158720, 1536, 8
  .long 158720, 158720, 1552, 24
  .long 158720, 158720, 1568, 40
  .long 158720, 158720, 1584, 56
  .long 153296, 153232, 1600, 72
  .long 153312, 153248, 1616, 88
  .long 153328, 153264, 1632, 104
  .long 153344, 153280, 1648, 120
  .long 158720, 158720, 1664, 136
  .long 158720, 158720, 1680, 152
  .long 158720, 158720, 1696, 168
  .long 158720, 158720, 1712, 184
  .long 153360, 153552, 1728, 200
  .long 153376, 153552, 1744, 216
  .long 153392, 153552, 1760, 232
  .long 153408, 153552, 1776, 248
  .long 158720, 158720, 1792, 264
  .long 158720, 158720, 1808, 280
  .long 158720, 158720, 1824, 296
  .long 158720, 158720, 1840, 312
  .long 153424, 153552, 1856, 328
  .long 153440, 153552, 1872, 344
  .long 153456, 153552, 1888, 360
  .long 153472, 153552, 1904, 376
  .long 158720, 158720, 1920, 392
  .long 158720, 158720, 1936, 408
  .long 158720, 158720, 1952, 424
  .long 158720, 158720, 1968, 440
  .long 153488, 153552, 1984, 456
  .long 153504, 153552, 2000, 472
  .long 153520, 153552, 2016, 488
  .long 153536, 153552, 2032, 504
  .long 0, 0, 7744, 15488
  .long 16, 16, 7760, 15504
  .long 32, 32, 7776, 16640
  .long 48, 48, 7792, 16656
  .long 64, 64, 7808, 16672
  .long 80, 80, 7824, 16688
  .long 96, 96, 8960, 16704
  .long 112, 112, 8976, 16720
  .long 128, 128, 8992, 16736
  .long 144, 144, 9008, 16752
  .long 160, 1280, 9024, 16768
  .long 176, 1296, 9040, 16784
  .long 192, 1312, 9056, 17920
  .long 208, 1328, 9072, 17936
  .long 224, 1344, 9088, 17952
  .long 240, 1360, 9104, 17968
  .long 512, 1376, 10240, 17984
  .long 528, 1392, 10256, 18000
  .long 544, 1408, 10272, 18016
  .long 560, 1424, 10288, 18032
  .long 576, 2560, 10304, 18048
  .long 592, 2576, 10320, 18064
  .long 608, 2592, 10336, 19200
  .long 624, 2608, 10352, 19216
  .long 640, 2624, 10368, 19232
  .long 656, 2640, 10384, 19248
  .long 672, 2656, 11520, 19264
  .long 688, 2672, 11536, 19280
  .long 704, 2688, 11552, 19296
  .long 720, 2704, 11568, 19312
  .long 736, 3840, 11584, 19328
  .long 752, 3856, 11600, 19344
  .long 1024, 3872, 11616, 1073741824
  .long 1040, 3888, 11632, 1073741824
  .long 1056, 3904, 11648, 1073741824
  .long 1072, 3920, 11664, 1073741824
  .long 1088, 3936, 12800, 1073741824
  .long 1104, 3952, 12816, 1073741824
  .long 1120, 3968, 12832, 1073741824
  .long 1136, 3984, 12848, 1073741824
  .long 1152, 5120, 12864, 1073741824
  .long 1168, 5136, 12880, 1073741824
  .long 1184, 5152, 12896, 1073741824
  .long 1200, 5168, 12912, 1073741824
  .long 1216, 5184, 12928, 1073741824
  .long 1232, 5200, 12944, 1073741824
  .long 1248, 5216, 14080, 1073741824
  .long 1264, 5232, 14096, 1073741824
  .long 1536, 5248, 14112, 1073741824
  .long 1552, 5264, 14128, 1073741824
  .long 1568, 6400, 14144, 1073741824
  .long 1584, 6416, 14160, 1073741824
  .long 1600, 6432, 14176, 1073741824
  .long 1616, 6448, 14192, 1073741824
  .long 1632, 6464, 14208, 1073741824
  .long 1648, 6480, 14224, 1073741824
  .long 1664, 6496, 15360, 1073741824
  .long 1680, 6512, 15376, 1073741824
  .long 1696, 6528, 15392, 1073741824
  .long 1712, 6544, 15408, 1073741824
  .long 1728, 7680, 15424, 1073741824
  .long 1744, 7696, 15440, 1073741824
  .long 1760, 7712, 15456, 1073741824
  .long 1776, 7728, 15472, 1073741824
  .long 102400, 103520, 104640, 102400
  .long 102416, 103536, 104656, 102576
  .long 102432, 103552, 104688, 102752
  .long 102448, 103568, 104704, 102928
  .long 102464, 103584, 104720, 103104
  .long 102480, 103600, 104736, 103280
  .long 102496, 103632, 104752, 103456
  .long 102512, 103648, 104768, 103632
  .long 102528, 103664, 104784, 103808
  .long 102544, 103680, 104800, 103984
  .long 102576, 103696, 104816, 104160
  .long 102592, 103712, 104832, 104336
  .long 102608, 103728, 104864, 104512
  .long 102624, 103744, 104880, 104688
  .long 102640, 103760, 104896, 104864
  .long 102656, 103776, 104912, 105040
  .long 102672, 103808, 104928, 102408
  .long 102688, 103824, 104944, 102584
  .long 102704, 103840, 104960, 102760
  .long 102720, 103856, 104976, 102936
  .long 102752, 103872, 104992, 103112
  .long 102768, 103888, 105008, 103288
  .long 102784, 103904, 105040, 103464
  .long 102800, 103920, 105056, 103640
  .long 102816, 103936, 105072, 103816
  .long 102832, 103952, 105088, 103992
  .long 102848, 103984, 105104, 104168
  .long 102864, 104000, 105120, 104344
  .long 102880, 104016, 105136, 104520
  .long 102896, 104032, 105152, 104696
  .long 102928, 104048, 105168, 104872
  .long 102944, 104064, 105184, 105048
  .long 102960, 104080, 105216, 102416
  .long 102976, 104096, 105232, 102592
  .long 102992, 104112, 105248, 102768
  .long 103008, 104128, 105264, 102944
  .long 103024, 104160, 105280, 103120
  .long 103040, 104176, 105296, 103296
  .long 103056, 104192, 105312, 103472
  .long 103072, 104208, 105328, 103648
  .long 103104, 104224, 105344, 103824
  .long 103120, 104240, 105360, 104000
  .long 103136, 104256, 105392, 104176
  .long 103152, 104272, 105408, 104352
  .long 103168, 104288, 105424, 104528
  .long 103184, 104304, 105440, 104704
  .long 103200, 104336, 105456, 104880
  .long 103216, 104352, 105472, 105056
  .long 103232, 104368, 105488, 102424
  .long 103248, 104384, 105504, 102600
  .long 103280, 104400, 105520, 102776
  .long 103296, 104416, 105536, 102952
  .long 103312, 104432, 105568, 103128
  .long 103328, 104448, 105584, 103304
  .long 103344, 104464, 105600, 103480
  .long 103360, 104480, 105616, 103656
  .long 103376, 104512, 105632, 103832
  .long 103392, 104528, 105648, 104008
  .long 103408, 104544, 105664, 104184
  .long 103424, 104560, 105680, 104360
  .long 103456, 104576, 105696, 104536
  .long 103472, 104592, 105712, 104712
  .long 103488, 104608, 105744, 104888
  .long 103504, 104624, 105760, 105064
CODE_END:
.section .rodata,"a"
.p2align 6
.amdhsa_kernel recurrent_scan__linear_kernel_hedgehog__glu_gated_geglu__prompt_kernel
  .amdhsa_next_free_vgpr 512
  .amdhsa_next_free_sgpr 102
  .amdhsa_accum_offset 256
  .amdhsa_group_segment_fixed_size 0
  .amdhsa_kernarg_size 88
  .amdhsa_user_sgpr_count 2
  .amdhsa_user_sgpr_kernarg_segment_ptr 1
  .amdhsa_system_sgpr_workgroup_id_x 1
  .amdhsa_float_denorm_mode_32 3
.end_amdhsa_kernel
```
